```python
import torch

def _softmax(x, axis=-1):
    return torch.softmax(x, dim=axis)

def _gelu(x):
    return torch.nn.functional.gelu(x, approximate='tanh')

def _silu(x):
    return torch.nn.functional.silu(x)

def _sigmoid(x):
    return torch.sigmoid(x)

def _layernorm(x, axis=-1, eps=1e-05):
    m = x.mean(dim=axis, keepdim=True)
    v = x.var(dim=axis, keepdim=True, unbiased=False)
    return (x - m) / torch.sqrt(v + eps)

def _scatter_add(tgt, idx, src, axis=0):
    return tgt.clone().index_add_(axis, idx, src)

def _segment_sum(src, seg, n):
    out = torch.zeros((n,) + src.shape[1:], dtype=src.dtype)
    return out.index_add_(0, seg, src)

def _pad(x, pw):
    flat = tuple((v for pair in reversed(pw) for v in pair))
    return torch.nn.functional.pad(x, flat)
kernel_name = 'sequential_preLN__memory_aug_recurrent_mem_tr__swiglu_ffn__prompt'

def setup_inputs():

    _w = lambda a: (lambda t: t.to(torch.bfloat16) if t.is_floating_point() else t)(torch.as_tensor(a))

    def _A_setup():
        B, S, Dm = (1, 2048, 1024)
        H, Dh = (32, 128)
        M, seg = (8, 32)
        seg = min(seg, S)
        S = S // seg * seg
        return {'x': _w((lambda *s: torch.randn(*s, dtype=torch.bfloat16) * 0.05)(B, S, Dm)), 'mem0': _w((lambda *s: torch.randn(*s, dtype=torch.bfloat16) * 0.2)(B, M, Dm)), 'Wq': _w((lambda *s: torch.randn(*s, dtype=torch.bfloat16) * 1.6)(Dm, H, Dh) * Dm ** (-0.5)), 'Wk': _w((lambda *s: torch.randn(*s, dtype=torch.bfloat16) * 1.6)(Dm, H, Dh) * Dm ** (-0.5)), 'Wv': _w((lambda *s: torch.randn(*s, dtype=torch.bfloat16) * 0.2)(Dm, H, Dh) * Dm ** (-0.5)), 'Wo': _w((lambda *s: torch.randn(*s, dtype=torch.bfloat16) * 0.2)(H, Dh, Dm) * (H * Dh) ** (-0.5)), 'seg_len': seg}
    _A_in = _A_setup()

    def _B_setup():
        B, S, D, F = (1, 2048, 1024, 3584)
        return {'x': _w((lambda *s: torch.randn(*s, dtype=torch.bfloat16) * 0.05)(B, S, D)), 'w_gate': _w((lambda *s: torch.randn(*s, dtype=torch.bfloat16) * 0.05)(D, F)), 'w_up': _w((lambda *s: torch.randn(*s, dtype=torch.bfloat16) * 0.05)(D, F)), 'w_down': _w((lambda *s: torch.randn(*s, dtype=torch.bfloat16) * 0.05)(F, D))}
    _B_in = _B_setup()
    return {'A_x': _A_in['x'], 'A_mem0': _A_in['mem0'], 'A_Wq': _A_in['Wq'], 'A_Wk': _A_in['Wk'], 'A_Wv': _A_in['Wv'], 'A_Wo': _A_in['Wo'], 'A_seg_len': _A_in['seg_len'], 'B_x': _B_in['x'], 'B_w_gate': _B_in['w_gate'], 'B_w_up': _B_in['w_up'], 'B_w_down': _B_in['w_down']}

def reference(A_x, A_mem0, A_Wq, A_Wk, A_Wv, A_Wo, A_seg_len, B_x, B_w_gate, B_w_up, B_w_down):

    def _A_ref(x, mem0, Wq, Wk, Wv, Wo, seg_len):
        B, S, Dm = x.shape
        H, Dh = (Wq.shape[1], Wq.shape[2])
        M = mem0.shape[1]
        scale = Dh ** (-0.5)
        n_seg = S // seg_len
        L = M + seg_len
        idx = torch.arange(L)
        mask = (idx[:, None] < M) | (idx[:, None] >= idx[None, :])
        mem = mem0
        outs = []
        for s in range(n_seg):
            xs = x[:, s * seg_len:(s + 1) * seg_len, :].clone()
            h = torch.concatenate([mem, xs], axis=1)
            q = torch.einsum('btd,dhe->bhte', h, Wq)
            k = torch.einsum('btd,dhe->bhte', h, Wk)
            v = torch.einsum('btd,dhe->bhte', h, Wv)
            scores = torch.einsum('bhqe,bhke->bhqk', q, k) * scale
            scores = torch.where(mask[None, None], scores, -1000000000.0)
            p = _softmax(scores, axis=-1)
            o = torch.einsum('bhqk,bhke->bhqe', p, v)
            o = torch.einsum('bhte,hed->btd', o, Wo)
            mem = o[:, :M, :].clone()
            outs.append(o[:, M:, :])
        return torch.concatenate(outs, axis=1)

    def _B_ref(x, w_gate, w_up, w_down):
        g = _silu(x @ w_gate)
        u = x @ w_up
        return g * u @ w_down
    x = A_x
    h = x + _A_ref(_layernorm(x, axis=-1), A_mem0, A_Wq, A_Wk, A_Wv, A_Wo, A_seg_len)
    h2 = h + _B_ref(_layernorm(h, axis=-1), B_w_gate, B_w_up, B_w_down)
    return h2
```

```asm
; @launch grid=(256,1,1) block=(256,1,1) lds=163840
.amdgcn_target "amdgcn-amd-amdhsa--gfx950"
.text
.globl sequential_preLN__memory_aug_recurrent_mem_tr__swiglu_ffn__prompt_kernel
.p2align 8
.type sequential_preLN__memory_aug_recurrent_mem_tr__swiglu_ffn__prompt_kernel,@function
sequential_preLN__memory_aug_recurrent_mem_tr__swiglu_ffn__prompt_kernel:
    s_cmp_ge_u32 s2, 256
    s_cbranch_scc1 L_end
    s_load_dwordx4 s[4:7], s[0:1], 96
    s_memtime s[94:95]
    s_getreg_b32 s20, hwreg(HW_REG_XCC_ID)
    s_and_b32 s20, s20, 15
    v_and_b32 v1, 63, v0
    v_lshrrev_b32 v3, 6, v0
    s_load_dwordx16 s[64:79], s[0:1], 0
    s_load_dwordx8 s[80:87], s[0:1], 64
    s_waitcnt lgkmcnt(0)
    v_lshlrev_b32 v2, 4, v1
    v_readfirstlane_b32 s21, v3
    s_mov_b32 s62, 200000
    s_mov_b32 s8, s6
    s_mov_b32 s9, s7
    s_mov_b32 s10, 0x10000000
    s_mov_b32 s11, 0x00020000
    s_mov_b32 s16, s4
    s_mov_b32 s17, s5
    s_mov_b32 s18, 0x100
    s_mov_b32 s19, 0x00020000
    s_mov_b32 s52, -1
    s_and_b32 s4, s2, 7
    s_cmp_lt_u32 s4, 2
    s_cbranch_scc1 L_e_tk
    s_lshr_b32 s52, s2, 3
    s_mul_i32 s52, s52, 6
    s_add_u32 s52, s52, s4
    s_sub_u32 s52, s52, 2
    s_cmp_ge_u32 s52, 128
    s_cbranch_scc1 L_e_nl
    s_mov_b32 s24, s64
    s_mov_b32 s25, s65
    s_mov_b32 s26, 0x400000
    s_mov_b32 s27, 0x00020000
    v_and_b32 v5, 15, v1
    v_lshlrev_b32 v5, 11, v5
    v_bfe_u32 v4, v1, 4, 1
    v_lshl_add_u32 v5, v4, 5, v5
    v_lshrrev_b32 v4, 5, v1
    v_lshl_add_u32 v5, v4, 4, v5
    s_lshl_b32 s4, s21, 9
    v_add_u32 v5, s4, v5
    s_lshl_b32 s6, s52, 15
    buffer_load_dwordx4 v[16:19], v5, s[24:27], s6 offen offset:0
    buffer_load_dwordx4 v[20:23], v5, s[24:27], s6 offen offset:64
    buffer_load_dwordx4 v[24:27], v5, s[24:27], s6 offen offset:128
    buffer_load_dwordx4 v[28:31], v5, s[24:27], s6 offen offset:192
    buffer_load_dwordx4 v[32:35], v5, s[24:27], s6 offen offset:256
    buffer_load_dwordx4 v[36:39], v5, s[24:27], s6 offen offset:320
    buffer_load_dwordx4 v[40:43], v5, s[24:27], s6 offen offset:384
    buffer_load_dwordx4 v[44:47], v5, s[24:27], s6 offen offset:448
    s_lshl_b32 s4, s21, 13
    s_add_u32 s4, s4, s6
    s_add_u32 s4, s4, 142606336
    s_add_u32 s5, s4, 4096
    s_waitcnt vmcnt(7)
    v_permlane16_swap_b32 v16, v18
    v_permlane16_swap_b32 v17, v19
    buffer_store_dwordx4 v[16:19], v2, s[8:11], s4 offen offset:0 sc1
    v_lshlrev_b32 v48, 16, v16
    v_and_b32 v49, 0xffff0000, v16
    v_lshlrev_b32 v50, 16, v17
    v_and_b32 v51, 0xffff0000, v17
    v_lshlrev_b32 v52, 16, v18
    v_and_b32 v53, 0xffff0000, v18
    v_lshlrev_b32 v54, 16, v19
    v_and_b32 v55, 0xffff0000, v19
    s_waitcnt vmcnt(7)
    v_permlane16_swap_b32 v20, v22
    v_permlane16_swap_b32 v21, v23
    buffer_store_dwordx4 v[20:23], v2, s[8:11], s4 offen offset:1024 sc1
    v_lshlrev_b32 v56, 16, v20
    v_and_b32 v57, 0xffff0000, v20
    v_lshlrev_b32 v58, 16, v21
    v_and_b32 v59, 0xffff0000, v21
    v_lshlrev_b32 v60, 16, v22
    v_and_b32 v61, 0xffff0000, v22
    v_lshlrev_b32 v62, 16, v23
    v_and_b32 v63, 0xffff0000, v23
    s_waitcnt vmcnt(7)
    v_permlane16_swap_b32 v24, v26
    v_permlane16_swap_b32 v25, v27
    buffer_store_dwordx4 v[24:27], v2, s[8:11], s4 offen offset:2048 sc1
    v_lshlrev_b32 v64, 16, v24
    v_and_b32 v65, 0xffff0000, v24
    v_lshlrev_b32 v66, 16, v25
    v_and_b32 v67, 0xffff0000, v25
    v_lshlrev_b32 v68, 16, v26
    v_and_b32 v69, 0xffff0000, v26
    v_lshlrev_b32 v70, 16, v27
    v_and_b32 v71, 0xffff0000, v27
    s_waitcnt vmcnt(7)
    v_permlane16_swap_b32 v28, v30
    v_permlane16_swap_b32 v29, v31
    buffer_store_dwordx4 v[28:31], v2, s[8:11], s4 offen offset:3072 sc1
    v_lshlrev_b32 v72, 16, v28
    v_and_b32 v73, 0xffff0000, v28
    v_lshlrev_b32 v74, 16, v29
    v_and_b32 v75, 0xffff0000, v29
    v_lshlrev_b32 v76, 16, v30
    v_and_b32 v77, 0xffff0000, v30
    v_lshlrev_b32 v78, 16, v31
    v_and_b32 v79, 0xffff0000, v31
    s_waitcnt vmcnt(7)
    v_permlane16_swap_b32 v32, v34
    v_permlane16_swap_b32 v33, v35
    buffer_store_dwordx4 v[32:35], v2, s[8:11], s5 offen offset:0 sc1
    v_lshlrev_b32 v80, 16, v32
    v_and_b32 v81, 0xffff0000, v32
    v_lshlrev_b32 v82, 16, v33
    v_and_b32 v83, 0xffff0000, v33
    v_lshlrev_b32 v84, 16, v34
    v_and_b32 v85, 0xffff0000, v34
    v_lshlrev_b32 v86, 16, v35
    v_and_b32 v87, 0xffff0000, v35
    s_waitcnt vmcnt(7)
    v_permlane16_swap_b32 v36, v38
    v_permlane16_swap_b32 v37, v39
    buffer_store_dwordx4 v[36:39], v2, s[8:11], s5 offen offset:1024 sc1
    v_lshlrev_b32 v88, 16, v36
    v_and_b32 v89, 0xffff0000, v36
    v_lshlrev_b32 v90, 16, v37
    v_and_b32 v91, 0xffff0000, v37
    v_lshlrev_b32 v92, 16, v38
    v_and_b32 v93, 0xffff0000, v38
    v_lshlrev_b32 v94, 16, v39
    v_and_b32 v95, 0xffff0000, v39
    s_waitcnt vmcnt(7)
    v_permlane16_swap_b32 v40, v42
    v_permlane16_swap_b32 v41, v43
    buffer_store_dwordx4 v[40:43], v2, s[8:11], s5 offen offset:2048 sc1
    v_lshlrev_b32 v96, 16, v40
    v_and_b32 v97, 0xffff0000, v40
    v_lshlrev_b32 v98, 16, v41
    v_and_b32 v99, 0xffff0000, v41
    v_lshlrev_b32 v100, 16, v42
    v_and_b32 v101, 0xffff0000, v42
    v_lshlrev_b32 v102, 16, v43
    v_and_b32 v103, 0xffff0000, v43
    s_waitcnt vmcnt(7)
    v_permlane16_swap_b32 v44, v46
    v_permlane16_swap_b32 v45, v47
    buffer_store_dwordx4 v[44:47], v2, s[8:11], s5 offen offset:3072 sc1
    v_lshlrev_b32 v104, 16, v44
    v_and_b32 v105, 0xffff0000, v44
    v_lshlrev_b32 v106, 16, v45
    v_and_b32 v107, 0xffff0000, v45
    v_lshlrev_b32 v108, 16, v46
    v_and_b32 v109, 0xffff0000, v46
    v_lshlrev_b32 v110, 16, v47
    v_and_b32 v111, 0xffff0000, v47
    s_add_u32 s6, s6, 0
    v_and_b32 v7, 15, v1
    v_lshlrev_b32 v7, 4, v7
    s_lshl_b32 s4, s21, 2
    v_add_u32 v6, s4, v7
    v_pk_add_f32 v[8:9], v[48:49], v[50:51]
    v_pk_add_f32 v[8:9], v[8:9], v[52:53]
    v_pk_add_f32 v[8:9], v[8:9], v[54:55]
    v_pk_add_f32 v[8:9], v[8:9], v[56:57]
    v_pk_add_f32 v[8:9], v[8:9], v[58:59]
    v_pk_add_f32 v[8:9], v[8:9], v[60:61]
    v_pk_add_f32 v[8:9], v[8:9], v[62:63]
    v_pk_add_f32 v[8:9], v[8:9], v[64:65]
    v_pk_add_f32 v[8:9], v[8:9], v[66:67]
    v_pk_add_f32 v[8:9], v[8:9], v[68:69]
    v_pk_add_f32 v[8:9], v[8:9], v[70:71]
    v_pk_add_f32 v[8:9], v[8:9], v[72:73]
    v_pk_add_f32 v[8:9], v[8:9], v[74:75]
    v_pk_add_f32 v[8:9], v[8:9], v[76:77]
    v_pk_add_f32 v[8:9], v[8:9], v[78:79]
    v_pk_add_f32 v[8:9], v[8:9], v[80:81]
    v_pk_add_f32 v[8:9], v[8:9], v[82:83]
    v_pk_add_f32 v[8:9], v[8:9], v[84:85]
    v_pk_add_f32 v[8:9], v[8:9], v[86:87]
    v_pk_add_f32 v[8:9], v[8:9], v[88:89]
    v_pk_add_f32 v[8:9], v[8:9], v[90:91]
    v_pk_add_f32 v[8:9], v[8:9], v[92:93]
    v_pk_add_f32 v[8:9], v[8:9], v[94:95]
    v_pk_add_f32 v[8:9], v[8:9], v[96:97]
    v_pk_add_f32 v[8:9], v[8:9], v[98:99]
    v_pk_add_f32 v[8:9], v[8:9], v[100:101]
    v_pk_add_f32 v[8:9], v[8:9], v[102:103]
    v_pk_add_f32 v[8:9], v[8:9], v[104:105]
    v_pk_add_f32 v[8:9], v[8:9], v[106:107]
    v_pk_add_f32 v[8:9], v[8:9], v[108:109]
    v_pk_add_f32 v[8:9], v[8:9], v[110:111]
    v_add_f32 v8, v8, v9
    v_mov_b32 v12, v8
    s_nop 1
    v_permlane32_swap_b32 v8, v12
    v_add_f32 v8, v8, v12
    v_mov_b32 v12, v8
    s_nop 1
    v_permlane16_swap_b32 v8, v12
    v_add_f32 v8, v8, v12
    ds_write_b32 v6, v8 offset:0
    s_waitcnt lgkmcnt(0)
    s_barrier
    ds_read_b128 v[12:15], v7 offset:0
    s_waitcnt lgkmcnt(0)
    v_add_f32 v12, v12, v13
    v_add_f32 v14, v14, v15
    v_add_f32 v8, v12, v14
    v_mul_f32 v8, 0xba800000, v8
    v_pk_add_f32 v[48:49], v[48:49], v[8:9] op_sel_hi:[1,0]
    v_pk_add_f32 v[50:51], v[50:51], v[8:9] op_sel_hi:[1,0]
    v_pk_add_f32 v[52:53], v[52:53], v[8:9] op_sel_hi:[1,0]
    v_pk_add_f32 v[54:55], v[54:55], v[8:9] op_sel_hi:[1,0]
    v_pk_add_f32 v[56:57], v[56:57], v[8:9] op_sel_hi:[1,0]
    v_pk_add_f32 v[58:59], v[58:59], v[8:9] op_sel_hi:[1,0]
    v_pk_add_f32 v[60:61], v[60:61], v[8:9] op_sel_hi:[1,0]
    v_pk_add_f32 v[62:63], v[62:63], v[8:9] op_sel_hi:[1,0]
    v_pk_add_f32 v[64:65], v[64:65], v[8:9] op_sel_hi:[1,0]
    v_pk_add_f32 v[66:67], v[66:67], v[8:9] op_sel_hi:[1,0]
    v_pk_add_f32 v[68:69], v[68:69], v[8:9] op_sel_hi:[1,0]
    v_pk_add_f32 v[70:71], v[70:71], v[8:9] op_sel_hi:[1,0]
    v_pk_add_f32 v[72:73], v[72:73], v[8:9] op_sel_hi:[1,0]
    v_pk_add_f32 v[74:75], v[74:75], v[8:9] op_sel_hi:[1,0]
    v_pk_add_f32 v[76:77], v[76:77], v[8:9] op_sel_hi:[1,0]
    v_pk_add_f32 v[78:79], v[78:79], v[8:9] op_sel_hi:[1,0]
    v_pk_add_f32 v[80:81], v[80:81], v[8:9] op_sel_hi:[1,0]
    v_pk_add_f32 v[82:83], v[82:83], v[8:9] op_sel_hi:[1,0]
    v_pk_add_f32 v[84:85], v[84:85], v[8:9] op_sel_hi:[1,0]
    v_pk_add_f32 v[86:87], v[86:87], v[8:9] op_sel_hi:[1,0]
    v_pk_add_f32 v[88:89], v[88:89], v[8:9] op_sel_hi:[1,0]
    v_pk_add_f32 v[90:91], v[90:91], v[8:9] op_sel_hi:[1,0]
    v_pk_add_f32 v[92:93], v[92:93], v[8:9] op_sel_hi:[1,0]
    v_pk_add_f32 v[94:95], v[94:95], v[8:9] op_sel_hi:[1,0]
    v_pk_add_f32 v[96:97], v[96:97], v[8:9] op_sel_hi:[1,0]
    v_pk_add_f32 v[98:99], v[98:99], v[8:9] op_sel_hi:[1,0]
    v_pk_add_f32 v[100:101], v[100:101], v[8:9] op_sel_hi:[1,0]
    v_pk_add_f32 v[102:103], v[102:103], v[8:9] op_sel_hi:[1,0]
    v_pk_add_f32 v[104:105], v[104:105], v[8:9] op_sel_hi:[1,0]
    v_pk_add_f32 v[106:107], v[106:107], v[8:9] op_sel_hi:[1,0]
    v_pk_add_f32 v[108:109], v[108:109], v[8:9] op_sel_hi:[1,0]
    v_pk_add_f32 v[110:111], v[110:111], v[8:9] op_sel_hi:[1,0]
    v_pk_mul_f32 v[8:9], v[48:49], v[48:49]
    v_pk_fma_f32 v[8:9], v[50:51], v[50:51], v[8:9]
    v_pk_fma_f32 v[8:9], v[52:53], v[52:53], v[8:9]
    v_pk_fma_f32 v[8:9], v[54:55], v[54:55], v[8:9]
    v_pk_fma_f32 v[8:9], v[56:57], v[56:57], v[8:9]
    v_pk_fma_f32 v[8:9], v[58:59], v[58:59], v[8:9]
    v_pk_fma_f32 v[8:9], v[60:61], v[60:61], v[8:9]
    v_pk_fma_f32 v[8:9], v[62:63], v[62:63], v[8:9]
    v_pk_fma_f32 v[8:9], v[64:65], v[64:65], v[8:9]
    v_pk_fma_f32 v[8:9], v[66:67], v[66:67], v[8:9]
    v_pk_fma_f32 v[8:9], v[68:69], v[68:69], v[8:9]
    v_pk_fma_f32 v[8:9], v[70:71], v[70:71], v[8:9]
    v_pk_fma_f32 v[8:9], v[72:73], v[72:73], v[8:9]
    v_pk_fma_f32 v[8:9], v[74:75], v[74:75], v[8:9]
    v_pk_fma_f32 v[8:9], v[76:77], v[76:77], v[8:9]
    v_pk_fma_f32 v[8:9], v[78:79], v[78:79], v[8:9]
    v_pk_fma_f32 v[8:9], v[80:81], v[80:81], v[8:9]
    v_pk_fma_f32 v[8:9], v[82:83], v[82:83], v[8:9]
    v_pk_fma_f32 v[8:9], v[84:85], v[84:85], v[8:9]
    v_pk_fma_f32 v[8:9], v[86:87], v[86:87], v[8:9]
    v_pk_fma_f32 v[8:9], v[88:89], v[88:89], v[8:9]
    v_pk_fma_f32 v[8:9], v[90:91], v[90:91], v[8:9]
    v_pk_fma_f32 v[8:9], v[92:93], v[92:93], v[8:9]
    v_pk_fma_f32 v[8:9], v[94:95], v[94:95], v[8:9]
    v_pk_fma_f32 v[8:9], v[96:97], v[96:97], v[8:9]
    v_pk_fma_f32 v[8:9], v[98:99], v[98:99], v[8:9]
    v_pk_fma_f32 v[8:9], v[100:101], v[100:101], v[8:9]
    v_pk_fma_f32 v[8:9], v[102:103], v[102:103], v[8:9]
    v_pk_fma_f32 v[8:9], v[104:105], v[104:105], v[8:9]
    v_pk_fma_f32 v[8:9], v[106:107], v[106:107], v[8:9]
    v_pk_fma_f32 v[8:9], v[108:109], v[108:109], v[8:9]
    v_pk_fma_f32 v[8:9], v[110:111], v[110:111], v[8:9]
    v_add_f32 v8, v8, v9
    v_mov_b32 v12, v8
    s_nop 1
    v_permlane32_swap_b32 v8, v12
    v_add_f32 v8, v8, v12
    v_mov_b32 v12, v8
    s_nop 1
    v_permlane16_swap_b32 v8, v12
    v_add_f32 v8, v8, v12
    ds_write_b32 v6, v8 offset:256
    s_waitcnt lgkmcnt(0)
    s_barrier
    ds_read_b128 v[12:15], v7 offset:256
    s_waitcnt lgkmcnt(0)
    v_add_f32 v12, v12, v13
    v_add_f32 v14, v14, v15
    v_add_f32 v8, v12, v14
    v_mov_b32 v12, 0x3727c5ac
    v_fmac_f32 v12, 0x3a800000, v8
    v_rsq_f32 v8, v12
    s_nop 0
    s_lshl_b32 s4, s21, 13
    s_add_u32 s4, s4, s6
    s_add_u32 s5, s4, 4096
    v_pk_mul_f32 v[48:49], v[48:49], v[8:9] op_sel_hi:[1,0]
    v_pk_mul_f32 v[50:51], v[50:51], v[8:9] op_sel_hi:[1,0]
    v_pk_mul_f32 v[52:53], v[52:53], v[8:9] op_sel_hi:[1,0]
    v_pk_mul_f32 v[54:55], v[54:55], v[8:9] op_sel_hi:[1,0]
    v_cvt_pk_bf16_f32 v16, v48, v49
    v_cvt_pk_bf16_f32 v17, v50, v51
    v_cvt_pk_bf16_f32 v18, v52, v53
    v_cvt_pk_bf16_f32 v19, v54, v55
    buffer_store_dwordx4 v[16:19], v2, s[8:11], s4 offen offset:0 sc1
    v_pk_mul_f32 v[56:57], v[56:57], v[8:9] op_sel_hi:[1,0]
    v_pk_mul_f32 v[58:59], v[58:59], v[8:9] op_sel_hi:[1,0]
    v_pk_mul_f32 v[60:61], v[60:61], v[8:9] op_sel_hi:[1,0]
    v_pk_mul_f32 v[62:63], v[62:63], v[8:9] op_sel_hi:[1,0]
    v_cvt_pk_bf16_f32 v20, v56, v57
    v_cvt_pk_bf16_f32 v21, v58, v59
    v_cvt_pk_bf16_f32 v22, v60, v61
    v_cvt_pk_bf16_f32 v23, v62, v63
    buffer_store_dwordx4 v[20:23], v2, s[8:11], s4 offen offset:1024 sc1
    v_pk_mul_f32 v[64:65], v[64:65], v[8:9] op_sel_hi:[1,0]
    v_pk_mul_f32 v[66:67], v[66:67], v[8:9] op_sel_hi:[1,0]
    v_pk_mul_f32 v[68:69], v[68:69], v[8:9] op_sel_hi:[1,0]
    v_pk_mul_f32 v[70:71], v[70:71], v[8:9] op_sel_hi:[1,0]
    v_cvt_pk_bf16_f32 v24, v64, v65
    v_cvt_pk_bf16_f32 v25, v66, v67
    v_cvt_pk_bf16_f32 v26, v68, v69
    v_cvt_pk_bf16_f32 v27, v70, v71
    buffer_store_dwordx4 v[24:27], v2, s[8:11], s4 offen offset:2048 sc1
    v_pk_mul_f32 v[72:73], v[72:73], v[8:9] op_sel_hi:[1,0]
    v_pk_mul_f32 v[74:75], v[74:75], v[8:9] op_sel_hi:[1,0]
    v_pk_mul_f32 v[76:77], v[76:77], v[8:9] op_sel_hi:[1,0]
    v_pk_mul_f32 v[78:79], v[78:79], v[8:9] op_sel_hi:[1,0]
    v_cvt_pk_bf16_f32 v28, v72, v73
    v_cvt_pk_bf16_f32 v29, v74, v75
    v_cvt_pk_bf16_f32 v30, v76, v77
    v_cvt_pk_bf16_f32 v31, v78, v79
    buffer_store_dwordx4 v[28:31], v2, s[8:11], s4 offen offset:3072 sc1
    v_pk_mul_f32 v[80:81], v[80:81], v[8:9] op_sel_hi:[1,0]
    v_pk_mul_f32 v[82:83], v[82:83], v[8:9] op_sel_hi:[1,0]
    v_pk_mul_f32 v[84:85], v[84:85], v[8:9] op_sel_hi:[1,0]
    v_pk_mul_f32 v[86:87], v[86:87], v[8:9] op_sel_hi:[1,0]
    v_cvt_pk_bf16_f32 v32, v80, v81
    v_cvt_pk_bf16_f32 v33, v82, v83
    v_cvt_pk_bf16_f32 v34, v84, v85
    v_cvt_pk_bf16_f32 v35, v86, v87
    buffer_store_dwordx4 v[32:35], v2, s[8:11], s5 offen offset:0 sc1
    v_pk_mul_f32 v[88:89], v[88:89], v[8:9] op_sel_hi:[1,0]
    v_pk_mul_f32 v[90:91], v[90:91], v[8:9] op_sel_hi:[1,0]
    v_pk_mul_f32 v[92:93], v[92:93], v[8:9] op_sel_hi:[1,0]
    v_pk_mul_f32 v[94:95], v[94:95], v[8:9] op_sel_hi:[1,0]
    v_cvt_pk_bf16_f32 v36, v88, v89
    v_cvt_pk_bf16_f32 v37, v90, v91
    v_cvt_pk_bf16_f32 v38, v92, v93
    v_cvt_pk_bf16_f32 v39, v94, v95
    buffer_store_dwordx4 v[36:39], v2, s[8:11], s5 offen offset:1024 sc1
    v_pk_mul_f32 v[96:97], v[96:97], v[8:9] op_sel_hi:[1,0]
    v_pk_mul_f32 v[98:99], v[98:99], v[8:9] op_sel_hi:[1,0]
    v_pk_mul_f32 v[100:101], v[100:101], v[8:9] op_sel_hi:[1,0]
    v_pk_mul_f32 v[102:103], v[102:103], v[8:9] op_sel_hi:[1,0]
    v_cvt_pk_bf16_f32 v40, v96, v97
    v_cvt_pk_bf16_f32 v41, v98, v99
    v_cvt_pk_bf16_f32 v42, v100, v101
    v_cvt_pk_bf16_f32 v43, v102, v103
    buffer_store_dwordx4 v[40:43], v2, s[8:11], s5 offen offset:2048 sc1
    v_pk_mul_f32 v[104:105], v[104:105], v[8:9] op_sel_hi:[1,0]
    v_pk_mul_f32 v[106:107], v[106:107], v[8:9] op_sel_hi:[1,0]
    v_pk_mul_f32 v[108:109], v[108:109], v[8:9] op_sel_hi:[1,0]
    v_pk_mul_f32 v[110:111], v[110:111], v[8:9] op_sel_hi:[1,0]
    v_cvt_pk_bf16_f32 v44, v104, v105
    v_cvt_pk_bf16_f32 v45, v106, v107
    v_cvt_pk_bf16_f32 v46, v108, v109
    v_cvt_pk_bf16_f32 v47, v110, v111
    buffer_store_dwordx4 v[44:47], v2, s[8:11], s5 offen offset:3072 sc1
    s_cmp_lg_u32 s21, 0
    s_cbranch_scc1 L_e_l1
    v_mov_b32 v4, 128
L_e_l0:
    buffer_load_dword v5, v4, s[16:19], 0 offen sc1
    s_sub_u32 s62, s62, 1
    s_cbranch_scc1 L_e_l1
    s_waitcnt vmcnt(0)
    v_cmp_gt_u32 vcc, 4, v5
    s_cbranch_vccnz L_e_l0
L_e_l1:
    s_waitcnt vmcnt(0)
    s_barrier
    s_cmp_lg_u32 s21, 0
    s_cbranch_scc1 L_e_bc
    s_mov_b64 exec, 1
    s_lshr_b32 s5, s52, 4
    s_lshl_b32 s5, s5, 7
    s_add_u32 s5, s5, 243269632
    v_mov_b32 v6, 0
    v_mov_b32 v5, 1
    buffer_atomic_add v5, v6, s[8:11], s5 offen sc0
    v_mov_b32 v3, 1
    s_lshl_b32 s22, s20, 2
    v_mov_b32 v4, s22
    buffer_atomic_add v3, v4, s[16:19], 0 offen sc0
    s_waitcnt vmcnt(1)
    v_cmp_eq_u32 vcc, 15, v5
    s_cbranch_vccz L_e_l2
    v_mov_b32 v5, 16
    s_add_u32 s5, s5, 18432
    buffer_store_dword v5, v6, s[8:11], s5 offen sc1
    s_waitcnt vmcnt(1)
    s_branch L_e_put
L_e_l2:
    s_waitcnt vmcnt(0)
    s_branch L_e_put
L_e_nl:
    s_cmp_ge_u32 s52, 132
    s_cbranch_scc1 L_e_tk
    s_sub_u32 s30, s52, 128
    v_lshlrev_b32 v3, 4, v0
    v_mov_b32 v4, 0
    v_mov_b32 v5, 0
    v_mov_b32 v6, 0
    v_mov_b32 v7, 0
    s_mul_i32 s30, s30, 49152
    s_add_u32 s30, s30, 243269632
    buffer_store_dwordx4 v[4:7], v3, s[8:11], s30 offen sc1
    s_add_u32 s30, s30, 4096
    buffer_store_dwordx4 v[4:7], v3, s[8:11], s30 offen sc1
    s_add_u32 s30, s30, 4096
    buffer_store_dwordx4 v[4:7], v3, s[8:11], s30 offen sc1
    s_add_u32 s30, s30, 4096
    buffer_store_dwordx4 v[4:7], v3, s[8:11], s30 offen sc1
    s_add_u32 s30, s30, 4096
    buffer_store_dwordx4 v[4:7], v3, s[8:11], s30 offen sc1
    s_add_u32 s30, s30, 4096
    buffer_store_dwordx4 v[4:7], v3, s[8:11], s30 offen sc1
    s_add_u32 s30, s30, 4096
    buffer_store_dwordx4 v[4:7], v3, s[8:11], s30 offen sc1
    s_add_u32 s30, s30, 4096
    buffer_store_dwordx4 v[4:7], v3, s[8:11], s30 offen sc1
    s_add_u32 s30, s30, 4096
    buffer_store_dwordx4 v[4:7], v3, s[8:11], s30 offen sc1
    s_add_u32 s30, s30, 4096
    buffer_store_dwordx4 v[4:7], v3, s[8:11], s30 offen sc1
    s_add_u32 s30, s30, 4096
    buffer_store_dwordx4 v[4:7], v3, s[8:11], s30 offen sc1
    s_add_u32 s30, s30, 4096
    buffer_store_dwordx4 v[4:7], v3, s[8:11], s30 offen sc1
    s_add_u32 s30, s30, 4096
    s_waitcnt vmcnt(0)
    s_barrier
    v_mov_b32 v4, 1
    v_lshlrev_b32 v5, 6, v0
    v_add_u32 v5, 64, v5
    v_cmp_gt_u32 vcc, 2, v0
    s_and_saveexec_b64 s[48:49], vcc
    s_cbranch_execz L_ini2
    buffer_atomic_add v4, v5, s[16:19], 0 offen
L_ini2:
    s_mov_b64 exec, s[48:49]
L_e_tk:
    s_sub_u32 s4, s52, 132
    s_cmp_ge_u32 s4, 32
    s_cbranch_scc1 L_e_nt
    s_lshl_b32 s4, s4, 18
    v_lshlrev_b32 v4, 10, v0
    v_or_b32 v5, 0x1f80, v4
    s_mov_b32 s12, s74
    s_mov_b32 s13, s75
    s_mov_b32 s14, 0x800000
    s_mov_b32 s15, 0x00020000
    buffer_load_dwordx2 v[124:125], v4, s[12:15], s4 offen offset:444
    buffer_load_dwordx2 v[124:125], v5, s[12:15], s4 offen offset:60
    s_mov_b32 s12, s68
    s_mov_b32 s13, s69
    s_mov_b32 s14, 0x800000
    s_mov_b32 s15, 0x00020000
    buffer_load_dwordx2 v[124:125], v4, s[12:15], s4 offen offset:444
    buffer_load_dwordx2 v[124:125], v5, s[12:15], s4 offen offset:60
    s_mov_b32 s12, s70
    s_mov_b32 s13, s71
    s_mov_b32 s14, 0x800000
    s_mov_b32 s15, 0x00020000
    buffer_load_dwordx2 v[124:125], v4, s[12:15], s4 offen offset:444
    buffer_load_dwordx2 v[124:125], v5, s[12:15], s4 offen offset:60
    s_mov_b32 s12, s72
    s_mov_b32 s13, s73
    s_mov_b32 s14, 0x800000
    s_mov_b32 s15, 0x00020000
    buffer_load_dwordx2 v[124:125], v4, s[12:15], s4 offen offset:444
    buffer_load_dwordx2 v[124:125], v5, s[12:15], s4 offen offset:60
    s_waitcnt vmcnt(0)
    s_barrier
L_e_nt:
    s_cmp_lg_u32 s21, 0
    s_cbranch_scc1 L_e_t1
    s_mov_b64 exec, 1
    v_mov_b32 v3, 1
    s_lshl_b32 s22, s20, 2
    v_mov_b32 v4, s22
    buffer_atomic_add v3, v4, s[16:19], 0 offen sc0
    s_mov_b64 exec, -1
L_e_t1:
    s_barrier
    s_cmp_ge_u32 s20, 2
    s_cbranch_scc1 L_e_w0
    s_mov_b32 s12, s74
    s_mov_b32 s13, s75
    s_mov_b32 s14, 0x800000
    s_mov_b32 s15, 0x00020000
    s_lshr_b32 s4, s2, 3
    s_and_b32 s5, s4, 1
    s_lshl_b32 s5, s5, 10
    s_lshr_b32 s4, s4, 1
    s_lshl_b32 s6, s20, 4
    s_add_u32 s4, s4, s6
    s_lshl_b32 s4, s4, 18
    s_add_u32 s4, s4, s5
    s_lshr_b32 s5, s21, 1
    s_lshl_b32 s5, s5, 17
    s_add_u32 s4, s4, s5
    s_and_b32 s5, s21, 1
    s_lshl_b32 s5, s5, 14
    s_add_u32 s4, s4, s5
    buffer_load_dwordx4 v[124:127], v2, s[12:15], s4 offen
    s_add_u32 s4, s4, 2048
    buffer_load_dwordx4 v[124:127], v2, s[12:15], s4 offen
    s_add_u32 s4, s4, 2048
    buffer_load_dwordx4 v[124:127], v2, s[12:15], s4 offen
    s_add_u32 s4, s4, 2048
    buffer_load_dwordx4 v[124:127], v2, s[12:15], s4 offen
    s_add_u32 s4, s4, 2048
    buffer_load_dwordx4 v[124:127], v2, s[12:15], s4 offen
    s_add_u32 s4, s4, 2048
    buffer_load_dwordx4 v[124:127], v2, s[12:15], s4 offen
    s_add_u32 s4, s4, 2048
    buffer_load_dwordx4 v[124:127], v2, s[12:15], s4 offen
    s_add_u32 s4, s4, 2048
    buffer_load_dwordx4 v[124:127], v2, s[12:15], s4 offen
L_e_w8:
    s_waitcnt vmcnt(8)
    s_branch L_e_w
L_e_w0:
    s_waitcnt vmcnt(0)
L_e_w:
    s_cmp_lg_u32 s21, 0
    s_cbranch_scc1 L_e_bc
    s_mov_b64 exec, 1
L_e_put:
    v_mov_b32 v5, 158720
    ds_write_b32 v5, v3
    s_waitcnt lgkmcnt(0)
    s_mov_b64 exec, -1
L_e_bc:
    s_barrier
    v_mov_b32 v5, 158720
    ds_read_b32 v3, v5
    s_waitcnt lgkmcnt(0)
    v_readfirstlane_b32 s22, v3
    s_barrier
    s_cmp_ge_u32 s22, 32
    s_cbranch_scc1 L_end
    s_cmp_ge_u32 s20, 8
    s_cbranch_scc1 L_end
    s_cmp_ge_u32 s20, 2
    s_cbranch_scc1 L_worker
    s_mov_b32 s23, s20
    s_load_dwordx8 s[48:55], s[0:1], 16
    s_lshr_b32 s24, s22, 1
    s_lshl_b32 s4, s23, 4
    s_add_u32 s24, s24, s4
    s_and_b32 s25, s22, 1
    v_lshlrev_b32 v2, 4, v1
    v_lshlrev_b32 v3, 3, v1
    v_lshrrev_b32 v44, 3, v1
    v_lshlrev_b32 v44, 13, v44
    v_and_b32 v45, 7, v1
    v_lshl_add_u32 v40, v45, 4, v44
    v_bfe_u32 v44, v1, 5, 1
    v_lshlrev_b32 v44, 4, v44
    v_bfe_u32 v45, v1, 3, 1
    v_lshl_add_u32 v44, v45, 3, v44
    v_bfe_u32 v45, v1, 2, 1
    v_add_u32 v44, v45, v44
    v_bfe_u32 v45, v1, 4, 1
    v_lshl_add_u32 v44, v45, 2, v44
    v_and_b32 v45, 3, v1
    v_lshlrev_b32 v45, 3, v45
    s_lshl_b32 s4, s21, 5
    v_add_u32 v46, s4, v45
    v_lshl_add_u32 v42, v44, 7, v46
    v_bfe_u32 v44, v1, 4, 1
    v_xor_b32 v44, s25, v44
    v_lshlrev_b32 v44, 4, v44
    v_bfe_u32 v46, v1, 5, 1
    v_lshl_add_u32 v44, v46, 2, v44
    v_bfe_u32 v46, v1, 2, 1
    v_add_u32 v44, v46, v44
    v_bfe_u32 v46, v1, 3, 1
    v_lshl_add_u32 v45, v46, 5, v45
    s_lshl_b32 s4, s21, 8
    v_add_u32 v46, s4, v45
    v_lshl_add_u32 v43, v44, 10, v46
    s_waitcnt lgkmcnt(0)
    s_mov_b32 s12, s54
    s_mov_b32 s13, s55
    s_mov_b32 s14, 0x800000
    s_mov_b32 s15, 0x00020000
    s_lshl_b32 s6, s21, 13
    s_add_u32 s6, s6, 65536
    s_lshr_b32 s4, s21, 1
    s_lshl_b32 s4, s4, 6
    s_and_b32 s5, s21, 1
    s_lshl_b32 s5, s5, 3
    s_add_u32 s4, s4, s5
    s_lshl_b32 s5, s24, 7
    s_add_u32 s4, s4, s5
    s_add_u32 s4, s4, 0
    s_lshl_b32 s4, s4, 11
    s_lshl_b32 s5, s25, 10
    s_add_u32 s4, s4, s5
    s_add_u32 m0, s6, 0
    s_nop 0
    buffer_load_dwordx4 v2, s[12:15], s4 offen lds
    s_add_u32 s4, s4, 2048
    s_add_u32 m0, s6, 1024
    s_nop 0
    buffer_load_dwordx4 v2, s[12:15], s4 offen lds
    s_add_u32 s4, s4, 2048
    s_add_u32 m0, s6, 2048
    s_nop 0
    buffer_load_dwordx4 v2, s[12:15], s4 offen lds
    s_add_u32 s4, s4, 2048
    s_add_u32 m0, s6, 3072
    s_nop 0
    buffer_load_dwordx4 v2, s[12:15], s4 offen lds
    s_add_u32 s4, s4, 2048
    s_add_u32 m0, s6, 4096
    s_nop 0
    buffer_load_dwordx4 v2, s[12:15], s4 offen lds
    s_add_u32 s4, s4, 2048
    s_add_u32 m0, s6, 5120
    s_nop 0
    buffer_load_dwordx4 v2, s[12:15], s4 offen lds
    s_add_u32 s4, s4, 2048
    s_add_u32 m0, s6, 6144
    s_nop 0
    buffer_load_dwordx4 v2, s[12:15], s4 offen lds
    s_add_u32 s4, s4, 2048
    s_add_u32 m0, s6, 7168
    s_nop 0
    buffer_load_dwordx4 v2, s[12:15], s4 offen lds
    s_mov_b32 s12, s54
    s_mov_b32 s13, s55
    s_mov_b32 s14, 0x800000
    s_mov_b32 s15, 0x00020000
    s_lshl_b32 s6, s21, 13
    s_add_u32 s6, s6, 98304
    s_lshr_b32 s4, s21, 1
    s_lshl_b32 s4, s4, 6
    s_and_b32 s5, s21, 1
    s_lshl_b32 s5, s5, 3
    s_add_u32 s4, s4, s5
    s_lshl_b32 s5, s24, 7
    s_add_u32 s4, s4, s5
    s_add_u32 s4, s4, 16
    s_lshl_b32 s4, s4, 11
    s_lshl_b32 s5, s25, 10
    s_add_u32 s4, s4, s5
    s_add_u32 m0, s6, 0
    s_nop 0
    buffer_load_dwordx4 v2, s[12:15], s4 offen lds
    s_add_u32 s4, s4, 2048
    s_add_u32 m0, s6, 1024
    s_nop 0
    buffer_load_dwordx4 v2, s[12:15], s4 offen lds
    s_add_u32 s4, s4, 2048
    s_add_u32 m0, s6, 2048
    s_nop 0
    buffer_load_dwordx4 v2, s[12:15], s4 offen lds
    s_add_u32 s4, s4, 2048
    s_add_u32 m0, s6, 3072
    s_nop 0
    buffer_load_dwordx4 v2, s[12:15], s4 offen lds
    s_add_u32 s4, s4, 2048
    s_add_u32 m0, s6, 4096
    s_nop 0
    buffer_load_dwordx4 v2, s[12:15], s4 offen lds
    s_add_u32 s4, s4, 2048
    s_add_u32 m0, s6, 5120
    s_nop 0
    buffer_load_dwordx4 v2, s[12:15], s4 offen lds
    s_add_u32 s4, s4, 2048
    s_add_u32 m0, s6, 6144
    s_nop 0
    buffer_load_dwordx4 v2, s[12:15], s4 offen lds
    s_add_u32 s4, s4, 2048
    s_add_u32 m0, s6, 7168
    s_nop 0
    buffer_load_dwordx4 v2, s[12:15], s4 offen lds
    s_mov_b32 s12, s54
    s_mov_b32 s13, s55
    s_mov_b32 s14, 0x800000
    s_mov_b32 s15, 0x00020000
    s_lshl_b32 s6, s21, 13
    s_add_u32 s6, s6, 131072
    s_lshr_b32 s4, s21, 1
    s_lshl_b32 s4, s4, 6
    s_and_b32 s5, s21, 1
    s_lshl_b32 s5, s5, 3
    s_add_u32 s4, s4, s5
    s_lshl_b32 s5, s24, 7
    s_add_u32 s4, s4, s5
    s_add_u32 s4, s4, 32
    s_lshl_b32 s4, s4, 11
    s_lshl_b32 s5, s25, 10
    s_add_u32 s4, s4, s5
    s_add_u32 m0, s6, 0
    s_nop 0
    buffer_load_dwordx4 v2, s[12:15], s4 offen lds
    s_add_u32 s4, s4, 2048
    s_add_u32 m0, s6, 1024
    s_nop 0
    buffer_load_dwordx4 v2, s[12:15], s4 offen lds
    s_add_u32 s4, s4, 2048
    s_add_u32 m0, s6, 2048
    s_nop 0
    buffer_load_dwordx4 v2, s[12:15], s4 offen lds
    s_add_u32 s4, s4, 2048
    s_add_u32 m0, s6, 3072
    s_nop 0
    buffer_load_dwordx4 v2, s[12:15], s4 offen lds
    s_add_u32 s4, s4, 2048
    s_add_u32 m0, s6, 4096
    s_nop 0
    buffer_load_dwordx4 v2, s[12:15], s4 offen lds
    s_add_u32 s4, s4, 2048
    s_add_u32 m0, s6, 5120
    s_nop 0
    buffer_load_dwordx4 v2, s[12:15], s4 offen lds
    s_add_u32 s4, s4, 2048
    s_add_u32 m0, s6, 6144
    s_nop 0
    buffer_load_dwordx4 v2, s[12:15], s4 offen lds
    s_add_u32 s4, s4, 2048
    s_add_u32 m0, s6, 7168
    s_nop 0
    buffer_load_dwordx4 v2, s[12:15], s4 offen lds
    s_mov_b32 s12, s54
    s_mov_b32 s13, s55
    s_mov_b32 s14, 0x800000
    s_mov_b32 s15, 0x00020000
    s_lshl_b32 s6, s21, 13
    s_add_u32 s6, s6, 0
    s_lshr_b32 s4, s21, 1
    s_lshl_b32 s4, s4, 6
    s_and_b32 s5, s21, 1
    s_lshl_b32 s5, s5, 3
    s_add_u32 s4, s4, s5
    s_lshl_b32 s5, s24, 7
    s_add_u32 s4, s4, s5
    s_add_u32 s4, s4, 48
    s_lshl_b32 s4, s4, 11
    s_lshl_b32 s5, s25, 10
    s_add_u32 s4, s4, s5
    s_add_u32 m0, s6, 0
    s_nop 0
    buffer_load_dwordx4 v2, s[12:15], s4 offen lds
    s_add_u32 s4, s4, 2048
    s_add_u32 m0, s6, 1024
    s_nop 0
    buffer_load_dwordx4 v2, s[12:15], s4 offen lds
    s_add_u32 s4, s4, 2048
    s_add_u32 m0, s6, 2048
    s_nop 0
    buffer_load_dwordx4 v2, s[12:15], s4 offen lds
    s_add_u32 s4, s4, 2048
    s_add_u32 m0, s6, 3072
    s_nop 0
    buffer_load_dwordx4 v2, s[12:15], s4 offen lds
    s_add_u32 s4, s4, 2048
    s_add_u32 m0, s6, 4096
    s_nop 0
    buffer_load_dwordx4 v2, s[12:15], s4 offen lds
    s_add_u32 s4, s4, 2048
    s_add_u32 m0, s6, 5120
    s_nop 0
    buffer_load_dwordx4 v2, s[12:15], s4 offen lds
    s_add_u32 s4, s4, 2048
    s_add_u32 m0, s6, 6144
    s_nop 0
    buffer_load_dwordx4 v2, s[12:15], s4 offen lds
    s_add_u32 s4, s4, 2048
    s_add_u32 m0, s6, 7168
    s_nop 0
    buffer_load_dwordx4 v2, s[12:15], s4 offen lds
    s_mov_b32 s12, s48
    s_mov_b32 s13, s49
    s_mov_b32 s14, 0x800000
    s_mov_b32 s15, 0x00020000
    s_lshl_b32 s6, s21, 13
    s_add_u32 s6, s6, 32768
    s_lshl_b32 s4, s21, 6
    s_add_u32 s4, s4, 0
    s_lshl_b32 s4, s4, 13
    s_lshl_b32 s5, s24, 8
    s_add_u32 s4, s4, s5
    s_lshl_b32 s5, s25, 7
    s_add_u32 s4, s4, s5
    s_add_u32 m0, s6, 0
    s_nop 0
    buffer_load_dwordx4 v40, s[12:15], s4 offen lds
    s_add_u32 s4, s4, 65536
    s_add_u32 m0, s6, 1024
    s_nop 0
    buffer_load_dwordx4 v40, s[12:15], s4 offen lds
    s_add_u32 s4, s4, 65536
    s_add_u32 m0, s6, 2048
    s_nop 0
    buffer_load_dwordx4 v40, s[12:15], s4 offen lds
    s_add_u32 s4, s4, 65536
    s_add_u32 m0, s6, 3072
    s_nop 0
    buffer_load_dwordx4 v40, s[12:15], s4 offen lds
    s_add_u32 s4, s4, 65536
    s_add_u32 m0, s6, 4096
    s_nop 0
    buffer_load_dwordx4 v40, s[12:15], s4 offen lds
    s_add_u32 s4, s4, 65536
    s_add_u32 m0, s6, 5120
    s_nop 0
    buffer_load_dwordx4 v40, s[12:15], s4 offen lds
    s_add_u32 s4, s4, 65536
    s_add_u32 m0, s6, 6144
    s_nop 0
    buffer_load_dwordx4 v40, s[12:15], s4 offen lds
    s_add_u32 s4, s4, 65536
    s_add_u32 m0, s6, 7168
    s_nop 0
    buffer_load_dwordx4 v40, s[12:15], s4 offen lds
    s_mov_b32 s28, 0x7f817f81
    s_mov_b32 s29, 0x7f817f81
    s_mov_b32 s30, 0x3e0293ee
    v_and_b32 v52, 15, v1
    v_lshrrev_b32 v53, 4, v1
    v_and_b32 v54, 7, v1
    v_cmp_gt_u32 vcc, 8, v52
    v_mov_b32 v55, 0xeeee
    v_mov_b32 v56, 0x4444
    v_cndmask_b32 v4, v55, v56, vcc
    v_lshl_add_u32 v57, v53, 3, v54
    v_lshlrev_b32 v57, 4, v57
    v_add_u32 v0, 53248, v57
    s_lshl_b32 s4, s21, 9
    v_add_u32 v9, s4, v3
    v_lshrrev_b32 v9, 1, v9
    s_lshl_b32 s5, s21, 8
    s_cmp_lt_u32 s21, 2
    s_cselect_b32 s5, s5, 0x80000000
    s_lshl_b32 s4, s22, 9
    s_add_u32 s4, s4, s5
    v_mov_b32 v59, 0x80000000
    v_lshrrev_b32 v58, 5, v1
    v_lshl_add_u32 v58, v58, 3, v54
    v_lshlrev_b32 v58, 4, v58
    v_bfe_u32 v60, v1, 4, 1
    v_lshl_add_u32 v58, v60, 3, v58
    v_add_u32 v58, s4, v58
    v_bfe_u32 v60, v1, 3, 1
    v_lshl_add_u32 v6, v60, 2, v58
    s_lshl_b32 s4, s21, 9
    s_add_u32 s4, s4, 53248
    v_and_b32 v58, 5, v1
    v_bfe_u32 v59, v1, 3, 1
    v_lshl_add_u32 v58, v59, 1, v58
    v_lshl_add_u32 v58, v53, 3, v58
    v_lshl_add_u32 v58, v58, 4, s4
    v_add_u32 v59, 55296, v2
    v_and_b32 v60, 2, v1
    v_cmp_ne_u32 vcc, 0, v60
    s_nop 1
    v_cndmask_b32 v12, v59, v58, vcc
    v_lshrrev_b32 v55, 1, v53
    v_lshl_add_u32 v55, v55, 4, v52
    v_lshlrev_b32 v55, 4, v55
    v_and_b32 v56, 1, v53
    v_lshl_add_u32 v7, v56, 3, v55
    v_lshlrev_b32 v55, 4, v52
    v_lshl_add_u32 v8, v53, 9, v55
    v_lshlrev_b32 v55, 5, v52
    v_lshl_add_u32 v55, v53, 3, v55
    s_lshl_b32 s4, s21, 9
    s_add_u32 s4, s4, 49152
    v_add_u32 v10, s4, v55
    v_xor_b32 v11, 2048, v10
    s_lshl_b32 s4, s22, 1
    s_add_u32 s4, s4, s21
    v_mov_b32 v13, 0x80000000
    v_writelane_b32 v13, s4, 0
    s_add_u32 s4, s4, 256
    s_cmp_lt_u32 s21, 2
    s_cbranch_scc1 L_c_fl01
    s_and_b32 s4, s22, 0
    s_lshl_b32 s4, s4, 8
    v_lshl_add_u32 v13, v1, 2, s4
L_c_fl01:
    s_mul_i32 s4, s21, 24576
    s_add_u32 s4, s4, 65536
    v_add_u32 v5, s4, v2
    v_mov_b32 v55, 0x3f80
    v_mov_b32 v56, 0x3f800000
    v_mov_b32 v57, 0
    v_cmp_eq_u32 vcc, 0, v54
    s_nop 1
    v_cndmask_b32 v24, v57, v55, vcc
    v_cmp_eq_u32 vcc, 1, v54
    s_nop 1
    v_cndmask_b32 v24, v24, v56, vcc
    v_cmp_eq_u32 vcc, 2, v54
    s_nop 1
    v_cndmask_b32 v25, v57, v55, vcc
    v_cmp_eq_u32 vcc, 3, v54
    s_nop 1
    v_cndmask_b32 v25, v25, v56, vcc
    v_cmp_eq_u32 vcc, 4, v54
    s_nop 1
    v_cndmask_b32 v26, v57, v55, vcc
    v_cmp_eq_u32 vcc, 5, v54
    s_nop 1
    v_cndmask_b32 v26, v26, v56, vcc
    v_cmp_eq_u32 vcc, 6, v54
    s_nop 1
    v_cndmask_b32 v27, v57, v55, vcc
    v_cmp_eq_u32 vcc, 7, v54
    s_nop 1
    v_cndmask_b32 v27, v27, v56, vcc
    s_lshl_b32 s4, s23, 5
    s_add_u32 s4, s4, s22
    s_lshl_b32 s5, s4, 2
    s_add_u32 s5, s5, s21
    s_lshl_b32 s31, s5, 11
    s_xor_b32 s32, s31, 8192
    s_lshr_b32 s5, s4, 1
    s_lshl_b32 s5, s5, 14
    s_lshl_b32 s6, s25, 12
    s_add_u32 s5, s5, s6
    s_add_u32 s101, s5, 239075328
    s_lshl_b32 s2, s4, 7
    s_add_u32 s2, s2, 243302400
    s_lshl_b32 s5, s25, 2
    s_add_u32 s5, s5, s21
    s_lshl_b32 s5, s5, 6
    s_lshr_b32 s6, s22, 1
    s_add_u32 s5, s5, s6
    s_lshl_b32 s5, s5, 9
    s_lshl_b32 s6, s23, 18
    s_add_u32 s6, s6, 524288
    s_add_u32 s34, s5, s6
    s_add_u32 s35, s34, 8192
    s_add_u32 s36, s34, 16384
    s_add_u32 s37, s34, 24576
    s_lshl_b32 s5, s22, 13
    s_add_u32 s7, s5, s6
    s_lshl_b32 s5, s21, 8
    s_add_u32 s38, s7, s5
    s_add_u32 s39, s38, 4096
    s_lshl_b32 s3, s23, 12
    s_add_u32 s3, s3, 242221056
    v_mov_b32 v64, 0
    v_mov_b32 v68, -1
    v_mov_b32 v65, 0
    v_mov_b32 v69, -1
    v_mov_b32 v66, 0
    v_mov_b32 v70, -1
    v_mov_b32 v67, 0
    v_mov_b32 v71, -1
    v_mov_b64 v[72:73], s[28:29]
    s_lshl_b32 s5, s21, 11
    s_add_u32 s7, s7, s5
    s_add_u32 s4, s31, 234881024
    s_add_u32 s5, s7, 234881024
    buffer_store_dwordx4 v[64:67], v2, s[8:11], s4 offen offset:0
    buffer_store_dwordx4 v[68:71], v2, s[8:11], s5 offen offset:0
    buffer_store_dwordx4 v[64:67], v2, s[8:11], s4 offen offset:1024
    buffer_store_dwordx4 v[68:71], v2, s[8:11], s5 offen offset:1024
    s_lshl_b32 s4, s23, 14
    s_add_u32 s4, s4, 236978176
    buffer_store_dword v72, v6, s[8:11], s4 offen
    s_lshr_b32 s4, s31, 2
    s_add_u32 s4, s4, 237109248
    buffer_store_dwordx2 v[72:73], v3, s[8:11], s4 offen
    s_add_u32 s4, s31, 235929600
    s_add_u32 s5, s7, 235929600
    buffer_store_dwordx4 v[64:67], v2, s[8:11], s4 offen offset:0
    buffer_store_dwordx4 v[68:71], v2, s[8:11], s5 offen offset:0
    buffer_store_dwordx4 v[64:67], v2, s[8:11], s4 offen offset:1024
    buffer_store_dwordx4 v[68:71], v2, s[8:11], s5 offen offset:1024
    s_lshl_b32 s4, s23, 14
    s_add_u32 s4, s4, 237240320
    buffer_store_dword v72, v6, s[8:11], s4 offen
    s_lshr_b32 s4, s31, 2
    s_add_u32 s4, s4, 237371392
    buffer_store_dwordx2 v[72:73], v3, s[8:11], s4 offen
    s_lshr_b32 s4, s21, 1
    s_lshl_b32 s4, s4, 19
    s_and_b32 s5, s21, 1
    s_lshl_b32 s5, s5, 13
    s_add_u32 s4, s4, s5
    s_add_u32 s4, s4, s101
    buffer_store_dwordx4 v[68:71], v2, s[8:11], s4 offen sc1
    buffer_store_byte v64, v13, s[8:11], s3 offen
    s_waitcnt vmcnt(46)
    s_barrier
    v_add_u32 v48, 65536, v43
    ds_read_b64_tr_b16 v[128:129], v48 offset:0
    ds_read_b64_tr_b16 v[130:131], v48 offset:2048
    ds_read_b64_tr_b16 v[132:133], v48 offset:8192
    ds_read_b64_tr_b16 v[134:135], v48 offset:10240
    ds_read_b64_tr_b16 v[160:161], v48 offset:64
    ds_read_b64_tr_b16 v[162:163], v48 offset:2112
    ds_read_b64_tr_b16 v[164:165], v48 offset:8256
    ds_read_b64_tr_b16 v[166:167], v48 offset:10304
    ds_read_b64_tr_b16 v[192:193], v48 offset:128
    ds_read_b64_tr_b16 v[194:195], v48 offset:2176
    ds_read_b64_tr_b16 v[196:197], v48 offset:8320
    ds_read_b64_tr_b16 v[198:199], v48 offset:10368
    ds_read_b64_tr_b16 v[224:225], v48 offset:192
    ds_read_b64_tr_b16 v[226:227], v48 offset:2240
    ds_read_b64_tr_b16 v[228:229], v48 offset:8384
    ds_read_b64_tr_b16 v[230:231], v48 offset:10432
    s_waitcnt lgkmcnt(0)
    s_barrier
    s_mov_b32 s12, s48
    s_mov_b32 s13, s49
    s_mov_b32 s14, 0x800000
    s_mov_b32 s15, 0x00020000
    s_lshl_b32 s6, s21, 13
    s_add_u32 s6, s6, 65536
    s_lshl_b32 s4, s21, 6
    s_add_u32 s4, s4, 256
    s_lshl_b32 s4, s4, 13
    s_lshl_b32 s5, s24, 8
    s_add_u32 s4, s4, s5
    s_lshl_b32 s5, s25, 7
    s_add_u32 s4, s4, s5
    s_add_u32 m0, s6, 0
    s_nop 0
    buffer_load_dwordx4 v40, s[12:15], s4 offen lds
    s_add_u32 s4, s4, 65536
    s_add_u32 m0, s6, 1024
    s_nop 0
    buffer_load_dwordx4 v40, s[12:15], s4 offen lds
    s_add_u32 s4, s4, 65536
    s_add_u32 m0, s6, 2048
    s_nop 0
    buffer_load_dwordx4 v40, s[12:15], s4 offen lds
    s_add_u32 s4, s4, 65536
    s_add_u32 m0, s6, 3072
    s_nop 0
    buffer_load_dwordx4 v40, s[12:15], s4 offen lds
    s_add_u32 s4, s4, 65536
    s_add_u32 m0, s6, 4096
    s_nop 0
    buffer_load_dwordx4 v40, s[12:15], s4 offen lds
    s_add_u32 s4, s4, 65536
    s_add_u32 m0, s6, 5120
    s_nop 0
    buffer_load_dwordx4 v40, s[12:15], s4 offen lds
    s_add_u32 s4, s4, 65536
    s_add_u32 m0, s6, 6144
    s_nop 0
    buffer_load_dwordx4 v40, s[12:15], s4 offen lds
    s_add_u32 s4, s4, 65536
    s_add_u32 m0, s6, 7168
    s_nop 0
    buffer_load_dwordx4 v40, s[12:15], s4 offen lds
    s_waitcnt vmcnt(46)
    s_barrier
    v_add_u32 v48, 98304, v43
    ds_read_b64_tr_b16 v[136:137], v48 offset:0
    ds_read_b64_tr_b16 v[138:139], v48 offset:2048
    ds_read_b64_tr_b16 v[140:141], v48 offset:8192
    ds_read_b64_tr_b16 v[142:143], v48 offset:10240
    ds_read_b64_tr_b16 v[168:169], v48 offset:64
    ds_read_b64_tr_b16 v[170:171], v48 offset:2112
    ds_read_b64_tr_b16 v[172:173], v48 offset:8256
    ds_read_b64_tr_b16 v[174:175], v48 offset:10304
    ds_read_b64_tr_b16 v[200:201], v48 offset:128
    ds_read_b64_tr_b16 v[202:203], v48 offset:2176
    ds_read_b64_tr_b16 v[204:205], v48 offset:8320
    ds_read_b64_tr_b16 v[206:207], v48 offset:10368
    ds_read_b64_tr_b16 v[232:233], v48 offset:192
    ds_read_b64_tr_b16 v[234:235], v48 offset:2240
    ds_read_b64_tr_b16 v[236:237], v48 offset:8384
    ds_read_b64_tr_b16 v[238:239], v48 offset:10432
    s_waitcnt lgkmcnt(0)
    s_barrier
    s_mov_b32 s12, s48
    s_mov_b32 s13, s49
    s_mov_b32 s14, 0x800000
    s_mov_b32 s15, 0x00020000
    s_lshl_b32 s6, s21, 13
    s_add_u32 s6, s6, 98304
    s_lshl_b32 s4, s21, 6
    s_add_u32 s4, s4, 512
    s_lshl_b32 s4, s4, 13
    s_lshl_b32 s5, s24, 8
    s_add_u32 s4, s4, s5
    s_lshl_b32 s5, s25, 7
    s_add_u32 s4, s4, s5
    s_add_u32 m0, s6, 0
    s_nop 0
    buffer_load_dwordx4 v40, s[12:15], s4 offen lds
    s_add_u32 s4, s4, 65536
    s_add_u32 m0, s6, 1024
    s_nop 0
    buffer_load_dwordx4 v40, s[12:15], s4 offen lds
    s_add_u32 s4, s4, 65536
    s_add_u32 m0, s6, 2048
    s_nop 0
    buffer_load_dwordx4 v40, s[12:15], s4 offen lds
    s_add_u32 s4, s4, 65536
    s_add_u32 m0, s6, 3072
    s_nop 0
    buffer_load_dwordx4 v40, s[12:15], s4 offen lds
    s_add_u32 s4, s4, 65536
    s_add_u32 m0, s6, 4096
    s_nop 0
    buffer_load_dwordx4 v40, s[12:15], s4 offen lds
    s_add_u32 s4, s4, 65536
    s_add_u32 m0, s6, 5120
    s_nop 0
    buffer_load_dwordx4 v40, s[12:15], s4 offen lds
    s_add_u32 s4, s4, 65536
    s_add_u32 m0, s6, 6144
    s_nop 0
    buffer_load_dwordx4 v40, s[12:15], s4 offen lds
    s_add_u32 s4, s4, 65536
    s_add_u32 m0, s6, 7168
    s_nop 0
    buffer_load_dwordx4 v40, s[12:15], s4 offen lds
    s_waitcnt vmcnt(46)
    s_barrier
    v_add_u32 v48, 131072, v43
    ds_read_b64_tr_b16 v[144:145], v48 offset:0
    ds_read_b64_tr_b16 v[146:147], v48 offset:2048
    ds_read_b64_tr_b16 v[148:149], v48 offset:8192
    ds_read_b64_tr_b16 v[150:151], v48 offset:10240
    ds_read_b64_tr_b16 v[176:177], v48 offset:64
    ds_read_b64_tr_b16 v[178:179], v48 offset:2112
    ds_read_b64_tr_b16 v[180:181], v48 offset:8256
    ds_read_b64_tr_b16 v[182:183], v48 offset:10304
    ds_read_b64_tr_b16 v[208:209], v48 offset:128
    ds_read_b64_tr_b16 v[210:211], v48 offset:2176
    ds_read_b64_tr_b16 v[212:213], v48 offset:8320
    ds_read_b64_tr_b16 v[214:215], v48 offset:10368
    ds_read_b64_tr_b16 v[240:241], v48 offset:192
    ds_read_b64_tr_b16 v[242:243], v48 offset:2240
    ds_read_b64_tr_b16 v[244:245], v48 offset:8384
    ds_read_b64_tr_b16 v[246:247], v48 offset:10432
    s_waitcnt lgkmcnt(0)
    s_barrier
    s_mov_b32 s12, s48
    s_mov_b32 s13, s49
    s_mov_b32 s14, 0x800000
    s_mov_b32 s15, 0x00020000
    s_lshl_b32 s6, s21, 13
    s_add_u32 s6, s6, 131072
    s_lshl_b32 s4, s21, 6
    s_add_u32 s4, s4, 768
    s_lshl_b32 s4, s4, 13
    s_lshl_b32 s5, s24, 8
    s_add_u32 s4, s4, s5
    s_lshl_b32 s5, s25, 7
    s_add_u32 s4, s4, s5
    s_add_u32 m0, s6, 0
    s_nop 0
    buffer_load_dwordx4 v40, s[12:15], s4 offen lds
    s_add_u32 s4, s4, 65536
    s_add_u32 m0, s6, 1024
    s_nop 0
    buffer_load_dwordx4 v40, s[12:15], s4 offen lds
    s_add_u32 s4, s4, 65536
    s_add_u32 m0, s6, 2048
    s_nop 0
    buffer_load_dwordx4 v40, s[12:15], s4 offen lds
    s_add_u32 s4, s4, 65536
    s_add_u32 m0, s6, 3072
    s_nop 0
    buffer_load_dwordx4 v40, s[12:15], s4 offen lds
    s_add_u32 s4, s4, 65536
    s_add_u32 m0, s6, 4096
    s_nop 0
    buffer_load_dwordx4 v40, s[12:15], s4 offen lds
    s_add_u32 s4, s4, 65536
    s_add_u32 m0, s6, 5120
    s_nop 0
    buffer_load_dwordx4 v40, s[12:15], s4 offen lds
    s_add_u32 s4, s4, 65536
    s_add_u32 m0, s6, 6144
    s_nop 0
    buffer_load_dwordx4 v40, s[12:15], s4 offen lds
    s_add_u32 s4, s4, 65536
    s_add_u32 m0, s6, 7168
    s_nop 0
    buffer_load_dwordx4 v40, s[12:15], s4 offen lds
    s_waitcnt vmcnt(46)
    s_barrier
    v_add_u32 v48, 0, v43
    ds_read_b64_tr_b16 v[152:153], v48 offset:0
    ds_read_b64_tr_b16 v[154:155], v48 offset:2048
    ds_read_b64_tr_b16 v[156:157], v48 offset:8192
    ds_read_b64_tr_b16 v[158:159], v48 offset:10240
    ds_read_b64_tr_b16 v[184:185], v48 offset:64
    ds_read_b64_tr_b16 v[186:187], v48 offset:2112
    ds_read_b64_tr_b16 v[188:189], v48 offset:8256
    ds_read_b64_tr_b16 v[190:191], v48 offset:10304
    ds_read_b64_tr_b16 v[216:217], v48 offset:128
    ds_read_b64_tr_b16 v[218:219], v48 offset:2176
    ds_read_b64_tr_b16 v[220:221], v48 offset:8320
    ds_read_b64_tr_b16 v[222:223], v48 offset:10368
    ds_read_b64_tr_b16 v[248:249], v48 offset:192
    ds_read_b64_tr_b16 v[250:251], v48 offset:2240
    ds_read_b64_tr_b16 v[252:253], v48 offset:8384
    ds_read_b64_tr_b16 v[254:255], v48 offset:10432
    s_waitcnt lgkmcnt(0)
    s_barrier
    s_mov_b32 s12, s50
    s_mov_b32 s13, s51
    s_mov_b32 s14, 0x800000
    s_mov_b32 s15, 0x00020000
    s_lshl_b32 s6, s21, 13
    s_add_u32 s6, s6, 0
    s_lshl_b32 s4, s21, 6
    s_add_u32 s4, s4, 0
    s_lshl_b32 s4, s4, 13
    s_lshl_b32 s5, s24, 8
    s_add_u32 s4, s4, s5
    s_lshl_b32 s5, s25, 7
    s_add_u32 s4, s4, s5
    s_add_u32 m0, s6, 0
    s_nop 0
    buffer_load_dwordx4 v40, s[12:15], s4 offen lds
    s_add_u32 s4, s4, 65536
    s_add_u32 m0, s6, 1024
    s_nop 0
    buffer_load_dwordx4 v40, s[12:15], s4 offen lds
    s_add_u32 s4, s4, 65536
    s_add_u32 m0, s6, 2048
    s_nop 0
    buffer_load_dwordx4 v40, s[12:15], s4 offen lds
    s_add_u32 s4, s4, 65536
    s_add_u32 m0, s6, 3072
    s_nop 0
    buffer_load_dwordx4 v40, s[12:15], s4 offen lds
    s_add_u32 s4, s4, 65536
    s_add_u32 m0, s6, 4096
    s_nop 0
    buffer_load_dwordx4 v40, s[12:15], s4 offen lds
    s_add_u32 s4, s4, 65536
    s_add_u32 m0, s6, 5120
    s_nop 0
    buffer_load_dwordx4 v40, s[12:15], s4 offen lds
    s_add_u32 s4, s4, 65536
    s_add_u32 m0, s6, 6144
    s_nop 0
    buffer_load_dwordx4 v40, s[12:15], s4 offen lds
    s_add_u32 s4, s4, 65536
    s_add_u32 m0, s6, 7168
    s_nop 0
    buffer_load_dwordx4 v40, s[12:15], s4 offen lds
    s_waitcnt vmcnt(46)
    s_barrier
    v_add_u32 v48, 32768, v42
    ds_read_b64_tr_b16 a[0:1], v48 offset:0
    ds_read_b64_tr_b16 a[2:3], v48 offset:256
    ds_read_b64_tr_b16 a[4:5], v48 offset:4096
    ds_read_b64_tr_b16 a[6:7], v48 offset:4352
    ds_read_b64_tr_b16 a[8:9], v48 offset:8192
    ds_read_b64_tr_b16 a[10:11], v48 offset:8448
    ds_read_b64_tr_b16 a[12:13], v48 offset:12288
    ds_read_b64_tr_b16 a[14:15], v48 offset:12544
    ds_read_b64_tr_b16 a[16:17], v48 offset:16384
    ds_read_b64_tr_b16 a[18:19], v48 offset:16640
    ds_read_b64_tr_b16 a[20:21], v48 offset:20480
    ds_read_b64_tr_b16 a[22:23], v48 offset:20736
    ds_read_b64_tr_b16 a[24:25], v48 offset:24576
    ds_read_b64_tr_b16 a[26:27], v48 offset:24832
    ds_read_b64_tr_b16 a[28:29], v48 offset:28672
    ds_read_b64_tr_b16 a[30:31], v48 offset:28928
    s_waitcnt lgkmcnt(0)
    s_barrier
    s_mov_b32 s12, s50
    s_mov_b32 s13, s51
    s_mov_b32 s14, 0x800000
    s_mov_b32 s15, 0x00020000
    s_lshl_b32 s6, s21, 13
    s_add_u32 s6, s6, 32768
    s_lshl_b32 s4, s21, 6
    s_add_u32 s4, s4, 256
    s_lshl_b32 s4, s4, 13
    s_lshl_b32 s5, s24, 8
    s_add_u32 s4, s4, s5
    s_lshl_b32 s5, s25, 7
    s_add_u32 s4, s4, s5
    s_add_u32 m0, s6, 0
    s_nop 0
    buffer_load_dwordx4 v40, s[12:15], s4 offen lds
    s_add_u32 s4, s4, 65536
    s_add_u32 m0, s6, 1024
    s_nop 0
    buffer_load_dwordx4 v40, s[12:15], s4 offen lds
    s_add_u32 s4, s4, 65536
    s_add_u32 m0, s6, 2048
    s_nop 0
    buffer_load_dwordx4 v40, s[12:15], s4 offen lds
    s_add_u32 s4, s4, 65536
    s_add_u32 m0, s6, 3072
    s_nop 0
    buffer_load_dwordx4 v40, s[12:15], s4 offen lds
    s_add_u32 s4, s4, 65536
    s_add_u32 m0, s6, 4096
    s_nop 0
    buffer_load_dwordx4 v40, s[12:15], s4 offen lds
    s_add_u32 s4, s4, 65536
    s_add_u32 m0, s6, 5120
    s_nop 0
    buffer_load_dwordx4 v40, s[12:15], s4 offen lds
    s_add_u32 s4, s4, 65536
    s_add_u32 m0, s6, 6144
    s_nop 0
    buffer_load_dwordx4 v40, s[12:15], s4 offen lds
    s_add_u32 s4, s4, 65536
    s_add_u32 m0, s6, 7168
    s_nop 0
    buffer_load_dwordx4 v40, s[12:15], s4 offen lds
    s_waitcnt vmcnt(32)
    s_barrier
    v_add_u32 v48, 65536, v42
    ds_read_b64_tr_b16 a[32:33], v48 offset:0
    ds_read_b64_tr_b16 a[34:35], v48 offset:256
    ds_read_b64_tr_b16 a[36:37], v48 offset:4096
    ds_read_b64_tr_b16 a[38:39], v48 offset:4352
    ds_read_b64_tr_b16 a[40:41], v48 offset:8192
    ds_read_b64_tr_b16 a[42:43], v48 offset:8448
    ds_read_b64_tr_b16 a[44:45], v48 offset:12288
    ds_read_b64_tr_b16 a[46:47], v48 offset:12544
    ds_read_b64_tr_b16 a[48:49], v48 offset:16384
    ds_read_b64_tr_b16 a[50:51], v48 offset:16640
    ds_read_b64_tr_b16 a[52:53], v48 offset:20480
    ds_read_b64_tr_b16 a[54:55], v48 offset:20736
    ds_read_b64_tr_b16 a[56:57], v48 offset:24576
    ds_read_b64_tr_b16 a[58:59], v48 offset:24832
    ds_read_b64_tr_b16 a[60:61], v48 offset:28672
    ds_read_b64_tr_b16 a[62:63], v48 offset:28928
    s_waitcnt lgkmcnt(0)
    s_barrier
    s_cmp_lg_u32 s21, 0
    s_cbranch_scc1 L_c_nog
    v_mov_b32 v64, 1
    v_mov_b32 v65, 64
    s_mov_b64 exec, 1
    buffer_atomic_add v64, v65, s[16:19], 0 offen
    s_mov_b64 exec, -1
L_c_nog:
    s_mov_b32 s12, s50
    s_mov_b32 s13, s51
    s_mov_b32 s14, 0x800000
    s_mov_b32 s15, 0x00020000
    s_lshl_b32 s6, s21, 13
    s_add_u32 s6, s6, 65536
    s_lshl_b32 s4, s21, 6
    s_add_u32 s4, s4, 512
    s_lshl_b32 s4, s4, 13
    s_lshl_b32 s5, s24, 8
    s_add_u32 s4, s4, s5
    s_lshl_b32 s5, s25, 7
    s_add_u32 s4, s4, s5
    s_add_u32 m0, s6, 0
    s_nop 0
    buffer_load_dwordx4 v40, s[12:15], s4 offen lds
    s_add_u32 s4, s4, 65536
    s_add_u32 m0, s6, 1024
    s_nop 0
    buffer_load_dwordx4 v40, s[12:15], s4 offen lds
    s_add_u32 s4, s4, 65536
    s_add_u32 m0, s6, 2048
    s_nop 0
    buffer_load_dwordx4 v40, s[12:15], s4 offen lds
    s_add_u32 s4, s4, 65536
    s_add_u32 m0, s6, 3072
    s_nop 0
    buffer_load_dwordx4 v40, s[12:15], s4 offen lds
    s_add_u32 s4, s4, 65536
    s_add_u32 m0, s6, 4096
    s_nop 0
    buffer_load_dwordx4 v40, s[12:15], s4 offen lds
    s_add_u32 s4, s4, 65536
    s_add_u32 m0, s6, 5120
    s_nop 0
    buffer_load_dwordx4 v40, s[12:15], s4 offen lds
    s_add_u32 s4, s4, 65536
    s_add_u32 m0, s6, 6144
    s_nop 0
    buffer_load_dwordx4 v40, s[12:15], s4 offen lds
    s_add_u32 s4, s4, 65536
    s_add_u32 m0, s6, 7168
    s_nop 0
    buffer_load_dwordx4 v40, s[12:15], s4 offen lds
    s_waitcnt vmcnt(32)
    s_barrier
    v_add_u32 v48, 98304, v42
    ds_read_b64_tr_b16 a[64:65], v48 offset:0
    ds_read_b64_tr_b16 a[66:67], v48 offset:256
    ds_read_b64_tr_b16 a[68:69], v48 offset:4096
    ds_read_b64_tr_b16 a[70:71], v48 offset:4352
    ds_read_b64_tr_b16 a[72:73], v48 offset:8192
    ds_read_b64_tr_b16 a[74:75], v48 offset:8448
    ds_read_b64_tr_b16 a[76:77], v48 offset:12288
    ds_read_b64_tr_b16 a[78:79], v48 offset:12544
    ds_read_b64_tr_b16 a[80:81], v48 offset:16384
    ds_read_b64_tr_b16 a[82:83], v48 offset:16640
    ds_read_b64_tr_b16 a[84:85], v48 offset:20480
    ds_read_b64_tr_b16 a[86:87], v48 offset:20736
    ds_read_b64_tr_b16 a[88:89], v48 offset:24576
    ds_read_b64_tr_b16 a[90:91], v48 offset:24832
    ds_read_b64_tr_b16 a[92:93], v48 offset:28672
    ds_read_b64_tr_b16 a[94:95], v48 offset:28928
    s_waitcnt lgkmcnt(0)
    s_barrier
    s_mov_b32 s12, s50
    s_mov_b32 s13, s51
    s_mov_b32 s14, 0x800000
    s_mov_b32 s15, 0x00020000
    s_lshl_b32 s6, s21, 13
    s_add_u32 s6, s6, 98304
    s_lshl_b32 s4, s21, 6
    s_add_u32 s4, s4, 768
    s_lshl_b32 s4, s4, 13
    s_lshl_b32 s5, s24, 8
    s_add_u32 s4, s4, s5
    s_lshl_b32 s5, s25, 7
    s_add_u32 s4, s4, s5
    s_add_u32 m0, s6, 0
    s_nop 0
    buffer_load_dwordx4 v40, s[12:15], s4 offen lds
    s_add_u32 s4, s4, 65536
    s_add_u32 m0, s6, 1024
    s_nop 0
    buffer_load_dwordx4 v40, s[12:15], s4 offen lds
    s_add_u32 s4, s4, 65536
    s_add_u32 m0, s6, 2048
    s_nop 0
    buffer_load_dwordx4 v40, s[12:15], s4 offen lds
    s_add_u32 s4, s4, 65536
    s_add_u32 m0, s6, 3072
    s_nop 0
    buffer_load_dwordx4 v40, s[12:15], s4 offen lds
    s_add_u32 s4, s4, 65536
    s_add_u32 m0, s6, 4096
    s_nop 0
    buffer_load_dwordx4 v40, s[12:15], s4 offen lds
    s_add_u32 s4, s4, 65536
    s_add_u32 m0, s6, 5120
    s_nop 0
    buffer_load_dwordx4 v40, s[12:15], s4 offen lds
    s_add_u32 s4, s4, 65536
    s_add_u32 m0, s6, 6144
    s_nop 0
    buffer_load_dwordx4 v40, s[12:15], s4 offen lds
    s_add_u32 s4, s4, 65536
    s_add_u32 m0, s6, 7168
    s_nop 0
    buffer_load_dwordx4 v40, s[12:15], s4 offen lds
    s_waitcnt vmcnt(32)
    s_barrier
    v_add_u32 v48, 131072, v42
    ds_read_b64_tr_b16 a[96:97], v48 offset:0
    ds_read_b64_tr_b16 a[98:99], v48 offset:256
    ds_read_b64_tr_b16 a[100:101], v48 offset:4096
    ds_read_b64_tr_b16 a[102:103], v48 offset:4352
    ds_read_b64_tr_b16 a[104:105], v48 offset:8192
    ds_read_b64_tr_b16 a[106:107], v48 offset:8448
    ds_read_b64_tr_b16 a[108:109], v48 offset:12288
    ds_read_b64_tr_b16 a[110:111], v48 offset:12544
    ds_read_b64_tr_b16 a[112:113], v48 offset:16384
    ds_read_b64_tr_b16 a[114:115], v48 offset:16640
    ds_read_b64_tr_b16 a[116:117], v48 offset:20480
    ds_read_b64_tr_b16 a[118:119], v48 offset:20736
    ds_read_b64_tr_b16 a[120:121], v48 offset:24576
    ds_read_b64_tr_b16 a[122:123], v48 offset:24832
    ds_read_b64_tr_b16 a[124:125], v48 offset:28672
    ds_read_b64_tr_b16 a[126:127], v48 offset:28928
    s_waitcnt lgkmcnt(0)
    s_barrier
    s_waitcnt vmcnt(24)
    s_barrier
    v_add_u32 v48, 0, v42
    ds_read_b64_tr_b16 a[128:129], v48 offset:0
    ds_read_b64_tr_b16 a[130:131], v48 offset:256
    ds_read_b64_tr_b16 a[132:133], v48 offset:4096
    ds_read_b64_tr_b16 a[134:135], v48 offset:4352
    ds_read_b64_tr_b16 a[136:137], v48 offset:8192
    ds_read_b64_tr_b16 a[138:139], v48 offset:8448
    ds_read_b64_tr_b16 a[140:141], v48 offset:12288
    ds_read_b64_tr_b16 a[142:143], v48 offset:12544
    ds_read_b64_tr_b16 a[144:145], v48 offset:16384
    ds_read_b64_tr_b16 a[146:147], v48 offset:16640
    ds_read_b64_tr_b16 a[148:149], v48 offset:20480
    ds_read_b64_tr_b16 a[150:151], v48 offset:20736
    ds_read_b64_tr_b16 a[152:153], v48 offset:24576
    ds_read_b64_tr_b16 a[154:155], v48 offset:24832
    ds_read_b64_tr_b16 a[156:157], v48 offset:28672
    ds_read_b64_tr_b16 a[158:159], v48 offset:28928
    s_waitcnt lgkmcnt(0)
    s_barrier
    s_mov_b32 s12, s52
    s_mov_b32 s13, s53
    s_mov_b32 s14, 0x800000
    s_mov_b32 s15, 0x00020000
    s_lshl_b32 s6, s21, 13
    s_add_u32 s6, s6, 0
    s_lshl_b32 s4, s21, 6
    s_add_u32 s4, s4, 0
    s_lshl_b32 s4, s4, 13
    s_lshl_b32 s5, s24, 8
    s_add_u32 s4, s4, s5
    s_lshl_b32 s5, s25, 7
    s_add_u32 s4, s4, s5
    s_add_u32 m0, s6, 0
    s_nop 0
    buffer_load_dwordx4 v40, s[12:15], s4 offen lds
    s_add_u32 s4, s4, 65536
    s_add_u32 m0, s6, 1024
    s_nop 0
    buffer_load_dwordx4 v40, s[12:15], s4 offen lds
    s_add_u32 s4, s4, 65536
    s_add_u32 m0, s6, 2048
    s_nop 0
    buffer_load_dwordx4 v40, s[12:15], s4 offen lds
    s_add_u32 s4, s4, 65536
    s_add_u32 m0, s6, 3072
    s_nop 0
    buffer_load_dwordx4 v40, s[12:15], s4 offen lds
    s_add_u32 s4, s4, 65536
    s_add_u32 m0, s6, 4096
    s_nop 0
    buffer_load_dwordx4 v40, s[12:15], s4 offen lds
    s_add_u32 s4, s4, 65536
    s_add_u32 m0, s6, 5120
    s_nop 0
    buffer_load_dwordx4 v40, s[12:15], s4 offen lds
    s_add_u32 s4, s4, 65536
    s_add_u32 m0, s6, 6144
    s_nop 0
    buffer_load_dwordx4 v40, s[12:15], s4 offen lds
    s_add_u32 s4, s4, 65536
    s_add_u32 m0, s6, 7168
    s_nop 0
    buffer_load_dwordx4 v40, s[12:15], s4 offen lds
    s_waitcnt vmcnt(24)
    s_barrier
    v_add_u32 v48, 32768, v42
    ds_read_b64_tr_b16 a[160:161], v48 offset:0
    ds_read_b64_tr_b16 a[162:163], v48 offset:256
    ds_read_b64_tr_b16 a[164:165], v48 offset:4096
    ds_read_b64_tr_b16 a[166:167], v48 offset:4352
    ds_read_b64_tr_b16 a[168:169], v48 offset:8192
    ds_read_b64_tr_b16 a[170:171], v48 offset:8448
    ds_read_b64_tr_b16 a[172:173], v48 offset:12288
    ds_read_b64_tr_b16 a[174:175], v48 offset:12544
    ds_read_b64_tr_b16 a[176:177], v48 offset:16384
    ds_read_b64_tr_b16 a[178:179], v48 offset:16640
    ds_read_b64_tr_b16 a[180:181], v48 offset:20480
    ds_read_b64_tr_b16 a[182:183], v48 offset:20736
    ds_read_b64_tr_b16 a[184:185], v48 offset:24576
    ds_read_b64_tr_b16 a[186:187], v48 offset:24832
    ds_read_b64_tr_b16 a[188:189], v48 offset:28672
    ds_read_b64_tr_b16 a[190:191], v48 offset:28928
    s_waitcnt lgkmcnt(0)
    s_barrier
    s_mov_b32 s12, s52
    s_mov_b32 s13, s53
    s_mov_b32 s14, 0x800000
    s_mov_b32 s15, 0x00020000
    s_lshl_b32 s6, s21, 13
    s_add_u32 s6, s6, 32768
    s_lshl_b32 s4, s21, 6
    s_add_u32 s4, s4, 256
    s_lshl_b32 s4, s4, 13
    s_lshl_b32 s5, s24, 8
    s_add_u32 s4, s4, s5
    s_lshl_b32 s5, s25, 7
    s_add_u32 s4, s4, s5
    s_add_u32 m0, s6, 0
    s_nop 0
    buffer_load_dwordx4 v40, s[12:15], s4 offen lds
    s_add_u32 s4, s4, 65536
    s_add_u32 m0, s6, 1024
    s_nop 0
    buffer_load_dwordx4 v40, s[12:15], s4 offen lds
    s_add_u32 s4, s4, 65536
    s_add_u32 m0, s6, 2048
    s_nop 0
    buffer_load_dwordx4 v40, s[12:15], s4 offen lds
    s_add_u32 s4, s4, 65536
    s_add_u32 m0, s6, 3072
    s_nop 0
    buffer_load_dwordx4 v40, s[12:15], s4 offen lds
    s_add_u32 s4, s4, 65536
    s_add_u32 m0, s6, 4096
    s_nop 0
    buffer_load_dwordx4 v40, s[12:15], s4 offen lds
    s_add_u32 s4, s4, 65536
    s_add_u32 m0, s6, 5120
    s_nop 0
    buffer_load_dwordx4 v40, s[12:15], s4 offen lds
    s_add_u32 s4, s4, 65536
    s_add_u32 m0, s6, 6144
    s_nop 0
    buffer_load_dwordx4 v40, s[12:15], s4 offen lds
    s_add_u32 s4, s4, 65536
    s_add_u32 m0, s6, 7168
    s_nop 0
    buffer_load_dwordx4 v40, s[12:15], s4 offen lds
    s_waitcnt vmcnt(24)
    s_barrier
    v_add_u32 v48, 65536, v42
    ds_read_b64_tr_b16 a[192:193], v48 offset:0
    ds_read_b64_tr_b16 a[194:195], v48 offset:256
    ds_read_b64_tr_b16 a[196:197], v48 offset:4096
    ds_read_b64_tr_b16 a[198:199], v48 offset:4352
    ds_read_b64_tr_b16 a[200:201], v48 offset:8192
    ds_read_b64_tr_b16 a[202:203], v48 offset:8448
    ds_read_b64_tr_b16 a[204:205], v48 offset:12288
    ds_read_b64_tr_b16 a[206:207], v48 offset:12544
    ds_read_b64_tr_b16 a[208:209], v48 offset:16384
    ds_read_b64_tr_b16 a[210:211], v48 offset:16640
    ds_read_b64_tr_b16 a[212:213], v48 offset:20480
    ds_read_b64_tr_b16 a[214:215], v48 offset:20736
    ds_read_b64_tr_b16 a[216:217], v48 offset:24576
    ds_read_b64_tr_b16 a[218:219], v48 offset:24832
    ds_read_b64_tr_b16 a[220:221], v48 offset:28672
    ds_read_b64_tr_b16 a[222:223], v48 offset:28928
    s_waitcnt lgkmcnt(0)
    s_barrier
    s_waitcnt vmcnt(16)
    s_barrier
    v_add_u32 v48, 98304, v42
    ds_read_b64_tr_b16 a[224:225], v48 offset:0
    ds_read_b64_tr_b16 a[226:227], v48 offset:256
    ds_read_b64_tr_b16 a[228:229], v48 offset:4096
    ds_read_b64_tr_b16 a[230:231], v48 offset:4352
    ds_read_b64_tr_b16 a[232:233], v48 offset:8192
    ds_read_b64_tr_b16 a[234:235], v48 offset:8448
    ds_read_b64_tr_b16 a[236:237], v48 offset:12288
    ds_read_b64_tr_b16 a[238:239], v48 offset:12544
    ds_read_b64_tr_b16 a[240:241], v48 offset:16384
    ds_read_b64_tr_b16 a[242:243], v48 offset:16640
    ds_read_b64_tr_b16 a[244:245], v48 offset:20480
    ds_read_b64_tr_b16 a[246:247], v48 offset:20736
    ds_read_b64_tr_b16 a[248:249], v48 offset:24576
    ds_read_b64_tr_b16 a[250:251], v48 offset:24832
    ds_read_b64_tr_b16 a[252:253], v48 offset:28672
    ds_read_b64_tr_b16 a[254:255], v48 offset:28928
    s_waitcnt lgkmcnt(0)
    s_barrier
    ds_write_b128 v5, v[128:131] offset:0
    ds_write_b128 v5, v[132:135] offset:1024
    ds_write_b128 v5, v[136:139] offset:2048
    ds_write_b128 v5, v[140:143] offset:3072
    ds_write_b128 v5, v[144:147] offset:4096
    ds_write_b128 v5, v[148:151] offset:5120
    ds_write_b128 v5, v[152:155] offset:6144
    ds_write_b128 v5, v[156:159] offset:7168
    ds_write_b128 v5, v[160:163] offset:8192
    ds_write_b128 v5, v[164:167] offset:9216
    ds_write_b128 v5, v[168:171] offset:10240
    ds_write_b128 v5, v[172:175] offset:11264
    ds_write_b128 v5, v[176:179] offset:12288
    ds_write_b128 v5, v[180:183] offset:13312
    ds_write_b128 v5, v[184:187] offset:14336
    ds_write_b128 v5, v[188:191] offset:15360
    ds_write_b128 v5, v[192:195] offset:16384
    ds_write_b128 v5, v[196:199] offset:17408
    ds_write_b128 v5, v[200:203] offset:18432
    ds_write_b128 v5, v[204:207] offset:19456
    ds_write_b128 v5, v[208:211] offset:20480
    ds_write_b128 v5, v[212:215] offset:21504
    ds_write_b128 v5, v[216:219] offset:22528
    ds_write_b128 v5, v[220:223] offset:23552
    v_mov_b32 v96, v224
    v_mov_b32 v97, v225
    v_mov_b32 v98, v226
    v_mov_b32 v99, v227
    v_mov_b32 v100, v228
    v_mov_b32 v101, v229
    v_mov_b32 v102, v230
    v_mov_b32 v103, v231
    v_mov_b32 v104, v232
    v_mov_b32 v105, v233
    v_mov_b32 v106, v234
    v_mov_b32 v107, v235
    v_mov_b32 v108, v236
    v_mov_b32 v109, v237
    v_mov_b32 v110, v238
    v_mov_b32 v111, v239
    v_mov_b32 v112, v240
    v_mov_b32 v113, v241
    v_mov_b32 v114, v242
    v_mov_b32 v115, v243
    v_mov_b32 v116, v244
    v_mov_b32 v117, v245
    v_mov_b32 v118, v246
    v_mov_b32 v119, v247
    v_mov_b32 v120, v248
    v_mov_b32 v121, v249
    v_mov_b32 v122, v250
    v_mov_b32 v123, v251
    v_mov_b32 v124, v252
    v_mov_b32 v125, v253
    v_mov_b32 v126, v254
    v_mov_b32 v127, v255
    s_waitcnt lgkmcnt(0)
    s_waitcnt vmcnt(8)
    s_barrier
    v_add_u32 v48, 0, v42
    ds_read_b64_tr_b16 v[128:129], v48 offset:0
    ds_read_b64_tr_b16 v[130:131], v48 offset:256
    ds_read_b64_tr_b16 v[132:133], v48 offset:4096
    ds_read_b64_tr_b16 v[134:135], v48 offset:4352
    ds_read_b64_tr_b16 v[136:137], v48 offset:8192
    ds_read_b64_tr_b16 v[138:139], v48 offset:8448
    ds_read_b64_tr_b16 v[140:141], v48 offset:12288
    ds_read_b64_tr_b16 v[142:143], v48 offset:12544
    ds_read_b64_tr_b16 v[144:145], v48 offset:16384
    ds_read_b64_tr_b16 v[146:147], v48 offset:16640
    ds_read_b64_tr_b16 v[148:149], v48 offset:20480
    ds_read_b64_tr_b16 v[150:151], v48 offset:20736
    ds_read_b64_tr_b16 v[152:153], v48 offset:24576
    ds_read_b64_tr_b16 v[154:155], v48 offset:24832
    ds_read_b64_tr_b16 v[156:157], v48 offset:28672
    ds_read_b64_tr_b16 v[158:159], v48 offset:28928
    s_waitcnt lgkmcnt(0)
    s_barrier
    s_mov_b32 s12, s52
    s_mov_b32 s13, s53
    s_mov_b32 s14, 0x800000
    s_mov_b32 s15, 0x00020000
    s_lshl_b32 s6, s21, 13
    s_add_u32 s6, s6, 0
    s_lshl_b32 s4, s21, 6
    s_add_u32 s4, s4, 512
    s_lshl_b32 s4, s4, 13
    s_lshl_b32 s5, s24, 8
    s_add_u32 s4, s4, s5
    s_lshl_b32 s5, s25, 7
    s_add_u32 s4, s4, s5
    s_add_u32 m0, s6, 0
    s_nop 0
    buffer_load_dwordx4 v40, s[12:15], s4 offen lds
    s_add_u32 s4, s4, 65536
    s_add_u32 m0, s6, 1024
    s_nop 0
    buffer_load_dwordx4 v40, s[12:15], s4 offen lds
    s_add_u32 s4, s4, 65536
    s_add_u32 m0, s6, 2048
    s_nop 0
    buffer_load_dwordx4 v40, s[12:15], s4 offen lds
    s_add_u32 s4, s4, 65536
    s_add_u32 m0, s6, 3072
    s_nop 0
    buffer_load_dwordx4 v40, s[12:15], s4 offen lds
    s_add_u32 s4, s4, 65536
    s_add_u32 m0, s6, 4096
    s_nop 0
    buffer_load_dwordx4 v40, s[12:15], s4 offen lds
    s_add_u32 s4, s4, 65536
    s_add_u32 m0, s6, 5120
    s_nop 0
    buffer_load_dwordx4 v40, s[12:15], s4 offen lds
    s_add_u32 s4, s4, 65536
    s_add_u32 m0, s6, 6144
    s_nop 0
    buffer_load_dwordx4 v40, s[12:15], s4 offen lds
    s_add_u32 s4, s4, 65536
    s_add_u32 m0, s6, 7168
    s_nop 0
    buffer_load_dwordx4 v40, s[12:15], s4 offen lds
    s_waitcnt vmcnt(8)
    s_barrier
    v_add_u32 v48, 32768, v42
    ds_read_b64_tr_b16 v[160:161], v48 offset:0
    ds_read_b64_tr_b16 v[162:163], v48 offset:256
    ds_read_b64_tr_b16 v[164:165], v48 offset:4096
    ds_read_b64_tr_b16 v[166:167], v48 offset:4352
    ds_read_b64_tr_b16 v[168:169], v48 offset:8192
    ds_read_b64_tr_b16 v[170:171], v48 offset:8448
    ds_read_b64_tr_b16 v[172:173], v48 offset:12288
    ds_read_b64_tr_b16 v[174:175], v48 offset:12544
    ds_read_b64_tr_b16 v[176:177], v48 offset:16384
    ds_read_b64_tr_b16 v[178:179], v48 offset:16640
    ds_read_b64_tr_b16 v[180:181], v48 offset:20480
    ds_read_b64_tr_b16 v[182:183], v48 offset:20736
    ds_read_b64_tr_b16 v[184:185], v48 offset:24576
    ds_read_b64_tr_b16 v[186:187], v48 offset:24832
    ds_read_b64_tr_b16 v[188:189], v48 offset:28672
    ds_read_b64_tr_b16 v[190:191], v48 offset:28928
    s_waitcnt lgkmcnt(0)
    s_barrier
    s_mov_b32 s12, s52
    s_mov_b32 s13, s53
    s_mov_b32 s14, 0x800000
    s_mov_b32 s15, 0x00020000
    s_lshl_b32 s6, s21, 13
    s_add_u32 s6, s6, 32768
    s_lshl_b32 s4, s21, 6
    s_add_u32 s4, s4, 768
    s_lshl_b32 s4, s4, 13
    s_lshl_b32 s5, s24, 8
    s_add_u32 s4, s4, s5
    s_lshl_b32 s5, s25, 7
    s_add_u32 s4, s4, s5
    s_add_u32 m0, s6, 0
    s_nop 0
    buffer_load_dwordx4 v40, s[12:15], s4 offen lds
    s_add_u32 s4, s4, 65536
    s_add_u32 m0, s6, 1024
    s_nop 0
    buffer_load_dwordx4 v40, s[12:15], s4 offen lds
    s_add_u32 s4, s4, 65536
    s_add_u32 m0, s6, 2048
    s_nop 0
    buffer_load_dwordx4 v40, s[12:15], s4 offen lds
    s_add_u32 s4, s4, 65536
    s_add_u32 m0, s6, 3072
    s_nop 0
    buffer_load_dwordx4 v40, s[12:15], s4 offen lds
    s_add_u32 s4, s4, 65536
    s_add_u32 m0, s6, 4096
    s_nop 0
    buffer_load_dwordx4 v40, s[12:15], s4 offen lds
    s_add_u32 s4, s4, 65536
    s_add_u32 m0, s6, 5120
    s_nop 0
    buffer_load_dwordx4 v40, s[12:15], s4 offen lds
    s_add_u32 s4, s4, 65536
    s_add_u32 m0, s6, 6144
    s_nop 0
    buffer_load_dwordx4 v40, s[12:15], s4 offen lds
    s_add_u32 s4, s4, 65536
    s_add_u32 m0, s6, 7168
    s_nop 0
    buffer_load_dwordx4 v40, s[12:15], s4 offen lds
    s_waitcnt vmcnt(8)
    s_barrier
    v_add_u32 v48, 0, v42
    ds_read_b64_tr_b16 v[192:193], v48 offset:0
    ds_read_b64_tr_b16 v[194:195], v48 offset:256
    ds_read_b64_tr_b16 v[196:197], v48 offset:4096
    ds_read_b64_tr_b16 v[198:199], v48 offset:4352
    ds_read_b64_tr_b16 v[200:201], v48 offset:8192
    ds_read_b64_tr_b16 v[202:203], v48 offset:8448
    ds_read_b64_tr_b16 v[204:205], v48 offset:12288
    ds_read_b64_tr_b16 v[206:207], v48 offset:12544
    ds_read_b64_tr_b16 v[208:209], v48 offset:16384
    ds_read_b64_tr_b16 v[210:211], v48 offset:16640
    ds_read_b64_tr_b16 v[212:213], v48 offset:20480
    ds_read_b64_tr_b16 v[214:215], v48 offset:20736
    ds_read_b64_tr_b16 v[216:217], v48 offset:24576
    ds_read_b64_tr_b16 v[218:219], v48 offset:24832
    ds_read_b64_tr_b16 v[220:221], v48 offset:28672
    ds_read_b64_tr_b16 v[222:223], v48 offset:28928
    s_waitcnt lgkmcnt(0)
    s_barrier
    s_waitcnt vmcnt(0)
    s_barrier
    v_add_u32 v48, 32768, v42
    ds_read_b64_tr_b16 v[224:225], v48 offset:0
    ds_read_b64_tr_b16 v[226:227], v48 offset:256
    ds_read_b64_tr_b16 v[228:229], v48 offset:4096
    ds_read_b64_tr_b16 v[230:231], v48 offset:4352
    ds_read_b64_tr_b16 v[232:233], v48 offset:8192
    ds_read_b64_tr_b16 v[234:235], v48 offset:8448
    ds_read_b64_tr_b16 v[236:237], v48 offset:12288
    ds_read_b64_tr_b16 v[238:239], v48 offset:12544
    ds_read_b64_tr_b16 v[240:241], v48 offset:16384
    ds_read_b64_tr_b16 v[242:243], v48 offset:16640
    ds_read_b64_tr_b16 v[244:245], v48 offset:20480
    ds_read_b64_tr_b16 v[246:247], v48 offset:20736
    ds_read_b64_tr_b16 v[248:249], v48 offset:24576
    ds_read_b64_tr_b16 v[250:251], v48 offset:24832
    ds_read_b64_tr_b16 v[252:253], v48 offset:28672
    ds_read_b64_tr_b16 v[254:255], v48 offset:28928
    s_waitcnt lgkmcnt(0)
    s_barrier
    s_mul_i32 s7, s21, 1792
    s_add_u32 s7, s7, s38
    s_add_u32 s4, s31, 234881024
    s_add_u32 s5, s7, 234881024
    buffer_load_dwordx2 v[64:65], v3, s[8:11], s4 offen offset:1024 sc1
    buffer_load_dwordx4 v[64:67], v2, s[8:11], s5 offen offset:0 sc1
    buffer_load_dwordx4 v[64:67], v2, s[8:11], s5 offen offset:1024 sc1
    s_add_u32 s4, s31, 235929600
    s_add_u32 s5, s7, 235929600
    buffer_load_dwordx2 v[64:65], v3, s[8:11], s4 offen offset:1024 sc1
    buffer_load_dwordx4 v[64:67], v2, s[8:11], s5 offen offset:0 sc1
    buffer_load_dwordx4 v[64:67], v2, s[8:11], s5 offen offset:1024 sc1
    s_lshl_b32 s4, s23, 14
    s_add_u32 s4, s4, 236978176
    buffer_load_dword v64, v6, s[8:11], s4 offen sc1
    s_lshr_b32 s4, s31, 2
    s_add_u32 s4, s4, 237109248
    buffer_load_dwordx2 v[64:65], v3, s[8:11], s4 offen sc1
    s_lshl_b32 s4, s23, 14
    s_add_u32 s4, s4, 237240320
    buffer_load_dword v64, v6, s[8:11], s4 offen sc1
    s_lshr_b32 s4, s31, 2
    s_add_u32 s4, s4, 237371392
    buffer_load_dwordx2 v[64:65], v3, s[8:11], s4 offen sc1
    s_lshl_b32 s4, s23, 14
    s_add_u32 s4, s4, 237502464
    buffer_load_dword v64, v6, s[8:11], s4 offen sc1
    s_lshr_b32 s4, s31, 2
    s_add_u32 s4, s4, 237633536
    buffer_load_dwordx2 v[64:65], v3, s[8:11], s4 offen sc1
    s_lshl_b32 s4, s23, 14
    s_add_u32 s4, s4, 237764608
    buffer_load_dword v64, v6, s[8:11], s4 offen sc1
    s_lshr_b32 s4, s31, 2
    s_add_u32 s4, s4, 237895680
    buffer_load_dwordx2 v[64:65], v3, s[8:11], s4 offen sc1
    buffer_load_ubyte v64, v13, s[8:11], s3 offen sc1
    v_lshlrev_b32 v66, 21, v1
    s_mov_b32 s4, 20971392
    s_mov_b32 exec_hi, 0xffff
    buffer_load_dword v64, v66, s[8:11], s4 offen sc1
    s_mov_b32 exec_hi, -1
    s_load_dwordx2 s[48:49], s[0:1], 8
    s_mov_b32 s27, 400000
    v_lshlrev_b32 v41, 7, v1
    v_add_u32 v41, 64, v41
    s_mov_b64 exec, 3
L_c_w:
    buffer_load_dword v40, v41, s[16:19], 0 offen sc1
    s_sub_u32 s27, s27, 1
    s_cbranch_scc1 L_c_fail
    s_waitcnt vmcnt(0)
    v_readlane_b32 s4, v40, 0
    v_readlane_b32 s7, v40, 1
    s_cmp_lt_u32 s4, 68
    s_cbranch_scc1 L_c_w
    s_and_b32 s4, s7, 0xffff
    s_cmp_lt_u32 s4, 8
    s_cbranch_scc1 L_c_w
    s_mov_b64 exec, -1
    s_lshr_b32 s7, s7, 16
    s_cmp_ge_u32 s7, 4
    s_cselect_b32 s7, 8192, 0
    s_waitcnt lgkmcnt(0)
    s_mov_b32 s12, s48
    s_mov_b32 s13, s49
    s_mov_b32 s14, 0x4000
    s_mov_b32 s15, 0x00020000
    v_and_b32 v40, 7, v1
    v_lshlrev_b32 v40, 11, v40
    v_lshrrev_b32 v41, 4, v1
    v_lshl_add_u32 v40, v41, 3, v40
    s_lshl_b32 s4, s22, 6
    s_and_b32 s5, s21, 1
    s_lshl_b32 s5, s5, 5
    s_add_u32 s4, s4, s5
    buffer_load_dwordx2 v[48:49], v40, s[12:15], s4 offen
    s_add_u32 s101, s101, s7
    s_add_u32 s2, s2, s7
    s_lshr_b32 s4, s24, 1
    s_lshl_b32 s49, s4, 7
    s_add_u32 s49, s49, 243271680
    s_lshl_b32 s4, s4, 14
    s_and_b32 s6, s24, 1
    s_lshl_b32 s6, s6, 12
    s_add_u32 s4, s4, s6
    s_lshl_b32 s6, s21, 18
    s_add_u32 s6, s6, s4
    s_add_u32 s6, s6, 20971520
    s_lshl_b32 s4, s24, 14
    s_lshl_b32 s5, s21, 12
    s_add_u32 s47, s4, s5
    s_add_u32 s47, s47, 54517760
    s_cmp_lt_u32 s21, 2
    s_cselect_b32 s47, s6, s47
    s_add_u32 s47, s47, s7
    s_add_u32 s53, s5, 32768
    s_lshl_b32 s52, s25, 2
    s_add_u32 s52, s52, s21
    s_lshl_b32 s52, s52, 10
    s_lshr_b32 s5, s52, 1
    s_add_u32 s100, s4, s5
    s_add_u32 s100, s100, s7
    s_add_u32 s100, s100, 88080384
    s_lshl_b32 s54, s23, 14
    s_add_u32 s54, s54, 236978176
    s_add_u32 s4, s52, 32768
    v_add_u32 v1, s4, v2
    s_lshl_b32 s4, s25, 11
    s_sub_u32 s52, s52, s4
    v_mov_b32 v40, 0
L_c_kw0:
    buffer_load_dword v41, v40, s[8:11], s49 offen sc1
    s_sub_u32 s27, s27, 1
    s_cbranch_scc1 L_c_fail
    s_waitcnt vmcnt(0)
    v_and_b32 v41, 15, v41
    v_cmp_ne_u32 vcc, 8, v41
    s_cbranch_vccnz L_c_kw0
    s_mov_b32 m0, s53
    s_xor_b32 s53, s53, 49152
    buffer_load_dwordx4 v2, s[8:11], s47 offen offset:0 sc1 lds
    buffer_load_dwordx4 v2, s[8:11], s47 offen offset:1024 sc1 lds
    buffer_load_dwordx4 v2, s[8:11], s47 offen offset:2048 sc1 lds
    buffer_load_dwordx4 v2, s[8:11], s47 offen offset:3072 sc1 lds
    v_lshlrev_b32 v60, 16, v48
    v_and_b32 v61, 0xffff0000, v48
    v_lshlrev_b32 v62, 16, v49
    v_and_b32 v63, 0xffff0000, v49
    s_mov_b32 s14, 1048576
    s_mov_b32 s15, 0x00020000
    s_mov_b32 s26, 0
    s_mov_b32 s50, 0x3f803f80
    s_mov_b32 s51, 0x3f803f80
    s_and_b32 s4, s26, 3
    s_lshl_b32 s5, s4, 18
    s_add_u32 s42, s5, s54
    s_xor_b32 s44, s42, 524288
    s_lshr_b32 s20, s31, 2
    s_add_u32 s20, s20, s5
    s_add_u32 s20, s20, 237109248
    s_xor_b32 s24, s20, 2048
    s_lshl_b32 s5, s21, 10
    s_add_u32 s43, s42, s5
    s_lshr_b32 s55, s4, 1
    s_add_u32 s48, s26, 1
    s_and_b32 s4, s26, 1
    s_lshl_b32 s5, s4, 19
    s_add_u32 s40, s5, s101
    s_lshl_b32 s4, s4, 20
    s_add_u32 s4, s4, 234881024
    s_add_u32 s12, s8, s4
    s_addc_u32 s13, s9, 0
    s_add_u32 s4, s26, 0
    s_lshl_b32 s5, s4, 11
    s_and_b32 s5, s5, 8192
    s_xor_b32 s5, s5, s100
    s_lshl_b32 s4, s4, 19
    s_add_u32 s46, s4, s5
    s_add_u32 s4, s26, 1
    s_lshl_b32 s5, s4, 11
    s_and_b32 s5, s5, 8192
    s_xor_b32 s5, s5, s47
    s_lshl_b32 s4, s4, 19
    s_add_u32 s45, s4, s5
    s_waitcnt vmcnt(0)
    s_barrier
    s_cmp_ge_u32 s21, 2
    s_cbranch_scc1 L_c_idle3
    v_subrev_u32 v45, s52, v1
    v_xor_b32 v44, 2048, v45
    ds_read_b128 v[64:67], v45 offset:0
    ds_read_b128 v[68:71], v45 offset:1024
    ds_read_b128 v[72:75], v44 offset:0
    ds_read_b128 v[76:79], v44 offset:1024
    ds_read_b128 v[80:83], v45 offset:4096
    ds_read_b128 v[84:87], v45 offset:5120
    ds_read_b128 v[88:91], v44 offset:4096
    ds_read_b128 v[92:95], v44 offset:5120
    v_mov_b32 v19, s48
    v_mov_b64 v[28:29], 0
    v_mov_b64 v[30:31], 0
    v_mov_b64 v[32:33], 0
    v_mov_b64 v[34:35], 0
    v_mov_b64 v[36:37], 0
    v_mov_b64 v[38:39], 0
    v_mov_b64 v[40:41], s[28:29]
    buffer_store_dword v40, v6, s[8:11], s44 offen
    s_xor_b32 s4, s20, 524288
    buffer_store_dwordx2 v[40:41], v3, s[8:11], s4 offen
    s_mov_b32 s90, 0xff00ff00
    s_mov_b32 s91, 0xff00ff00
    v_cndmask_b32 v20, v60, v62, s[90:91]
    v_cndmask_b32 v21, v61, v63, s[90:91]
    v_cvt_pk_bf16_f32 v46, v20, v21
L_c_xok:
    buffer_store_dword v46, v6, s[8:11], s42 offen
    buffer_store_byte v19, v13, s[8:11], s3 offen
L_c_b0:
    s_barrier
    s_lshl_b32 m0, s21, 10
    s_mov_b32 s5, s43
L_c_b0x:
    s_barrier
    s_mov_b64 exec, -1
    buffer_load_dwordx4 v2, s[8:11], s5 offen sc1 lds
    s_add_u32 m0, m0, 4096
    s_add_u32 s5, s5, 4096
    buffer_load_dwordx4 v2, s[8:11], s5 offen sc1 lds
    s_add_u32 m0, m0, 4096
    s_add_u32 s5, s5, 4096
    buffer_load_dwordx4 v2, s[8:11], s5 offen sc1 lds
    s_add_u32 m0, m0, 4096
    s_add_u32 s5, s5, 4096
    buffer_load_dwordx4 v2, s[8:11], s5 offen sc1 lds
    s_mov_b32 m0, s53
    s_mov_b32 s33, s55
    s_waitcnt vmcnt(3) lgkmcnt(0)
L_c_b1:
    s_barrier
    ds_read_b128 v[40:43], v2 offset:0
    ds_read_b128 v[44:47], v2 offset:1024
    ds_read_b128 v[48:51], v2 offset:2048
    ds_read_b128 v[52:55], v2 offset:3072
    s_waitcnt lgkmcnt(3)
    v_smfmac_f32_16x16x64_bf16 v[28:31], v[40:43], a[0:7], v4
    v_smfmac_f32_16x16x64_bf16 v[32:35], v[40:43], a[128:135], v4
    buffer_load_dwordx4 v2, s[8:11], s45 offen offset:0 sc1 lds
    s_waitcnt lgkmcnt(2)
    v_smfmac_f32_16x16x64_bf16 v[28:31], v[44:47], a[8:15], v4
    s_waitcnt vmcnt(3)
    s_barrier
    ds_read_b128 v[56:59], v2 offset:4096
    ds_read_b128 v[60:63], v2 offset:5120
    ds_read_b128 v[40:43], v2 offset:6144
    v_smfmac_f32_16x16x64_bf16 v[32:35], v[44:47], a[136:143], v4
    buffer_load_dwordx4 v2, s[8:11], s45 offen offset:1024 sc1 lds
    s_waitcnt lgkmcnt(4)
    v_smfmac_f32_16x16x64_bf16 v[28:31], v[48:51], a[16:23], v4
    ds_read_b128 v[44:47], v2 offset:7168
    v_smfmac_f32_16x16x64_bf16 v[32:35], v[48:51], a[144:151], v4
    buffer_load_dwordx4 v2, s[8:11], s45 offen offset:2048 sc1 lds
    s_waitcnt lgkmcnt(4)
    v_smfmac_f32_16x16x64_bf16 v[28:31], v[52:55], a[24:31], v4
    s_waitcnt vmcnt(4)
    s_barrier
    ds_read_b128 v[48:51], v2 offset:8192
    v_smfmac_f32_16x16x64_bf16 v[32:35], v[52:55], a[152:159], v4
    s_waitcnt lgkmcnt(4)
    v_smfmac_f32_16x16x64_bf16 v[28:31], v[56:59], a[32:39], v4
    ds_read_b128 v[52:55], v2 offset:9216
    v_smfmac_f32_16x16x64_bf16 v[32:35], v[56:59], a[160:167], v4
    s_waitcnt lgkmcnt(4)
    v_smfmac_f32_16x16x64_bf16 v[28:31], v[60:63], a[40:47], v4
    ds_read_b128 v[56:59], v2 offset:10240
    v_smfmac_f32_16x16x64_bf16 v[32:35], v[60:63], a[168:175], v4
    s_waitcnt lgkmcnt(4)
    v_smfmac_f32_16x16x64_bf16 v[28:31], v[40:43], a[48:55], v4
    ds_read_b128 v[60:63], v2 offset:11264
    v_smfmac_f32_16x16x64_bf16 v[32:35], v[40:43], a[176:183], v4
    s_waitcnt lgkmcnt(4)
    v_smfmac_f32_16x16x64_bf16 v[28:31], v[44:47], a[56:63], v4
    s_waitcnt vmcnt(3)
    s_barrier
    ds_read_b128 v[40:43], v2 offset:12288
    v_smfmac_f32_16x16x64_bf16 v[32:35], v[44:47], a[184:191], v4
    s_waitcnt lgkmcnt(4)
    v_smfmac_f32_16x16x64_bf16 v[28:31], v[48:51], a[64:71], v4
    ds_read_b128 v[44:47], v2 offset:13312
    v_smfmac_f32_16x16x64_bf16 v[32:35], v[48:51], a[192:199], v4
    s_waitcnt lgkmcnt(4)
    v_smfmac_f32_16x16x64_bf16 v[28:31], v[52:55], a[72:79], v4
    ds_read_b128 v[48:51], v2 offset:14336
    v_smfmac_f32_16x16x64_bf16 v[32:35], v[52:55], a[200:207], v4
    s_waitcnt lgkmcnt(4)
    v_smfmac_f32_16x16x64_bf16 v[28:31], v[56:59], a[80:87], v4
    ds_read_b128 v[52:55], v2 offset:15360
    v_smfmac_f32_16x16x64_bf16 v[32:35], v[56:59], a[208:215], v4
    s_waitcnt lgkmcnt(4)
    v_smfmac_f32_16x16x64_bf16 v[28:31], v[60:63], a[88:95], v4
    s_waitcnt lgkmcnt(3)
    v_smfmac_f32_16x16x64_bf16 v[28:31], v[40:43], a[96:103], v4
    s_waitcnt lgkmcnt(2)
    v_smfmac_f32_16x16x64_bf16 v[28:31], v[44:47], a[104:111], v4
    s_waitcnt lgkmcnt(1)
    v_smfmac_f32_16x16x64_bf16 v[28:31], v[48:51], a[112:119], v4
    s_waitcnt lgkmcnt(0)
    v_smfmac_f32_16x16x64_bf16 v[28:31], v[52:55], a[120:127], v4
    v_smfmac_f32_16x16x64_bf16 v[32:35], v[60:63], a[216:223], v4
    ds_read_b128 v[56:59], v2 offset:0
    s_nop 0
    v_smfmac_f32_16x16x64_bf16 v[32:35], v[40:43], a[224:231], v4
    s_nop 1
    v_smfmac_f32_16x16x64_bf16 v[32:35], v[44:47], a[232:239], v4
    s_nop 0
    v_permlane32_swap_b32 v28, v30
    v_smfmac_f32_16x16x64_bf16 v[32:35], v[48:51], a[240:247], v4
    v_permlane32_swap_b32 v29, v31
    v_smfmac_f32_16x16x64_bf16 v[32:35], v[52:55], a[248:255], v4
    v_add_f32 v28, v28, v30
    v_add_f32 v29, v29, v31
    v_smfmac_f32_16x16x64_bf16 v[36:39], v[60:63], v[216:223], v4
    v_cmp_u_f32 vcc, v28, v29
    v_cvt_pk_bf16_f32 v15, v28, v29
    ds_read_b128 v[60:63], v2 offset:1024
    v_mov_b64 v[16:17], s[28:29]
    s_nop 0
    v_permlane32_swap_b32 v32, v34
    v_permlane32_swap_b32 v33, v35
    v_pk_add_f32 v[32:33], v[32:33], v[34:35]
    v_cvt_pk_bf16_f32 v14, v32, v33
    s_cbranch_vccnz L_c_nanq
L_c_qok:
    buffer_store_dwordx2 v[14:15], v3, s[8:11], s20 offen
    ds_write_b64 v10, v[14:15]
    v_smfmac_f32_16x16x64_bf16 v[36:39], v[40:43], v[224:231], v4
    ds_read_b128 v[40:43], v2 offset:2048
    v_smfmac_f32_16x16x64_bf16 v[36:39], v[44:47], v[232:239], v4
    ds_read_b128 v[44:47], v2 offset:3072
    v_smfmac_f32_16x16x64_bf16 v[36:39], v[48:51], v[240:247], v4
    ds_read_b128 v[48:51], v2 offset:4096
    v_smfmac_f32_16x16x64_bf16 v[36:39], v[52:55], v[248:255], v4
    ds_read_b128 v[52:55], v2 offset:5120
    s_waitcnt lgkmcnt(5)
    v_smfmac_f32_16x16x64_bf16 v[36:39], v[56:59], v[128:135], v4
    ds_read_b128 v[56:59], v2 offset:6144
    v_smfmac_f32_16x16x64_bf16 v[36:39], v[60:63], v[136:143], v4
    ds_read_b128 v[60:63], v2 offset:7168
    buffer_load_dwordx2 v[28:29], v3, s[8:11], s24 offen sc1
    s_waitcnt lgkmcnt(4)
    v_smfmac_f32_16x16x64_bf16 v[36:39], v[40:43], v[144:151], v4
    ds_read_b128 v[40:43], v2 offset:8192
    v_smfmac_f32_16x16x64_bf16 v[36:39], v[44:47], v[152:159], v4
    ds_read_b128 v[44:47], v2 offset:9216
    s_waitcnt lgkmcnt(4)
    v_smfmac_f32_16x16x64_bf16 v[36:39], v[48:51], v[160:167], v4
    ds_read_b128 v[48:51], v2 offset:10240
    v_smfmac_f32_16x16x64_bf16 v[36:39], v[52:55], v[168:175], v4
    s_barrier
    buffer_load_dwordx2 v[30:31], v3, s[8:11], s24 offen sc1
    s_waitcnt lgkmcnt(3)
    v_smfmac_f32_16x16x64_bf16 v[36:39], v[56:59], v[176:183], v4
    ds_read_b64_tr_b16 v[32:33], v3 offset:49152
    ds_read_b64_tr_b16 v[34:35], v3 offset:49664
    v_smfmac_f32_16x16x64_bf16 v[36:39], v[60:63], v[184:191], v4
    ds_read_b64_tr_b16 v[20:21], v3 offset:50176
    ds_read_b64_tr_b16 v[22:23], v3 offset:50688
    s_waitcnt lgkmcnt(5)
    v_smfmac_f32_16x16x64_bf16 v[36:39], v[40:43], v[192:199], v4
    v_smfmac_f32_16x16x64_bf16 v[36:39], v[44:47], v[200:207], v4
    buffer_load_dwordx2 v[16:17], v3, s[8:11], s24 offen sc1
    s_waitcnt lgkmcnt(4)
    v_smfmac_f32_16x16x64_bf16 v[36:39], v[48:51], v[208:215], v4
    s_waitcnt lgkmcnt(2)
    v_mfma_f32_16x16x32_bf16 v[52:55], v[32:35], v[32:35], 0
    v_xor_b32 v60, 4096, v1
    v_mfma_f32_16x16x32_bf16 v[48:51], v[64:67], v[32:35], 0
    buffer_load_dwordx2 v[16:17], v3, s[8:11], s24 offen sc1
    v_mfma_f32_16x16x32_bf16 v[56:59], v[80:83], v[32:35], 0
    s_waitcnt vmcnt(3)
    ds_write_b64 v11, v[28:29]
    v_cmp_eq_u32 vcc, s28, v28
    v_cmp_eq_u32 s[4:5], s28, v29
    s_or_b64 vcc, vcc, s[4:5]
    s_cbranch_vccnz L_c_qretry
L_c_qgot:
    s_waitcnt lgkmcnt(1)
    v_mfma_f32_16x16x32_bf16 v[52:55], v[20:23], v[20:23], v[52:55]
    v_mfma_f32_16x16x32_bf16 v[48:51], v[68:71], v[20:23], v[48:51]
    v_mfma_f32_16x16x32_bf16 v[56:59], v[84:87], v[20:23], v[56:59]
    v_permlane32_swap_b32 v36, v38
    v_permlane32_swap_b32 v37, v39
    v_pk_add_f32 v[36:37], v[36:37], v[38:39]
    v_cvt_pk_bf16_f32 v18, v36, v37
    buffer_store_dwordx2 v[18:19], v3, s[12:15], s31 offen offset:1024
    s_waitcnt lgkmcnt(0)
    s_barrier
    ds_read_b64_tr_b16 v[40:41], v3 offset:51200
    ds_read_b64_tr_b16 v[42:43], v3 offset:51712
    ds_read_b64_tr_b16 v[44:45], v3 offset:52224
    ds_read_b64_tr_b16 v[46:47], v3 offset:52736
    s_cmp_eq_u32 s26, 63
    v_mov_b32 v15, v18
    v_mov_b64 v[36:37], v[18:19]
    s_waitcnt lgkmcnt(2)
    v_mfma_f32_16x16x32_bf16 v[52:55], v[40:43], v[40:43], v[52:55]
    v_mov_b64 v[20:21], s[50:51]
    v_mfma_f32_16x16x32_bf16 v[48:51], v[72:75], v[40:43], v[48:51]
    v_mov_b64 v[22:23], s[50:51]
    v_mfma_f32_16x16x32_bf16 v[56:59], v[88:91], v[40:43], v[56:59]
    s_waitcnt lgkmcnt(0)
    v_mfma_f32_16x16x32_bf16 v[52:55], v[44:47], v[44:47], v[52:55]
    ds_read_b128 v[40:43], v1 offset:8192
    v_mfma_f32_16x16x32_bf16 v[48:51], v[76:79], v[44:47], v[48:51]
    v_mfma_f32_16x16x32_bf16 v[56:59], v[92:95], v[44:47], v[56:59]
    s_cbranch_scc1 L_c_last
    ds_read_b128 v[44:47], v60 offset:8192
    ds_read_b128 v[64:67], v5 offset:0
    ds_read_b128 v[68:71], v5 offset:1024
    s_waitcnt vmcnt(3)
    v_mov_b32 v29, 0
    v_mov_b64 v[30:31], 0
    v_max3_f32 v61, v52, v53, v48
    v_max3_f32 v62, v49, v50, v51
    v_max3_f32 v61, v56, v57, v61
    v_max3_f32 v62, v58, v59, v62
    v_max_f32 v61, v61, v62
    v_mov_b32 v62, v61
    ds_read_b128 v[72:75], v5 offset:2048
    ds_read_b128 v[76:79], v5 offset:3072
    v_permlane32_swap_b32 v61, v62
    v_max_f32 v61, v61, v62
    v_mov_b32 v62, v61
    buffer_load_dwordx2 v[38:39], v3, s[12:15], s32 offen offset:1024 sc1
    s_nop 0
    v_permlane16_swap_b32 v61, v62
    v_max_f32 v61, v61, v62
    v_mul_f32 v61, s30, v61
    v_fma_f32 v48, v48, s30, -v61
    v_fma_f32 v49, v49, s30, -v61
    v_fma_f32 v50, v50, s30, -v61
    v_fma_f32 v51, v51, s30, -v61
    v_fma_f32 v56, v56, s30, -v61
    v_fma_f32 v57, v57, s30, -v61
    v_fma_f32 v58, v58, s30, -v61
    v_fma_f32 v59, v59, s30, -v61
    v_exp_f32 v48, v48
    v_exp_f32 v49, v49
    v_exp_f32 v50, v50
    v_exp_f32 v51, v51
    v_exp_f32 v56, v56
    v_exp_f32 v57, v57
    v_exp_f32 v58, v58
    v_exp_f32 v59, v59
    v_fma_f32 v52, v52, s30, -v61
    v_cvt_pk_bf16_f32 v32, v48, v49
    v_cvt_pk_bf16_f32 v33, v50, v51
    v_cvt_pk_bf16_f32 v34, v56, v57
    v_cvt_pk_bf16_f32 v35, v58, v59
    v_fma_f32 v53, v53, s30, -v61
    s_waitcnt lgkmcnt(4)
    v_mfma_f32_16x16x32_bf16 v[60:63], v[20:23], v[32:35], 0
    v_exp_f32 v52, v52
    v_mfma_f32_16x16x32_bf16 v[56:59], v[40:43], v[32:35], 0
    v_exp_f32 v53, v53
    v_mfma_f32_16x16x32_bf16 v[48:51], v[44:47], v[32:35], 0
    buffer_load_dwordx2 v[16:17], v3, s[12:15], s32 offen offset:1024 sc1
    v_cvt_pk_bf16_f32 v28, v52, v53
    s_waitcnt vmcnt(1)
    v_cmp_ne_u32 vcc, s48, v39
    v_mfma_f32_16x16x32_bf16 v[60:63], v[20:23], v[28:31], v[60:63]
    s_cbranch_vccnz L_c_vretry
L_c_vok:
    v_mfma_f32_16x16x32_bf16 v[56:59], v[36:39], v[28:31], v[56:59]
    v_mfma_f32_16x16x32_bf16 v[48:51], v[38:41], v[28:31], v[48:51]
    ds_read_b128 v[80:83], v5 offset:4096
    ds_read_b128 v[84:87], v5 offset:5120
    v_mov_b64 v[20:21], 0
    v_mov_b64 v[22:23], 0
    v_xor_b32 v1, 49152, v1
    v_rcp_f32 v52, v60
    v_mov_b64 v[28:29], 0
    v_pk_mul_f32 v[56:57], v[56:57], v[52:53] op_sel_hi:[1,0]
    v_pk_mul_f32 v[58:59], v[58:59], v[52:53] op_sel_hi:[1,0]
    v_pk_mul_f32 v[48:49], v[48:49], v[52:53] op_sel_hi:[1,0]
    v_pk_mul_f32 v[50:51], v[50:51], v[52:53] op_sel_hi:[1,0]
    v_cvt_pk_bf16_f32 v44, v56, v57
    v_cvt_pk_bf16_f32 v45, v58, v59
    v_cvt_pk_bf16_f32 v46, v48, v49
    v_cvt_pk_bf16_f32 v47, v50, v51
    ds_write_b128 v12, v[44:47]
    ds_read_b128 v[88:91], v5 offset:6144
    ds_read_b128 v[92:95], v5 offset:7168
    ds_read_b128 v[56:59], v5 offset:8192
    ds_read_b128 v[60:63], v5 offset:9216
    buffer_store_dwordx2 v[14:15], v3, s[8:11], s46 offen sc1
    v_mov_b64 v[32:33], 0
    v_mov_b64 v[34:35], 0
    v_mov_b64 v[38:39], 0
    v_mov_b64 v[36:37], 0
    s_waitcnt lgkmcnt(4)
    s_barrier
    ds_read_b128 v[40:43], v0 offset:0
    ds_read_b128 v[44:47], v0 offset:512
    ds_read_b128 v[48:51], v0 offset:1024
    ds_read_b128 v[52:55], v0 offset:1536
    buffer_load_dwordx4 v2, s[8:11], s45 offen offset:3072 sc1 lds
    s_xor_b32 s53, s53, 49152
    s_add_u32 s26, s26, 1
    s_waitcnt lgkmcnt(3)
    v_smfmac_f32_16x16x64_bf16 v[20:23], v[40:43], v[64:71], v4
    ds_read_b128 v[64:67], v5 offset:10240
    ds_read_b128 v[68:71], v5 offset:11264
    s_waitcnt lgkmcnt(4)
    v_smfmac_f32_16x16x64_bf16 v[20:23], v[44:47], v[72:79], v4
    ds_read_b128 v[72:75], v5 offset:12288
    ds_read_b128 v[76:79], v5 offset:13312
    s_waitcnt lgkmcnt(5)
    v_smfmac_f32_16x16x64_bf16 v[20:23], v[48:51], v[80:87], v4
    ds_read_b128 v[80:83], v5 offset:14336
    ds_read_b128 v[84:87], v5 offset:15360
    s_waitcnt lgkmcnt(6)
    v_smfmac_f32_16x16x64_bf16 v[20:23], v[52:55], v[88:95], v4
    ds_read_b128 v[88:91], v5 offset:16384
    ds_read_b128 v[92:95], v5 offset:17408
    v_smfmac_f32_16x16x64_bf16 v[32:35], v[40:43], v[56:63], v4
    ds_read_b128 v[56:59], v5 offset:18432
    ds_read_b128 v[60:63], v5 offset:19456
    v_smfmac_f32_16x16x64_bf16 v[36:39], v[40:43], v[96:103], v4
    v_smfmac_f32_16x16x64_bf16 v[36:39], v[44:47], v[104:111], v4
    v_smfmac_f32_16x16x64_bf16 v[36:39], v[48:51], v[112:119], v4
    v_smfmac_f32_16x16x64_bf16 v[36:39], v[52:55], v[120:127], v4
    v_cvt_pk_bf16_f32 v20, v20, v21
    v_cvt_pk_bf16_f32 v21, v22, v23
    v_and_or_b32 v20, v20, -2, s33
    buffer_store_dwordx2 v[20:21], v7, s[12:15], s34 offen
    s_waitcnt lgkmcnt(8)
    v_smfmac_f32_16x16x64_bf16 v[32:35], v[44:47], v[64:71], v4
    ds_read_b128 v[64:67], v5 offset:20480
    ds_read_b128 v[68:71], v5 offset:21504
    s_waitcnt lgkmcnt(8)
    v_smfmac_f32_16x16x64_bf16 v[32:35], v[48:51], v[72:79], v4
    ds_read_b128 v[72:75], v5 offset:22528
    ds_read_b128 v[76:79], v5 offset:23552
    v_cvt_pk_bf16_f32 v36, v36, v37
    v_cvt_pk_bf16_f32 v37, v38, v39
    v_and_or_b32 v36, v36, -2, s33
    buffer_store_dwordx2 v[36:37], v7, s[12:15], s37 offen
    s_waitcnt lgkmcnt(8)
    v_smfmac_f32_16x16x64_bf16 v[32:35], v[52:55], v[80:87], v4
    s_waitcnt lgkmcnt(6)
    v_smfmac_f32_16x16x64_bf16 v[28:31], v[40:43], v[88:95], v4
    s_waitcnt lgkmcnt(4)
    v_smfmac_f32_16x16x64_bf16 v[28:31], v[44:47], v[56:63], v4
    s_waitcnt lgkmcnt(2)
    v_smfmac_f32_16x16x64_bf16 v[28:31], v[48:51], v[64:71], v4
    s_waitcnt lgkmcnt(0)
    v_smfmac_f32_16x16x64_bf16 v[28:31], v[52:55], v[72:79], v4
    s_cmp_ge_u32 s21, 2
    v_cvt_pk_bf16_f32 v32, v32, v33
    v_cvt_pk_bf16_f32 v33, v34, v35
    v_and_or_b32 v32, v32, -2, s33
    buffer_store_dwordx2 v[32:33], v7, s[12:15], s35 offen
    s_nop 2
    v_cvt_pk_bf16_f32 v28, v28, v29
    v_cvt_pk_bf16_f32 v29, v30, v31
    v_and_or_b32 v28, v28, -2, s33
    buffer_store_dwordx2 v[28:29], v7, s[12:15], s36 offen
    s_cbranch_scc1 L_c_idle
    v_mov_b64 v[58:59], 0
    v_mov_b64 v[56:57], 0
    v_mov_b64 v[54:55], 0
    s_xor_b32 s41, s40, 262144
    s_nop 15
    s_nop 15
    s_nop 3
    buffer_load_dwordx4 v[64:67], v8, s[12:15], s38 offen offset:0 sc1
    buffer_load_dwordx4 v[68:71], v8, s[12:15], s38 offen offset:2048 sc1
    buffer_load_dwordx4 v[72:75], v8, s[12:15], s39 offen offset:0 sc1
    buffer_load_dwordx4 v[76:79], v8, s[12:15], s39 offen offset:2048 sc1
    s_nop 15
    s_nop 15
    s_nop 4
    buffer_load_dwordx4 v[80:83], v8, s[12:15], s38 offen offset:0 sc1
    buffer_load_dwordx4 v[84:87], v8, s[12:15], s38 offen offset:2048 sc1
    buffer_load_dwordx4 v[88:91], v8, s[12:15], s39 offen offset:0 sc1
    buffer_load_dwordx4 v[92:95], v8, s[12:15], s39 offen offset:2048 sc1
    s_waitcnt vmcnt(7)
    v_mfma_f32_16x16x32_bf16 v[60:63], v[64:67], v[24:27], 0
    v_bitop3_b32 v40, v64, v66, s33 bitop3:0x7e
    s_waitcnt vmcnt(6)
    v_mfma_f32_16x16x32_bf16 v[60:63], v[68:71], v[24:27], v[60:63]
    v_bitop3_b32 v41, v68, v70, s33 bitop3:0x7e
    s_waitcnt vmcnt(5)
    v_mfma_f32_16x16x32_bf16 v[60:63], v[72:75], v[24:27], v[60:63]
    v_bitop3_b32 v42, v72, v74, s33 bitop3:0x7e
    v_or3_b32 v40, v40, v41, v42
    s_waitcnt vmcnt(4)
    v_mfma_f32_16x16x32_bf16 v[60:63], v[76:79], v[24:27], v[60:63]
    v_bitop3_b32 v43, v76, v78, s33 bitop3:0x7e
    v_or_b32 v40, v40, v43
    v_and_b32 v40, 1, v40
    v_cmp_ne_u32 vcc, 0, v40
    s_nop 2
    s_cbranch_vccnz L_c_r1
L_c_rok:
    v_cndmask_b32 v20, v60, v62, s[90:91]
    v_cndmask_b32 v21, v61, v63, s[90:91]
    v_cvt_pk_bf16_f32 v22, v20, v21
    v_and_or_b32 v22, v22, -2, s33
    buffer_store_dword v22, v9, s[8:11], s40 offen sc1
    s_and_b32 s4, s26, 3
    s_lshl_b32 s5, s4, 18
    s_add_u32 s42, s5, s54
    s_xor_b32 s44, s42, 524288
    s_lshr_b32 s20, s31, 2
    s_add_u32 s20, s20, s5
    s_add_u32 s20, s20, 237109248
    s_xor_b32 s24, s20, 2048
    s_lshl_b32 s5, s21, 10
    s_add_u32 s43, s42, s5
    s_lshr_b32 s55, s4, 1
    s_add_u32 s48, s26, 1
    s_and_b32 s4, s26, 1
    s_lshl_b32 s5, s4, 19
    buffer_atomic_add v58, v9, s[8:11], s41 offen sc0
    s_add_u32 s40, s5, s101
    s_lshl_b32 s4, s4, 20
    s_add_u32 s4, s4, 234881024
    s_add_u32 s12, s8, s4
    s_addc_u32 s13, s9, 0
    s_add_u32 s4, s26, 0
    s_lshl_b32 s5, s4, 11
    s_and_b32 s5, s5, 8192
    s_xor_b32 s5, s5, s100
    s_lshl_b32 s4, s4, 19
    s_add_u32 s46, s4, s5
    s_add_u32 s4, s26, 1
    s_lshl_b32 s5, s4, 11
    s_and_b32 s5, s5, 8192
    s_xor_b32 s5, s5, s47
    s_lshl_b32 s4, s4, 19
    s_add_u32 s45, s4, s5
    s_waitcnt vmcnt(2)
    s_barrier
    v_subrev_u32 v45, s52, v1
    v_xor_b32 v44, 2048, v45
    ds_read_b128 v[64:67], v45 offset:0
    ds_read_b128 v[68:71], v45 offset:1024
    ds_read_b128 v[72:75], v44 offset:0
    ds_read_b128 v[76:79], v44 offset:1024
    buffer_atomic_add v56, v9, s[8:11], s41 offen sc0
    ds_read_b128 v[80:83], v45 offset:4096
    ds_read_b128 v[84:87], v45 offset:5120
    ds_read_b128 v[88:91], v44 offset:4096
    ds_read_b128 v[92:95], v44 offset:5120
    v_mov_b32 v19, s48
    v_mov_b64 v[28:29], 0
    v_mov_b64 v[30:31], 0
    v_mov_b64 v[32:33], 0
    v_mov_b64 v[34:35], 0
    v_mov_b64 v[36:37], 0
    v_mov_b64 v[38:39], 0
    v_mov_b64 v[40:41], s[28:29]
    buffer_store_dword v40, v6, s[8:11], s44 offen
    s_xor_b32 s4, s20, 524288
    buffer_store_dwordx2 v[40:41], v3, s[8:11], s4 offen
    s_nop 15
    s_nop 4
    buffer_atomic_add v54, v9, s[8:11], s41 offen sc0
    s_waitcnt vmcnt(4)
    v_and_b32 v42, 1, v58
    v_cmp_ne_u32 vcc, s33, v42
    v_and_b32 v59, 0xffff0000, v58
    v_lshlrev_b32 v58, 16, v58
    v_pk_add_f32 v[48:49], v[20:21], v[58:59]
    v_cvt_pk_bf16_f32 v46, v48, v49
    s_cbranch_vccz L_c_xok
    s_waitcnt vmcnt(3)
    v_and_b32 v42, 1, v56
    v_cmp_ne_u32 vcc, s33, v42
    v_and_b32 v57, 0xffff0000, v56
    v_lshlrev_b32 v56, 16, v56
    v_pk_add_f32 v[48:49], v[20:21], v[56:57]
    v_cvt_pk_bf16_f32 v46, v48, v49
    s_cbranch_vccz L_c_xok
    v_mov_b64 v[56:57], 0
    buffer_atomic_add v56, v9, s[8:11], s41 offen sc0
    s_waitcnt vmcnt(1)
    v_and_b32 v42, 1, v54
    v_cmp_ne_u32 vcc, s33, v42
    v_and_b32 v55, 0xffff0000, v54
    v_lshlrev_b32 v54, 16, v54
    v_pk_add_f32 v[48:49], v[20:21], v[54:55]
    v_cvt_pk_bf16_f32 v46, v48, v49
    s_cbranch_vccz L_c_xok
    v_mov_b64 v[54:55], 0
    buffer_atomic_add v54, v9, s[8:11], s41 offen sc0
L_c_xl:
    s_waitcnt vmcnt(1)
    v_and_b32 v42, 1, v56
    v_cmp_ne_u32 vcc, s33, v42
    v_and_b32 v57, 0xffff0000, v56
    v_lshlrev_b32 v56, 16, v56
    v_pk_add_f32 v[48:49], v[20:21], v[56:57]
    v_cvt_pk_bf16_f32 v46, v48, v49
    s_cbranch_vccz L_c_xok
    v_mov_b64 v[56:57], 0
    buffer_atomic_add v56, v9, s[8:11], s41 offen sc0
    s_waitcnt vmcnt(1)
    v_and_b32 v42, 1, v54
    v_cmp_ne_u32 vcc, s33, v42
    v_and_b32 v55, 0xffff0000, v54
    v_lshlrev_b32 v54, 16, v54
    v_pk_add_f32 v[48:49], v[20:21], v[54:55]
    v_cvt_pk_bf16_f32 v46, v48, v49
    s_cbranch_vccz L_c_xok
    v_mov_b64 v[54:55], 0
    buffer_atomic_add v54, v9, s[8:11], s41 offen sc0
    s_sub_u32 s27, s27, 1
    s_cbranch_scc0 L_c_xl
    s_branch L_c_fail
L_c_r1:
    buffer_load_dwordx4 v[64:67], v8, s[12:15], s38 offen offset:0 sc1
    buffer_load_dwordx4 v[68:71], v8, s[12:15], s38 offen offset:2048 sc1
    buffer_load_dwordx4 v[72:75], v8, s[12:15], s39 offen offset:0 sc1
    buffer_load_dwordx4 v[76:79], v8, s[12:15], s39 offen offset:2048 sc1
    s_waitcnt vmcnt(7)
    v_mfma_f32_16x16x32_bf16 v[60:63], v[80:83], v[24:27], 0
    v_bitop3_b32 v40, v80, v82, s33 bitop3:0x7e
    s_waitcnt vmcnt(6)
    v_mfma_f32_16x16x32_bf16 v[60:63], v[84:87], v[24:27], v[60:63]
    v_bitop3_b32 v41, v84, v86, s33 bitop3:0x7e
    s_waitcnt vmcnt(5)
    v_mfma_f32_16x16x32_bf16 v[60:63], v[88:91], v[24:27], v[60:63]
    v_bitop3_b32 v42, v88, v90, s33 bitop3:0x7e
    v_or3_b32 v40, v40, v41, v42
    s_waitcnt vmcnt(4)
    v_mfma_f32_16x16x32_bf16 v[60:63], v[92:95], v[24:27], v[60:63]
    v_bitop3_b32 v43, v92, v94, s33 bitop3:0x7e
    v_or_b32 v40, v40, v43
    v_and_b32 v40, 1, v40
    v_cmp_ne_u32 vcc, 0, v40
    s_nop 2
    s_cbranch_vccz L_c_rok
    buffer_load_dwordx4 v[80:83], v8, s[12:15], s38 offen offset:0 sc1
    buffer_load_dwordx4 v[84:87], v8, s[12:15], s38 offen offset:2048 sc1
    buffer_load_dwordx4 v[88:91], v8, s[12:15], s39 offen offset:0 sc1
    buffer_load_dwordx4 v[92:95], v8, s[12:15], s39 offen offset:2048 sc1
    s_waitcnt vmcnt(7)
    v_mfma_f32_16x16x32_bf16 v[60:63], v[64:67], v[24:27], 0
    v_bitop3_b32 v40, v64, v66, s33 bitop3:0x7e
    s_waitcnt vmcnt(6)
    v_mfma_f32_16x16x32_bf16 v[60:63], v[68:71], v[24:27], v[60:63]
    v_bitop3_b32 v41, v68, v70, s33 bitop3:0x7e
    s_waitcnt vmcnt(5)
    v_mfma_f32_16x16x32_bf16 v[60:63], v[72:75], v[24:27], v[60:63]
    v_bitop3_b32 v42, v72, v74, s33 bitop3:0x7e
    v_or3_b32 v40, v40, v41, v42
    s_waitcnt vmcnt(4)
    v_mfma_f32_16x16x32_bf16 v[60:63], v[76:79], v[24:27], v[60:63]
    v_bitop3_b32 v43, v76, v78, s33 bitop3:0x7e
    v_or_b32 v40, v40, v43
    v_and_b32 v40, 1, v40
    v_cmp_ne_u32 vcc, 0, v40
    s_nop 2
    s_cbranch_vccz L_c_rok
    s_sub_u32 s27, s27, 1
    s_cbranch_scc0 L_c_r1
    s_branch L_c_fail
L_c_idle:
    s_and_b32 s4, s26, 3
    s_lshl_b32 s5, s4, 18
    s_add_u32 s42, s5, s54
    s_xor_b32 s44, s42, 524288
    s_lshr_b32 s20, s31, 2
    s_add_u32 s20, s20, s5
    s_add_u32 s20, s20, 237109248
    s_xor_b32 s24, s20, 2048
    s_lshl_b32 s5, s21, 10
    s_add_u32 s43, s42, s5
    s_lshr_b32 s55, s4, 1
    s_add_u32 s48, s26, 1
    s_and_b32 s4, s26, 1
    s_lshl_b32 s5, s4, 19
    s_add_u32 s40, s5, s101
    s_lshl_b32 s4, s4, 20
    s_add_u32 s4, s4, 234881024
    s_add_u32 s12, s8, s4
    s_addc_u32 s13, s9, 0
    s_add_u32 s4, s26, 0
    s_lshl_b32 s5, s4, 11
    s_and_b32 s5, s5, 8192
    s_xor_b32 s5, s5, s100
    s_lshl_b32 s4, s4, 19
    s_add_u32 s46, s4, s5
    s_add_u32 s4, s26, 1
    s_lshl_b32 s5, s4, 11
    s_and_b32 s5, s5, 8192
    s_xor_b32 s5, s5, s47
    s_lshl_b32 s4, s4, 19
    s_add_u32 s45, s4, s5
    s_waitcnt vmcnt(0)
    s_barrier
    s_cmp_lg_u32 s21, 3
    s_cbranch_scc1 L_c_idle3
    v_mov_b32 v40, 0
    v_mov_b32 v41, s26
    s_mov_b64 exec, 1
    buffer_store_dword v41, v40, s[8:11], s2 offen sc1
    s_mov_b64 exec, -1
    s_add_u32 s5, s26, 1
    s_and_b32 s4, s5, 7
    s_cbranch_scc1 L_c_idle3
    s_cmp_ge_u32 s5, 64
    s_cbranch_scc1 L_c_idle3
    s_lshl_b32 s4, s5, 8
    s_add_u32 s4, s4, s49
    v_mov_b32 v40, 0
L_c_kwn:
    buffer_load_dword v41, v40, s[8:11], s4 offen sc1
    s_sub_u32 s27, s27, 1
    s_cbranch_scc1 L_c_fail
    s_waitcnt vmcnt(0)
    v_and_b32 v41, 15, v41
    v_cmp_ne_u32 vcc, 8, v41
    s_cbranch_vccnz L_c_kwn
L_c_idle3:
    v_subrev_u32 v45, s52, v1
    v_xor_b32 v44, 2048, v45
    ds_read_b128 v[64:67], v45 offset:0
    ds_read_b128 v[68:71], v45 offset:1024
    ds_read_b128 v[72:75], v44 offset:0
    ds_read_b128 v[76:79], v44 offset:1024
    ds_read_b128 v[80:83], v45 offset:4096
    ds_read_b128 v[84:87], v45 offset:5120
    ds_read_b128 v[88:91], v44 offset:4096
    ds_read_b128 v[92:95], v44 offset:5120
    v_mov_b32 v19, s48
    v_mov_b64 v[28:29], 0
    v_mov_b64 v[30:31], 0
    v_mov_b64 v[32:33], 0
    v_mov_b64 v[34:35], 0
    v_mov_b64 v[36:37], 0
    v_mov_b64 v[38:39], 0
    v_mov_b64 v[40:41], s[28:29]
    s_xor_b32 s4, s20, 524288
    buffer_store_dwordx2 v[40:41], v3, s[8:11], s4 offen
    s_cmp_lg_u32 s21, 2
    s_cbranch_scc1 L_c_b0
    s_lshl_b32 m0, s21, 10
    s_mov_b32 s5, s43
    v_mov_b32 v46, 0
    s_mul_i32 s6, s48, 0x01010101
    s_mov_b64 exec, 0xffff
    s_barrier
L_c_fp:
    s_waitcnt vmcnt(24)
    buffer_load_dword v46, v13, s[8:11], s3 offen sc1
    v_cmp_ne_u32 vcc, s6, v46
    s_cbranch_vccz L_c_b0x
    buffer_load_dword v46, v13, s[8:11], s3 offen sc1
    v_cmp_ne_u32 vcc, s6, v46
    s_cbranch_vccz L_c_b0x
    s_sub_u32 s27, s27, 1
    s_cbranch_scc0 L_c_fp
    s_branch L_c_fail
L_c_qretry:
    s_waitcnt vmcnt(2)
    ds_write_b64 v11, v[30:31]
    v_cmp_eq_u32 vcc, s28, v30
    v_cmp_eq_u32 s[4:5], s28, v31
    s_or_b64 vcc, vcc, s[4:5]
    s_cbranch_vccz L_c_qgot
L_c_qr1:
    buffer_load_dwordx2 v[16:17], v3, s[8:11], s24 offen sc1
    s_waitcnt vmcnt(24)
    v_cmp_eq_u32 vcc, s28, v16
    v_cmp_eq_u32 s[4:5], s28, v17
    s_or_b64 vcc, vcc, s[4:5]
    s_cbranch_vccz L_c_qr2
    s_sub_u32 s27, s27, 1
    s_cbranch_scc0 L_c_qr1
    s_branch L_c_fail
L_c_qr2:
    ds_write_b64 v11, v[16:17]
    s_branch L_c_qgot
L_c_vretry:
    s_waitcnt vmcnt(0)
    v_mov_b64 v[38:39], v[16:17]
    v_cmp_ne_u32 vcc, s48, v17
    s_cbranch_vccz L_c_vok
L_c_vr2:
    buffer_load_dwordx2 v[38:39], v3, s[12:15], s32 offen offset:1024 sc1
    s_sub_u32 s27, s27, 1
    s_cbranch_scc1 L_c_fail
    s_waitcnt vmcnt(0)
    v_cmp_ne_u32 vcc, s48, v39
    s_cbranch_vccnz L_c_vr2
    s_branch L_c_vok
L_c_nanq:
    v_mov_b32 v34, -1
    ds_read_b128 v[20:23], v2 offset:0
    s_waitcnt lgkmcnt(0)
    v_xor_b32 v20, s28, v20
    v_xor_b32 v21, s28, v21
    v_xor_b32 v22, s28, v22
    v_xor_b32 v23, s28, v23
    v_min3_u32 v34, v20, v21, v34
    v_min3_u32 v34, v22, v23, v34
    ds_read_b128 v[20:23], v2 offset:1024
    s_waitcnt lgkmcnt(0)
    v_xor_b32 v20, s28, v20
    v_xor_b32 v21, s28, v21
    v_xor_b32 v22, s28, v22
    v_xor_b32 v23, s28, v23
    v_min3_u32 v34, v20, v21, v34
    v_min3_u32 v34, v22, v23, v34
    ds_read_b128 v[20:23], v2 offset:2048
    s_waitcnt lgkmcnt(0)
    v_xor_b32 v20, s28, v20
    v_xor_b32 v21, s28, v21
    v_xor_b32 v22, s28, v22
    v_xor_b32 v23, s28, v23
    v_min3_u32 v34, v20, v21, v34
    v_min3_u32 v34, v22, v23, v34
    ds_read_b128 v[20:23], v2 offset:3072
    s_waitcnt lgkmcnt(0)
    v_xor_b32 v20, s28, v20
    v_xor_b32 v21, s28, v21
    v_xor_b32 v22, s28, v22
    v_xor_b32 v23, s28, v23
    v_min3_u32 v34, v20, v21, v34
    v_min3_u32 v34, v22, v23, v34
    ds_read_b128 v[20:23], v2 offset:4096
    s_waitcnt lgkmcnt(0)
    v_xor_b32 v20, s28, v20
    v_xor_b32 v21, s28, v21
    v_xor_b32 v22, s28, v22
    v_xor_b32 v23, s28, v23
    v_min3_u32 v34, v20, v21, v34
    v_min3_u32 v34, v22, v23, v34
    ds_read_b128 v[20:23], v2 offset:5120
    s_waitcnt lgkmcnt(0)
    v_xor_b32 v20, s28, v20
    v_xor_b32 v21, s28, v21
    v_xor_b32 v22, s28, v22
    v_xor_b32 v23, s28, v23
    v_min3_u32 v34, v20, v21, v34
    v_min3_u32 v34, v22, v23, v34
    ds_read_b128 v[20:23], v2 offset:6144
    s_waitcnt lgkmcnt(0)
    v_xor_b32 v20, s28, v20
    v_xor_b32 v21, s28, v21
    v_xor_b32 v22, s28, v22
    v_xor_b32 v23, s28, v23
    v_min3_u32 v34, v20, v21, v34
    v_min3_u32 v34, v22, v23, v34
    ds_read_b128 v[20:23], v2 offset:7168
    s_waitcnt lgkmcnt(0)
    v_xor_b32 v20, s28, v20
    v_xor_b32 v21, s28, v21
    v_xor_b32 v22, s28, v22
    v_xor_b32 v23, s28, v23
    v_min3_u32 v34, v20, v21, v34
    v_min3_u32 v34, v22, v23, v34
    ds_read_b128 v[20:23], v2 offset:8192
    s_waitcnt lgkmcnt(0)
    v_xor_b32 v20, s28, v20
    v_xor_b32 v21, s28, v21
    v_xor_b32 v22, s28, v22
    v_xor_b32 v23, s28, v23
    v_min3_u32 v34, v20, v21, v34
    v_min3_u32 v34, v22, v23, v34
    ds_read_b128 v[20:23], v2 offset:9216
    s_waitcnt lgkmcnt(0)
    v_xor_b32 v20, s28, v20
    v_xor_b32 v21, s28, v21
    v_xor_b32 v22, s28, v22
    v_xor_b32 v23, s28, v23
    v_min3_u32 v34, v20, v21, v34
    v_min3_u32 v34, v22, v23, v34
    ds_read_b128 v[20:23], v2 offset:10240
    s_waitcnt lgkmcnt(0)
    v_xor_b32 v20, s28, v20
    v_xor_b32 v21, s28, v21
    v_xor_b32 v22, s28, v22
    v_xor_b32 v23, s28, v23
    v_min3_u32 v34, v20, v21, v34
    v_min3_u32 v34, v22, v23, v34
    ds_read_b128 v[20:23], v2 offset:11264
    s_waitcnt lgkmcnt(0)
    v_xor_b32 v20, s28, v20
    v_xor_b32 v21, s28, v21
    v_xor_b32 v22, s28, v22
    v_xor_b32 v23, s28, v23
    v_min3_u32 v34, v20, v21, v34
    v_min3_u32 v34, v22, v23, v34
    ds_read_b128 v[20:23], v2 offset:12288
    s_waitcnt lgkmcnt(0)
    v_xor_b32 v20, s28, v20
    v_xor_b32 v21, s28, v21
    v_xor_b32 v22, s28, v22
    v_xor_b32 v23, s28, v23
    v_min3_u32 v34, v20, v21, v34
    v_min3_u32 v34, v22, v23, v34
    ds_read_b128 v[20:23], v2 offset:13312
    s_waitcnt lgkmcnt(0)
    v_xor_b32 v20, s28, v20
    v_xor_b32 v21, s28, v21
    v_xor_b32 v22, s28, v22
    v_xor_b32 v23, s28, v23
    v_min3_u32 v34, v20, v21, v34
    v_min3_u32 v34, v22, v23, v34
    ds_read_b128 v[20:23], v2 offset:14336
    s_waitcnt lgkmcnt(0)
    v_xor_b32 v20, s28, v20
    v_xor_b32 v21, s28, v21
    v_xor_b32 v22, s28, v22
    v_xor_b32 v23, s28, v23
    v_min3_u32 v34, v20, v21, v34
    v_min3_u32 v34, v22, v23, v34
    ds_read_b128 v[20:23], v2 offset:15360
    s_waitcnt lgkmcnt(0)
    v_xor_b32 v20, s28, v20
    v_xor_b32 v21, s28, v21
    v_xor_b32 v22, s28, v22
    v_xor_b32 v23, s28, v23
    v_min3_u32 v34, v20, v21, v34
    v_min3_u32 v34, v22, v23, v34
    v_cmp_eq_u32 vcc, 0, v34
    s_cbranch_vccz L_c_qok
    s_sub_u32 s27, s27, 1
    s_cbranch_scc1 L_c_fail
    v_mov_b64 v[28:29], 0
    v_mov_b64 v[30:31], 0
    v_mov_b64 v[32:33], 0
    v_mov_b64 v[34:35], 0
    v_mov_b64 v[36:37], 0
    v_mov_b64 v[38:39], 0
    s_lshl_b32 m0, s21, 10
    s_mov_b32 s5, s43
    s_barrier
    buffer_load_dwordx4 v2, s[8:11], s5 offen sc1 lds
    s_add_u32 m0, m0, 4096
    s_add_u32 s5, s5, 4096
    buffer_load_dwordx4 v2, s[8:11], s5 offen sc1 lds
    s_add_u32 m0, m0, 4096
    s_add_u32 s5, s5, 4096
    buffer_load_dwordx4 v2, s[8:11], s5 offen sc1 lds
    s_add_u32 m0, m0, 4096
    s_add_u32 s5, s5, 4096
    buffer_load_dwordx4 v2, s[8:11], s5 offen sc1 lds
    s_mov_b32 m0, s53
    s_waitcnt vmcnt(0)
    s_branch L_c_b1
L_c_last:
    buffer_store_dwordx2 v[14:15], v3, s[8:11], s46 offen sc1
    s_waitcnt vmcnt(0)
    s_barrier
    s_cmp_lg_u32 s21, 0
    s_cbranch_scc1 L_c_done
    v_mov_b32 v40, 0
    v_mov_b32 v41, 64
    s_mov_b64 exec, 1
    buffer_store_dword v41, v40, s[8:11], s2 offen sc1
    s_mov_b64 exec, -1
    s_branch L_c_done
L_c_fail:
    s_mov_b64 exec, -1
    v_mov_b32 v40, 1
    v_mov_b32 v41, 96
    buffer_atomic_add v40, v41, s[16:19], 0 offen
L_c_done:
    s_waitcnt vmcnt(0)
    s_endpgm
L_worker:
    s_getpc_b64 s[56:57]
    s_add_u32 s56, s56, task_table@rel32@lo+4
    s_addc_u32 s57, s57, task_table@rel32@hi+12
    s_sub_u32 s20, s20, 2
    s_lshl_b32 s4, s20, 3
    s_load_dwordx2 s[58:59], s[56:57], s4
    s_lshl_b32 s60, s20, 7
    s_add_u32 s60, s60, 243270656
    s_mov_b32 s61, s22
    s_mov_b32 s62, 200000
    s_mov_b32 s63, -1
    s_cmp_ge_u32 s20, 2
    s_cbranch_scc1 L_w_nov
    s_cmp_ge_u32 s22, 4
    s_cbranch_scc1 L_w_nov
    s_cmp_lg_u32 s21, 0
    s_cbranch_scc1 L_w_nov
    s_lshl_b32 s4, s20, 5
    s_add_u32 s4, s4, s22
    s_lshl_b32 s4, s4, 14
    s_add_u32 s4, s4, 240123904
    s_mov_b32 s30, -1
    s_mov_b32 s31, -1
    v_lshlrev_b32 v4, 2, v1
    s_waitcnt vmcnt(0)
    s_add_u32 s5, s4, 0
    s_memtime s[32:33]
    s_waitcnt lgkmcnt(0)
    buffer_store_dword v4, v4, s[8:11], s5 offen sc1
    s_waitcnt vmcnt(0)
    s_memtime s[34:35]
    s_waitcnt lgkmcnt(0)
    s_sub_u32 s34, s34, s32
    s_min_u32 s30, s30, s34
    s_add_u32 s5, s4, 8192
    s_memtime s[32:33]
    s_waitcnt lgkmcnt(0)
    buffer_store_dword v4, v4, s[8:11], s5 offen sc1
    s_waitcnt vmcnt(0)
    s_memtime s[34:35]
    s_waitcnt lgkmcnt(0)
    s_sub_u32 s34, s34, s32
    s_min_u32 s31, s31, s34
    s_add_u32 s5, s4, 9216
    s_memtime s[32:33]
    s_waitcnt lgkmcnt(0)
    buffer_store_dword v4, v4, s[8:11], s5 offen sc1
    s_waitcnt vmcnt(0)
    s_memtime s[34:35]
    s_waitcnt lgkmcnt(0)
    s_sub_u32 s34, s34, s32
    s_min_u32 s31, s31, s34
    s_add_u32 s5, s4, 1024
    s_memtime s[32:33]
    s_waitcnt lgkmcnt(0)
    buffer_store_dword v4, v4, s[8:11], s5 offen sc1
    s_waitcnt vmcnt(0)
    s_memtime s[34:35]
    s_waitcnt lgkmcnt(0)
    s_sub_u32 s34, s34, s32
    s_min_u32 s30, s30, s34
    s_add_u32 s5, s4, 2048
    s_memtime s[32:33]
    s_waitcnt lgkmcnt(0)
    buffer_store_dword v4, v4, s[8:11], s5 offen sc1
    s_waitcnt vmcnt(0)
    s_memtime s[34:35]
    s_waitcnt lgkmcnt(0)
    s_sub_u32 s34, s34, s32
    s_min_u32 s30, s30, s34
    s_add_u32 s5, s4, 10240
    s_memtime s[32:33]
    s_waitcnt lgkmcnt(0)
    buffer_store_dword v4, v4, s[8:11], s5 offen sc1
    s_waitcnt vmcnt(0)
    s_memtime s[34:35]
    s_waitcnt lgkmcnt(0)
    s_sub_u32 s34, s34, s32
    s_min_u32 s31, s31, s34
    s_cmp_lt_u32 s31, s30
    s_cselect_b32 s4, 0x10001, 1
    v_mov_b32 v5, s4
    v_mov_b32 v4, 192
    s_mov_b64 exec, 1
    buffer_atomic_add v5, v4, s[16:19], 0 offen
    s_mov_b64 exec, -1
L_w_nov:
L_w_task:
    s_waitcnt lgkmcnt(0)
    s_cmp_ge_u32 s61, s59
    s_cbranch_scc1 L_end
    s_lshl_b32 s4, s61, 5
    s_add_u32 s4, s4, s58
    s_load_dwordx8 s[48:55], s[56:57], s4
    s_waitcnt lgkmcnt(0)
    s_cmp_lg_u32 s21, 0
    s_cbranch_scc1 L_w_go
    s_cmp_eq_u32 s50, 0
    s_cbranch_scc1 L_w_go
    s_cmp_ge_u32 s61, 32
    s_cbranch_scc1 L_wi1_d
    v_mov_b32 v4, 128
L_wi1:
    buffer_load_dword v5, v4, s[16:19], 0 offen sc1
    s_sub_u32 s62, s62, 1
    s_cbranch_scc1 L_w_fail
    s_waitcnt vmcnt(0)
    v_cmp_gt_u32 vcc, 4, v5
    s_cbranch_vccnz L_wi1
L_wi1_d:
    v_mov_b32 v4, 0
L_w_poll:
    buffer_load_dword v5, v4, s[8:11], s49 offen sc1
    s_sub_u32 s62, s62, 1
    s_cbranch_scc1 L_w_fail
    s_waitcnt vmcnt(0)
    v_cmp_le_u32 vcc, s50, v5
    s_cbranch_vccnz L_w_go
    s_sleep 1
    s_branch L_w_poll
L_w_go:
    s_barrier
    s_mov_b32 s30, s52
    s_mov_b32 s31, s53
    s_mov_b32 s37, s54
    s_cmp_eq_u32 s48, 0
    s_cbranch_scc1 L_t0
    s_cmp_eq_u32 s48, 1
    s_cbranch_scc1 L_t1
    s_cmp_eq_u32 s48, 2
    s_cbranch_scc1 L_t2
    s_cmp_eq_u32 s48, 3
    s_cbranch_scc1 L_t3
    s_cmp_eq_u32 s48, 4
    s_cbranch_scc1 L_t4
    s_cmp_eq_u32 s48, 5
    s_cbranch_scc1 L_t5
    s_cmp_eq_u32 s48, 6
    s_cbranch_scc1 L_t6
    s_cmp_eq_u32 s48, 7
    s_cbranch_scc1 L_t7
    s_cmp_eq_u32 s48, 8
    s_cbranch_scc1 L_t8
    s_cmp_eq_u32 s48, 9
    s_cbranch_scc1 L_t9
    s_cmp_eq_u32 s48, 10
    s_cbranch_scc1 L_t10
    s_cmp_eq_u32 s48, 11
    s_cbranch_scc1 L_t11
    s_cmp_eq_u32 s48, 12
    s_cbranch_scc1 L_t12
    s_branch L_end
L_t1:
    s_mov_b32 s12, s68
    s_mov_b32 s13, s69
    s_mov_b32 s14, 0x800000
    s_mov_b32 s15, 0x00020000
    s_mov_b32 s32, 32768
    s_mov_b32 s33, 8192
    s_mov_b32 s35, 8
    s_mov_b32 s38, 131072
    s_mov_b32 s41, 4096
    s_mov_b32 s36, 0
    s_lshr_b32 s4, s21, 1
    s_mul_i32 s4, s4, 256
    s_add_u32 s31, s31, s4
    s_branch L_ga
L_t2:
    s_mov_b32 s12, s70
    s_mov_b32 s13, s71
    s_mov_b32 s14, 0x800000
    s_mov_b32 s15, 0x00020000
    s_mov_b32 s32, 32768
    s_mov_b32 s33, 8192
    s_mov_b32 s35, 8
    s_mov_b32 s38, 262144
    s_mov_b32 s41, 4096
    s_mov_b32 s36, 1
    s_lshr_b32 s4, s21, 1
    s_mul_i32 s4, s4, 256
    s_add_u32 s31, s31, s4
    s_branch L_ga
L_t3:
    s_mov_b32 s12, s72
    s_mov_b32 s13, s73
    s_mov_b32 s14, 0x800000
    s_mov_b32 s15, 0x00020000
    s_mov_b32 s32, 32768
    s_mov_b32 s33, 8192
    s_mov_b32 s35, 8
    s_mov_b32 s38, 524288
    s_mov_b32 s41, 16384
    s_mov_b32 s36, 1
    s_lshr_b32 s4, s21, 1
    s_mul_i32 s4, s4, 256
    s_add_u32 s31, s31, s4
    s_branch L_gas
L_t4:
    s_mov_b32 s12, s70
    s_mov_b32 s13, s71
    s_mov_b32 s14, 0x800000
    s_mov_b32 s15, 0x00020000
    s_mov_b32 s32, 32768
    s_mov_b32 s33, 8192
    s_mov_b32 s35, 4
    s_mov_b32 s38, 262144
    s_mov_b32 s41, 2048
    s_mov_b32 s36, 1
    s_lshr_b32 s4, s21, 1
    s_mul_i32 s4, s4, 128
    s_add_u32 s31, s31, s4
    s_branch L_gb
L_t5:
    s_mov_b32 s12, s72
    s_mov_b32 s13, s73
    s_mov_b32 s14, 0x800000
    s_mov_b32 s15, 0x00020000
    s_mov_b32 s32, 32768
    s_mov_b32 s33, 8192
    s_mov_b32 s35, 4
    s_mov_b32 s38, 524288
    s_mov_b32 s41, 4096
    s_mov_b32 s36, 1
    s_lshr_b32 s4, s21, 1
    s_mul_i32 s4, s4, 128
    s_add_u32 s31, s31, s4
    s_branch L_gbs
L_t7:
    s_mov_b32 s12, s74
    s_mov_b32 s13, s75
    s_mov_b32 s14, 0x800000
    s_mov_b32 s15, 0x00020000
    s_mov_b32 s32, 131072
    s_mov_b32 s33, 2048
    s_mov_b32 s35, 0
    s_mov_b32 s38, 32768
    s_mov_b32 s41, 0
    s_mov_b32 s36, 0
    s_lshr_b32 s4, s21, 1
    s_mul_i32 s4, s4, 128
    s_add_u32 s31, s31, s4
    s_branch L_so
L_t9:
    s_cmp_lt_u32 s21, 2
    s_cselect_b32 s12, s80, s82
    s_cselect_b32 s13, s81, s83
    s_mov_b32 s14, 0x700000
    s_mov_b32 s15, 0x00020000
    s_mov_b32 s32, 32768
    s_mov_b32 s33, 7168
    s_mov_b32 s35, 0
    s_mov_b32 s38, 114688
    s_mov_b32 s41, 0
    s_mov_b32 s36, 0
    s_branch L_sgu
L_t10:
    s_mov_b32 s12, s84
    s_mov_b32 s13, s85
    s_mov_b32 s14, 0x700000
    s_mov_b32 s15, 0x00020000
    s_mov_b32 s32, 114688
    s_mov_b32 s33, 2048
    s_mov_b32 s35, 0
    s_mov_b32 s38, 32768
    s_mov_b32 s41, 0
    s_mov_b32 s36, 0
    s_lshr_b32 s4, s21, 1
    s_mul_i32 s4, s4, 128
    s_add_u32 s31, s31, s4
    s_branch L_sd
L_ga:
    s_mul_i32 s4, s21, 4
    s_mul_i32 s4, s4, s32
    s_sub_u32 s5, s32, 1024
    v_add_u32 v8, s4, v2
    s_add_u32 s4, s4, s5
    v_add_u32 v9, s4, v2
    s_add_u32 s4, s4, s5
    v_add_u32 v10, s4, v2
    s_add_u32 s4, s4, s5
    v_add_u32 v11, s4, v2
    v_lshrrev_b32 v4, 4, v1
    v_and_b32 v5, 15, v1
    s_and_b32 s6, s21, 1
    s_lshl_b32 s4, s6, 4
    s_add_u32 s5, s4, 0
    v_add_u32 v6, s5, v4
    v_and_b32 v7, 7, v6
    v_lshlrev_b32 v7, 1, v7
    v_xor_b32 v7, v7, v5
    v_lshlrev_b32 v7, 4, v7
    v_mul_lo_u32 v6, v6, s33
    v_add_u32 v6, v6, v7
    v_subrev_u32 v12, 0, v6
    s_add_u32 s5, s4, 4
    v_add_u32 v6, s5, v4
    v_and_b32 v7, 7, v6
    v_lshlrev_b32 v7, 1, v7
    v_xor_b32 v7, v7, v5
    v_lshlrev_b32 v7, 4, v7
    v_mul_lo_u32 v6, v6, s33
    v_add_u32 v6, v6, v7
    v_subrev_u32 v13, 1024, v6
    s_add_u32 s5, s4, 8
    v_add_u32 v6, s5, v4
    v_and_b32 v7, 7, v6
    v_lshlrev_b32 v7, 1, v7
    v_xor_b32 v7, v7, v5
    v_lshlrev_b32 v7, 4, v7
    v_mul_lo_u32 v6, v6, s33
    v_add_u32 v6, v6, v7
    v_subrev_u32 v14, 2048, v6
    s_add_u32 s5, s4, 12
    v_add_u32 v6, s5, v4
    v_and_b32 v7, 7, v6
    v_lshlrev_b32 v7, 1, v7
    v_xor_b32 v7, v7, v5
    v_lshlrev_b32 v7, 4, v7
    v_mul_lo_u32 v6, v6, s33
    v_add_u32 v6, v6, v7
    v_subrev_u32 v15, 3072, v6
    s_lshr_b32 s7, s21, 1
    s_mul_i32 s4, s7, 8192
    s_add_u32 s5, s4, 0
    v_add_u32 v16, s5, v2
    s_add_u32 s5, s4, 65536
    v_add_u32 v17, s5, v2
    v_lshrrev_b32 v5, 2, v1
    v_and_b32 v4, 7, v5
    v_mul_u32_u24 v5, 256, v5
    v_and_b32 v6, 3, v1
    v_lshl_add_u32 v5, v6, 3, v5
    s_mul_i32 s4, s6, 4
    s_add_u32 s4, s4, 0
    v_xor_b32 v6, s4, v4
    v_lshl_add_u32 v6, v6, 5, v5
    v_add_u32 v18, 16384, v6
    v_add_u32 v22, 81920, v6
    s_mul_i32 s4, s6, 4
    s_add_u32 s4, s4, 1
    v_xor_b32 v6, s4, v4
    v_lshl_add_u32 v6, v6, 5, v5
    v_add_u32 v19, 16384, v6
    v_add_u32 v23, 81920, v6
    s_mul_i32 s4, s6, 4
    s_add_u32 s4, s4, 2
    v_xor_b32 v6, s4, v4
    v_lshl_add_u32 v6, v6, 5, v5
    v_add_u32 v20, 16384, v6
    v_add_u32 v24, 81920, v6
    s_mul_i32 s4, s6, 4
    s_add_u32 s4, s4, 3
    v_xor_b32 v6, s4, v4
    v_lshl_add_u32 v6, v6, 5, v5
    v_add_u32 v21, 16384, v6
    v_add_u32 v25, 81920, v6
    s_mul_i32 s39, s21, 4096
    s_mul_i32 s40, s21, 4096
    s_add_u32 s40, s40, 16384
    s_lshl_b32 s34, s33, 5
    s_add_u32 m0, s39, 0
    s_nop 0
    buffer_load_dwordx4 v8, s[8:11], s30 offen offset:0 sc1 lds
    buffer_load_dwordx4 v9, s[8:11], s30 offen offset:1024 sc1 lds
    buffer_load_dwordx4 v10, s[8:11], s30 offen offset:2048 sc1 lds
    buffer_load_dwordx4 v11, s[8:11], s30 offen offset:3072 sc1 lds
    s_add_u32 m0, s40, 0
    s_add_u32 s30, s30, 1024
    buffer_load_dwordx4 v12, s[12:15], s31 offen offset:0 lds
    buffer_load_dwordx4 v13, s[12:15], s31 offen offset:1024 lds
    buffer_load_dwordx4 v14, s[12:15], s31 offen offset:2048 lds
    buffer_load_dwordx4 v15, s[12:15], s31 offen offset:3072 lds
    s_add_u32 s31, s31, s34
    s_add_u32 m0, s39, 32768
    s_nop 0
    buffer_load_dwordx4 v8, s[8:11], s30 offen offset:0 sc1 lds
    buffer_load_dwordx4 v9, s[8:11], s30 offen offset:1024 sc1 lds
    buffer_load_dwordx4 v10, s[8:11], s30 offen offset:2048 sc1 lds
    buffer_load_dwordx4 v11, s[8:11], s30 offen offset:3072 sc1 lds
    s_add_u32 m0, s40, 32768
    s_add_u32 s30, s30, 1024
    buffer_load_dwordx4 v12, s[12:15], s31 offen offset:0 lds
    buffer_load_dwordx4 v13, s[12:15], s31 offen offset:1024 lds
    buffer_load_dwordx4 v14, s[12:15], s31 offen offset:2048 lds
    buffer_load_dwordx4 v15, s[12:15], s31 offen offset:3072 lds
    s_add_u32 s31, s31, s34
    s_add_u32 m0, s39, 65536
    s_nop 0
    buffer_load_dwordx4 v8, s[8:11], s30 offen offset:0 sc1 lds
    buffer_load_dwordx4 v9, s[8:11], s30 offen offset:1024 sc1 lds
    buffer_load_dwordx4 v10, s[8:11], s30 offen offset:2048 sc1 lds
    buffer_load_dwordx4 v11, s[8:11], s30 offen offset:3072 sc1 lds
    s_add_u32 m0, s40, 65536
    s_add_u32 s30, s30, 1024
    buffer_load_dwordx4 v12, s[12:15], s31 offen offset:0 lds
    buffer_load_dwordx4 v13, s[12:15], s31 offen offset:1024 lds
    buffer_load_dwordx4 v14, s[12:15], s31 offen offset:2048 lds
    buffer_load_dwordx4 v15, s[12:15], s31 offen offset:3072 lds
    s_add_u32 s31, s31, s34
    s_add_u32 m0, s39, 98304
    s_nop 0
    buffer_load_dwordx4 v8, s[8:11], s30 offen offset:0 sc1 lds
    buffer_load_dwordx4 v9, s[8:11], s30 offen offset:1024 sc1 lds
    buffer_load_dwordx4 v10, s[8:11], s30 offen offset:2048 sc1 lds
    buffer_load_dwordx4 v11, s[8:11], s30 offen offset:3072 sc1 lds
    s_add_u32 m0, s40, 98304
    s_add_u32 s30, s30, 1024
    buffer_load_dwordx4 v12, s[12:15], s31 offen offset:0 lds
    buffer_load_dwordx4 v13, s[12:15], s31 offen offset:1024 lds
    buffer_load_dwordx4 v14, s[12:15], s31 offen offset:2048 lds
    buffer_load_dwordx4 v15, s[12:15], s31 offen offset:3072 lds
    s_add_u32 s31, s31, s34
    s_waitcnt vmcnt(24)
    s_barrier
    ds_read_b64_tr_b16 v[28:29], v18 offset:0
    ds_read_b64_tr_b16 v[30:31], v18 offset:4096
    ds_read_b128 v[60:63], v16 offset:0
    ds_read_b64_tr_b16 v[32:33], v19 offset:0
    ds_read_b64_tr_b16 v[34:35], v19 offset:4096
    ds_read_b128 v[64:67], v16 offset:1024
    ds_read_b64_tr_b16 v[36:37], v20 offset:0
    ds_read_b64_tr_b16 v[38:39], v20 offset:4096
    ds_read_b128 v[68:71], v16 offset:2048
    ds_read_b64_tr_b16 v[40:41], v21 offset:0
    ds_read_b64_tr_b16 v[42:43], v21 offset:4096
    ds_read_b128 v[72:75], v16 offset:3072
    ds_read_b64_tr_b16 v[44:45], v18 offset:8192
    ds_read_b64_tr_b16 v[46:47], v18 offset:12288
    ds_read_b128 v[76:79], v16 offset:4096
    ds_read_b64_tr_b16 v[48:49], v19 offset:8192
    ds_read_b64_tr_b16 v[50:51], v19 offset:12288
    ds_read_b128 v[80:83], v16 offset:5120
    ds_read_b64_tr_b16 v[52:53], v20 offset:8192
    ds_read_b64_tr_b16 v[54:55], v20 offset:12288
    ds_read_b128 v[84:87], v16 offset:6144
    ds_read_b64_tr_b16 v[56:57], v21 offset:8192
    ds_read_b64_tr_b16 v[58:59], v21 offset:12288
    ds_read_b128 v[88:91], v16 offset:7168
    s_waitcnt lgkmcnt(0)
    v_mfma_f32_16x16x32_bf16 a[0:3], v[28:31], v[60:63], 0
    s_waitcnt vmcnt(16)
    s_barrier
    ds_read_b64_tr_b16 v[92:93], v18 offset:32768
    v_mfma_f32_16x16x32_bf16 a[4:7], v[28:31], v[64:67], 0
    ds_read_b64_tr_b16 v[94:95], v18 offset:36864
    v_mfma_f32_16x16x32_bf16 a[8:11], v[28:31], v[68:71], 0
    ds_read_b128 v[124:127], v16 offset:32768
    v_mfma_f32_16x16x32_bf16 a[12:15], v[28:31], v[72:75], 0
    ds_read_b64_tr_b16 v[96:97], v19 offset:32768
    v_mfma_f32_16x16x32_bf16 a[16:19], v[28:31], v[76:79], 0
    s_add_u32 m0, s39, 0
    s_nop 0
    buffer_load_dwordx4 v8, s[8:11], s30 offen offset:0 sc1 lds
    v_mfma_f32_16x16x32_bf16 a[20:23], v[28:31], v[80:83], 0
    ds_read_b64_tr_b16 v[98:99], v19 offset:36864
    v_mfma_f32_16x16x32_bf16 a[24:27], v[28:31], v[84:87], 0
    ds_read_b128 v[128:131], v16 offset:33792
    v_mfma_f32_16x16x32_bf16 a[28:31], v[28:31], v[88:91], 0
    ds_read_b64_tr_b16 v[100:101], v20 offset:32768
    v_mfma_f32_16x16x32_bf16 a[32:35], v[32:35], v[60:63], 0
    ds_read_b64_tr_b16 v[102:103], v20 offset:36864
    v_mfma_f32_16x16x32_bf16 a[36:39], v[32:35], v[64:67], 0
    ds_read_b128 v[132:135], v16 offset:34816
    v_mfma_f32_16x16x32_bf16 a[40:43], v[32:35], v[68:71], 0
    ds_read_b64_tr_b16 v[104:105], v21 offset:32768
    v_mfma_f32_16x16x32_bf16 a[44:47], v[32:35], v[72:75], 0
    ds_read_b64_tr_b16 v[106:107], v21 offset:36864
    v_mfma_f32_16x16x32_bf16 a[48:51], v[32:35], v[76:79], 0
    buffer_load_dwordx4 v9, s[8:11], s30 offen offset:1024 sc1 lds
    v_mfma_f32_16x16x32_bf16 a[52:55], v[32:35], v[80:83], 0
    ds_read_b128 v[136:139], v16 offset:35840
    v_mfma_f32_16x16x32_bf16 a[56:59], v[32:35], v[84:87], 0
    ds_read_b64_tr_b16 v[108:109], v18 offset:40960
    v_mfma_f32_16x16x32_bf16 a[60:63], v[32:35], v[88:91], 0
    ds_read_b64_tr_b16 v[110:111], v18 offset:45056
    v_mfma_f32_16x16x32_bf16 a[64:67], v[36:39], v[60:63], 0
    ds_read_b128 v[140:143], v16 offset:36864
    v_mfma_f32_16x16x32_bf16 a[68:71], v[36:39], v[64:67], 0
    ds_read_b64_tr_b16 v[112:113], v19 offset:40960
    v_mfma_f32_16x16x32_bf16 a[72:75], v[36:39], v[68:71], 0
    ds_read_b64_tr_b16 v[114:115], v19 offset:45056
    v_mfma_f32_16x16x32_bf16 a[76:79], v[36:39], v[72:75], 0
    ds_read_b128 v[144:147], v16 offset:37888
    v_mfma_f32_16x16x32_bf16 a[80:83], v[36:39], v[76:79], 0
    buffer_load_dwordx4 v10, s[8:11], s30 offen offset:2048 sc1 lds
    v_mfma_f32_16x16x32_bf16 a[84:87], v[36:39], v[80:83], 0
    ds_read_b64_tr_b16 v[116:117], v20 offset:40960
    v_mfma_f32_16x16x32_bf16 a[88:91], v[36:39], v[84:87], 0
    ds_read_b64_tr_b16 v[118:119], v20 offset:45056
    v_mfma_f32_16x16x32_bf16 a[92:95], v[36:39], v[88:91], 0
    ds_read_b128 v[148:151], v16 offset:38912
    v_mfma_f32_16x16x32_bf16 a[96:99], v[40:43], v[60:63], 0
    ds_read_b64_tr_b16 v[120:121], v21 offset:40960
    v_mfma_f32_16x16x32_bf16 a[100:103], v[40:43], v[64:67], 0
    ds_read_b64_tr_b16 v[122:123], v21 offset:45056
    v_mfma_f32_16x16x32_bf16 a[104:107], v[40:43], v[68:71], 0
    ds_read_b128 v[152:155], v16 offset:39936
    v_mfma_f32_16x16x32_bf16 a[108:111], v[40:43], v[72:75], 0
    v_mfma_f32_16x16x32_bf16 a[112:115], v[40:43], v[76:79], 0
    buffer_load_dwordx4 v11, s[8:11], s30 offen offset:3072 sc1 lds
    v_mfma_f32_16x16x32_bf16 a[116:119], v[40:43], v[80:83], 0
    v_mfma_f32_16x16x32_bf16 a[120:123], v[40:43], v[84:87], 0
    v_mfma_f32_16x16x32_bf16 a[124:127], v[40:43], v[88:91], 0
    v_mfma_f32_16x16x32_bf16 a[128:131], v[44:47], v[60:63], 0
    v_mfma_f32_16x16x32_bf16 a[132:135], v[44:47], v[64:67], 0
    v_mfma_f32_16x16x32_bf16 a[136:139], v[44:47], v[68:71], 0
    v_mfma_f32_16x16x32_bf16 a[140:143], v[44:47], v[72:75], 0
    v_mfma_f32_16x16x32_bf16 a[144:147], v[44:47], v[76:79], 0
    s_add_u32 m0, s40, 0
    s_add_u32 s30, s30, 1024
    buffer_load_dwordx4 v12, s[12:15], s31 offen offset:0 lds
    v_mfma_f32_16x16x32_bf16 a[148:151], v[44:47], v[80:83], 0
    v_mfma_f32_16x16x32_bf16 a[152:155], v[44:47], v[84:87], 0
    v_mfma_f32_16x16x32_bf16 a[156:159], v[44:47], v[88:91], 0
    v_mfma_f32_16x16x32_bf16 a[160:163], v[48:51], v[60:63], 0
    v_mfma_f32_16x16x32_bf16 a[164:167], v[48:51], v[64:67], 0
    v_mfma_f32_16x16x32_bf16 a[168:171], v[48:51], v[68:71], 0
    v_mfma_f32_16x16x32_bf16 a[172:175], v[48:51], v[72:75], 0
    v_mfma_f32_16x16x32_bf16 a[176:179], v[48:51], v[76:79], 0
    buffer_load_dwordx4 v13, s[12:15], s31 offen offset:1024 lds
    v_mfma_f32_16x16x32_bf16 a[180:183], v[48:51], v[80:83], 0
    v_mfma_f32_16x16x32_bf16 a[184:187], v[48:51], v[84:87], 0
    v_mfma_f32_16x16x32_bf16 a[188:191], v[48:51], v[88:91], 0
    v_mfma_f32_16x16x32_bf16 a[192:195], v[52:55], v[60:63], 0
    v_mfma_f32_16x16x32_bf16 a[196:199], v[52:55], v[64:67], 0
    v_mfma_f32_16x16x32_bf16 a[200:203], v[52:55], v[68:71], 0
    v_mfma_f32_16x16x32_bf16 a[204:207], v[52:55], v[72:75], 0
    v_mfma_f32_16x16x32_bf16 a[208:211], v[52:55], v[76:79], 0
    buffer_load_dwordx4 v14, s[12:15], s31 offen offset:2048 lds
    v_mfma_f32_16x16x32_bf16 a[212:215], v[52:55], v[80:83], 0
    v_mfma_f32_16x16x32_bf16 a[216:219], v[52:55], v[84:87], 0
    v_mfma_f32_16x16x32_bf16 a[220:223], v[52:55], v[88:91], 0
    v_mfma_f32_16x16x32_bf16 a[224:227], v[56:59], v[60:63], 0
    v_mfma_f32_16x16x32_bf16 a[228:231], v[56:59], v[64:67], 0
    v_mfma_f32_16x16x32_bf16 a[232:235], v[56:59], v[68:71], 0
    v_mfma_f32_16x16x32_bf16 a[236:239], v[56:59], v[72:75], 0
    v_mfma_f32_16x16x32_bf16 a[240:243], v[56:59], v[76:79], 0
    buffer_load_dwordx4 v15, s[12:15], s31 offen offset:3072 lds
    s_add_u32 s31, s31, s34
    v_mfma_f32_16x16x32_bf16 a[244:247], v[56:59], v[80:83], 0
    v_mfma_f32_16x16x32_bf16 a[248:251], v[56:59], v[84:87], 0
    v_mfma_f32_16x16x32_bf16 a[252:255], v[56:59], v[88:91], 0
    s_branch L_ga_s1
L_ga_loop:
    s_cmp_eq_u32 s35, 1
    s_cselect_b32 s30, 0x80000000, s30
    s_cselect_b32 s31, 0x80000000, s31
    s_waitcnt lgkmcnt(0)
    v_mfma_f32_16x16x32_bf16 a[0:3], v[28:31], v[60:63], a[0:3]
    s_waitcnt vmcnt(16)
    s_barrier
    ds_read_b64_tr_b16 v[92:93], v18 offset:32768
    v_mfma_f32_16x16x32_bf16 a[4:7], v[28:31], v[64:67], a[4:7]
    ds_read_b64_tr_b16 v[94:95], v18 offset:36864
    v_mfma_f32_16x16x32_bf16 a[8:11], v[28:31], v[68:71], a[8:11]
    ds_read_b128 v[124:127], v16 offset:32768
    v_mfma_f32_16x16x32_bf16 a[12:15], v[28:31], v[72:75], a[12:15]
    ds_read_b64_tr_b16 v[96:97], v19 offset:32768
    v_mfma_f32_16x16x32_bf16 a[16:19], v[28:31], v[76:79], a[16:19]
    s_add_u32 m0, s39, 0
    s_nop 0
    buffer_load_dwordx4 v8, s[8:11], s30 offen offset:0 sc1 lds
    v_mfma_f32_16x16x32_bf16 a[20:23], v[28:31], v[80:83], a[20:23]
    ds_read_b64_tr_b16 v[98:99], v19 offset:36864
    v_mfma_f32_16x16x32_bf16 a[24:27], v[28:31], v[84:87], a[24:27]
    ds_read_b128 v[128:131], v16 offset:33792
    v_mfma_f32_16x16x32_bf16 a[28:31], v[28:31], v[88:91], a[28:31]
    ds_read_b64_tr_b16 v[100:101], v20 offset:32768
    v_mfma_f32_16x16x32_bf16 a[32:35], v[32:35], v[60:63], a[32:35]
    ds_read_b64_tr_b16 v[102:103], v20 offset:36864
    v_mfma_f32_16x16x32_bf16 a[36:39], v[32:35], v[64:67], a[36:39]
    ds_read_b128 v[132:135], v16 offset:34816
    v_mfma_f32_16x16x32_bf16 a[40:43], v[32:35], v[68:71], a[40:43]
    ds_read_b64_tr_b16 v[104:105], v21 offset:32768
    v_mfma_f32_16x16x32_bf16 a[44:47], v[32:35], v[72:75], a[44:47]
    ds_read_b64_tr_b16 v[106:107], v21 offset:36864
    v_mfma_f32_16x16x32_bf16 a[48:51], v[32:35], v[76:79], a[48:51]
    buffer_load_dwordx4 v9, s[8:11], s30 offen offset:1024 sc1 lds
    v_mfma_f32_16x16x32_bf16 a[52:55], v[32:35], v[80:83], a[52:55]
    ds_read_b128 v[136:139], v16 offset:35840
    v_mfma_f32_16x16x32_bf16 a[56:59], v[32:35], v[84:87], a[56:59]
    ds_read_b64_tr_b16 v[108:109], v18 offset:40960
    v_mfma_f32_16x16x32_bf16 a[60:63], v[32:35], v[88:91], a[60:63]
    ds_read_b64_tr_b16 v[110:111], v18 offset:45056
    v_mfma_f32_16x16x32_bf16 a[64:67], v[36:39], v[60:63], a[64:67]
    ds_read_b128 v[140:143], v16 offset:36864
    v_mfma_f32_16x16x32_bf16 a[68:71], v[36:39], v[64:67], a[68:71]
    ds_read_b64_tr_b16 v[112:113], v19 offset:40960
    v_mfma_f32_16x16x32_bf16 a[72:75], v[36:39], v[68:71], a[72:75]
    ds_read_b64_tr_b16 v[114:115], v19 offset:45056
    v_mfma_f32_16x16x32_bf16 a[76:79], v[36:39], v[72:75], a[76:79]
    ds_read_b128 v[144:147], v16 offset:37888
    v_mfma_f32_16x16x32_bf16 a[80:83], v[36:39], v[76:79], a[80:83]
    buffer_load_dwordx4 v10, s[8:11], s30 offen offset:2048 sc1 lds
    v_mfma_f32_16x16x32_bf16 a[84:87], v[36:39], v[80:83], a[84:87]
    ds_read_b64_tr_b16 v[116:117], v20 offset:40960
    v_mfma_f32_16x16x32_bf16 a[88:91], v[36:39], v[84:87], a[88:91]
    ds_read_b64_tr_b16 v[118:119], v20 offset:45056
    v_mfma_f32_16x16x32_bf16 a[92:95], v[36:39], v[88:91], a[92:95]
    ds_read_b128 v[148:151], v16 offset:38912
    v_mfma_f32_16x16x32_bf16 a[96:99], v[40:43], v[60:63], a[96:99]
    ds_read_b64_tr_b16 v[120:121], v21 offset:40960
    v_mfma_f32_16x16x32_bf16 a[100:103], v[40:43], v[64:67], a[100:103]
    ds_read_b64_tr_b16 v[122:123], v21 offset:45056
    v_mfma_f32_16x16x32_bf16 a[104:107], v[40:43], v[68:71], a[104:107]
    ds_read_b128 v[152:155], v16 offset:39936
    v_mfma_f32_16x16x32_bf16 a[108:111], v[40:43], v[72:75], a[108:111]
    v_mfma_f32_16x16x32_bf16 a[112:115], v[40:43], v[76:79], a[112:115]
    buffer_load_dwordx4 v11, s[8:11], s30 offen offset:3072 sc1 lds
    v_mfma_f32_16x16x32_bf16 a[116:119], v[40:43], v[80:83], a[116:119]
    v_mfma_f32_16x16x32_bf16 a[120:123], v[40:43], v[84:87], a[120:123]
    v_mfma_f32_16x16x32_bf16 a[124:127], v[40:43], v[88:91], a[124:127]
    v_mfma_f32_16x16x32_bf16 a[128:131], v[44:47], v[60:63], a[128:131]
    v_mfma_f32_16x16x32_bf16 a[132:135], v[44:47], v[64:67], a[132:135]
    v_mfma_f32_16x16x32_bf16 a[136:139], v[44:47], v[68:71], a[136:139]
    v_mfma_f32_16x16x32_bf16 a[140:143], v[44:47], v[72:75], a[140:143]
    v_mfma_f32_16x16x32_bf16 a[144:147], v[44:47], v[76:79], a[144:147]
    s_add_u32 m0, s40, 0
    s_add_u32 s30, s30, 1024
    buffer_load_dwordx4 v12, s[12:15], s31 offen offset:0 lds
    v_mfma_f32_16x16x32_bf16 a[148:151], v[44:47], v[80:83], a[148:151]
    v_mfma_f32_16x16x32_bf16 a[152:155], v[44:47], v[84:87], a[152:155]
    v_mfma_f32_16x16x32_bf16 a[156:159], v[44:47], v[88:91], a[156:159]
    v_mfma_f32_16x16x32_bf16 a[160:163], v[48:51], v[60:63], a[160:163]
    v_mfma_f32_16x16x32_bf16 a[164:167], v[48:51], v[64:67], a[164:167]
    v_mfma_f32_16x16x32_bf16 a[168:171], v[48:51], v[68:71], a[168:171]
    v_mfma_f32_16x16x32_bf16 a[172:175], v[48:51], v[72:75], a[172:175]
    v_mfma_f32_16x16x32_bf16 a[176:179], v[48:51], v[76:79], a[176:179]
    buffer_load_dwordx4 v13, s[12:15], s31 offen offset:1024 lds
    v_mfma_f32_16x16x32_bf16 a[180:183], v[48:51], v[80:83], a[180:183]
    v_mfma_f32_16x16x32_bf16 a[184:187], v[48:51], v[84:87], a[184:187]
    v_mfma_f32_16x16x32_bf16 a[188:191], v[48:51], v[88:91], a[188:191]
    v_mfma_f32_16x16x32_bf16 a[192:195], v[52:55], v[60:63], a[192:195]
    v_mfma_f32_16x16x32_bf16 a[196:199], v[52:55], v[64:67], a[196:199]
    v_mfma_f32_16x16x32_bf16 a[200:203], v[52:55], v[68:71], a[200:203]
    v_mfma_f32_16x16x32_bf16 a[204:207], v[52:55], v[72:75], a[204:207]
    v_mfma_f32_16x16x32_bf16 a[208:211], v[52:55], v[76:79], a[208:211]
    buffer_load_dwordx4 v14, s[12:15], s31 offen offset:2048 lds
    v_mfma_f32_16x16x32_bf16 a[212:215], v[52:55], v[80:83], a[212:215]
    v_mfma_f32_16x16x32_bf16 a[216:219], v[52:55], v[84:87], a[216:219]
    v_mfma_f32_16x16x32_bf16 a[220:223], v[52:55], v[88:91], a[220:223]
    v_mfma_f32_16x16x32_bf16 a[224:227], v[56:59], v[60:63], a[224:227]
    v_mfma_f32_16x16x32_bf16 a[228:231], v[56:59], v[64:67], a[228:231]
    v_mfma_f32_16x16x32_bf16 a[232:235], v[56:59], v[68:71], a[232:235]
    v_mfma_f32_16x16x32_bf16 a[236:239], v[56:59], v[72:75], a[236:239]
    v_mfma_f32_16x16x32_bf16 a[240:243], v[56:59], v[76:79], a[240:243]
    buffer_load_dwordx4 v15, s[12:15], s31 offen offset:3072 lds
    s_add_u32 s31, s31, s34
    v_mfma_f32_16x16x32_bf16 a[244:247], v[56:59], v[80:83], a[244:247]
    v_mfma_f32_16x16x32_bf16 a[248:251], v[56:59], v[84:87], a[248:251]
    v_mfma_f32_16x16x32_bf16 a[252:255], v[56:59], v[88:91], a[252:255]
L_ga_s1:
    s_waitcnt lgkmcnt(0)
    v_mfma_f32_16x16x32_bf16 a[0:3], v[92:95], v[124:127], a[0:3]
    s_waitcnt vmcnt(16)
    s_barrier
    ds_read_b64_tr_b16 v[28:29], v22 offset:0
    v_mfma_f32_16x16x32_bf16 a[4:7], v[92:95], v[128:131], a[4:7]
    ds_read_b64_tr_b16 v[30:31], v22 offset:4096
    v_mfma_f32_16x16x32_bf16 a[8:11], v[92:95], v[132:135], a[8:11]
    ds_read_b128 v[60:63], v17 offset:0
    v_mfma_f32_16x16x32_bf16 a[12:15], v[92:95], v[136:139], a[12:15]
    ds_read_b64_tr_b16 v[32:33], v23 offset:0
    v_mfma_f32_16x16x32_bf16 a[16:19], v[92:95], v[140:143], a[16:19]
    s_add_u32 m0, s39, 32768
    s_nop 0
    buffer_load_dwordx4 v8, s[8:11], s30 offen offset:0 sc1 lds
    v_mfma_f32_16x16x32_bf16 a[20:23], v[92:95], v[144:147], a[20:23]
    ds_read_b64_tr_b16 v[34:35], v23 offset:4096
    v_mfma_f32_16x16x32_bf16 a[24:27], v[92:95], v[148:151], a[24:27]
    ds_read_b128 v[64:67], v17 offset:1024
    v_mfma_f32_16x16x32_bf16 a[28:31], v[92:95], v[152:155], a[28:31]
    ds_read_b64_tr_b16 v[36:37], v24 offset:0
    v_mfma_f32_16x16x32_bf16 a[32:35], v[96:99], v[124:127], a[32:35]
    ds_read_b64_tr_b16 v[38:39], v24 offset:4096
    v_mfma_f32_16x16x32_bf16 a[36:39], v[96:99], v[128:131], a[36:39]
    ds_read_b128 v[68:71], v17 offset:2048
    v_mfma_f32_16x16x32_bf16 a[40:43], v[96:99], v[132:135], a[40:43]
    ds_read_b64_tr_b16 v[40:41], v25 offset:0
    v_mfma_f32_16x16x32_bf16 a[44:47], v[96:99], v[136:139], a[44:47]
    ds_read_b64_tr_b16 v[42:43], v25 offset:4096
    v_mfma_f32_16x16x32_bf16 a[48:51], v[96:99], v[140:143], a[48:51]
    buffer_load_dwordx4 v9, s[8:11], s30 offen offset:1024 sc1 lds
    v_mfma_f32_16x16x32_bf16 a[52:55], v[96:99], v[144:147], a[52:55]
    ds_read_b128 v[72:75], v17 offset:3072
    v_mfma_f32_16x16x32_bf16 a[56:59], v[96:99], v[148:151], a[56:59]
    ds_read_b64_tr_b16 v[44:45], v22 offset:8192
    v_mfma_f32_16x16x32_bf16 a[60:63], v[96:99], v[152:155], a[60:63]
    ds_read_b64_tr_b16 v[46:47], v22 offset:12288
    v_mfma_f32_16x16x32_bf16 a[64:67], v[100:103], v[124:127], a[64:67]
    ds_read_b128 v[76:79], v17 offset:4096
    v_mfma_f32_16x16x32_bf16 a[68:71], v[100:103], v[128:131], a[68:71]
    ds_read_b64_tr_b16 v[48:49], v23 offset:8192
    v_mfma_f32_16x16x32_bf16 a[72:75], v[100:103], v[132:135], a[72:75]
    ds_read_b64_tr_b16 v[50:51], v23 offset:12288
    v_mfma_f32_16x16x32_bf16 a[76:79], v[100:103], v[136:139], a[76:79]
    ds_read_b128 v[80:83], v17 offset:5120
    v_mfma_f32_16x16x32_bf16 a[80:83], v[100:103], v[140:143], a[80:83]
    buffer_load_dwordx4 v10, s[8:11], s30 offen offset:2048 sc1 lds
    v_mfma_f32_16x16x32_bf16 a[84:87], v[100:103], v[144:147], a[84:87]
    ds_read_b64_tr_b16 v[52:53], v24 offset:8192
    v_mfma_f32_16x16x32_bf16 a[88:91], v[100:103], v[148:151], a[88:91]
    ds_read_b64_tr_b16 v[54:55], v24 offset:12288
    v_mfma_f32_16x16x32_bf16 a[92:95], v[100:103], v[152:155], a[92:95]
    ds_read_b128 v[84:87], v17 offset:6144
    v_mfma_f32_16x16x32_bf16 a[96:99], v[104:107], v[124:127], a[96:99]
    ds_read_b64_tr_b16 v[56:57], v25 offset:8192
    v_mfma_f32_16x16x32_bf16 a[100:103], v[104:107], v[128:131], a[100:103]
    ds_read_b64_tr_b16 v[58:59], v25 offset:12288
    v_mfma_f32_16x16x32_bf16 a[104:107], v[104:107], v[132:135], a[104:107]
    ds_read_b128 v[88:91], v17 offset:7168
    v_mfma_f32_16x16x32_bf16 a[108:111], v[104:107], v[136:139], a[108:111]
    v_mfma_f32_16x16x32_bf16 a[112:115], v[104:107], v[140:143], a[112:115]
    buffer_load_dwordx4 v11, s[8:11], s30 offen offset:3072 sc1 lds
    v_mfma_f32_16x16x32_bf16 a[116:119], v[104:107], v[144:147], a[116:119]
    v_mfma_f32_16x16x32_bf16 a[120:123], v[104:107], v[148:151], a[120:123]
    v_mfma_f32_16x16x32_bf16 a[124:127], v[104:107], v[152:155], a[124:127]
    v_mfma_f32_16x16x32_bf16 a[128:131], v[108:111], v[124:127], a[128:131]
    v_mfma_f32_16x16x32_bf16 a[132:135], v[108:111], v[128:131], a[132:135]
    v_mfma_f32_16x16x32_bf16 a[136:139], v[108:111], v[132:135], a[136:139]
    v_mfma_f32_16x16x32_bf16 a[140:143], v[108:111], v[136:139], a[140:143]
    v_mfma_f32_16x16x32_bf16 a[144:147], v[108:111], v[140:143], a[144:147]
    s_add_u32 m0, s40, 32768
    s_add_u32 s30, s30, 1024
    buffer_load_dwordx4 v12, s[12:15], s31 offen offset:0 lds
    v_mfma_f32_16x16x32_bf16 a[148:151], v[108:111], v[144:147], a[148:151]
    v_mfma_f32_16x16x32_bf16 a[152:155], v[108:111], v[148:151], a[152:155]
    v_mfma_f32_16x16x32_bf16 a[156:159], v[108:111], v[152:155], a[156:159]
    v_mfma_f32_16x16x32_bf16 a[160:163], v[112:115], v[124:127], a[160:163]
    v_mfma_f32_16x16x32_bf16 a[164:167], v[112:115], v[128:131], a[164:167]
    v_mfma_f32_16x16x32_bf16 a[168:171], v[112:115], v[132:135], a[168:171]
    v_mfma_f32_16x16x32_bf16 a[172:175], v[112:115], v[136:139], a[172:175]
    v_mfma_f32_16x16x32_bf16 a[176:179], v[112:115], v[140:143], a[176:179]
    buffer_load_dwordx4 v13, s[12:15], s31 offen offset:1024 lds
    v_mfma_f32_16x16x32_bf16 a[180:183], v[112:115], v[144:147], a[180:183]
    v_mfma_f32_16x16x32_bf16 a[184:187], v[112:115], v[148:151], a[184:187]
    v_mfma_f32_16x16x32_bf16 a[188:191], v[112:115], v[152:155], a[188:191]
    v_mfma_f32_16x16x32_bf16 a[192:195], v[116:119], v[124:127], a[192:195]
    v_mfma_f32_16x16x32_bf16 a[196:199], v[116:119], v[128:131], a[196:199]
    v_mfma_f32_16x16x32_bf16 a[200:203], v[116:119], v[132:135], a[200:203]
    v_mfma_f32_16x16x32_bf16 a[204:207], v[116:119], v[136:139], a[204:207]
    v_mfma_f32_16x16x32_bf16 a[208:211], v[116:119], v[140:143], a[208:211]
    buffer_load_dwordx4 v14, s[12:15], s31 offen offset:2048 lds
    v_mfma_f32_16x16x32_bf16 a[212:215], v[116:119], v[144:147], a[212:215]
    v_mfma_f32_16x16x32_bf16 a[216:219], v[116:119], v[148:151], a[216:219]
    v_mfma_f32_16x16x32_bf16 a[220:223], v[116:119], v[152:155], a[220:223]
    v_mfma_f32_16x16x32_bf16 a[224:227], v[120:123], v[124:127], a[224:227]
    v_mfma_f32_16x16x32_bf16 a[228:231], v[120:123], v[128:131], a[228:231]
    v_mfma_f32_16x16x32_bf16 a[232:235], v[120:123], v[132:135], a[232:235]
    v_mfma_f32_16x16x32_bf16 a[236:239], v[120:123], v[136:139], a[236:239]
    v_mfma_f32_16x16x32_bf16 a[240:243], v[120:123], v[140:143], a[240:243]
    buffer_load_dwordx4 v15, s[12:15], s31 offen offset:3072 lds
    s_add_u32 s31, s31, s34
    v_mfma_f32_16x16x32_bf16 a[244:247], v[120:123], v[144:147], a[244:247]
    v_mfma_f32_16x16x32_bf16 a[248:251], v[120:123], v[148:151], a[248:251]
    v_mfma_f32_16x16x32_bf16 a[252:255], v[120:123], v[152:155], a[252:255]
    s_waitcnt lgkmcnt(0)
    v_mfma_f32_16x16x32_bf16 a[0:3], v[28:31], v[60:63], a[0:3]
    s_waitcnt vmcnt(16)
    s_barrier
    ds_read_b64_tr_b16 v[92:93], v22 offset:32768
    v_mfma_f32_16x16x32_bf16 a[4:7], v[28:31], v[64:67], a[4:7]
    ds_read_b64_tr_b16 v[94:95], v22 offset:36864
    v_mfma_f32_16x16x32_bf16 a[8:11], v[28:31], v[68:71], a[8:11]
    ds_read_b128 v[124:127], v17 offset:32768
    v_mfma_f32_16x16x32_bf16 a[12:15], v[28:31], v[72:75], a[12:15]
    ds_read_b64_tr_b16 v[96:97], v23 offset:32768
    v_mfma_f32_16x16x32_bf16 a[16:19], v[28:31], v[76:79], a[16:19]
    s_add_u32 m0, s39, 65536
    s_nop 0
    buffer_load_dwordx4 v8, s[8:11], s30 offen offset:0 sc1 lds
    v_mfma_f32_16x16x32_bf16 a[20:23], v[28:31], v[80:83], a[20:23]
    ds_read_b64_tr_b16 v[98:99], v23 offset:36864
    v_mfma_f32_16x16x32_bf16 a[24:27], v[28:31], v[84:87], a[24:27]
    ds_read_b128 v[128:131], v17 offset:33792
    v_mfma_f32_16x16x32_bf16 a[28:31], v[28:31], v[88:91], a[28:31]
    ds_read_b64_tr_b16 v[100:101], v24 offset:32768
    v_mfma_f32_16x16x32_bf16 a[32:35], v[32:35], v[60:63], a[32:35]
    ds_read_b64_tr_b16 v[102:103], v24 offset:36864
    v_mfma_f32_16x16x32_bf16 a[36:39], v[32:35], v[64:67], a[36:39]
    ds_read_b128 v[132:135], v17 offset:34816
    v_mfma_f32_16x16x32_bf16 a[40:43], v[32:35], v[68:71], a[40:43]
    ds_read_b64_tr_b16 v[104:105], v25 offset:32768
    v_mfma_f32_16x16x32_bf16 a[44:47], v[32:35], v[72:75], a[44:47]
    ds_read_b64_tr_b16 v[106:107], v25 offset:36864
    v_mfma_f32_16x16x32_bf16 a[48:51], v[32:35], v[76:79], a[48:51]
    buffer_load_dwordx4 v9, s[8:11], s30 offen offset:1024 sc1 lds
    v_mfma_f32_16x16x32_bf16 a[52:55], v[32:35], v[80:83], a[52:55]
    ds_read_b128 v[136:139], v17 offset:35840
    v_mfma_f32_16x16x32_bf16 a[56:59], v[32:35], v[84:87], a[56:59]
    ds_read_b64_tr_b16 v[108:109], v22 offset:40960
    v_mfma_f32_16x16x32_bf16 a[60:63], v[32:35], v[88:91], a[60:63]
    ds_read_b64_tr_b16 v[110:111], v22 offset:45056
    v_mfma_f32_16x16x32_bf16 a[64:67], v[36:39], v[60:63], a[64:67]
    ds_read_b128 v[140:143], v17 offset:36864
    v_mfma_f32_16x16x32_bf16 a[68:71], v[36:39], v[64:67], a[68:71]
    ds_read_b64_tr_b16 v[112:113], v23 offset:40960
    v_mfma_f32_16x16x32_bf16 a[72:75], v[36:39], v[68:71], a[72:75]
    ds_read_b64_tr_b16 v[114:115], v23 offset:45056
    v_mfma_f32_16x16x32_bf16 a[76:79], v[36:39], v[72:75], a[76:79]
    ds_read_b128 v[144:147], v17 offset:37888
    v_mfma_f32_16x16x32_bf16 a[80:83], v[36:39], v[76:79], a[80:83]
    buffer_load_dwordx4 v10, s[8:11], s30 offen offset:2048 sc1 lds
    v_mfma_f32_16x16x32_bf16 a[84:87], v[36:39], v[80:83], a[84:87]
    ds_read_b64_tr_b16 v[116:117], v24 offset:40960
    v_mfma_f32_16x16x32_bf16 a[88:91], v[36:39], v[84:87], a[88:91]
    ds_read_b64_tr_b16 v[118:119], v24 offset:45056
    v_mfma_f32_16x16x32_bf16 a[92:95], v[36:39], v[88:91], a[92:95]
    ds_read_b128 v[148:151], v17 offset:38912
    v_mfma_f32_16x16x32_bf16 a[96:99], v[40:43], v[60:63], a[96:99]
    ds_read_b64_tr_b16 v[120:121], v25 offset:40960
    v_mfma_f32_16x16x32_bf16 a[100:103], v[40:43], v[64:67], a[100:103]
    ds_read_b64_tr_b16 v[122:123], v25 offset:45056
    v_mfma_f32_16x16x32_bf16 a[104:107], v[40:43], v[68:71], a[104:107]
    ds_read_b128 v[152:155], v17 offset:39936
    v_mfma_f32_16x16x32_bf16 a[108:111], v[40:43], v[72:75], a[108:111]
    v_mfma_f32_16x16x32_bf16 a[112:115], v[40:43], v[76:79], a[112:115]
    buffer_load_dwordx4 v11, s[8:11], s30 offen offset:3072 sc1 lds
    v_mfma_f32_16x16x32_bf16 a[116:119], v[40:43], v[80:83], a[116:119]
    v_mfma_f32_16x16x32_bf16 a[120:123], v[40:43], v[84:87], a[120:123]
    v_mfma_f32_16x16x32_bf16 a[124:127], v[40:43], v[88:91], a[124:127]
    v_mfma_f32_16x16x32_bf16 a[128:131], v[44:47], v[60:63], a[128:131]
    v_mfma_f32_16x16x32_bf16 a[132:135], v[44:47], v[64:67], a[132:135]
    v_mfma_f32_16x16x32_bf16 a[136:139], v[44:47], v[68:71], a[136:139]
    v_mfma_f32_16x16x32_bf16 a[140:143], v[44:47], v[72:75], a[140:143]
    v_mfma_f32_16x16x32_bf16 a[144:147], v[44:47], v[76:79], a[144:147]
    s_add_u32 m0, s40, 65536
    s_add_u32 s30, s30, 1024
    buffer_load_dwordx4 v12, s[12:15], s31 offen offset:0 lds
    v_mfma_f32_16x16x32_bf16 a[148:151], v[44:47], v[80:83], a[148:151]
    v_mfma_f32_16x16x32_bf16 a[152:155], v[44:47], v[84:87], a[152:155]
    v_mfma_f32_16x16x32_bf16 a[156:159], v[44:47], v[88:91], a[156:159]
    v_mfma_f32_16x16x32_bf16 a[160:163], v[48:51], v[60:63], a[160:163]
    v_mfma_f32_16x16x32_bf16 a[164:167], v[48:51], v[64:67], a[164:167]
    v_mfma_f32_16x16x32_bf16 a[168:171], v[48:51], v[68:71], a[168:171]
    v_mfma_f32_16x16x32_bf16 a[172:175], v[48:51], v[72:75], a[172:175]
    v_mfma_f32_16x16x32_bf16 a[176:179], v[48:51], v[76:79], a[176:179]
    buffer_load_dwordx4 v13, s[12:15], s31 offen offset:1024 lds
    v_mfma_f32_16x16x32_bf16 a[180:183], v[48:51], v[80:83], a[180:183]
    v_mfma_f32_16x16x32_bf16 a[184:187], v[48:51], v[84:87], a[184:187]
    v_mfma_f32_16x16x32_bf16 a[188:191], v[48:51], v[88:91], a[188:191]
    v_mfma_f32_16x16x32_bf16 a[192:195], v[52:55], v[60:63], a[192:195]
    v_mfma_f32_16x16x32_bf16 a[196:199], v[52:55], v[64:67], a[196:199]
    v_mfma_f32_16x16x32_bf16 a[200:203], v[52:55], v[68:71], a[200:203]
    v_mfma_f32_16x16x32_bf16 a[204:207], v[52:55], v[72:75], a[204:207]
    v_mfma_f32_16x16x32_bf16 a[208:211], v[52:55], v[76:79], a[208:211]
    buffer_load_dwordx4 v14, s[12:15], s31 offen offset:2048 lds
    v_mfma_f32_16x16x32_bf16 a[212:215], v[52:55], v[80:83], a[212:215]
    v_mfma_f32_16x16x32_bf16 a[216:219], v[52:55], v[84:87], a[216:219]
    v_mfma_f32_16x16x32_bf16 a[220:223], v[52:55], v[88:91], a[220:223]
    v_mfma_f32_16x16x32_bf16 a[224:227], v[56:59], v[60:63], a[224:227]
    v_mfma_f32_16x16x32_bf16 a[228:231], v[56:59], v[64:67], a[228:231]
    v_mfma_f32_16x16x32_bf16 a[232:235], v[56:59], v[68:71], a[232:235]
    v_mfma_f32_16x16x32_bf16 a[236:239], v[56:59], v[72:75], a[236:239]
    v_mfma_f32_16x16x32_bf16 a[240:243], v[56:59], v[76:79], a[240:243]
    buffer_load_dwordx4 v15, s[12:15], s31 offen offset:3072 lds
    s_add_u32 s31, s31, s34
    v_mfma_f32_16x16x32_bf16 a[244:247], v[56:59], v[80:83], a[244:247]
    v_mfma_f32_16x16x32_bf16 a[248:251], v[56:59], v[84:87], a[248:251]
    v_mfma_f32_16x16x32_bf16 a[252:255], v[56:59], v[88:91], a[252:255]
    s_waitcnt lgkmcnt(0)
    v_mfma_f32_16x16x32_bf16 a[0:3], v[92:95], v[124:127], a[0:3]
    s_waitcnt vmcnt(16)
    s_barrier
    ds_read_b64_tr_b16 v[28:29], v18 offset:0
    v_mfma_f32_16x16x32_bf16 a[4:7], v[92:95], v[128:131], a[4:7]
    ds_read_b64_tr_b16 v[30:31], v18 offset:4096
    v_mfma_f32_16x16x32_bf16 a[8:11], v[92:95], v[132:135], a[8:11]
    ds_read_b128 v[60:63], v16 offset:0
    v_mfma_f32_16x16x32_bf16 a[12:15], v[92:95], v[136:139], a[12:15]
    ds_read_b64_tr_b16 v[32:33], v19 offset:0
    v_mfma_f32_16x16x32_bf16 a[16:19], v[92:95], v[140:143], a[16:19]
    s_add_u32 m0, s39, 98304
    s_nop 0
    buffer_load_dwordx4 v8, s[8:11], s30 offen offset:0 sc1 lds
    v_mfma_f32_16x16x32_bf16 a[20:23], v[92:95], v[144:147], a[20:23]
    ds_read_b64_tr_b16 v[34:35], v19 offset:4096
    v_mfma_f32_16x16x32_bf16 a[24:27], v[92:95], v[148:151], a[24:27]
    ds_read_b128 v[64:67], v16 offset:1024
    v_mfma_f32_16x16x32_bf16 a[28:31], v[92:95], v[152:155], a[28:31]
    ds_read_b64_tr_b16 v[36:37], v20 offset:0
    v_mfma_f32_16x16x32_bf16 a[32:35], v[96:99], v[124:127], a[32:35]
    ds_read_b64_tr_b16 v[38:39], v20 offset:4096
    v_mfma_f32_16x16x32_bf16 a[36:39], v[96:99], v[128:131], a[36:39]
    ds_read_b128 v[68:71], v16 offset:2048
    v_mfma_f32_16x16x32_bf16 a[40:43], v[96:99], v[132:135], a[40:43]
    ds_read_b64_tr_b16 v[40:41], v21 offset:0
    v_mfma_f32_16x16x32_bf16 a[44:47], v[96:99], v[136:139], a[44:47]
    ds_read_b64_tr_b16 v[42:43], v21 offset:4096
    v_mfma_f32_16x16x32_bf16 a[48:51], v[96:99], v[140:143], a[48:51]
    buffer_load_dwordx4 v9, s[8:11], s30 offen offset:1024 sc1 lds
    v_mfma_f32_16x16x32_bf16 a[52:55], v[96:99], v[144:147], a[52:55]
    ds_read_b128 v[72:75], v16 offset:3072
    v_mfma_f32_16x16x32_bf16 a[56:59], v[96:99], v[148:151], a[56:59]
    ds_read_b64_tr_b16 v[44:45], v18 offset:8192
    v_mfma_f32_16x16x32_bf16 a[60:63], v[96:99], v[152:155], a[60:63]
    ds_read_b64_tr_b16 v[46:47], v18 offset:12288
    v_mfma_f32_16x16x32_bf16 a[64:67], v[100:103], v[124:127], a[64:67]
    ds_read_b128 v[76:79], v16 offset:4096
    v_mfma_f32_16x16x32_bf16 a[68:71], v[100:103], v[128:131], a[68:71]
    ds_read_b64_tr_b16 v[48:49], v19 offset:8192
    v_mfma_f32_16x16x32_bf16 a[72:75], v[100:103], v[132:135], a[72:75]
    ds_read_b64_tr_b16 v[50:51], v19 offset:12288
    v_mfma_f32_16x16x32_bf16 a[76:79], v[100:103], v[136:139], a[76:79]
    ds_read_b128 v[80:83], v16 offset:5120
    v_mfma_f32_16x16x32_bf16 a[80:83], v[100:103], v[140:143], a[80:83]
    buffer_load_dwordx4 v10, s[8:11], s30 offen offset:2048 sc1 lds
    v_mfma_f32_16x16x32_bf16 a[84:87], v[100:103], v[144:147], a[84:87]
    ds_read_b64_tr_b16 v[52:53], v20 offset:8192
    v_mfma_f32_16x16x32_bf16 a[88:91], v[100:103], v[148:151], a[88:91]
    ds_read_b64_tr_b16 v[54:55], v20 offset:12288
    v_mfma_f32_16x16x32_bf16 a[92:95], v[100:103], v[152:155], a[92:95]
    ds_read_b128 v[84:87], v16 offset:6144
    v_mfma_f32_16x16x32_bf16 a[96:99], v[104:107], v[124:127], a[96:99]
    ds_read_b64_tr_b16 v[56:57], v21 offset:8192
    v_mfma_f32_16x16x32_bf16 a[100:103], v[104:107], v[128:131], a[100:103]
    ds_read_b64_tr_b16 v[58:59], v21 offset:12288
    v_mfma_f32_16x16x32_bf16 a[104:107], v[104:107], v[132:135], a[104:107]
    ds_read_b128 v[88:91], v16 offset:7168
    v_mfma_f32_16x16x32_bf16 a[108:111], v[104:107], v[136:139], a[108:111]
    v_mfma_f32_16x16x32_bf16 a[112:115], v[104:107], v[140:143], a[112:115]
    buffer_load_dwordx4 v11, s[8:11], s30 offen offset:3072 sc1 lds
    v_mfma_f32_16x16x32_bf16 a[116:119], v[104:107], v[144:147], a[116:119]
    v_mfma_f32_16x16x32_bf16 a[120:123], v[104:107], v[148:151], a[120:123]
    v_mfma_f32_16x16x32_bf16 a[124:127], v[104:107], v[152:155], a[124:127]
    v_mfma_f32_16x16x32_bf16 a[128:131], v[108:111], v[124:127], a[128:131]
    v_mfma_f32_16x16x32_bf16 a[132:135], v[108:111], v[128:131], a[132:135]
    v_mfma_f32_16x16x32_bf16 a[136:139], v[108:111], v[132:135], a[136:139]
    v_mfma_f32_16x16x32_bf16 a[140:143], v[108:111], v[136:139], a[140:143]
    v_mfma_f32_16x16x32_bf16 a[144:147], v[108:111], v[140:143], a[144:147]
    s_add_u32 m0, s40, 98304
    s_add_u32 s30, s30, 1024
    buffer_load_dwordx4 v12, s[12:15], s31 offen offset:0 lds
    v_mfma_f32_16x16x32_bf16 a[148:151], v[108:111], v[144:147], a[148:151]
    v_mfma_f32_16x16x32_bf16 a[152:155], v[108:111], v[148:151], a[152:155]
    v_mfma_f32_16x16x32_bf16 a[156:159], v[108:111], v[152:155], a[156:159]
    v_mfma_f32_16x16x32_bf16 a[160:163], v[112:115], v[124:127], a[160:163]
    v_mfma_f32_16x16x32_bf16 a[164:167], v[112:115], v[128:131], a[164:167]
    v_mfma_f32_16x16x32_bf16 a[168:171], v[112:115], v[132:135], a[168:171]
    v_mfma_f32_16x16x32_bf16 a[172:175], v[112:115], v[136:139], a[172:175]
    v_mfma_f32_16x16x32_bf16 a[176:179], v[112:115], v[140:143], a[176:179]
    buffer_load_dwordx4 v13, s[12:15], s31 offen offset:1024 lds
    v_mfma_f32_16x16x32_bf16 a[180:183], v[112:115], v[144:147], a[180:183]
    v_mfma_f32_16x16x32_bf16 a[184:187], v[112:115], v[148:151], a[184:187]
    v_mfma_f32_16x16x32_bf16 a[188:191], v[112:115], v[152:155], a[188:191]
    v_mfma_f32_16x16x32_bf16 a[192:195], v[116:119], v[124:127], a[192:195]
    v_mfma_f32_16x16x32_bf16 a[196:199], v[116:119], v[128:131], a[196:199]
    v_mfma_f32_16x16x32_bf16 a[200:203], v[116:119], v[132:135], a[200:203]
    v_mfma_f32_16x16x32_bf16 a[204:207], v[116:119], v[136:139], a[204:207]
    v_mfma_f32_16x16x32_bf16 a[208:211], v[116:119], v[140:143], a[208:211]
    buffer_load_dwordx4 v14, s[12:15], s31 offen offset:2048 lds
    v_mfma_f32_16x16x32_bf16 a[212:215], v[116:119], v[144:147], a[212:215]
    v_mfma_f32_16x16x32_bf16 a[216:219], v[116:119], v[148:151], a[216:219]
    v_mfma_f32_16x16x32_bf16 a[220:223], v[116:119], v[152:155], a[220:223]
    v_mfma_f32_16x16x32_bf16 a[224:227], v[120:123], v[124:127], a[224:227]
    v_mfma_f32_16x16x32_bf16 a[228:231], v[120:123], v[128:131], a[228:231]
    v_mfma_f32_16x16x32_bf16 a[232:235], v[120:123], v[132:135], a[232:235]
    v_mfma_f32_16x16x32_bf16 a[236:239], v[120:123], v[136:139], a[236:239]
    v_mfma_f32_16x16x32_bf16 a[240:243], v[120:123], v[140:143], a[240:243]
    buffer_load_dwordx4 v15, s[12:15], s31 offen offset:3072 lds
    s_add_u32 s31, s31, s34
    v_mfma_f32_16x16x32_bf16 a[244:247], v[120:123], v[144:147], a[244:247]
    v_mfma_f32_16x16x32_bf16 a[248:251], v[120:123], v[148:151], a[248:251]
    v_mfma_f32_16x16x32_bf16 a[252:255], v[120:123], v[152:155], a[252:255]
    s_sub_u32 s35, s35, 1
    s_cmp_lg_u32 s35, 0
    s_cbranch_scc1 L_ga_loop
    s_waitcnt lgkmcnt(0)
    s_nop 7
    s_cmp_eq_u32 s36, 0
    s_cbranch_scc1 L_na_n
    s_cmp_lg_u32 s63, -1
    s_cbranch_scc1 L_na_c
    v_mov_b32 v4, 192
L_na_p:
    buffer_load_dword v5, v4, s[16:19], 0 offen sc1
    s_sub_u32 s62, s62, 1
    s_cbranch_scc1 L_w_fail
    s_waitcnt vmcnt(0)
    v_readfirstlane_b32 s4, v5
    s_and_b32 s5, s4, 0xffff
    s_cmp_lt_u32 s5, 8
    s_cbranch_scc1 L_na_p
    s_lshr_b32 s4, s4, 16
    s_cmp_ge_u32 s4, 4
    s_cselect_b32 s63, 8192, 0
L_na_c:
    s_lshl_b32 s4, s21, 12
    s_xor_b32 s4, s4, s63
    s_and_b32 s4, s4, 8192
    s_add_u32 s37, s37, s4
L_na_n:
    s_lshr_b32 s4, s55, 28
    s_cmp_eq_u32 s4, 0
    s_cbranch_scc1 L_na_pf
    s_and_b32 s5, s55, 0xfffffff
    s_and_b32 s6, s21, 1
    s_lshl_b32 s6, s6, 15
    s_add_u32 s5, s5, s6
    s_cmp_lt_u32 s21, 2
    s_cselect_b32 s12, s80, s82
    s_cselect_b32 s13, s81, s83
    s_mov_b32 s14, 0x700000
    s_mov_b32 s15, 0x00020000
    s_cmp_eq_u32 s4, 1
    s_cbranch_scc1 L_na_p1
    s_mov_b32 s12, s84
    s_mov_b32 s13, s85
    s_mov_b32 s14, 0x700000
    s_mov_b32 s15, 0x00020000
    s_lshr_b32 s6, s21, 1
    s_lshl_b32 s6, s6, 16
    s_add_u32 s5, s5, s6
L_na_p1:
    v_lshlrev_b32 v4, 7, v1
    buffer_load_dword v5, v4, s[12:15], s5 offen
    buffer_load_dword v5, v4, s[12:15], s5 offen offset:64
    s_add_u32 s5, s5, 8192
    buffer_load_dword v5, v4, s[12:15], s5 offen
    buffer_load_dword v5, v4, s[12:15], s5 offen offset:64
    s_add_u32 s5, s5, 8192
    buffer_load_dword v5, v4, s[12:15], s5 offen
    buffer_load_dword v5, v4, s[12:15], s5 offen offset:64
    s_add_u32 s5, s5, 8192
    buffer_load_dword v5, v4, s[12:15], s5 offen
    buffer_load_dword v5, v4, s[12:15], s5 offen offset:64
    s_add_u32 s5, s5, 8192
L_na_pf:
    s_lshr_b32 s4, s21, 1
    s_mul_i32 s4, s4, 8
    s_mul_i32 s4, s4, s38
    s_add_u32 s4, s4, s37
    s_and_b32 s5, s21, 1
    s_mul_i32 s5, s5, 2048
    s_add_u32 s4, s4, s5
    s_add_u32 s5, s4, s41
    v_accvgpr_read_b32 v32, a0
    v_accvgpr_read_b32 v33, a1
    v_accvgpr_read_b32 v34, a2
    v_accvgpr_read_b32 v35, a3
    v_accvgpr_read_b32 v36, a32
    v_accvgpr_read_b32 v37, a33
    v_accvgpr_read_b32 v38, a34
    v_accvgpr_read_b32 v39, a35
    v_cvt_pk_bf16_f32 v28, v32, v33
    v_cvt_pk_bf16_f32 v29, v34, v35
    v_cvt_pk_bf16_f32 v30, v36, v37
    v_cvt_pk_bf16_f32 v31, v38, v39
    buffer_store_dwordx4 v[28:31], v2, s[8:11], s4 offen offset:0 sc1
    v_accvgpr_read_b32 v44, a64
    v_accvgpr_read_b32 v45, a65
    v_accvgpr_read_b32 v46, a66
    v_accvgpr_read_b32 v47, a67
    v_accvgpr_read_b32 v48, a96
    v_accvgpr_read_b32 v49, a97
    v_accvgpr_read_b32 v50, a98
    v_accvgpr_read_b32 v51, a99
    v_cvt_pk_bf16_f32 v40, v44, v45
    v_cvt_pk_bf16_f32 v41, v46, v47
    v_cvt_pk_bf16_f32 v42, v48, v49
    v_cvt_pk_bf16_f32 v43, v50, v51
    buffer_store_dwordx4 v[40:43], v2, s[8:11], s4 offen offset:1024 sc1
    v_accvgpr_read_b32 v56, a128
    v_accvgpr_read_b32 v57, a129
    v_accvgpr_read_b32 v58, a130
    v_accvgpr_read_b32 v59, a131
    v_accvgpr_read_b32 v60, a160
    v_accvgpr_read_b32 v61, a161
    v_accvgpr_read_b32 v62, a162
    v_accvgpr_read_b32 v63, a163
    v_cvt_pk_bf16_f32 v52, v56, v57
    v_cvt_pk_bf16_f32 v53, v58, v59
    v_cvt_pk_bf16_f32 v54, v60, v61
    v_cvt_pk_bf16_f32 v55, v62, v63
    buffer_store_dwordx4 v[52:55], v2, s[8:11], s5 offen offset:0 sc1
    v_accvgpr_read_b32 v68, a192
    v_accvgpr_read_b32 v69, a193
    v_accvgpr_read_b32 v70, a194
    v_accvgpr_read_b32 v71, a195
    v_accvgpr_read_b32 v72, a224
    v_accvgpr_read_b32 v73, a225
    v_accvgpr_read_b32 v74, a226
    v_accvgpr_read_b32 v75, a227
    v_cvt_pk_bf16_f32 v64, v68, v69
    v_cvt_pk_bf16_f32 v65, v70, v71
    v_cvt_pk_bf16_f32 v66, v72, v73
    v_cvt_pk_bf16_f32 v67, v74, v75
    buffer_store_dwordx4 v[64:67], v2, s[8:11], s5 offen offset:1024 sc1
    s_add_u32 s4, s4, s38
    s_add_u32 s5, s4, s41
    v_accvgpr_read_b32 v32, a4
    v_accvgpr_read_b32 v33, a5
    v_accvgpr_read_b32 v34, a6
    v_accvgpr_read_b32 v35, a7
    v_accvgpr_read_b32 v36, a36
    v_accvgpr_read_b32 v37, a37
    v_accvgpr_read_b32 v38, a38
    v_accvgpr_read_b32 v39, a39
    v_cvt_pk_bf16_f32 v28, v32, v33
    v_cvt_pk_bf16_f32 v29, v34, v35
    v_cvt_pk_bf16_f32 v30, v36, v37
    v_cvt_pk_bf16_f32 v31, v38, v39
    buffer_store_dwordx4 v[28:31], v2, s[8:11], s4 offen offset:0 sc1
    v_accvgpr_read_b32 v44, a68
    v_accvgpr_read_b32 v45, a69
    v_accvgpr_read_b32 v46, a70
    v_accvgpr_read_b32 v47, a71
    v_accvgpr_read_b32 v48, a100
    v_accvgpr_read_b32 v49, a101
    v_accvgpr_read_b32 v50, a102
    v_accvgpr_read_b32 v51, a103
    v_cvt_pk_bf16_f32 v40, v44, v45
    v_cvt_pk_bf16_f32 v41, v46, v47
    v_cvt_pk_bf16_f32 v42, v48, v49
    v_cvt_pk_bf16_f32 v43, v50, v51
    buffer_store_dwordx4 v[40:43], v2, s[8:11], s4 offen offset:1024 sc1
    v_accvgpr_read_b32 v56, a132
    v_accvgpr_read_b32 v57, a133
    v_accvgpr_read_b32 v58, a134
    v_accvgpr_read_b32 v59, a135
    v_accvgpr_read_b32 v60, a164
    v_accvgpr_read_b32 v61, a165
    v_accvgpr_read_b32 v62, a166
    v_accvgpr_read_b32 v63, a167
    v_cvt_pk_bf16_f32 v52, v56, v57
    v_cvt_pk_bf16_f32 v53, v58, v59
    v_cvt_pk_bf16_f32 v54, v60, v61
    v_cvt_pk_bf16_f32 v55, v62, v63
    buffer_store_dwordx4 v[52:55], v2, s[8:11], s5 offen offset:0 sc1
    v_accvgpr_read_b32 v68, a196
    v_accvgpr_read_b32 v69, a197
    v_accvgpr_read_b32 v70, a198
    v_accvgpr_read_b32 v71, a199
    v_accvgpr_read_b32 v72, a228
    v_accvgpr_read_b32 v73, a229
    v_accvgpr_read_b32 v74, a230
    v_accvgpr_read_b32 v75, a231
    v_cvt_pk_bf16_f32 v64, v68, v69
    v_cvt_pk_bf16_f32 v65, v70, v71
    v_cvt_pk_bf16_f32 v66, v72, v73
    v_cvt_pk_bf16_f32 v67, v74, v75
    buffer_store_dwordx4 v[64:67], v2, s[8:11], s5 offen offset:1024 sc1
    s_add_u32 s4, s4, s38
    s_add_u32 s5, s4, s41
    v_accvgpr_read_b32 v32, a8
    v_accvgpr_read_b32 v33, a9
    v_accvgpr_read_b32 v34, a10
    v_accvgpr_read_b32 v35, a11
    v_accvgpr_read_b32 v36, a40
    v_accvgpr_read_b32 v37, a41
    v_accvgpr_read_b32 v38, a42
    v_accvgpr_read_b32 v39, a43
    v_cvt_pk_bf16_f32 v28, v32, v33
    v_cvt_pk_bf16_f32 v29, v34, v35
    v_cvt_pk_bf16_f32 v30, v36, v37
    v_cvt_pk_bf16_f32 v31, v38, v39
    buffer_store_dwordx4 v[28:31], v2, s[8:11], s4 offen offset:0 sc1
    v_accvgpr_read_b32 v44, a72
    v_accvgpr_read_b32 v45, a73
    v_accvgpr_read_b32 v46, a74
    v_accvgpr_read_b32 v47, a75
    v_accvgpr_read_b32 v48, a104
    v_accvgpr_read_b32 v49, a105
    v_accvgpr_read_b32 v50, a106
    v_accvgpr_read_b32 v51, a107
    v_cvt_pk_bf16_f32 v40, v44, v45
    v_cvt_pk_bf16_f32 v41, v46, v47
    v_cvt_pk_bf16_f32 v42, v48, v49
    v_cvt_pk_bf16_f32 v43, v50, v51
    buffer_store_dwordx4 v[40:43], v2, s[8:11], s4 offen offset:1024 sc1
    v_accvgpr_read_b32 v56, a136
    v_accvgpr_read_b32 v57, a137
    v_accvgpr_read_b32 v58, a138
    v_accvgpr_read_b32 v59, a139
    v_accvgpr_read_b32 v60, a168
    v_accvgpr_read_b32 v61, a169
    v_accvgpr_read_b32 v62, a170
    v_accvgpr_read_b32 v63, a171
    v_cvt_pk_bf16_f32 v52, v56, v57
    v_cvt_pk_bf16_f32 v53, v58, v59
    v_cvt_pk_bf16_f32 v54, v60, v61
    v_cvt_pk_bf16_f32 v55, v62, v63
    buffer_store_dwordx4 v[52:55], v2, s[8:11], s5 offen offset:0 sc1
    v_accvgpr_read_b32 v68, a200
    v_accvgpr_read_b32 v69, a201
    v_accvgpr_read_b32 v70, a202
    v_accvgpr_read_b32 v71, a203
    v_accvgpr_read_b32 v72, a232
    v_accvgpr_read_b32 v73, a233
    v_accvgpr_read_b32 v74, a234
    v_accvgpr_read_b32 v75, a235
    v_cvt_pk_bf16_f32 v64, v68, v69
    v_cvt_pk_bf16_f32 v65, v70, v71
    v_cvt_pk_bf16_f32 v66, v72, v73
    v_cvt_pk_bf16_f32 v67, v74, v75
    buffer_store_dwordx4 v[64:67], v2, s[8:11], s5 offen offset:1024 sc1
    s_add_u32 s4, s4, s38
    s_add_u32 s5, s4, s41
    v_accvgpr_read_b32 v32, a12
    v_accvgpr_read_b32 v33, a13
    v_accvgpr_read_b32 v34, a14
    v_accvgpr_read_b32 v35, a15
    v_accvgpr_read_b32 v36, a44
    v_accvgpr_read_b32 v37, a45
    v_accvgpr_read_b32 v38, a46
    v_accvgpr_read_b32 v39, a47
    v_cvt_pk_bf16_f32 v28, v32, v33
    v_cvt_pk_bf16_f32 v29, v34, v35
    v_cvt_pk_bf16_f32 v30, v36, v37
    v_cvt_pk_bf16_f32 v31, v38, v39
    buffer_store_dwordx4 v[28:31], v2, s[8:11], s4 offen offset:0 sc1
    v_accvgpr_read_b32 v44, a76
    v_accvgpr_read_b32 v45, a77
    v_accvgpr_read_b32 v46, a78
    v_accvgpr_read_b32 v47, a79
    v_accvgpr_read_b32 v48, a108
    v_accvgpr_read_b32 v49, a109
    v_accvgpr_read_b32 v50, a110
    v_accvgpr_read_b32 v51, a111
    v_cvt_pk_bf16_f32 v40, v44, v45
    v_cvt_pk_bf16_f32 v41, v46, v47
    v_cvt_pk_bf16_f32 v42, v48, v49
    v_cvt_pk_bf16_f32 v43, v50, v51
    buffer_store_dwordx4 v[40:43], v2, s[8:11], s4 offen offset:1024 sc1
    v_accvgpr_read_b32 v56, a140
    v_accvgpr_read_b32 v57, a141
    v_accvgpr_read_b32 v58, a142
    v_accvgpr_read_b32 v59, a143
    v_accvgpr_read_b32 v60, a172
    v_accvgpr_read_b32 v61, a173
    v_accvgpr_read_b32 v62, a174
    v_accvgpr_read_b32 v63, a175
    v_cvt_pk_bf16_f32 v52, v56, v57
    v_cvt_pk_bf16_f32 v53, v58, v59
    v_cvt_pk_bf16_f32 v54, v60, v61
    v_cvt_pk_bf16_f32 v55, v62, v63
    buffer_store_dwordx4 v[52:55], v2, s[8:11], s5 offen offset:0 sc1
    v_accvgpr_read_b32 v68, a204
    v_accvgpr_read_b32 v69, a205
    v_accvgpr_read_b32 v70, a206
    v_accvgpr_read_b32 v71, a207
    v_accvgpr_read_b32 v72, a236
    v_accvgpr_read_b32 v73, a237
    v_accvgpr_read_b32 v74, a238
    v_accvgpr_read_b32 v75, a239
    v_cvt_pk_bf16_f32 v64, v68, v69
    v_cvt_pk_bf16_f32 v65, v70, v71
    v_cvt_pk_bf16_f32 v66, v72, v73
    v_cvt_pk_bf16_f32 v67, v74, v75
    buffer_store_dwordx4 v[64:67], v2, s[8:11], s5 offen offset:1024 sc1
    s_add_u32 s4, s4, s38
    s_add_u32 s5, s4, s41
    v_accvgpr_read_b32 v32, a16
    v_accvgpr_read_b32 v33, a17
    v_accvgpr_read_b32 v34, a18
    v_accvgpr_read_b32 v35, a19
    v_accvgpr_read_b32 v36, a48
    v_accvgpr_read_b32 v37, a49
    v_accvgpr_read_b32 v38, a50
    v_accvgpr_read_b32 v39, a51
    v_cvt_pk_bf16_f32 v28, v32, v33
    v_cvt_pk_bf16_f32 v29, v34, v35
    v_cvt_pk_bf16_f32 v30, v36, v37
    v_cvt_pk_bf16_f32 v31, v38, v39
    buffer_store_dwordx4 v[28:31], v2, s[8:11], s4 offen offset:0 sc1
    v_accvgpr_read_b32 v44, a80
    v_accvgpr_read_b32 v45, a81
    v_accvgpr_read_b32 v46, a82
    v_accvgpr_read_b32 v47, a83
    v_accvgpr_read_b32 v48, a112
    v_accvgpr_read_b32 v49, a113
    v_accvgpr_read_b32 v50, a114
    v_accvgpr_read_b32 v51, a115
    v_cvt_pk_bf16_f32 v40, v44, v45
    v_cvt_pk_bf16_f32 v41, v46, v47
    v_cvt_pk_bf16_f32 v42, v48, v49
    v_cvt_pk_bf16_f32 v43, v50, v51
    buffer_store_dwordx4 v[40:43], v2, s[8:11], s4 offen offset:1024 sc1
    v_accvgpr_read_b32 v56, a144
    v_accvgpr_read_b32 v57, a145
    v_accvgpr_read_b32 v58, a146
    v_accvgpr_read_b32 v59, a147
    v_accvgpr_read_b32 v60, a176
    v_accvgpr_read_b32 v61, a177
    v_accvgpr_read_b32 v62, a178
    v_accvgpr_read_b32 v63, a179
    v_cvt_pk_bf16_f32 v52, v56, v57
    v_cvt_pk_bf16_f32 v53, v58, v59
    v_cvt_pk_bf16_f32 v54, v60, v61
    v_cvt_pk_bf16_f32 v55, v62, v63
    buffer_store_dwordx4 v[52:55], v2, s[8:11], s5 offen offset:0 sc1
    v_accvgpr_read_b32 v68, a208
    v_accvgpr_read_b32 v69, a209
    v_accvgpr_read_b32 v70, a210
    v_accvgpr_read_b32 v71, a211
    v_accvgpr_read_b32 v72, a240
    v_accvgpr_read_b32 v73, a241
    v_accvgpr_read_b32 v74, a242
    v_accvgpr_read_b32 v75, a243
    v_cvt_pk_bf16_f32 v64, v68, v69
    v_cvt_pk_bf16_f32 v65, v70, v71
    v_cvt_pk_bf16_f32 v66, v72, v73
    v_cvt_pk_bf16_f32 v67, v74, v75
    buffer_store_dwordx4 v[64:67], v2, s[8:11], s5 offen offset:1024 sc1
    s_add_u32 s4, s4, s38
    s_add_u32 s5, s4, s41
    v_accvgpr_read_b32 v32, a20
    v_accvgpr_read_b32 v33, a21
    v_accvgpr_read_b32 v34, a22
    v_accvgpr_read_b32 v35, a23
    v_accvgpr_read_b32 v36, a52
    v_accvgpr_read_b32 v37, a53
    v_accvgpr_read_b32 v38, a54
    v_accvgpr_read_b32 v39, a55
    v_cvt_pk_bf16_f32 v28, v32, v33
    v_cvt_pk_bf16_f32 v29, v34, v35
    v_cvt_pk_bf16_f32 v30, v36, v37
    v_cvt_pk_bf16_f32 v31, v38, v39
    buffer_store_dwordx4 v[28:31], v2, s[8:11], s4 offen offset:0 sc1
    v_accvgpr_read_b32 v44, a84
    v_accvgpr_read_b32 v45, a85
    v_accvgpr_read_b32 v46, a86
    v_accvgpr_read_b32 v47, a87
    v_accvgpr_read_b32 v48, a116
    v_accvgpr_read_b32 v49, a117
    v_accvgpr_read_b32 v50, a118
    v_accvgpr_read_b32 v51, a119
    v_cvt_pk_bf16_f32 v40, v44, v45
    v_cvt_pk_bf16_f32 v41, v46, v47
    v_cvt_pk_bf16_f32 v42, v48, v49
    v_cvt_pk_bf16_f32 v43, v50, v51
    buffer_store_dwordx4 v[40:43], v2, s[8:11], s4 offen offset:1024 sc1
    v_accvgpr_read_b32 v56, a148
    v_accvgpr_read_b32 v57, a149
    v_accvgpr_read_b32 v58, a150
    v_accvgpr_read_b32 v59, a151
    v_accvgpr_read_b32 v60, a180
    v_accvgpr_read_b32 v61, a181
    v_accvgpr_read_b32 v62, a182
    v_accvgpr_read_b32 v63, a183
    v_cvt_pk_bf16_f32 v52, v56, v57
    v_cvt_pk_bf16_f32 v53, v58, v59
    v_cvt_pk_bf16_f32 v54, v60, v61
    v_cvt_pk_bf16_f32 v55, v62, v63
    buffer_store_dwordx4 v[52:55], v2, s[8:11], s5 offen offset:0 sc1
    v_accvgpr_read_b32 v68, a212
    v_accvgpr_read_b32 v69, a213
    v_accvgpr_read_b32 v70, a214
    v_accvgpr_read_b32 v71, a215
    v_accvgpr_read_b32 v72, a244
    v_accvgpr_read_b32 v73, a245
    v_accvgpr_read_b32 v74, a246
    v_accvgpr_read_b32 v75, a247
    v_cvt_pk_bf16_f32 v64, v68, v69
    v_cvt_pk_bf16_f32 v65, v70, v71
    v_cvt_pk_bf16_f32 v66, v72, v73
    v_cvt_pk_bf16_f32 v67, v74, v75
    buffer_store_dwordx4 v[64:67], v2, s[8:11], s5 offen offset:1024 sc1
    s_add_u32 s4, s4, s38
    s_add_u32 s5, s4, s41
    v_accvgpr_read_b32 v32, a24
    v_accvgpr_read_b32 v33, a25
    v_accvgpr_read_b32 v34, a26
    v_accvgpr_read_b32 v35, a27
    v_accvgpr_read_b32 v36, a56
    v_accvgpr_read_b32 v37, a57
    v_accvgpr_read_b32 v38, a58
    v_accvgpr_read_b32 v39, a59
    v_cvt_pk_bf16_f32 v28, v32, v33
    v_cvt_pk_bf16_f32 v29, v34, v35
    v_cvt_pk_bf16_f32 v30, v36, v37
    v_cvt_pk_bf16_f32 v31, v38, v39
    buffer_store_dwordx4 v[28:31], v2, s[8:11], s4 offen offset:0 sc1
    v_accvgpr_read_b32 v44, a88
    v_accvgpr_read_b32 v45, a89
    v_accvgpr_read_b32 v46, a90
    v_accvgpr_read_b32 v47, a91
    v_accvgpr_read_b32 v48, a120
    v_accvgpr_read_b32 v49, a121
    v_accvgpr_read_b32 v50, a122
    v_accvgpr_read_b32 v51, a123
    v_cvt_pk_bf16_f32 v40, v44, v45
    v_cvt_pk_bf16_f32 v41, v46, v47
    v_cvt_pk_bf16_f32 v42, v48, v49
    v_cvt_pk_bf16_f32 v43, v50, v51
    buffer_store_dwordx4 v[40:43], v2, s[8:11], s4 offen offset:1024 sc1
    v_accvgpr_read_b32 v56, a152
    v_accvgpr_read_b32 v57, a153
    v_accvgpr_read_b32 v58, a154
    v_accvgpr_read_b32 v59, a155
    v_accvgpr_read_b32 v60, a184
    v_accvgpr_read_b32 v61, a185
    v_accvgpr_read_b32 v62, a186
    v_accvgpr_read_b32 v63, a187
    v_cvt_pk_bf16_f32 v52, v56, v57
    v_cvt_pk_bf16_f32 v53, v58, v59
    v_cvt_pk_bf16_f32 v54, v60, v61
    v_cvt_pk_bf16_f32 v55, v62, v63
    buffer_store_dwordx4 v[52:55], v2, s[8:11], s5 offen offset:0 sc1
    v_accvgpr_read_b32 v68, a216
    v_accvgpr_read_b32 v69, a217
    v_accvgpr_read_b32 v70, a218
    v_accvgpr_read_b32 v71, a219
    v_accvgpr_read_b32 v72, a248
    v_accvgpr_read_b32 v73, a249
    v_accvgpr_read_b32 v74, a250
    v_accvgpr_read_b32 v75, a251
    v_cvt_pk_bf16_f32 v64, v68, v69
    v_cvt_pk_bf16_f32 v65, v70, v71
    v_cvt_pk_bf16_f32 v66, v72, v73
    v_cvt_pk_bf16_f32 v67, v74, v75
    buffer_store_dwordx4 v[64:67], v2, s[8:11], s5 offen offset:1024 sc1
    s_add_u32 s4, s4, s38
    s_add_u32 s5, s4, s41
    v_accvgpr_read_b32 v32, a28
    v_accvgpr_read_b32 v33, a29
    v_accvgpr_read_b32 v34, a30
    v_accvgpr_read_b32 v35, a31
    v_accvgpr_read_b32 v36, a60
    v_accvgpr_read_b32 v37, a61
    v_accvgpr_read_b32 v38, a62
    v_accvgpr_read_b32 v39, a63
    v_cvt_pk_bf16_f32 v28, v32, v33
    v_cvt_pk_bf16_f32 v29, v34, v35
    v_cvt_pk_bf16_f32 v30, v36, v37
    v_cvt_pk_bf16_f32 v31, v38, v39
    buffer_store_dwordx4 v[28:31], v2, s[8:11], s4 offen offset:0 sc1
    v_accvgpr_read_b32 v44, a92
    v_accvgpr_read_b32 v45, a93
    v_accvgpr_read_b32 v46, a94
    v_accvgpr_read_b32 v47, a95
    v_accvgpr_read_b32 v48, a124
    v_accvgpr_read_b32 v49, a125
    v_accvgpr_read_b32 v50, a126
    v_accvgpr_read_b32 v51, a127
    v_cvt_pk_bf16_f32 v40, v44, v45
    v_cvt_pk_bf16_f32 v41, v46, v47
    v_cvt_pk_bf16_f32 v42, v48, v49
    v_cvt_pk_bf16_f32 v43, v50, v51
    buffer_store_dwordx4 v[40:43], v2, s[8:11], s4 offen offset:1024 sc1
    v_accvgpr_read_b32 v56, a156
    v_accvgpr_read_b32 v57, a157
    v_accvgpr_read_b32 v58, a158
    v_accvgpr_read_b32 v59, a159
    v_accvgpr_read_b32 v60, a188
    v_accvgpr_read_b32 v61, a189
    v_accvgpr_read_b32 v62, a190
    v_accvgpr_read_b32 v63, a191
    v_cvt_pk_bf16_f32 v52, v56, v57
    v_cvt_pk_bf16_f32 v53, v58, v59
    v_cvt_pk_bf16_f32 v54, v60, v61
    v_cvt_pk_bf16_f32 v55, v62, v63
    buffer_store_dwordx4 v[52:55], v2, s[8:11], s5 offen offset:0 sc1
    v_accvgpr_read_b32 v68, a220
    v_accvgpr_read_b32 v69, a221
    v_accvgpr_read_b32 v70, a222
    v_accvgpr_read_b32 v71, a223
    v_accvgpr_read_b32 v72, a252
    v_accvgpr_read_b32 v73, a253
    v_accvgpr_read_b32 v74, a254
    v_accvgpr_read_b32 v75, a255
    v_cvt_pk_bf16_f32 v64, v68, v69
    v_cvt_pk_bf16_f32 v65, v70, v71
    v_cvt_pk_bf16_f32 v66, v72, v73
    v_cvt_pk_bf16_f32 v67, v74, v75
    buffer_store_dwordx4 v[64:67], v2, s[8:11], s5 offen offset:1024 sc1
    s_add_u32 s4, s4, s38
    s_branch L_w_done
L_gas:
    s_mul_i32 s4, s21, 4
    s_mul_i32 s4, s4, s32
    s_sub_u32 s5, s32, 1024
    v_add_u32 v8, s4, v2
    s_add_u32 s4, s4, s5
    v_add_u32 v9, s4, v2
    s_add_u32 s4, s4, s5
    v_add_u32 v10, s4, v2
    s_add_u32 s4, s4, s5
    v_add_u32 v11, s4, v2
    v_lshrrev_b32 v4, 4, v1
    v_and_b32 v5, 15, v1
    s_and_b32 s6, s21, 1
    s_lshl_b32 s4, s6, 4
    s_add_u32 s5, s4, 0
    v_add_u32 v6, s5, v4
    v_and_b32 v7, 7, v6
    v_lshlrev_b32 v7, 1, v7
    v_xor_b32 v7, v7, v5
    v_lshlrev_b32 v7, 4, v7
    v_mul_lo_u32 v6, v6, s33
    v_add_u32 v6, v6, v7
    v_subrev_u32 v12, 0, v6
    s_add_u32 s5, s4, 4
    v_add_u32 v6, s5, v4
    v_and_b32 v7, 7, v6
    v_lshlrev_b32 v7, 1, v7
    v_xor_b32 v7, v7, v5
    v_lshlrev_b32 v7, 4, v7
    v_mul_lo_u32 v6, v6, s33
    v_add_u32 v6, v6, v7
    v_subrev_u32 v13, 1024, v6
    s_add_u32 s5, s4, 8
    v_add_u32 v6, s5, v4
    v_and_b32 v7, 7, v6
    v_lshlrev_b32 v7, 1, v7
    v_xor_b32 v7, v7, v5
    v_lshlrev_b32 v7, 4, v7
    v_mul_lo_u32 v6, v6, s33
    v_add_u32 v6, v6, v7
    v_subrev_u32 v14, 2048, v6
    s_add_u32 s5, s4, 12
    v_add_u32 v6, s5, v4
    v_and_b32 v7, 7, v6
    v_lshlrev_b32 v7, 1, v7
    v_xor_b32 v7, v7, v5
    v_lshlrev_b32 v7, 4, v7
    v_mul_lo_u32 v6, v6, s33
    v_add_u32 v6, v6, v7
    v_subrev_u32 v15, 3072, v6
    s_lshr_b32 s7, s21, 1
    s_mul_i32 s4, s7, 8192
    s_add_u32 s5, s4, 0
    v_add_u32 v16, s5, v2
    s_add_u32 s5, s4, 65536
    v_add_u32 v17, s5, v2
    v_lshrrev_b32 v5, 2, v1
    v_and_b32 v4, 7, v5
    v_mul_u32_u24 v5, 256, v5
    v_and_b32 v6, 3, v1
    v_lshl_add_u32 v5, v6, 3, v5
    s_mul_i32 s4, s6, 4
    s_add_u32 s4, s4, 0
    v_xor_b32 v6, s4, v4
    v_lshl_add_u32 v6, v6, 5, v5
    v_add_u32 v18, 16384, v6
    v_add_u32 v22, 81920, v6
    s_mul_i32 s4, s6, 4
    s_add_u32 s4, s4, 1
    v_xor_b32 v6, s4, v4
    v_lshl_add_u32 v6, v6, 5, v5
    v_add_u32 v19, 16384, v6
    v_add_u32 v23, 81920, v6
    s_mul_i32 s4, s6, 4
    s_add_u32 s4, s4, 2
    v_xor_b32 v6, s4, v4
    v_lshl_add_u32 v6, v6, 5, v5
    v_add_u32 v20, 16384, v6
    v_add_u32 v24, 81920, v6
    s_mul_i32 s4, s6, 4
    s_add_u32 s4, s4, 3
    v_xor_b32 v6, s4, v4
    v_lshl_add_u32 v6, v6, 5, v5
    v_add_u32 v21, 16384, v6
    v_add_u32 v25, 81920, v6
    s_mul_i32 s39, s21, 4096
    s_mul_i32 s40, s21, 4096
    s_add_u32 s40, s40, 16384
    s_lshl_b32 s34, s33, 5
    s_add_u32 m0, s39, 0
    s_nop 0
    buffer_load_dwordx4 v8, s[8:11], s30 offen offset:0 sc1 lds
    buffer_load_dwordx4 v9, s[8:11], s30 offen offset:1024 sc1 lds
    buffer_load_dwordx4 v10, s[8:11], s30 offen offset:2048 sc1 lds
    buffer_load_dwordx4 v11, s[8:11], s30 offen offset:3072 sc1 lds
    s_add_u32 m0, s40, 0
    s_add_u32 s30, s30, 1024
    buffer_load_dwordx4 v12, s[12:15], s31 offen offset:0 lds
    buffer_load_dwordx4 v13, s[12:15], s31 offen offset:1024 lds
    buffer_load_dwordx4 v14, s[12:15], s31 offen offset:2048 lds
    buffer_load_dwordx4 v15, s[12:15], s31 offen offset:3072 lds
    s_add_u32 s31, s31, s34
    s_add_u32 m0, s39, 32768
    s_nop 0
    buffer_load_dwordx4 v8, s[8:11], s30 offen offset:0 sc1 lds
    buffer_load_dwordx4 v9, s[8:11], s30 offen offset:1024 sc1 lds
    buffer_load_dwordx4 v10, s[8:11], s30 offen offset:2048 sc1 lds
    buffer_load_dwordx4 v11, s[8:11], s30 offen offset:3072 sc1 lds
    s_add_u32 m0, s40, 32768
    s_add_u32 s30, s30, 1024
    buffer_load_dwordx4 v12, s[12:15], s31 offen offset:0 lds
    buffer_load_dwordx4 v13, s[12:15], s31 offen offset:1024 lds
    buffer_load_dwordx4 v14, s[12:15], s31 offen offset:2048 lds
    buffer_load_dwordx4 v15, s[12:15], s31 offen offset:3072 lds
    s_add_u32 s31, s31, s34
    s_add_u32 m0, s39, 65536
    s_nop 0
    buffer_load_dwordx4 v8, s[8:11], s30 offen offset:0 sc1 lds
    buffer_load_dwordx4 v9, s[8:11], s30 offen offset:1024 sc1 lds
    buffer_load_dwordx4 v10, s[8:11], s30 offen offset:2048 sc1 lds
    buffer_load_dwordx4 v11, s[8:11], s30 offen offset:3072 sc1 lds
    s_add_u32 m0, s40, 65536
    s_add_u32 s30, s30, 1024
    buffer_load_dwordx4 v12, s[12:15], s31 offen offset:0 lds
    buffer_load_dwordx4 v13, s[12:15], s31 offen offset:1024 lds
    buffer_load_dwordx4 v14, s[12:15], s31 offen offset:2048 lds
    buffer_load_dwordx4 v15, s[12:15], s31 offen offset:3072 lds
    s_add_u32 s31, s31, s34
    s_add_u32 m0, s39, 98304
    s_nop 0
    buffer_load_dwordx4 v8, s[8:11], s30 offen offset:0 sc1 lds
    buffer_load_dwordx4 v9, s[8:11], s30 offen offset:1024 sc1 lds
    buffer_load_dwordx4 v10, s[8:11], s30 offen offset:2048 sc1 lds
    buffer_load_dwordx4 v11, s[8:11], s30 offen offset:3072 sc1 lds
    s_add_u32 m0, s40, 98304
    s_add_u32 s30, s30, 1024
    buffer_load_dwordx4 v12, s[12:15], s31 offen offset:0 lds
    buffer_load_dwordx4 v13, s[12:15], s31 offen offset:1024 lds
    buffer_load_dwordx4 v14, s[12:15], s31 offen offset:2048 lds
    buffer_load_dwordx4 v15, s[12:15], s31 offen offset:3072 lds
    s_add_u32 s31, s31, s34
    s_waitcnt vmcnt(24)
    s_barrier
    ds_read_b64_tr_b16 v[28:29], v18 offset:0
    ds_read_b64_tr_b16 v[30:31], v18 offset:4096
    ds_read_b128 v[60:63], v16 offset:0
    ds_read_b64_tr_b16 v[32:33], v19 offset:0
    ds_read_b64_tr_b16 v[34:35], v19 offset:4096
    ds_read_b128 v[64:67], v16 offset:1024
    ds_read_b64_tr_b16 v[36:37], v20 offset:0
    ds_read_b64_tr_b16 v[38:39], v20 offset:4096
    ds_read_b128 v[68:71], v16 offset:2048
    ds_read_b64_tr_b16 v[40:41], v21 offset:0
    ds_read_b64_tr_b16 v[42:43], v21 offset:4096
    ds_read_b128 v[72:75], v16 offset:3072
    ds_read_b64_tr_b16 v[44:45], v18 offset:8192
    ds_read_b64_tr_b16 v[46:47], v18 offset:12288
    ds_read_b128 v[76:79], v16 offset:4096
    ds_read_b64_tr_b16 v[48:49], v19 offset:8192
    ds_read_b64_tr_b16 v[50:51], v19 offset:12288
    ds_read_b128 v[80:83], v16 offset:5120
    ds_read_b64_tr_b16 v[52:53], v20 offset:8192
    ds_read_b64_tr_b16 v[54:55], v20 offset:12288
    ds_read_b128 v[84:87], v16 offset:6144
    ds_read_b64_tr_b16 v[56:57], v21 offset:8192
    ds_read_b64_tr_b16 v[58:59], v21 offset:12288
    ds_read_b128 v[88:91], v16 offset:7168
    s_waitcnt lgkmcnt(0)
    v_mfma_f32_16x16x32_bf16 a[0:3], v[60:63], v[28:31], 0
    s_waitcnt vmcnt(16)
    s_barrier
    ds_read_b64_tr_b16 v[92:93], v18 offset:32768
    v_mfma_f32_16x16x32_bf16 a[4:7], v[64:67], v[28:31], 0
    ds_read_b64_tr_b16 v[94:95], v18 offset:36864
    v_mfma_f32_16x16x32_bf16 a[8:11], v[68:71], v[28:31], 0
    ds_read_b128 v[124:127], v16 offset:32768
    v_mfma_f32_16x16x32_bf16 a[12:15], v[72:75], v[28:31], 0
    ds_read_b64_tr_b16 v[96:97], v19 offset:32768
    v_mfma_f32_16x16x32_bf16 a[16:19], v[76:79], v[28:31], 0
    s_add_u32 m0, s39, 0
    s_nop 0
    buffer_load_dwordx4 v8, s[8:11], s30 offen offset:0 sc1 lds
    v_mfma_f32_16x16x32_bf16 a[20:23], v[80:83], v[28:31], 0
    ds_read_b64_tr_b16 v[98:99], v19 offset:36864
    v_mfma_f32_16x16x32_bf16 a[24:27], v[84:87], v[28:31], 0
    ds_read_b128 v[128:131], v16 offset:33792
    v_mfma_f32_16x16x32_bf16 a[28:31], v[88:91], v[28:31], 0
    ds_read_b64_tr_b16 v[100:101], v20 offset:32768
    v_mfma_f32_16x16x32_bf16 a[32:35], v[60:63], v[32:35], 0
    ds_read_b64_tr_b16 v[102:103], v20 offset:36864
    v_mfma_f32_16x16x32_bf16 a[36:39], v[64:67], v[32:35], 0
    ds_read_b128 v[132:135], v16 offset:34816
    v_mfma_f32_16x16x32_bf16 a[40:43], v[68:71], v[32:35], 0
    ds_read_b64_tr_b16 v[104:105], v21 offset:32768
    v_mfma_f32_16x16x32_bf16 a[44:47], v[72:75], v[32:35], 0
    ds_read_b64_tr_b16 v[106:107], v21 offset:36864
    v_mfma_f32_16x16x32_bf16 a[48:51], v[76:79], v[32:35], 0
    buffer_load_dwordx4 v9, s[8:11], s30 offen offset:1024 sc1 lds
    v_mfma_f32_16x16x32_bf16 a[52:55], v[80:83], v[32:35], 0
    ds_read_b128 v[136:139], v16 offset:35840
    v_mfma_f32_16x16x32_bf16 a[56:59], v[84:87], v[32:35], 0
    ds_read_b64_tr_b16 v[108:109], v18 offset:40960
    v_mfma_f32_16x16x32_bf16 a[60:63], v[88:91], v[32:35], 0
    ds_read_b64_tr_b16 v[110:111], v18 offset:45056
    v_mfma_f32_16x16x32_bf16 a[64:67], v[60:63], v[36:39], 0
    ds_read_b128 v[140:143], v16 offset:36864
    v_mfma_f32_16x16x32_bf16 a[68:71], v[64:67], v[36:39], 0
    ds_read_b64_tr_b16 v[112:113], v19 offset:40960
    v_mfma_f32_16x16x32_bf16 a[72:75], v[68:71], v[36:39], 0
    ds_read_b64_tr_b16 v[114:115], v19 offset:45056
    v_mfma_f32_16x16x32_bf16 a[76:79], v[72:75], v[36:39], 0
    ds_read_b128 v[144:147], v16 offset:37888
    v_mfma_f32_16x16x32_bf16 a[80:83], v[76:79], v[36:39], 0
    buffer_load_dwordx4 v10, s[8:11], s30 offen offset:2048 sc1 lds
    v_mfma_f32_16x16x32_bf16 a[84:87], v[80:83], v[36:39], 0
    ds_read_b64_tr_b16 v[116:117], v20 offset:40960
    v_mfma_f32_16x16x32_bf16 a[88:91], v[84:87], v[36:39], 0
    ds_read_b64_tr_b16 v[118:119], v20 offset:45056
    v_mfma_f32_16x16x32_bf16 a[92:95], v[88:91], v[36:39], 0
    ds_read_b128 v[148:151], v16 offset:38912
    v_mfma_f32_16x16x32_bf16 a[96:99], v[60:63], v[40:43], 0
    ds_read_b64_tr_b16 v[120:121], v21 offset:40960
    v_mfma_f32_16x16x32_bf16 a[100:103], v[64:67], v[40:43], 0
    ds_read_b64_tr_b16 v[122:123], v21 offset:45056
    v_mfma_f32_16x16x32_bf16 a[104:107], v[68:71], v[40:43], 0
    ds_read_b128 v[152:155], v16 offset:39936
    v_mfma_f32_16x16x32_bf16 a[108:111], v[72:75], v[40:43], 0
    v_mfma_f32_16x16x32_bf16 a[112:115], v[76:79], v[40:43], 0
    buffer_load_dwordx4 v11, s[8:11], s30 offen offset:3072 sc1 lds
    v_mfma_f32_16x16x32_bf16 a[116:119], v[80:83], v[40:43], 0
    v_mfma_f32_16x16x32_bf16 a[120:123], v[84:87], v[40:43], 0
    v_mfma_f32_16x16x32_bf16 a[124:127], v[88:91], v[40:43], 0
    v_mfma_f32_16x16x32_bf16 a[128:131], v[60:63], v[44:47], 0
    v_mfma_f32_16x16x32_bf16 a[132:135], v[64:67], v[44:47], 0
    v_mfma_f32_16x16x32_bf16 a[136:139], v[68:71], v[44:47], 0
    v_mfma_f32_16x16x32_bf16 a[140:143], v[72:75], v[44:47], 0
    v_mfma_f32_16x16x32_bf16 a[144:147], v[76:79], v[44:47], 0
    s_add_u32 m0, s40, 0
    s_add_u32 s30, s30, 1024
    buffer_load_dwordx4 v12, s[12:15], s31 offen offset:0 lds
    v_mfma_f32_16x16x32_bf16 a[148:151], v[80:83], v[44:47], 0
    v_mfma_f32_16x16x32_bf16 a[152:155], v[84:87], v[44:47], 0
    v_mfma_f32_16x16x32_bf16 a[156:159], v[88:91], v[44:47], 0
    v_mfma_f32_16x16x32_bf16 a[160:163], v[60:63], v[48:51], 0
    v_mfma_f32_16x16x32_bf16 a[164:167], v[64:67], v[48:51], 0
    v_mfma_f32_16x16x32_bf16 a[168:171], v[68:71], v[48:51], 0
    v_mfma_f32_16x16x32_bf16 a[172:175], v[72:75], v[48:51], 0
    v_mfma_f32_16x16x32_bf16 a[176:179], v[76:79], v[48:51], 0
    buffer_load_dwordx4 v13, s[12:15], s31 offen offset:1024 lds
    v_mfma_f32_16x16x32_bf16 a[180:183], v[80:83], v[48:51], 0
    v_mfma_f32_16x16x32_bf16 a[184:187], v[84:87], v[48:51], 0
    v_mfma_f32_16x16x32_bf16 a[188:191], v[88:91], v[48:51], 0
    v_mfma_f32_16x16x32_bf16 a[192:195], v[60:63], v[52:55], 0
    v_mfma_f32_16x16x32_bf16 a[196:199], v[64:67], v[52:55], 0
    v_mfma_f32_16x16x32_bf16 a[200:203], v[68:71], v[52:55], 0
    v_mfma_f32_16x16x32_bf16 a[204:207], v[72:75], v[52:55], 0
    v_mfma_f32_16x16x32_bf16 a[208:211], v[76:79], v[52:55], 0
    buffer_load_dwordx4 v14, s[12:15], s31 offen offset:2048 lds
    v_mfma_f32_16x16x32_bf16 a[212:215], v[80:83], v[52:55], 0
    v_mfma_f32_16x16x32_bf16 a[216:219], v[84:87], v[52:55], 0
    v_mfma_f32_16x16x32_bf16 a[220:223], v[88:91], v[52:55], 0
    v_mfma_f32_16x16x32_bf16 a[224:227], v[60:63], v[56:59], 0
    v_mfma_f32_16x16x32_bf16 a[228:231], v[64:67], v[56:59], 0
    v_mfma_f32_16x16x32_bf16 a[232:235], v[68:71], v[56:59], 0
    v_mfma_f32_16x16x32_bf16 a[236:239], v[72:75], v[56:59], 0
    v_mfma_f32_16x16x32_bf16 a[240:243], v[76:79], v[56:59], 0
    buffer_load_dwordx4 v15, s[12:15], s31 offen offset:3072 lds
    s_add_u32 s31, s31, s34
    v_mfma_f32_16x16x32_bf16 a[244:247], v[80:83], v[56:59], 0
    v_mfma_f32_16x16x32_bf16 a[248:251], v[84:87], v[56:59], 0
    v_mfma_f32_16x16x32_bf16 a[252:255], v[88:91], v[56:59], 0
    s_branch L_gas_s1
L_gas_loop:
    s_cmp_eq_u32 s35, 1
    s_cselect_b32 s30, 0x80000000, s30
    s_cselect_b32 s31, 0x80000000, s31
    s_waitcnt lgkmcnt(0)
    v_mfma_f32_16x16x32_bf16 a[0:3], v[60:63], v[28:31], a[0:3]
    s_waitcnt vmcnt(16)
    s_barrier
    ds_read_b64_tr_b16 v[92:93], v18 offset:32768
    v_mfma_f32_16x16x32_bf16 a[4:7], v[64:67], v[28:31], a[4:7]
    ds_read_b64_tr_b16 v[94:95], v18 offset:36864
    v_mfma_f32_16x16x32_bf16 a[8:11], v[68:71], v[28:31], a[8:11]
    ds_read_b128 v[124:127], v16 offset:32768
    v_mfma_f32_16x16x32_bf16 a[12:15], v[72:75], v[28:31], a[12:15]
    ds_read_b64_tr_b16 v[96:97], v19 offset:32768
    v_mfma_f32_16x16x32_bf16 a[16:19], v[76:79], v[28:31], a[16:19]
    s_add_u32 m0, s39, 0
    s_nop 0
    buffer_load_dwordx4 v8, s[8:11], s30 offen offset:0 sc1 lds
    v_mfma_f32_16x16x32_bf16 a[20:23], v[80:83], v[28:31], a[20:23]
    ds_read_b64_tr_b16 v[98:99], v19 offset:36864
    v_mfma_f32_16x16x32_bf16 a[24:27], v[84:87], v[28:31], a[24:27]
    ds_read_b128 v[128:131], v16 offset:33792
    v_mfma_f32_16x16x32_bf16 a[28:31], v[88:91], v[28:31], a[28:31]
    ds_read_b64_tr_b16 v[100:101], v20 offset:32768
    v_mfma_f32_16x16x32_bf16 a[32:35], v[60:63], v[32:35], a[32:35]
    ds_read_b64_tr_b16 v[102:103], v20 offset:36864
    v_mfma_f32_16x16x32_bf16 a[36:39], v[64:67], v[32:35], a[36:39]
    ds_read_b128 v[132:135], v16 offset:34816
    v_mfma_f32_16x16x32_bf16 a[40:43], v[68:71], v[32:35], a[40:43]
    ds_read_b64_tr_b16 v[104:105], v21 offset:32768
    v_mfma_f32_16x16x32_bf16 a[44:47], v[72:75], v[32:35], a[44:47]
    ds_read_b64_tr_b16 v[106:107], v21 offset:36864
    v_mfma_f32_16x16x32_bf16 a[48:51], v[76:79], v[32:35], a[48:51]
    buffer_load_dwordx4 v9, s[8:11], s30 offen offset:1024 sc1 lds
    v_mfma_f32_16x16x32_bf16 a[52:55], v[80:83], v[32:35], a[52:55]
    ds_read_b128 v[136:139], v16 offset:35840
    v_mfma_f32_16x16x32_bf16 a[56:59], v[84:87], v[32:35], a[56:59]
    ds_read_b64_tr_b16 v[108:109], v18 offset:40960
    v_mfma_f32_16x16x32_bf16 a[60:63], v[88:91], v[32:35], a[60:63]
    ds_read_b64_tr_b16 v[110:111], v18 offset:45056
    v_mfma_f32_16x16x32_bf16 a[64:67], v[60:63], v[36:39], a[64:67]
    ds_read_b128 v[140:143], v16 offset:36864
    v_mfma_f32_16x16x32_bf16 a[68:71], v[64:67], v[36:39], a[68:71]
    ds_read_b64_tr_b16 v[112:113], v19 offset:40960
    v_mfma_f32_16x16x32_bf16 a[72:75], v[68:71], v[36:39], a[72:75]
    ds_read_b64_tr_b16 v[114:115], v19 offset:45056
    v_mfma_f32_16x16x32_bf16 a[76:79], v[72:75], v[36:39], a[76:79]
    ds_read_b128 v[144:147], v16 offset:37888
    v_mfma_f32_16x16x32_bf16 a[80:83], v[76:79], v[36:39], a[80:83]
    buffer_load_dwordx4 v10, s[8:11], s30 offen offset:2048 sc1 lds
    v_mfma_f32_16x16x32_bf16 a[84:87], v[80:83], v[36:39], a[84:87]
    ds_read_b64_tr_b16 v[116:117], v20 offset:40960
    v_mfma_f32_16x16x32_bf16 a[88:91], v[84:87], v[36:39], a[88:91]
    ds_read_b64_tr_b16 v[118:119], v20 offset:45056
    v_mfma_f32_16x16x32_bf16 a[92:95], v[88:91], v[36:39], a[92:95]
    ds_read_b128 v[148:151], v16 offset:38912
    v_mfma_f32_16x16x32_bf16 a[96:99], v[60:63], v[40:43], a[96:99]
    ds_read_b64_tr_b16 v[120:121], v21 offset:40960
    v_mfma_f32_16x16x32_bf16 a[100:103], v[64:67], v[40:43], a[100:103]
    ds_read_b64_tr_b16 v[122:123], v21 offset:45056
    v_mfma_f32_16x16x32_bf16 a[104:107], v[68:71], v[40:43], a[104:107]
    ds_read_b128 v[152:155], v16 offset:39936
    v_mfma_f32_16x16x32_bf16 a[108:111], v[72:75], v[40:43], a[108:111]
    v_mfma_f32_16x16x32_bf16 a[112:115], v[76:79], v[40:43], a[112:115]
    buffer_load_dwordx4 v11, s[8:11], s30 offen offset:3072 sc1 lds
    v_mfma_f32_16x16x32_bf16 a[116:119], v[80:83], v[40:43], a[116:119]
    v_mfma_f32_16x16x32_bf16 a[120:123], v[84:87], v[40:43], a[120:123]
    v_mfma_f32_16x16x32_bf16 a[124:127], v[88:91], v[40:43], a[124:127]
    v_mfma_f32_16x16x32_bf16 a[128:131], v[60:63], v[44:47], a[128:131]
    v_mfma_f32_16x16x32_bf16 a[132:135], v[64:67], v[44:47], a[132:135]
    v_mfma_f32_16x16x32_bf16 a[136:139], v[68:71], v[44:47], a[136:139]
    v_mfma_f32_16x16x32_bf16 a[140:143], v[72:75], v[44:47], a[140:143]
    v_mfma_f32_16x16x32_bf16 a[144:147], v[76:79], v[44:47], a[144:147]
    s_add_u32 m0, s40, 0
    s_add_u32 s30, s30, 1024
    buffer_load_dwordx4 v12, s[12:15], s31 offen offset:0 lds
    v_mfma_f32_16x16x32_bf16 a[148:151], v[80:83], v[44:47], a[148:151]
    v_mfma_f32_16x16x32_bf16 a[152:155], v[84:87], v[44:47], a[152:155]
    v_mfma_f32_16x16x32_bf16 a[156:159], v[88:91], v[44:47], a[156:159]
    v_mfma_f32_16x16x32_bf16 a[160:163], v[60:63], v[48:51], a[160:163]
    v_mfma_f32_16x16x32_bf16 a[164:167], v[64:67], v[48:51], a[164:167]
    v_mfma_f32_16x16x32_bf16 a[168:171], v[68:71], v[48:51], a[168:171]
    v_mfma_f32_16x16x32_bf16 a[172:175], v[72:75], v[48:51], a[172:175]
    v_mfma_f32_16x16x32_bf16 a[176:179], v[76:79], v[48:51], a[176:179]
    buffer_load_dwordx4 v13, s[12:15], s31 offen offset:1024 lds
    v_mfma_f32_16x16x32_bf16 a[180:183], v[80:83], v[48:51], a[180:183]
    v_mfma_f32_16x16x32_bf16 a[184:187], v[84:87], v[48:51], a[184:187]
    v_mfma_f32_16x16x32_bf16 a[188:191], v[88:91], v[48:51], a[188:191]
    v_mfma_f32_16x16x32_bf16 a[192:195], v[60:63], v[52:55], a[192:195]
    v_mfma_f32_16x16x32_bf16 a[196:199], v[64:67], v[52:55], a[196:199]
    v_mfma_f32_16x16x32_bf16 a[200:203], v[68:71], v[52:55], a[200:203]
    v_mfma_f32_16x16x32_bf16 a[204:207], v[72:75], v[52:55], a[204:207]
    v_mfma_f32_16x16x32_bf16 a[208:211], v[76:79], v[52:55], a[208:211]
    buffer_load_dwordx4 v14, s[12:15], s31 offen offset:2048 lds
    v_mfma_f32_16x16x32_bf16 a[212:215], v[80:83], v[52:55], a[212:215]
    v_mfma_f32_16x16x32_bf16 a[216:219], v[84:87], v[52:55], a[216:219]
    v_mfma_f32_16x16x32_bf16 a[220:223], v[88:91], v[52:55], a[220:223]
    v_mfma_f32_16x16x32_bf16 a[224:227], v[60:63], v[56:59], a[224:227]
    v_mfma_f32_16x16x32_bf16 a[228:231], v[64:67], v[56:59], a[228:231]
    v_mfma_f32_16x16x32_bf16 a[232:235], v[68:71], v[56:59], a[232:235]
    v_mfma_f32_16x16x32_bf16 a[236:239], v[72:75], v[56:59], a[236:239]
    v_mfma_f32_16x16x32_bf16 a[240:243], v[76:79], v[56:59], a[240:243]
    buffer_load_dwordx4 v15, s[12:15], s31 offen offset:3072 lds
    s_add_u32 s31, s31, s34
    v_mfma_f32_16x16x32_bf16 a[244:247], v[80:83], v[56:59], a[244:247]
    v_mfma_f32_16x16x32_bf16 a[248:251], v[84:87], v[56:59], a[248:251]
    v_mfma_f32_16x16x32_bf16 a[252:255], v[88:91], v[56:59], a[252:255]
L_gas_s1:
    s_waitcnt lgkmcnt(0)
    v_mfma_f32_16x16x32_bf16 a[0:3], v[124:127], v[92:95], a[0:3]
    s_waitcnt vmcnt(16)
    s_barrier
    ds_read_b64_tr_b16 v[28:29], v22 offset:0
    v_mfma_f32_16x16x32_bf16 a[4:7], v[128:131], v[92:95], a[4:7]
    ds_read_b64_tr_b16 v[30:31], v22 offset:4096
    v_mfma_f32_16x16x32_bf16 a[8:11], v[132:135], v[92:95], a[8:11]
    ds_read_b128 v[60:63], v17 offset:0
    v_mfma_f32_16x16x32_bf16 a[12:15], v[136:139], v[92:95], a[12:15]
    ds_read_b64_tr_b16 v[32:33], v23 offset:0
    v_mfma_f32_16x16x32_bf16 a[16:19], v[140:143], v[92:95], a[16:19]
    s_add_u32 m0, s39, 32768
    s_nop 0
    buffer_load_dwordx4 v8, s[8:11], s30 offen offset:0 sc1 lds
    v_mfma_f32_16x16x32_bf16 a[20:23], v[144:147], v[92:95], a[20:23]
    ds_read_b64_tr_b16 v[34:35], v23 offset:4096
    v_mfma_f32_16x16x32_bf16 a[24:27], v[148:151], v[92:95], a[24:27]
    ds_read_b128 v[64:67], v17 offset:1024
    v_mfma_f32_16x16x32_bf16 a[28:31], v[152:155], v[92:95], a[28:31]
    ds_read_b64_tr_b16 v[36:37], v24 offset:0
    v_mfma_f32_16x16x32_bf16 a[32:35], v[124:127], v[96:99], a[32:35]
    ds_read_b64_tr_b16 v[38:39], v24 offset:4096
    v_mfma_f32_16x16x32_bf16 a[36:39], v[128:131], v[96:99], a[36:39]
    ds_read_b128 v[68:71], v17 offset:2048
    v_mfma_f32_16x16x32_bf16 a[40:43], v[132:135], v[96:99], a[40:43]
    ds_read_b64_tr_b16 v[40:41], v25 offset:0
    v_mfma_f32_16x16x32_bf16 a[44:47], v[136:139], v[96:99], a[44:47]
    ds_read_b64_tr_b16 v[42:43], v25 offset:4096
    v_mfma_f32_16x16x32_bf16 a[48:51], v[140:143], v[96:99], a[48:51]
    buffer_load_dwordx4 v9, s[8:11], s30 offen offset:1024 sc1 lds
    v_mfma_f32_16x16x32_bf16 a[52:55], v[144:147], v[96:99], a[52:55]
    ds_read_b128 v[72:75], v17 offset:3072
    v_mfma_f32_16x16x32_bf16 a[56:59], v[148:151], v[96:99], a[56:59]
    ds_read_b64_tr_b16 v[44:45], v22 offset:8192
    v_mfma_f32_16x16x32_bf16 a[60:63], v[152:155], v[96:99], a[60:63]
    ds_read_b64_tr_b16 v[46:47], v22 offset:12288
    v_mfma_f32_16x16x32_bf16 a[64:67], v[124:127], v[100:103], a[64:67]
    ds_read_b128 v[76:79], v17 offset:4096
    v_mfma_f32_16x16x32_bf16 a[68:71], v[128:131], v[100:103], a[68:71]
    ds_read_b64_tr_b16 v[48:49], v23 offset:8192
    v_mfma_f32_16x16x32_bf16 a[72:75], v[132:135], v[100:103], a[72:75]
    ds_read_b64_tr_b16 v[50:51], v23 offset:12288
    v_mfma_f32_16x16x32_bf16 a[76:79], v[136:139], v[100:103], a[76:79]
    ds_read_b128 v[80:83], v17 offset:5120
    v_mfma_f32_16x16x32_bf16 a[80:83], v[140:143], v[100:103], a[80:83]
    buffer_load_dwordx4 v10, s[8:11], s30 offen offset:2048 sc1 lds
    v_mfma_f32_16x16x32_bf16 a[84:87], v[144:147], v[100:103], a[84:87]
    ds_read_b64_tr_b16 v[52:53], v24 offset:8192
    v_mfma_f32_16x16x32_bf16 a[88:91], v[148:151], v[100:103], a[88:91]
    ds_read_b64_tr_b16 v[54:55], v24 offset:12288
    v_mfma_f32_16x16x32_bf16 a[92:95], v[152:155], v[100:103], a[92:95]
    ds_read_b128 v[84:87], v17 offset:6144
    v_mfma_f32_16x16x32_bf16 a[96:99], v[124:127], v[104:107], a[96:99]
    ds_read_b64_tr_b16 v[56:57], v25 offset:8192
    v_mfma_f32_16x16x32_bf16 a[100:103], v[128:131], v[104:107], a[100:103]
    ds_read_b64_tr_b16 v[58:59], v25 offset:12288
    v_mfma_f32_16x16x32_bf16 a[104:107], v[132:135], v[104:107], a[104:107]
    ds_read_b128 v[88:91], v17 offset:7168
    v_mfma_f32_16x16x32_bf16 a[108:111], v[136:139], v[104:107], a[108:111]
    v_mfma_f32_16x16x32_bf16 a[112:115], v[140:143], v[104:107], a[112:115]
    buffer_load_dwordx4 v11, s[8:11], s30 offen offset:3072 sc1 lds
    v_mfma_f32_16x16x32_bf16 a[116:119], v[144:147], v[104:107], a[116:119]
    v_mfma_f32_16x16x32_bf16 a[120:123], v[148:151], v[104:107], a[120:123]
    v_mfma_f32_16x16x32_bf16 a[124:127], v[152:155], v[104:107], a[124:127]
    v_mfma_f32_16x16x32_bf16 a[128:131], v[124:127], v[108:111], a[128:131]
    v_mfma_f32_16x16x32_bf16 a[132:135], v[128:131], v[108:111], a[132:135]
    v_mfma_f32_16x16x32_bf16 a[136:139], v[132:135], v[108:111], a[136:139]
    v_mfma_f32_16x16x32_bf16 a[140:143], v[136:139], v[108:111], a[140:143]
    v_mfma_f32_16x16x32_bf16 a[144:147], v[140:143], v[108:111], a[144:147]
    s_add_u32 m0, s40, 32768
    s_add_u32 s30, s30, 1024
    buffer_load_dwordx4 v12, s[12:15], s31 offen offset:0 lds
    v_mfma_f32_16x16x32_bf16 a[148:151], v[144:147], v[108:111], a[148:151]
    v_mfma_f32_16x16x32_bf16 a[152:155], v[148:151], v[108:111], a[152:155]
    v_mfma_f32_16x16x32_bf16 a[156:159], v[152:155], v[108:111], a[156:159]
    v_mfma_f32_16x16x32_bf16 a[160:163], v[124:127], v[112:115], a[160:163]
    v_mfma_f32_16x16x32_bf16 a[164:167], v[128:131], v[112:115], a[164:167]
    v_mfma_f32_16x16x32_bf16 a[168:171], v[132:135], v[112:115], a[168:171]
    v_mfma_f32_16x16x32_bf16 a[172:175], v[136:139], v[112:115], a[172:175]
    v_mfma_f32_16x16x32_bf16 a[176:179], v[140:143], v[112:115], a[176:179]
    buffer_load_dwordx4 v13, s[12:15], s31 offen offset:1024 lds
    v_mfma_f32_16x16x32_bf16 a[180:183], v[144:147], v[112:115], a[180:183]
    v_mfma_f32_16x16x32_bf16 a[184:187], v[148:151], v[112:115], a[184:187]
    v_mfma_f32_16x16x32_bf16 a[188:191], v[152:155], v[112:115], a[188:191]
    v_mfma_f32_16x16x32_bf16 a[192:195], v[124:127], v[116:119], a[192:195]
    v_mfma_f32_16x16x32_bf16 a[196:199], v[128:131], v[116:119], a[196:199]
    v_mfma_f32_16x16x32_bf16 a[200:203], v[132:135], v[116:119], a[200:203]
    v_mfma_f32_16x16x32_bf16 a[204:207], v[136:139], v[116:119], a[204:207]
    v_mfma_f32_16x16x32_bf16 a[208:211], v[140:143], v[116:119], a[208:211]
    buffer_load_dwordx4 v14, s[12:15], s31 offen offset:2048 lds
    v_mfma_f32_16x16x32_bf16 a[212:215], v[144:147], v[116:119], a[212:215]
    v_mfma_f32_16x16x32_bf16 a[216:219], v[148:151], v[116:119], a[216:219]
    v_mfma_f32_16x16x32_bf16 a[220:223], v[152:155], v[116:119], a[220:223]
    v_mfma_f32_16x16x32_bf16 a[224:227], v[124:127], v[120:123], a[224:227]
    v_mfma_f32_16x16x32_bf16 a[228:231], v[128:131], v[120:123], a[228:231]
    v_mfma_f32_16x16x32_bf16 a[232:235], v[132:135], v[120:123], a[232:235]
    v_mfma_f32_16x16x32_bf16 a[236:239], v[136:139], v[120:123], a[236:239]
    v_mfma_f32_16x16x32_bf16 a[240:243], v[140:143], v[120:123], a[240:243]
    buffer_load_dwordx4 v15, s[12:15], s31 offen offset:3072 lds
    s_add_u32 s31, s31, s34
    v_mfma_f32_16x16x32_bf16 a[244:247], v[144:147], v[120:123], a[244:247]
    v_mfma_f32_16x16x32_bf16 a[248:251], v[148:151], v[120:123], a[248:251]
    v_mfma_f32_16x16x32_bf16 a[252:255], v[152:155], v[120:123], a[252:255]
    s_waitcnt lgkmcnt(0)
    v_mfma_f32_16x16x32_bf16 a[0:3], v[60:63], v[28:31], a[0:3]
    s_waitcnt vmcnt(16)
    s_barrier
    ds_read_b64_tr_b16 v[92:93], v22 offset:32768
    v_mfma_f32_16x16x32_bf16 a[4:7], v[64:67], v[28:31], a[4:7]
    ds_read_b64_tr_b16 v[94:95], v22 offset:36864
    v_mfma_f32_16x16x32_bf16 a[8:11], v[68:71], v[28:31], a[8:11]
    ds_read_b128 v[124:127], v17 offset:32768
    v_mfma_f32_16x16x32_bf16 a[12:15], v[72:75], v[28:31], a[12:15]
    ds_read_b64_tr_b16 v[96:97], v23 offset:32768
    v_mfma_f32_16x16x32_bf16 a[16:19], v[76:79], v[28:31], a[16:19]
    s_add_u32 m0, s39, 65536
    s_nop 0
    buffer_load_dwordx4 v8, s[8:11], s30 offen offset:0 sc1 lds
    v_mfma_f32_16x16x32_bf16 a[20:23], v[80:83], v[28:31], a[20:23]
    ds_read_b64_tr_b16 v[98:99], v23 offset:36864
    v_mfma_f32_16x16x32_bf16 a[24:27], v[84:87], v[28:31], a[24:27]
    ds_read_b128 v[128:131], v17 offset:33792
    v_mfma_f32_16x16x32_bf16 a[28:31], v[88:91], v[28:31], a[28:31]
    ds_read_b64_tr_b16 v[100:101], v24 offset:32768
    v_mfma_f32_16x16x32_bf16 a[32:35], v[60:63], v[32:35], a[32:35]
    ds_read_b64_tr_b16 v[102:103], v24 offset:36864
    v_mfma_f32_16x16x32_bf16 a[36:39], v[64:67], v[32:35], a[36:39]
    ds_read_b128 v[132:135], v17 offset:34816
    v_mfma_f32_16x16x32_bf16 a[40:43], v[68:71], v[32:35], a[40:43]
    ds_read_b64_tr_b16 v[104:105], v25 offset:32768
    v_mfma_f32_16x16x32_bf16 a[44:47], v[72:75], v[32:35], a[44:47]
    ds_read_b64_tr_b16 v[106:107], v25 offset:36864
    v_mfma_f32_16x16x32_bf16 a[48:51], v[76:79], v[32:35], a[48:51]
    buffer_load_dwordx4 v9, s[8:11], s30 offen offset:1024 sc1 lds
    v_mfma_f32_16x16x32_bf16 a[52:55], v[80:83], v[32:35], a[52:55]
    ds_read_b128 v[136:139], v17 offset:35840
    v_mfma_f32_16x16x32_bf16 a[56:59], v[84:87], v[32:35], a[56:59]
    ds_read_b64_tr_b16 v[108:109], v22 offset:40960
    v_mfma_f32_16x16x32_bf16 a[60:63], v[88:91], v[32:35], a[60:63]
    ds_read_b64_tr_b16 v[110:111], v22 offset:45056
    v_mfma_f32_16x16x32_bf16 a[64:67], v[60:63], v[36:39], a[64:67]
    ds_read_b128 v[140:143], v17 offset:36864
    v_mfma_f32_16x16x32_bf16 a[68:71], v[64:67], v[36:39], a[68:71]
    ds_read_b64_tr_b16 v[112:113], v23 offset:40960
    v_mfma_f32_16x16x32_bf16 a[72:75], v[68:71], v[36:39], a[72:75]
    ds_read_b64_tr_b16 v[114:115], v23 offset:45056
    v_mfma_f32_16x16x32_bf16 a[76:79], v[72:75], v[36:39], a[76:79]
    ds_read_b128 v[144:147], v17 offset:37888
    v_mfma_f32_16x16x32_bf16 a[80:83], v[76:79], v[36:39], a[80:83]
    buffer_load_dwordx4 v10, s[8:11], s30 offen offset:2048 sc1 lds
    v_mfma_f32_16x16x32_bf16 a[84:87], v[80:83], v[36:39], a[84:87]
    ds_read_b64_tr_b16 v[116:117], v24 offset:40960
    v_mfma_f32_16x16x32_bf16 a[88:91], v[84:87], v[36:39], a[88:91]
    ds_read_b64_tr_b16 v[118:119], v24 offset:45056
    v_mfma_f32_16x16x32_bf16 a[92:95], v[88:91], v[36:39], a[92:95]
    ds_read_b128 v[148:151], v17 offset:38912
    v_mfma_f32_16x16x32_bf16 a[96:99], v[60:63], v[40:43], a[96:99]
    ds_read_b64_tr_b16 v[120:121], v25 offset:40960
    v_mfma_f32_16x16x32_bf16 a[100:103], v[64:67], v[40:43], a[100:103]
    ds_read_b64_tr_b16 v[122:123], v25 offset:45056
    v_mfma_f32_16x16x32_bf16 a[104:107], v[68:71], v[40:43], a[104:107]
    ds_read_b128 v[152:155], v17 offset:39936
    v_mfma_f32_16x16x32_bf16 a[108:111], v[72:75], v[40:43], a[108:111]
    v_mfma_f32_16x16x32_bf16 a[112:115], v[76:79], v[40:43], a[112:115]
    buffer_load_dwordx4 v11, s[8:11], s30 offen offset:3072 sc1 lds
    v_mfma_f32_16x16x32_bf16 a[116:119], v[80:83], v[40:43], a[116:119]
    v_mfma_f32_16x16x32_bf16 a[120:123], v[84:87], v[40:43], a[120:123]
    v_mfma_f32_16x16x32_bf16 a[124:127], v[88:91], v[40:43], a[124:127]
    v_mfma_f32_16x16x32_bf16 a[128:131], v[60:63], v[44:47], a[128:131]
    v_mfma_f32_16x16x32_bf16 a[132:135], v[64:67], v[44:47], a[132:135]
    v_mfma_f32_16x16x32_bf16 a[136:139], v[68:71], v[44:47], a[136:139]
    v_mfma_f32_16x16x32_bf16 a[140:143], v[72:75], v[44:47], a[140:143]
    v_mfma_f32_16x16x32_bf16 a[144:147], v[76:79], v[44:47], a[144:147]
    s_add_u32 m0, s40, 65536
    s_add_u32 s30, s30, 1024
    buffer_load_dwordx4 v12, s[12:15], s31 offen offset:0 lds
    v_mfma_f32_16x16x32_bf16 a[148:151], v[80:83], v[44:47], a[148:151]
    v_mfma_f32_16x16x32_bf16 a[152:155], v[84:87], v[44:47], a[152:155]
    v_mfma_f32_16x16x32_bf16 a[156:159], v[88:91], v[44:47], a[156:159]
    v_mfma_f32_16x16x32_bf16 a[160:163], v[60:63], v[48:51], a[160:163]
    v_mfma_f32_16x16x32_bf16 a[164:167], v[64:67], v[48:51], a[164:167]
    v_mfma_f32_16x16x32_bf16 a[168:171], v[68:71], v[48:51], a[168:171]
    v_mfma_f32_16x16x32_bf16 a[172:175], v[72:75], v[48:51], a[172:175]
    v_mfma_f32_16x16x32_bf16 a[176:179], v[76:79], v[48:51], a[176:179]
    buffer_load_dwordx4 v13, s[12:15], s31 offen offset:1024 lds
    v_mfma_f32_16x16x32_bf16 a[180:183], v[80:83], v[48:51], a[180:183]
    v_mfma_f32_16x16x32_bf16 a[184:187], v[84:87], v[48:51], a[184:187]
    v_mfma_f32_16x16x32_bf16 a[188:191], v[88:91], v[48:51], a[188:191]
    v_mfma_f32_16x16x32_bf16 a[192:195], v[60:63], v[52:55], a[192:195]
    v_mfma_f32_16x16x32_bf16 a[196:199], v[64:67], v[52:55], a[196:199]
    v_mfma_f32_16x16x32_bf16 a[200:203], v[68:71], v[52:55], a[200:203]
    v_mfma_f32_16x16x32_bf16 a[204:207], v[72:75], v[52:55], a[204:207]
    v_mfma_f32_16x16x32_bf16 a[208:211], v[76:79], v[52:55], a[208:211]
    buffer_load_dwordx4 v14, s[12:15], s31 offen offset:2048 lds
    v_mfma_f32_16x16x32_bf16 a[212:215], v[80:83], v[52:55], a[212:215]
    v_mfma_f32_16x16x32_bf16 a[216:219], v[84:87], v[52:55], a[216:219]
    v_mfma_f32_16x16x32_bf16 a[220:223], v[88:91], v[52:55], a[220:223]
    v_mfma_f32_16x16x32_bf16 a[224:227], v[60:63], v[56:59], a[224:227]
    v_mfma_f32_16x16x32_bf16 a[228:231], v[64:67], v[56:59], a[228:231]
    v_mfma_f32_16x16x32_bf16 a[232:235], v[68:71], v[56:59], a[232:235]
    v_mfma_f32_16x16x32_bf16 a[236:239], v[72:75], v[56:59], a[236:239]
    v_mfma_f32_16x16x32_bf16 a[240:243], v[76:79], v[56:59], a[240:243]
    buffer_load_dwordx4 v15, s[12:15], s31 offen offset:3072 lds
    s_add_u32 s31, s31, s34
    v_mfma_f32_16x16x32_bf16 a[244:247], v[80:83], v[56:59], a[244:247]
    v_mfma_f32_16x16x32_bf16 a[248:251], v[84:87], v[56:59], a[248:251]
    v_mfma_f32_16x16x32_bf16 a[252:255], v[88:91], v[56:59], a[252:255]
    s_waitcnt lgkmcnt(0)
    v_mfma_f32_16x16x32_bf16 a[0:3], v[124:127], v[92:95], a[0:3]
    s_waitcnt vmcnt(16)
    s_barrier
    ds_read_b64_tr_b16 v[28:29], v18 offset:0
    v_mfma_f32_16x16x32_bf16 a[4:7], v[128:131], v[92:95], a[4:7]
    ds_read_b64_tr_b16 v[30:31], v18 offset:4096
    v_mfma_f32_16x16x32_bf16 a[8:11], v[132:135], v[92:95], a[8:11]
    ds_read_b128 v[60:63], v16 offset:0
    v_mfma_f32_16x16x32_bf16 a[12:15], v[136:139], v[92:95], a[12:15]
    ds_read_b64_tr_b16 v[32:33], v19 offset:0
    v_mfma_f32_16x16x32_bf16 a[16:19], v[140:143], v[92:95], a[16:19]
    s_add_u32 m0, s39, 98304
    s_nop 0
    buffer_load_dwordx4 v8, s[8:11], s30 offen offset:0 sc1 lds
    v_mfma_f32_16x16x32_bf16 a[20:23], v[144:147], v[92:95], a[20:23]
    ds_read_b64_tr_b16 v[34:35], v19 offset:4096
    v_mfma_f32_16x16x32_bf16 a[24:27], v[148:151], v[92:95], a[24:27]
    ds_read_b128 v[64:67], v16 offset:1024
    v_mfma_f32_16x16x32_bf16 a[28:31], v[152:155], v[92:95], a[28:31]
    ds_read_b64_tr_b16 v[36:37], v20 offset:0
    v_mfma_f32_16x16x32_bf16 a[32:35], v[124:127], v[96:99], a[32:35]
    ds_read_b64_tr_b16 v[38:39], v20 offset:4096
    v_mfma_f32_16x16x32_bf16 a[36:39], v[128:131], v[96:99], a[36:39]
    ds_read_b128 v[68:71], v16 offset:2048
    v_mfma_f32_16x16x32_bf16 a[40:43], v[132:135], v[96:99], a[40:43]
    ds_read_b64_tr_b16 v[40:41], v21 offset:0
    v_mfma_f32_16x16x32_bf16 a[44:47], v[136:139], v[96:99], a[44:47]
    ds_read_b64_tr_b16 v[42:43], v21 offset:4096
    v_mfma_f32_16x16x32_bf16 a[48:51], v[140:143], v[96:99], a[48:51]
    buffer_load_dwordx4 v9, s[8:11], s30 offen offset:1024 sc1 lds
    v_mfma_f32_16x16x32_bf16 a[52:55], v[144:147], v[96:99], a[52:55]
    ds_read_b128 v[72:75], v16 offset:3072
    v_mfma_f32_16x16x32_bf16 a[56:59], v[148:151], v[96:99], a[56:59]
    ds_read_b64_tr_b16 v[44:45], v18 offset:8192
    v_mfma_f32_16x16x32_bf16 a[60:63], v[152:155], v[96:99], a[60:63]
    ds_read_b64_tr_b16 v[46:47], v18 offset:12288
    v_mfma_f32_16x16x32_bf16 a[64:67], v[124:127], v[100:103], a[64:67]
    ds_read_b128 v[76:79], v16 offset:4096
    v_mfma_f32_16x16x32_bf16 a[68:71], v[128:131], v[100:103], a[68:71]
    ds_read_b64_tr_b16 v[48:49], v19 offset:8192
    v_mfma_f32_16x16x32_bf16 a[72:75], v[132:135], v[100:103], a[72:75]
    ds_read_b64_tr_b16 v[50:51], v19 offset:12288
    v_mfma_f32_16x16x32_bf16 a[76:79], v[136:139], v[100:103], a[76:79]
    ds_read_b128 v[80:83], v16 offset:5120
    v_mfma_f32_16x16x32_bf16 a[80:83], v[140:143], v[100:103], a[80:83]
    buffer_load_dwordx4 v10, s[8:11], s30 offen offset:2048 sc1 lds
    v_mfma_f32_16x16x32_bf16 a[84:87], v[144:147], v[100:103], a[84:87]
    ds_read_b64_tr_b16 v[52:53], v20 offset:8192
    v_mfma_f32_16x16x32_bf16 a[88:91], v[148:151], v[100:103], a[88:91]
    ds_read_b64_tr_b16 v[54:55], v20 offset:12288
    v_mfma_f32_16x16x32_bf16 a[92:95], v[152:155], v[100:103], a[92:95]
    ds_read_b128 v[84:87], v16 offset:6144
    v_mfma_f32_16x16x32_bf16 a[96:99], v[124:127], v[104:107], a[96:99]
    ds_read_b64_tr_b16 v[56:57], v21 offset:8192
    v_mfma_f32_16x16x32_bf16 a[100:103], v[128:131], v[104:107], a[100:103]
    ds_read_b64_tr_b16 v[58:59], v21 offset:12288
    v_mfma_f32_16x16x32_bf16 a[104:107], v[132:135], v[104:107], a[104:107]
    ds_read_b128 v[88:91], v16 offset:7168
    v_mfma_f32_16x16x32_bf16 a[108:111], v[136:139], v[104:107], a[108:111]
    v_mfma_f32_16x16x32_bf16 a[112:115], v[140:143], v[104:107], a[112:115]
    buffer_load_dwordx4 v11, s[8:11], s30 offen offset:3072 sc1 lds
    v_mfma_f32_16x16x32_bf16 a[116:119], v[144:147], v[104:107], a[116:119]
    v_mfma_f32_16x16x32_bf16 a[120:123], v[148:151], v[104:107], a[120:123]
    v_mfma_f32_16x16x32_bf16 a[124:127], v[152:155], v[104:107], a[124:127]
    v_mfma_f32_16x16x32_bf16 a[128:131], v[124:127], v[108:111], a[128:131]
    v_mfma_f32_16x16x32_bf16 a[132:135], v[128:131], v[108:111], a[132:135]
    v_mfma_f32_16x16x32_bf16 a[136:139], v[132:135], v[108:111], a[136:139]
    v_mfma_f32_16x16x32_bf16 a[140:143], v[136:139], v[108:111], a[140:143]
    v_mfma_f32_16x16x32_bf16 a[144:147], v[140:143], v[108:111], a[144:147]
    s_add_u32 m0, s40, 98304
    s_add_u32 s30, s30, 1024
    buffer_load_dwordx4 v12, s[12:15], s31 offen offset:0 lds
    v_mfma_f32_16x16x32_bf16 a[148:151], v[144:147], v[108:111], a[148:151]
    v_mfma_f32_16x16x32_bf16 a[152:155], v[148:151], v[108:111], a[152:155]
    v_mfma_f32_16x16x32_bf16 a[156:159], v[152:155], v[108:111], a[156:159]
    v_mfma_f32_16x16x32_bf16 a[160:163], v[124:127], v[112:115], a[160:163]
    v_mfma_f32_16x16x32_bf16 a[164:167], v[128:131], v[112:115], a[164:167]
    v_mfma_f32_16x16x32_bf16 a[168:171], v[132:135], v[112:115], a[168:171]
    v_mfma_f32_16x16x32_bf16 a[172:175], v[136:139], v[112:115], a[172:175]
    v_mfma_f32_16x16x32_bf16 a[176:179], v[140:143], v[112:115], a[176:179]
    buffer_load_dwordx4 v13, s[12:15], s31 offen offset:1024 lds
    v_mfma_f32_16x16x32_bf16 a[180:183], v[144:147], v[112:115], a[180:183]
    v_mfma_f32_16x16x32_bf16 a[184:187], v[148:151], v[112:115], a[184:187]
    v_mfma_f32_16x16x32_bf16 a[188:191], v[152:155], v[112:115], a[188:191]
    v_mfma_f32_16x16x32_bf16 a[192:195], v[124:127], v[116:119], a[192:195]
    v_mfma_f32_16x16x32_bf16 a[196:199], v[128:131], v[116:119], a[196:199]
    v_mfma_f32_16x16x32_bf16 a[200:203], v[132:135], v[116:119], a[200:203]
    v_mfma_f32_16x16x32_bf16 a[204:207], v[136:139], v[116:119], a[204:207]
    v_mfma_f32_16x16x32_bf16 a[208:211], v[140:143], v[116:119], a[208:211]
    buffer_load_dwordx4 v14, s[12:15], s31 offen offset:2048 lds
    v_mfma_f32_16x16x32_bf16 a[212:215], v[144:147], v[116:119], a[212:215]
    v_mfma_f32_16x16x32_bf16 a[216:219], v[148:151], v[116:119], a[216:219]
    v_mfma_f32_16x16x32_bf16 a[220:223], v[152:155], v[116:119], a[220:223]
    v_mfma_f32_16x16x32_bf16 a[224:227], v[124:127], v[120:123], a[224:227]
    v_mfma_f32_16x16x32_bf16 a[228:231], v[128:131], v[120:123], a[228:231]
    v_mfma_f32_16x16x32_bf16 a[232:235], v[132:135], v[120:123], a[232:235]
    v_mfma_f32_16x16x32_bf16 a[236:239], v[136:139], v[120:123], a[236:239]
    v_mfma_f32_16x16x32_bf16 a[240:243], v[140:143], v[120:123], a[240:243]
    buffer_load_dwordx4 v15, s[12:15], s31 offen offset:3072 lds
    s_add_u32 s31, s31, s34
    v_mfma_f32_16x16x32_bf16 a[244:247], v[144:147], v[120:123], a[244:247]
    v_mfma_f32_16x16x32_bf16 a[248:251], v[148:151], v[120:123], a[248:251]
    v_mfma_f32_16x16x32_bf16 a[252:255], v[152:155], v[120:123], a[252:255]
    s_sub_u32 s35, s35, 1
    s_cmp_lg_u32 s35, 0
    s_cbranch_scc1 L_gas_loop
    s_waitcnt lgkmcnt(0)
    s_nop 7
    s_cmp_eq_u32 s36, 0
    s_cbranch_scc1 L_nas_n
    s_cmp_lg_u32 s63, -1
    s_cbranch_scc1 L_nas_c
    v_mov_b32 v4, 192
L_nas_p:
    buffer_load_dword v5, v4, s[16:19], 0 offen sc1
    s_sub_u32 s62, s62, 1
    s_cbranch_scc1 L_w_fail
    s_waitcnt vmcnt(0)
    v_readfirstlane_b32 s4, v5
    s_and_b32 s5, s4, 0xffff
    s_cmp_lt_u32 s5, 8
    s_cbranch_scc1 L_nas_p
    s_lshr_b32 s4, s4, 16
    s_cmp_ge_u32 s4, 4
    s_cselect_b32 s63, 8192, 0
L_nas_c:
    s_lshl_b32 s4, s21, 12
    s_xor_b32 s4, s4, s63
    s_and_b32 s4, s4, 8192
    s_add_u32 s37, s37, s4
L_nas_n:
    s_lshr_b32 s4, s55, 28
    s_cmp_eq_u32 s4, 0
    s_cbranch_scc1 L_nas_pf
    s_and_b32 s5, s55, 0xfffffff
    s_and_b32 s6, s21, 1
    s_lshl_b32 s6, s6, 15
    s_add_u32 s5, s5, s6
    s_cmp_lt_u32 s21, 2
    s_cselect_b32 s12, s80, s82
    s_cselect_b32 s13, s81, s83
    s_mov_b32 s14, 0x700000
    s_mov_b32 s15, 0x00020000
    s_cmp_eq_u32 s4, 1
    s_cbranch_scc1 L_nas_p1
    s_mov_b32 s12, s84
    s_mov_b32 s13, s85
    s_mov_b32 s14, 0x700000
    s_mov_b32 s15, 0x00020000
    s_lshr_b32 s6, s21, 1
    s_lshl_b32 s6, s6, 16
    s_add_u32 s5, s5, s6
L_nas_p1:
    v_lshlrev_b32 v4, 7, v1
    buffer_load_dword v5, v4, s[12:15], s5 offen
    buffer_load_dword v5, v4, s[12:15], s5 offen offset:64
    s_add_u32 s5, s5, 8192
    buffer_load_dword v5, v4, s[12:15], s5 offen
    buffer_load_dword v5, v4, s[12:15], s5 offen offset:64
    s_add_u32 s5, s5, 8192
    buffer_load_dword v5, v4, s[12:15], s5 offen
    buffer_load_dword v5, v4, s[12:15], s5 offen offset:64
    s_add_u32 s5, s5, 8192
    buffer_load_dword v5, v4, s[12:15], s5 offen
    buffer_load_dword v5, v4, s[12:15], s5 offen offset:64
    s_add_u32 s5, s5, 8192
L_nas_pf:
    s_lshr_b32 s4, s21, 1
    s_mul_i32 s4, s4, 4
    s_mul_i32 s4, s4, s38
    s_add_u32 s4, s4, s37
    s_and_b32 s5, s21, 1
    s_mul_i32 s5, s5, 4096
    s_add_u32 s4, s4, s5
    s_add_u32 s5, s4, s41
    v_accvgpr_read_b32 v32, a0
    v_accvgpr_read_b32 v33, a1
    v_accvgpr_read_b32 v34, a2
    v_accvgpr_read_b32 v35, a3
    v_accvgpr_read_b32 v36, a4
    v_accvgpr_read_b32 v37, a5
    v_accvgpr_read_b32 v38, a6
    v_accvgpr_read_b32 v39, a7
    v_cvt_pk_bf16_f32 v28, v32, v33
    v_cvt_pk_bf16_f32 v29, v34, v35
    v_cvt_pk_bf16_f32 v30, v36, v37
    v_cvt_pk_bf16_f32 v31, v38, v39
    buffer_store_dwordx4 v[28:31], v2, s[8:11], s4 offen offset:0 sc1
    v_accvgpr_read_b32 v44, a32
    v_accvgpr_read_b32 v45, a33
    v_accvgpr_read_b32 v46, a34
    v_accvgpr_read_b32 v47, a35
    v_accvgpr_read_b32 v48, a36
    v_accvgpr_read_b32 v49, a37
    v_accvgpr_read_b32 v50, a38
    v_accvgpr_read_b32 v51, a39
    v_cvt_pk_bf16_f32 v40, v44, v45
    v_cvt_pk_bf16_f32 v41, v46, v47
    v_cvt_pk_bf16_f32 v42, v48, v49
    v_cvt_pk_bf16_f32 v43, v50, v51
    buffer_store_dwordx4 v[40:43], v2, s[8:11], s4 offen offset:1024 sc1
    v_accvgpr_read_b32 v56, a64
    v_accvgpr_read_b32 v57, a65
    v_accvgpr_read_b32 v58, a66
    v_accvgpr_read_b32 v59, a67
    v_accvgpr_read_b32 v60, a68
    v_accvgpr_read_b32 v61, a69
    v_accvgpr_read_b32 v62, a70
    v_accvgpr_read_b32 v63, a71
    v_cvt_pk_bf16_f32 v52, v56, v57
    v_cvt_pk_bf16_f32 v53, v58, v59
    v_cvt_pk_bf16_f32 v54, v60, v61
    v_cvt_pk_bf16_f32 v55, v62, v63
    buffer_store_dwordx4 v[52:55], v2, s[8:11], s4 offen offset:2048 sc1
    v_accvgpr_read_b32 v68, a96
    v_accvgpr_read_b32 v69, a97
    v_accvgpr_read_b32 v70, a98
    v_accvgpr_read_b32 v71, a99
    v_accvgpr_read_b32 v72, a100
    v_accvgpr_read_b32 v73, a101
    v_accvgpr_read_b32 v74, a102
    v_accvgpr_read_b32 v75, a103
    v_cvt_pk_bf16_f32 v64, v68, v69
    v_cvt_pk_bf16_f32 v65, v70, v71
    v_cvt_pk_bf16_f32 v66, v72, v73
    v_cvt_pk_bf16_f32 v67, v74, v75
    buffer_store_dwordx4 v[64:67], v2, s[8:11], s4 offen offset:3072 sc1
    v_accvgpr_read_b32 v32, a128
    v_accvgpr_read_b32 v33, a129
    v_accvgpr_read_b32 v34, a130
    v_accvgpr_read_b32 v35, a131
    v_accvgpr_read_b32 v36, a132
    v_accvgpr_read_b32 v37, a133
    v_accvgpr_read_b32 v38, a134
    v_accvgpr_read_b32 v39, a135
    v_cvt_pk_bf16_f32 v28, v32, v33
    v_cvt_pk_bf16_f32 v29, v34, v35
    v_cvt_pk_bf16_f32 v30, v36, v37
    v_cvt_pk_bf16_f32 v31, v38, v39
    buffer_store_dwordx4 v[28:31], v2, s[8:11], s5 offen offset:0 sc1
    v_accvgpr_read_b32 v44, a160
    v_accvgpr_read_b32 v45, a161
    v_accvgpr_read_b32 v46, a162
    v_accvgpr_read_b32 v47, a163
    v_accvgpr_read_b32 v48, a164
    v_accvgpr_read_b32 v49, a165
    v_accvgpr_read_b32 v50, a166
    v_accvgpr_read_b32 v51, a167
    v_cvt_pk_bf16_f32 v40, v44, v45
    v_cvt_pk_bf16_f32 v41, v46, v47
    v_cvt_pk_bf16_f32 v42, v48, v49
    v_cvt_pk_bf16_f32 v43, v50, v51
    buffer_store_dwordx4 v[40:43], v2, s[8:11], s5 offen offset:1024 sc1
    v_accvgpr_read_b32 v56, a192
    v_accvgpr_read_b32 v57, a193
    v_accvgpr_read_b32 v58, a194
    v_accvgpr_read_b32 v59, a195
    v_accvgpr_read_b32 v60, a196
    v_accvgpr_read_b32 v61, a197
    v_accvgpr_read_b32 v62, a198
    v_accvgpr_read_b32 v63, a199
    v_cvt_pk_bf16_f32 v52, v56, v57
    v_cvt_pk_bf16_f32 v53, v58, v59
    v_cvt_pk_bf16_f32 v54, v60, v61
    v_cvt_pk_bf16_f32 v55, v62, v63
    buffer_store_dwordx4 v[52:55], v2, s[8:11], s5 offen offset:2048 sc1
    v_accvgpr_read_b32 v68, a224
    v_accvgpr_read_b32 v69, a225
    v_accvgpr_read_b32 v70, a226
    v_accvgpr_read_b32 v71, a227
    v_accvgpr_read_b32 v72, a228
    v_accvgpr_read_b32 v73, a229
    v_accvgpr_read_b32 v74, a230
    v_accvgpr_read_b32 v75, a231
    v_cvt_pk_bf16_f32 v64, v68, v69
    v_cvt_pk_bf16_f32 v65, v70, v71
    v_cvt_pk_bf16_f32 v66, v72, v73
    v_cvt_pk_bf16_f32 v67, v74, v75
    buffer_store_dwordx4 v[64:67], v2, s[8:11], s5 offen offset:3072 sc1
    s_add_u32 s4, s4, s38
    s_add_u32 s5, s4, s41
    v_accvgpr_read_b32 v32, a8
    v_accvgpr_read_b32 v33, a9
    v_accvgpr_read_b32 v34, a10
    v_accvgpr_read_b32 v35, a11
    v_accvgpr_read_b32 v36, a12
    v_accvgpr_read_b32 v37, a13
    v_accvgpr_read_b32 v38, a14
    v_accvgpr_read_b32 v39, a15
    v_cvt_pk_bf16_f32 v28, v32, v33
    v_cvt_pk_bf16_f32 v29, v34, v35
    v_cvt_pk_bf16_f32 v30, v36, v37
    v_cvt_pk_bf16_f32 v31, v38, v39
    buffer_store_dwordx4 v[28:31], v2, s[8:11], s4 offen offset:0 sc1
    v_accvgpr_read_b32 v44, a40
    v_accvgpr_read_b32 v45, a41
    v_accvgpr_read_b32 v46, a42
    v_accvgpr_read_b32 v47, a43
    v_accvgpr_read_b32 v48, a44
    v_accvgpr_read_b32 v49, a45
    v_accvgpr_read_b32 v50, a46
    v_accvgpr_read_b32 v51, a47
    v_cvt_pk_bf16_f32 v40, v44, v45
    v_cvt_pk_bf16_f32 v41, v46, v47
    v_cvt_pk_bf16_f32 v42, v48, v49
    v_cvt_pk_bf16_f32 v43, v50, v51
    buffer_store_dwordx4 v[40:43], v2, s[8:11], s4 offen offset:1024 sc1
    v_accvgpr_read_b32 v56, a72
    v_accvgpr_read_b32 v57, a73
    v_accvgpr_read_b32 v58, a74
    v_accvgpr_read_b32 v59, a75
    v_accvgpr_read_b32 v60, a76
    v_accvgpr_read_b32 v61, a77
    v_accvgpr_read_b32 v62, a78
    v_accvgpr_read_b32 v63, a79
    v_cvt_pk_bf16_f32 v52, v56, v57
    v_cvt_pk_bf16_f32 v53, v58, v59
    v_cvt_pk_bf16_f32 v54, v60, v61
    v_cvt_pk_bf16_f32 v55, v62, v63
    buffer_store_dwordx4 v[52:55], v2, s[8:11], s4 offen offset:2048 sc1
    v_accvgpr_read_b32 v68, a104
    v_accvgpr_read_b32 v69, a105
    v_accvgpr_read_b32 v70, a106
    v_accvgpr_read_b32 v71, a107
    v_accvgpr_read_b32 v72, a108
    v_accvgpr_read_b32 v73, a109
    v_accvgpr_read_b32 v74, a110
    v_accvgpr_read_b32 v75, a111
    v_cvt_pk_bf16_f32 v64, v68, v69
    v_cvt_pk_bf16_f32 v65, v70, v71
    v_cvt_pk_bf16_f32 v66, v72, v73
    v_cvt_pk_bf16_f32 v67, v74, v75
    buffer_store_dwordx4 v[64:67], v2, s[8:11], s4 offen offset:3072 sc1
    v_accvgpr_read_b32 v32, a136
    v_accvgpr_read_b32 v33, a137
    v_accvgpr_read_b32 v34, a138
    v_accvgpr_read_b32 v35, a139
    v_accvgpr_read_b32 v36, a140
    v_accvgpr_read_b32 v37, a141
    v_accvgpr_read_b32 v38, a142
    v_accvgpr_read_b32 v39, a143
    v_cvt_pk_bf16_f32 v28, v32, v33
    v_cvt_pk_bf16_f32 v29, v34, v35
    v_cvt_pk_bf16_f32 v30, v36, v37
    v_cvt_pk_bf16_f32 v31, v38, v39
    buffer_store_dwordx4 v[28:31], v2, s[8:11], s5 offen offset:0 sc1
    v_accvgpr_read_b32 v44, a168
    v_accvgpr_read_b32 v45, a169
    v_accvgpr_read_b32 v46, a170
    v_accvgpr_read_b32 v47, a171
    v_accvgpr_read_b32 v48, a172
    v_accvgpr_read_b32 v49, a173
    v_accvgpr_read_b32 v50, a174
    v_accvgpr_read_b32 v51, a175
    v_cvt_pk_bf16_f32 v40, v44, v45
    v_cvt_pk_bf16_f32 v41, v46, v47
    v_cvt_pk_bf16_f32 v42, v48, v49
    v_cvt_pk_bf16_f32 v43, v50, v51
    buffer_store_dwordx4 v[40:43], v2, s[8:11], s5 offen offset:1024 sc1
    v_accvgpr_read_b32 v56, a200
    v_accvgpr_read_b32 v57, a201
    v_accvgpr_read_b32 v58, a202
    v_accvgpr_read_b32 v59, a203
    v_accvgpr_read_b32 v60, a204
    v_accvgpr_read_b32 v61, a205
    v_accvgpr_read_b32 v62, a206
    v_accvgpr_read_b32 v63, a207
    v_cvt_pk_bf16_f32 v52, v56, v57
    v_cvt_pk_bf16_f32 v53, v58, v59
    v_cvt_pk_bf16_f32 v54, v60, v61
    v_cvt_pk_bf16_f32 v55, v62, v63
    buffer_store_dwordx4 v[52:55], v2, s[8:11], s5 offen offset:2048 sc1
    v_accvgpr_read_b32 v68, a232
    v_accvgpr_read_b32 v69, a233
    v_accvgpr_read_b32 v70, a234
    v_accvgpr_read_b32 v71, a235
    v_accvgpr_read_b32 v72, a236
    v_accvgpr_read_b32 v73, a237
    v_accvgpr_read_b32 v74, a238
    v_accvgpr_read_b32 v75, a239
    v_cvt_pk_bf16_f32 v64, v68, v69
    v_cvt_pk_bf16_f32 v65, v70, v71
    v_cvt_pk_bf16_f32 v66, v72, v73
    v_cvt_pk_bf16_f32 v67, v74, v75
    buffer_store_dwordx4 v[64:67], v2, s[8:11], s5 offen offset:3072 sc1
    s_add_u32 s4, s4, s38
    s_add_u32 s5, s4, s41
    v_accvgpr_read_b32 v32, a16
    v_accvgpr_read_b32 v33, a17
    v_accvgpr_read_b32 v34, a18
    v_accvgpr_read_b32 v35, a19
    v_accvgpr_read_b32 v36, a20
    v_accvgpr_read_b32 v37, a21
    v_accvgpr_read_b32 v38, a22
    v_accvgpr_read_b32 v39, a23
    v_cvt_pk_bf16_f32 v28, v32, v33
    v_cvt_pk_bf16_f32 v29, v34, v35
    v_cvt_pk_bf16_f32 v30, v36, v37
    v_cvt_pk_bf16_f32 v31, v38, v39
    buffer_store_dwordx4 v[28:31], v2, s[8:11], s4 offen offset:0 sc1
    v_accvgpr_read_b32 v44, a48
    v_accvgpr_read_b32 v45, a49
    v_accvgpr_read_b32 v46, a50
    v_accvgpr_read_b32 v47, a51
    v_accvgpr_read_b32 v48, a52
    v_accvgpr_read_b32 v49, a53
    v_accvgpr_read_b32 v50, a54
    v_accvgpr_read_b32 v51, a55
    v_cvt_pk_bf16_f32 v40, v44, v45
    v_cvt_pk_bf16_f32 v41, v46, v47
    v_cvt_pk_bf16_f32 v42, v48, v49
    v_cvt_pk_bf16_f32 v43, v50, v51
    buffer_store_dwordx4 v[40:43], v2, s[8:11], s4 offen offset:1024 sc1
    v_accvgpr_read_b32 v56, a80
    v_accvgpr_read_b32 v57, a81
    v_accvgpr_read_b32 v58, a82
    v_accvgpr_read_b32 v59, a83
    v_accvgpr_read_b32 v60, a84
    v_accvgpr_read_b32 v61, a85
    v_accvgpr_read_b32 v62, a86
    v_accvgpr_read_b32 v63, a87
    v_cvt_pk_bf16_f32 v52, v56, v57
    v_cvt_pk_bf16_f32 v53, v58, v59
    v_cvt_pk_bf16_f32 v54, v60, v61
    v_cvt_pk_bf16_f32 v55, v62, v63
    buffer_store_dwordx4 v[52:55], v2, s[8:11], s4 offen offset:2048 sc1
    v_accvgpr_read_b32 v68, a112
    v_accvgpr_read_b32 v69, a113
    v_accvgpr_read_b32 v70, a114
    v_accvgpr_read_b32 v71, a115
    v_accvgpr_read_b32 v72, a116
    v_accvgpr_read_b32 v73, a117
    v_accvgpr_read_b32 v74, a118
    v_accvgpr_read_b32 v75, a119
    v_cvt_pk_bf16_f32 v64, v68, v69
    v_cvt_pk_bf16_f32 v65, v70, v71
    v_cvt_pk_bf16_f32 v66, v72, v73
    v_cvt_pk_bf16_f32 v67, v74, v75
    buffer_store_dwordx4 v[64:67], v2, s[8:11], s4 offen offset:3072 sc1
    v_accvgpr_read_b32 v32, a144
    v_accvgpr_read_b32 v33, a145
    v_accvgpr_read_b32 v34, a146
    v_accvgpr_read_b32 v35, a147
    v_accvgpr_read_b32 v36, a148
    v_accvgpr_read_b32 v37, a149
    v_accvgpr_read_b32 v38, a150
    v_accvgpr_read_b32 v39, a151
    v_cvt_pk_bf16_f32 v28, v32, v33
    v_cvt_pk_bf16_f32 v29, v34, v35
    v_cvt_pk_bf16_f32 v30, v36, v37
    v_cvt_pk_bf16_f32 v31, v38, v39
    buffer_store_dwordx4 v[28:31], v2, s[8:11], s5 offen offset:0 sc1
    v_accvgpr_read_b32 v44, a176
    v_accvgpr_read_b32 v45, a177
    v_accvgpr_read_b32 v46, a178
    v_accvgpr_read_b32 v47, a179
    v_accvgpr_read_b32 v48, a180
    v_accvgpr_read_b32 v49, a181
    v_accvgpr_read_b32 v50, a182
    v_accvgpr_read_b32 v51, a183
    v_cvt_pk_bf16_f32 v40, v44, v45
    v_cvt_pk_bf16_f32 v41, v46, v47
    v_cvt_pk_bf16_f32 v42, v48, v49
    v_cvt_pk_bf16_f32 v43, v50, v51
    buffer_store_dwordx4 v[40:43], v2, s[8:11], s5 offen offset:1024 sc1
    v_accvgpr_read_b32 v56, a208
    v_accvgpr_read_b32 v57, a209
    v_accvgpr_read_b32 v58, a210
    v_accvgpr_read_b32 v59, a211
    v_accvgpr_read_b32 v60, a212
    v_accvgpr_read_b32 v61, a213
    v_accvgpr_read_b32 v62, a214
    v_accvgpr_read_b32 v63, a215
    v_cvt_pk_bf16_f32 v52, v56, v57
    v_cvt_pk_bf16_f32 v53, v58, v59
    v_cvt_pk_bf16_f32 v54, v60, v61
    v_cvt_pk_bf16_f32 v55, v62, v63
    buffer_store_dwordx4 v[52:55], v2, s[8:11], s5 offen offset:2048 sc1
    v_accvgpr_read_b32 v68, a240
    v_accvgpr_read_b32 v69, a241
    v_accvgpr_read_b32 v70, a242
    v_accvgpr_read_b32 v71, a243
    v_accvgpr_read_b32 v72, a244
    v_accvgpr_read_b32 v73, a245
    v_accvgpr_read_b32 v74, a246
    v_accvgpr_read_b32 v75, a247
    v_cvt_pk_bf16_f32 v64, v68, v69
    v_cvt_pk_bf16_f32 v65, v70, v71
    v_cvt_pk_bf16_f32 v66, v72, v73
    v_cvt_pk_bf16_f32 v67, v74, v75
    buffer_store_dwordx4 v[64:67], v2, s[8:11], s5 offen offset:3072 sc1
    s_add_u32 s4, s4, s38
    s_add_u32 s5, s4, s41
    v_accvgpr_read_b32 v32, a24
    v_accvgpr_read_b32 v33, a25
    v_accvgpr_read_b32 v34, a26
    v_accvgpr_read_b32 v35, a27
    v_accvgpr_read_b32 v36, a28
    v_accvgpr_read_b32 v37, a29
    v_accvgpr_read_b32 v38, a30
    v_accvgpr_read_b32 v39, a31
    v_cvt_pk_bf16_f32 v28, v32, v33
    v_cvt_pk_bf16_f32 v29, v34, v35
    v_cvt_pk_bf16_f32 v30, v36, v37
    v_cvt_pk_bf16_f32 v31, v38, v39
    buffer_store_dwordx4 v[28:31], v2, s[8:11], s4 offen offset:0 sc1
    v_accvgpr_read_b32 v44, a56
    v_accvgpr_read_b32 v45, a57
    v_accvgpr_read_b32 v46, a58
    v_accvgpr_read_b32 v47, a59
    v_accvgpr_read_b32 v48, a60
    v_accvgpr_read_b32 v49, a61
    v_accvgpr_read_b32 v50, a62
    v_accvgpr_read_b32 v51, a63
    v_cvt_pk_bf16_f32 v40, v44, v45
    v_cvt_pk_bf16_f32 v41, v46, v47
    v_cvt_pk_bf16_f32 v42, v48, v49
    v_cvt_pk_bf16_f32 v43, v50, v51
    buffer_store_dwordx4 v[40:43], v2, s[8:11], s4 offen offset:1024 sc1
    v_accvgpr_read_b32 v56, a88
    v_accvgpr_read_b32 v57, a89
    v_accvgpr_read_b32 v58, a90
    v_accvgpr_read_b32 v59, a91
    v_accvgpr_read_b32 v60, a92
    v_accvgpr_read_b32 v61, a93
    v_accvgpr_read_b32 v62, a94
    v_accvgpr_read_b32 v63, a95
    v_cvt_pk_bf16_f32 v52, v56, v57
    v_cvt_pk_bf16_f32 v53, v58, v59
    v_cvt_pk_bf16_f32 v54, v60, v61
    v_cvt_pk_bf16_f32 v55, v62, v63
    buffer_store_dwordx4 v[52:55], v2, s[8:11], s4 offen offset:2048 sc1
    v_accvgpr_read_b32 v68, a120
    v_accvgpr_read_b32 v69, a121
    v_accvgpr_read_b32 v70, a122
    v_accvgpr_read_b32 v71, a123
    v_accvgpr_read_b32 v72, a124
    v_accvgpr_read_b32 v73, a125
    v_accvgpr_read_b32 v74, a126
    v_accvgpr_read_b32 v75, a127
    v_cvt_pk_bf16_f32 v64, v68, v69
    v_cvt_pk_bf16_f32 v65, v70, v71
    v_cvt_pk_bf16_f32 v66, v72, v73
    v_cvt_pk_bf16_f32 v67, v74, v75
    buffer_store_dwordx4 v[64:67], v2, s[8:11], s4 offen offset:3072 sc1
    v_accvgpr_read_b32 v32, a152
    v_accvgpr_read_b32 v33, a153
    v_accvgpr_read_b32 v34, a154
    v_accvgpr_read_b32 v35, a155
    v_accvgpr_read_b32 v36, a156
    v_accvgpr_read_b32 v37, a157
    v_accvgpr_read_b32 v38, a158
    v_accvgpr_read_b32 v39, a159
    v_cvt_pk_bf16_f32 v28, v32, v33
    v_cvt_pk_bf16_f32 v29, v34, v35
    v_cvt_pk_bf16_f32 v30, v36, v37
    v_cvt_pk_bf16_f32 v31, v38, v39
    buffer_store_dwordx4 v[28:31], v2, s[8:11], s5 offen offset:0 sc1
    v_accvgpr_read_b32 v44, a184
    v_accvgpr_read_b32 v45, a185
    v_accvgpr_read_b32 v46, a186
    v_accvgpr_read_b32 v47, a187
    v_accvgpr_read_b32 v48, a188
    v_accvgpr_read_b32 v49, a189
    v_accvgpr_read_b32 v50, a190
    v_accvgpr_read_b32 v51, a191
    v_cvt_pk_bf16_f32 v40, v44, v45
    v_cvt_pk_bf16_f32 v41, v46, v47
    v_cvt_pk_bf16_f32 v42, v48, v49
    v_cvt_pk_bf16_f32 v43, v50, v51
    buffer_store_dwordx4 v[40:43], v2, s[8:11], s5 offen offset:1024 sc1
    v_accvgpr_read_b32 v56, a216
    v_accvgpr_read_b32 v57, a217
    v_accvgpr_read_b32 v58, a218
    v_accvgpr_read_b32 v59, a219
    v_accvgpr_read_b32 v60, a220
    v_accvgpr_read_b32 v61, a221
    v_accvgpr_read_b32 v62, a222
    v_accvgpr_read_b32 v63, a223
    v_cvt_pk_bf16_f32 v52, v56, v57
    v_cvt_pk_bf16_f32 v53, v58, v59
    v_cvt_pk_bf16_f32 v54, v60, v61
    v_cvt_pk_bf16_f32 v55, v62, v63
    buffer_store_dwordx4 v[52:55], v2, s[8:11], s5 offen offset:2048 sc1
    v_accvgpr_read_b32 v68, a248
    v_accvgpr_read_b32 v69, a249
    v_accvgpr_read_b32 v70, a250
    v_accvgpr_read_b32 v71, a251
    v_accvgpr_read_b32 v72, a252
    v_accvgpr_read_b32 v73, a253
    v_accvgpr_read_b32 v74, a254
    v_accvgpr_read_b32 v75, a255
    v_cvt_pk_bf16_f32 v64, v68, v69
    v_cvt_pk_bf16_f32 v65, v70, v71
    v_cvt_pk_bf16_f32 v66, v72, v73
    v_cvt_pk_bf16_f32 v67, v74, v75
    buffer_store_dwordx4 v[64:67], v2, s[8:11], s5 offen offset:3072 sc1
    s_add_u32 s4, s4, s38
    s_branch L_w_done
L_gbs:
    s_mul_i32 s4, s21, 2
    s_mul_i32 s4, s4, s32
    s_sub_u32 s5, s32, 1024
    v_add_u32 v8, s4, v2
    s_add_u32 s4, s4, s5
    v_add_u32 v9, s4, v2
    v_lshrrev_b32 v4, 3, v1
    v_and_b32 v5, 7, v1
    s_and_b32 s6, s21, 1
    s_lshl_b32 s4, s6, 4
    s_add_u32 s5, s4, 0
    v_add_u32 v6, s5, v4
    v_bfe_u32 v7, v6, 1, 2
    v_lshlrev_b32 v7, 1, v7
    v_xor_b32 v7, v7, v5
    v_lshlrev_b32 v7, 4, v7
    v_mul_lo_u32 v6, v6, s33
    v_add_u32 v6, v6, v7
    v_subrev_u32 v10, 0, v6
    s_add_u32 s5, s4, 8
    v_add_u32 v6, s5, v4
    v_bfe_u32 v7, v6, 1, 2
    v_lshlrev_b32 v7, 1, v7
    v_xor_b32 v7, v7, v5
    v_lshlrev_b32 v7, 4, v7
    v_mul_lo_u32 v6, v6, s33
    v_add_u32 v6, v6, v7
    v_subrev_u32 v11, 1024, v6
    s_lshr_b32 s7, s21, 1
    s_mul_i32 s4, s7, 4096
    s_add_u32 s5, s4, 0
    v_add_u32 v12, s5, v2
    s_add_u32 s5, s4, 65536
    v_add_u32 v13, s5, v2
    v_lshrrev_b32 v5, 2, v1
    v_bfe_u32 v4, v5, 1, 2
    v_mul_u32_u24 v5, 128, v5
    v_and_b32 v6, 3, v1
    v_lshl_add_u32 v5, v6, 3, v5
    s_mul_i32 s4, s6, 2
    s_add_u32 s4, s4, 0
    v_xor_b32 v6, s4, v4
    v_lshl_add_u32 v6, v6, 5, v5
    v_add_u32 v14, 8192, v6
    v_add_u32 v16, 73728, v6
    s_mul_i32 s4, s6, 2
    s_add_u32 s4, s4, 1
    v_xor_b32 v6, s4, v4
    v_lshl_add_u32 v6, v6, 5, v5
    v_add_u32 v15, 8192, v6
    v_add_u32 v17, 73728, v6
    s_mul_i32 s39, s21, 2048
    s_mul_i32 s40, s21, 2048
    s_add_u32 s40, s40, 8192
    s_lshl_b32 s34, s33, 5
    s_add_u32 m0, s39, 0
    s_nop 0
    buffer_load_dwordx4 v8, s[8:11], s30 offen offset:0 sc1 lds
    buffer_load_dwordx4 v9, s[8:11], s30 offen offset:1024 sc1 lds
    s_add_u32 m0, s40, 0
    s_add_u32 s30, s30, 1024
    buffer_load_dwordx4 v10, s[12:15], s31 offen offset:0 lds
    buffer_load_dwordx4 v11, s[12:15], s31 offen offset:1024 lds
    s_add_u32 s31, s31, s34
    s_add_u32 m0, s39, 16384
    s_nop 0
    buffer_load_dwordx4 v8, s[8:11], s30 offen offset:0 sc1 lds
    buffer_load_dwordx4 v9, s[8:11], s30 offen offset:1024 sc1 lds
    s_add_u32 m0, s40, 16384
    s_add_u32 s30, s30, 1024
    buffer_load_dwordx4 v10, s[12:15], s31 offen offset:0 lds
    buffer_load_dwordx4 v11, s[12:15], s31 offen offset:1024 lds
    s_add_u32 s31, s31, s34
    s_add_u32 m0, s39, 32768
    s_nop 0
    buffer_load_dwordx4 v8, s[8:11], s30 offen offset:0 sc1 lds
    buffer_load_dwordx4 v9, s[8:11], s30 offen offset:1024 sc1 lds
    s_add_u32 m0, s40, 32768
    s_add_u32 s30, s30, 1024
    buffer_load_dwordx4 v10, s[12:15], s31 offen offset:0 lds
    buffer_load_dwordx4 v11, s[12:15], s31 offen offset:1024 lds
    s_add_u32 s31, s31, s34
    s_add_u32 m0, s39, 49152
    s_nop 0
    buffer_load_dwordx4 v8, s[8:11], s30 offen offset:0 sc1 lds
    buffer_load_dwordx4 v9, s[8:11], s30 offen offset:1024 sc1 lds
    s_add_u32 m0, s40, 49152
    s_add_u32 s30, s30, 1024
    buffer_load_dwordx4 v10, s[12:15], s31 offen offset:0 lds
    buffer_load_dwordx4 v11, s[12:15], s31 offen offset:1024 lds
    s_add_u32 s31, s31, s34
    s_add_u32 m0, s39, 65536
    s_nop 0
    buffer_load_dwordx4 v8, s[8:11], s30 offen offset:0 sc1 lds
    buffer_load_dwordx4 v9, s[8:11], s30 offen offset:1024 sc1 lds
    s_add_u32 m0, s40, 65536
    s_add_u32 s30, s30, 1024
    buffer_load_dwordx4 v10, s[12:15], s31 offen offset:0 lds
    buffer_load_dwordx4 v11, s[12:15], s31 offen offset:1024 lds
    s_add_u32 s31, s31, s34
    s_add_u32 m0, s39, 81920
    s_nop 0
    buffer_load_dwordx4 v8, s[8:11], s30 offen offset:0 sc1 lds
    buffer_load_dwordx4 v9, s[8:11], s30 offen offset:1024 sc1 lds
    s_add_u32 m0, s40, 81920
    s_add_u32 s30, s30, 1024
    buffer_load_dwordx4 v10, s[12:15], s31 offen offset:0 lds
    buffer_load_dwordx4 v11, s[12:15], s31 offen offset:1024 lds
    s_add_u32 s31, s31, s34
    s_add_u32 m0, s39, 98304
    s_nop 0
    buffer_load_dwordx4 v8, s[8:11], s30 offen offset:0 sc1 lds
    buffer_load_dwordx4 v9, s[8:11], s30 offen offset:1024 sc1 lds
    s_add_u32 m0, s40, 98304
    s_add_u32 s30, s30, 1024
    buffer_load_dwordx4 v10, s[12:15], s31 offen offset:0 lds
    buffer_load_dwordx4 v11, s[12:15], s31 offen offset:1024 lds
    s_add_u32 s31, s31, s34
    s_add_u32 m0, s39, 114688
    s_nop 0
    buffer_load_dwordx4 v8, s[8:11], s30 offen offset:0 sc1 lds
    buffer_load_dwordx4 v9, s[8:11], s30 offen offset:1024 sc1 lds
    s_add_u32 m0, s40, 114688
    s_add_u32 s30, s30, 1024
    buffer_load_dwordx4 v10, s[12:15], s31 offen offset:0 lds
    buffer_load_dwordx4 v11, s[12:15], s31 offen offset:1024 lds
    s_add_u32 s31, s31, s34
    s_waitcnt vmcnt(28)
    s_barrier
    ds_read_b64_tr_b16 v[20:21], v14 offset:0
    ds_read_b64_tr_b16 v[22:23], v14 offset:2048
    ds_read_b128 v[36:39], v12 offset:0
    ds_read_b64_tr_b16 v[24:25], v15 offset:0
    ds_read_b64_tr_b16 v[26:27], v15 offset:2048
    ds_read_b128 v[40:43], v12 offset:1024
    ds_read_b64_tr_b16 v[28:29], v14 offset:4096
    ds_read_b64_tr_b16 v[30:31], v14 offset:6144
    ds_read_b128 v[44:47], v12 offset:2048
    ds_read_b64_tr_b16 v[32:33], v15 offset:4096
    ds_read_b64_tr_b16 v[34:35], v15 offset:6144
    ds_read_b128 v[48:51], v12 offset:3072
    s_waitcnt lgkmcnt(0)
    v_mfma_f32_16x16x32_bf16 a[0:3], v[36:39], v[20:23], 0
    s_waitcnt vmcnt(24)
    s_barrier
    ds_read_b64_tr_b16 v[52:53], v14 offset:16384
    v_mfma_f32_16x16x32_bf16 a[4:7], v[40:43], v[20:23], 0
    ds_read_b64_tr_b16 v[54:55], v14 offset:18432
    v_mfma_f32_16x16x32_bf16 a[8:11], v[44:47], v[20:23], 0
    s_add_u32 m0, s39, 0
    s_nop 0
    buffer_load_dwordx4 v8, s[8:11], s30 offen offset:0 sc1 lds
    v_mfma_f32_16x16x32_bf16 a[12:15], v[48:51], v[20:23], 0
    ds_read_b128 v[68:71], v12 offset:16384
    v_mfma_f32_16x16x32_bf16 a[16:19], v[36:39], v[24:27], 0
    ds_read_b64_tr_b16 v[56:57], v15 offset:16384
    v_mfma_f32_16x16x32_bf16 a[20:23], v[40:43], v[24:27], 0
    ds_read_b64_tr_b16 v[58:59], v15 offset:18432
    v_mfma_f32_16x16x32_bf16 a[24:27], v[44:47], v[24:27], 0
    buffer_load_dwordx4 v9, s[8:11], s30 offen offset:1024 sc1 lds
    v_mfma_f32_16x16x32_bf16 a[28:31], v[48:51], v[24:27], 0
    ds_read_b128 v[72:75], v12 offset:17408
    v_mfma_f32_16x16x32_bf16 a[32:35], v[36:39], v[28:31], 0
    ds_read_b64_tr_b16 v[60:61], v14 offset:20480
    v_mfma_f32_16x16x32_bf16 a[36:39], v[40:43], v[28:31], 0
    ds_read_b64_tr_b16 v[62:63], v14 offset:22528
    v_mfma_f32_16x16x32_bf16 a[40:43], v[44:47], v[28:31], 0
    s_add_u32 m0, s40, 0
    s_add_u32 s30, s30, 1024
    buffer_load_dwordx4 v10, s[12:15], s31 offen offset:0 lds
    v_mfma_f32_16x16x32_bf16 a[44:47], v[48:51], v[28:31], 0
    ds_read_b128 v[76:79], v12 offset:18432
    v_mfma_f32_16x16x32_bf16 a[48:51], v[36:39], v[32:35], 0
    ds_read_b64_tr_b16 v[64:65], v15 offset:20480
    v_mfma_f32_16x16x32_bf16 a[52:55], v[40:43], v[32:35], 0
    ds_read_b64_tr_b16 v[66:67], v15 offset:22528
    v_mfma_f32_16x16x32_bf16 a[56:59], v[44:47], v[32:35], 0
    buffer_load_dwordx4 v11, s[12:15], s31 offen offset:1024 lds
    s_add_u32 s31, s31, s34
    v_mfma_f32_16x16x32_bf16 a[60:63], v[48:51], v[32:35], 0
    ds_read_b128 v[80:83], v12 offset:19456
    s_branch L_gbs_s1
L_gbs_loop:
    s_cmp_eq_u32 s35, 1
    s_cselect_b32 s30, 0x80000000, s30
    s_cselect_b32 s31, 0x80000000, s31
    s_waitcnt lgkmcnt(0)
    v_mfma_f32_16x16x32_bf16 a[0:3], v[36:39], v[20:23], a[0:3]
    s_waitcnt vmcnt(24)
    s_barrier
    ds_read_b64_tr_b16 v[52:53], v14 offset:16384
    v_mfma_f32_16x16x32_bf16 a[4:7], v[40:43], v[20:23], a[4:7]
    ds_read_b64_tr_b16 v[54:55], v14 offset:18432
    v_mfma_f32_16x16x32_bf16 a[8:11], v[44:47], v[20:23], a[8:11]
    s_add_u32 m0, s39, 0
    s_nop 0
    buffer_load_dwordx4 v8, s[8:11], s30 offen offset:0 sc1 lds
    v_mfma_f32_16x16x32_bf16 a[12:15], v[48:51], v[20:23], a[12:15]
    ds_read_b128 v[68:71], v12 offset:16384
    v_mfma_f32_16x16x32_bf16 a[16:19], v[36:39], v[24:27], a[16:19]
    ds_read_b64_tr_b16 v[56:57], v15 offset:16384
    v_mfma_f32_16x16x32_bf16 a[20:23], v[40:43], v[24:27], a[20:23]
    ds_read_b64_tr_b16 v[58:59], v15 offset:18432
    v_mfma_f32_16x16x32_bf16 a[24:27], v[44:47], v[24:27], a[24:27]
    buffer_load_dwordx4 v9, s[8:11], s30 offen offset:1024 sc1 lds
    v_mfma_f32_16x16x32_bf16 a[28:31], v[48:51], v[24:27], a[28:31]
    ds_read_b128 v[72:75], v12 offset:17408
    v_mfma_f32_16x16x32_bf16 a[32:35], v[36:39], v[28:31], a[32:35]
    ds_read_b64_tr_b16 v[60:61], v14 offset:20480
    v_mfma_f32_16x16x32_bf16 a[36:39], v[40:43], v[28:31], a[36:39]
    ds_read_b64_tr_b16 v[62:63], v14 offset:22528
    v_mfma_f32_16x16x32_bf16 a[40:43], v[44:47], v[28:31], a[40:43]
    s_add_u32 m0, s40, 0
    s_add_u32 s30, s30, 1024
    buffer_load_dwordx4 v10, s[12:15], s31 offen offset:0 lds
    v_mfma_f32_16x16x32_bf16 a[44:47], v[48:51], v[28:31], a[44:47]
    ds_read_b128 v[76:79], v12 offset:18432
    v_mfma_f32_16x16x32_bf16 a[48:51], v[36:39], v[32:35], a[48:51]
    ds_read_b64_tr_b16 v[64:65], v15 offset:20480
    v_mfma_f32_16x16x32_bf16 a[52:55], v[40:43], v[32:35], a[52:55]
    ds_read_b64_tr_b16 v[66:67], v15 offset:22528
    v_mfma_f32_16x16x32_bf16 a[56:59], v[44:47], v[32:35], a[56:59]
    buffer_load_dwordx4 v11, s[12:15], s31 offen offset:1024 lds
    s_add_u32 s31, s31, s34
    v_mfma_f32_16x16x32_bf16 a[60:63], v[48:51], v[32:35], a[60:63]
    ds_read_b128 v[80:83], v12 offset:19456
L_gbs_s1:
    s_waitcnt lgkmcnt(0)
    v_mfma_f32_16x16x32_bf16 a[0:3], v[68:71], v[52:55], a[0:3]
    s_waitcnt vmcnt(24)
    s_barrier
    ds_read_b64_tr_b16 v[20:21], v14 offset:32768
    v_mfma_f32_16x16x32_bf16 a[4:7], v[72:75], v[52:55], a[4:7]
    ds_read_b64_tr_b16 v[22:23], v14 offset:34816
    v_mfma_f32_16x16x32_bf16 a[8:11], v[76:79], v[52:55], a[8:11]
    s_add_u32 m0, s39, 16384
    s_nop 0
    buffer_load_dwordx4 v8, s[8:11], s30 offen offset:0 sc1 lds
    v_mfma_f32_16x16x32_bf16 a[12:15], v[80:83], v[52:55], a[12:15]
    ds_read_b128 v[36:39], v12 offset:32768
    v_mfma_f32_16x16x32_bf16 a[16:19], v[68:71], v[56:59], a[16:19]
    ds_read_b64_tr_b16 v[24:25], v15 offset:32768
    v_mfma_f32_16x16x32_bf16 a[20:23], v[72:75], v[56:59], a[20:23]
    ds_read_b64_tr_b16 v[26:27], v15 offset:34816
    v_mfma_f32_16x16x32_bf16 a[24:27], v[76:79], v[56:59], a[24:27]
    buffer_load_dwordx4 v9, s[8:11], s30 offen offset:1024 sc1 lds
    v_mfma_f32_16x16x32_bf16 a[28:31], v[80:83], v[56:59], a[28:31]
    ds_read_b128 v[40:43], v12 offset:33792
    v_mfma_f32_16x16x32_bf16 a[32:35], v[68:71], v[60:63], a[32:35]
    ds_read_b64_tr_b16 v[28:29], v14 offset:36864
    v_mfma_f32_16x16x32_bf16 a[36:39], v[72:75], v[60:63], a[36:39]
    ds_read_b64_tr_b16 v[30:31], v14 offset:38912
    v_mfma_f32_16x16x32_bf16 a[40:43], v[76:79], v[60:63], a[40:43]
    s_add_u32 m0, s40, 16384
    s_add_u32 s30, s30, 1024
    buffer_load_dwordx4 v10, s[12:15], s31 offen offset:0 lds
    v_mfma_f32_16x16x32_bf16 a[44:47], v[80:83], v[60:63], a[44:47]
    ds_read_b128 v[44:47], v12 offset:34816
    v_mfma_f32_16x16x32_bf16 a[48:51], v[68:71], v[64:67], a[48:51]
    ds_read_b64_tr_b16 v[32:33], v15 offset:36864
    v_mfma_f32_16x16x32_bf16 a[52:55], v[72:75], v[64:67], a[52:55]
    ds_read_b64_tr_b16 v[34:35], v15 offset:38912
    v_mfma_f32_16x16x32_bf16 a[56:59], v[76:79], v[64:67], a[56:59]
    buffer_load_dwordx4 v11, s[12:15], s31 offen offset:1024 lds
    s_add_u32 s31, s31, s34
    v_mfma_f32_16x16x32_bf16 a[60:63], v[80:83], v[64:67], a[60:63]
    ds_read_b128 v[48:51], v12 offset:35840
    s_waitcnt lgkmcnt(0)
    v_mfma_f32_16x16x32_bf16 a[0:3], v[36:39], v[20:23], a[0:3]
    s_waitcnt vmcnt(24)
    s_barrier
    ds_read_b64_tr_b16 v[52:53], v14 offset:49152
    v_mfma_f32_16x16x32_bf16 a[4:7], v[40:43], v[20:23], a[4:7]
    ds_read_b64_tr_b16 v[54:55], v14 offset:51200
    v_mfma_f32_16x16x32_bf16 a[8:11], v[44:47], v[20:23], a[8:11]
    s_add_u32 m0, s39, 32768
    s_nop 0
    buffer_load_dwordx4 v8, s[8:11], s30 offen offset:0 sc1 lds
    v_mfma_f32_16x16x32_bf16 a[12:15], v[48:51], v[20:23], a[12:15]
    ds_read_b128 v[68:71], v12 offset:49152
    v_mfma_f32_16x16x32_bf16 a[16:19], v[36:39], v[24:27], a[16:19]
    ds_read_b64_tr_b16 v[56:57], v15 offset:49152
    v_mfma_f32_16x16x32_bf16 a[20:23], v[40:43], v[24:27], a[20:23]
    ds_read_b64_tr_b16 v[58:59], v15 offset:51200
    v_mfma_f32_16x16x32_bf16 a[24:27], v[44:47], v[24:27], a[24:27]
    buffer_load_dwordx4 v9, s[8:11], s30 offen offset:1024 sc1 lds
    v_mfma_f32_16x16x32_bf16 a[28:31], v[48:51], v[24:27], a[28:31]
    ds_read_b128 v[72:75], v12 offset:50176
    v_mfma_f32_16x16x32_bf16 a[32:35], v[36:39], v[28:31], a[32:35]
    ds_read_b64_tr_b16 v[60:61], v14 offset:53248
    v_mfma_f32_16x16x32_bf16 a[36:39], v[40:43], v[28:31], a[36:39]
    ds_read_b64_tr_b16 v[62:63], v14 offset:55296
    v_mfma_f32_16x16x32_bf16 a[40:43], v[44:47], v[28:31], a[40:43]
    s_add_u32 m0, s40, 32768
    s_add_u32 s30, s30, 1024
    buffer_load_dwordx4 v10, s[12:15], s31 offen offset:0 lds
    v_mfma_f32_16x16x32_bf16 a[44:47], v[48:51], v[28:31], a[44:47]
    ds_read_b128 v[76:79], v12 offset:51200
    v_mfma_f32_16x16x32_bf16 a[48:51], v[36:39], v[32:35], a[48:51]
    ds_read_b64_tr_b16 v[64:65], v15 offset:53248
    v_mfma_f32_16x16x32_bf16 a[52:55], v[40:43], v[32:35], a[52:55]
    ds_read_b64_tr_b16 v[66:67], v15 offset:55296
    v_mfma_f32_16x16x32_bf16 a[56:59], v[44:47], v[32:35], a[56:59]
    buffer_load_dwordx4 v11, s[12:15], s31 offen offset:1024 lds
    s_add_u32 s31, s31, s34
    v_mfma_f32_16x16x32_bf16 a[60:63], v[48:51], v[32:35], a[60:63]
    ds_read_b128 v[80:83], v12 offset:52224
    s_waitcnt lgkmcnt(0)
    v_mfma_f32_16x16x32_bf16 a[0:3], v[68:71], v[52:55], a[0:3]
    s_waitcnt vmcnt(24)
    s_barrier
    ds_read_b64_tr_b16 v[20:21], v16 offset:0
    v_mfma_f32_16x16x32_bf16 a[4:7], v[72:75], v[52:55], a[4:7]
    ds_read_b64_tr_b16 v[22:23], v16 offset:2048
    v_mfma_f32_16x16x32_bf16 a[8:11], v[76:79], v[52:55], a[8:11]
    s_add_u32 m0, s39, 49152
    s_nop 0
    buffer_load_dwordx4 v8, s[8:11], s30 offen offset:0 sc1 lds
    v_mfma_f32_16x16x32_bf16 a[12:15], v[80:83], v[52:55], a[12:15]
    ds_read_b128 v[36:39], v13 offset:0
    v_mfma_f32_16x16x32_bf16 a[16:19], v[68:71], v[56:59], a[16:19]
    ds_read_b64_tr_b16 v[24:25], v17 offset:0
    v_mfma_f32_16x16x32_bf16 a[20:23], v[72:75], v[56:59], a[20:23]
    ds_read_b64_tr_b16 v[26:27], v17 offset:2048
    v_mfma_f32_16x16x32_bf16 a[24:27], v[76:79], v[56:59], a[24:27]
    buffer_load_dwordx4 v9, s[8:11], s30 offen offset:1024 sc1 lds
    v_mfma_f32_16x16x32_bf16 a[28:31], v[80:83], v[56:59], a[28:31]
    ds_read_b128 v[40:43], v13 offset:1024
    v_mfma_f32_16x16x32_bf16 a[32:35], v[68:71], v[60:63], a[32:35]
    ds_read_b64_tr_b16 v[28:29], v16 offset:4096
    v_mfma_f32_16x16x32_bf16 a[36:39], v[72:75], v[60:63], a[36:39]
    ds_read_b64_tr_b16 v[30:31], v16 offset:6144
    v_mfma_f32_16x16x32_bf16 a[40:43], v[76:79], v[60:63], a[40:43]
    s_add_u32 m0, s40, 49152
    s_add_u32 s30, s30, 1024
    buffer_load_dwordx4 v10, s[12:15], s31 offen offset:0 lds
    v_mfma_f32_16x16x32_bf16 a[44:47], v[80:83], v[60:63], a[44:47]
    ds_read_b128 v[44:47], v13 offset:2048
    v_mfma_f32_16x16x32_bf16 a[48:51], v[68:71], v[64:67], a[48:51]
    ds_read_b64_tr_b16 v[32:33], v17 offset:4096
    v_mfma_f32_16x16x32_bf16 a[52:55], v[72:75], v[64:67], a[52:55]
    ds_read_b64_tr_b16 v[34:35], v17 offset:6144
    v_mfma_f32_16x16x32_bf16 a[56:59], v[76:79], v[64:67], a[56:59]
    buffer_load_dwordx4 v11, s[12:15], s31 offen offset:1024 lds
    s_add_u32 s31, s31, s34
    v_mfma_f32_16x16x32_bf16 a[60:63], v[80:83], v[64:67], a[60:63]
    ds_read_b128 v[48:51], v13 offset:3072
    s_waitcnt lgkmcnt(0)
    v_mfma_f32_16x16x32_bf16 a[0:3], v[36:39], v[20:23], a[0:3]
    s_waitcnt vmcnt(24)
    s_barrier
    ds_read_b64_tr_b16 v[52:53], v16 offset:16384
    v_mfma_f32_16x16x32_bf16 a[4:7], v[40:43], v[20:23], a[4:7]
    ds_read_b64_tr_b16 v[54:55], v16 offset:18432
    v_mfma_f32_16x16x32_bf16 a[8:11], v[44:47], v[20:23], a[8:11]
    s_add_u32 m0, s39, 65536
    s_nop 0
    buffer_load_dwordx4 v8, s[8:11], s30 offen offset:0 sc1 lds
    v_mfma_f32_16x16x32_bf16 a[12:15], v[48:51], v[20:23], a[12:15]
    ds_read_b128 v[68:71], v13 offset:16384
    v_mfma_f32_16x16x32_bf16 a[16:19], v[36:39], v[24:27], a[16:19]
    ds_read_b64_tr_b16 v[56:57], v17 offset:16384
    v_mfma_f32_16x16x32_bf16 a[20:23], v[40:43], v[24:27], a[20:23]
    ds_read_b64_tr_b16 v[58:59], v17 offset:18432
    v_mfma_f32_16x16x32_bf16 a[24:27], v[44:47], v[24:27], a[24:27]
    buffer_load_dwordx4 v9, s[8:11], s30 offen offset:1024 sc1 lds
    v_mfma_f32_16x16x32_bf16 a[28:31], v[48:51], v[24:27], a[28:31]
    ds_read_b128 v[72:75], v13 offset:17408
    v_mfma_f32_16x16x32_bf16 a[32:35], v[36:39], v[28:31], a[32:35]
    ds_read_b64_tr_b16 v[60:61], v16 offset:20480
    v_mfma_f32_16x16x32_bf16 a[36:39], v[40:43], v[28:31], a[36:39]
    ds_read_b64_tr_b16 v[62:63], v16 offset:22528
    v_mfma_f32_16x16x32_bf16 a[40:43], v[44:47], v[28:31], a[40:43]
    s_add_u32 m0, s40, 65536
    s_add_u32 s30, s30, 1024
    buffer_load_dwordx4 v10, s[12:15], s31 offen offset:0 lds
    v_mfma_f32_16x16x32_bf16 a[44:47], v[48:51], v[28:31], a[44:47]
    ds_read_b128 v[76:79], v13 offset:18432
    v_mfma_f32_16x16x32_bf16 a[48:51], v[36:39], v[32:35], a[48:51]
    ds_read_b64_tr_b16 v[64:65], v17 offset:20480
    v_mfma_f32_16x16x32_bf16 a[52:55], v[40:43], v[32:35], a[52:55]
    ds_read_b64_tr_b16 v[66:67], v17 offset:22528
    v_mfma_f32_16x16x32_bf16 a[56:59], v[44:47], v[32:35], a[56:59]
    buffer_load_dwordx4 v11, s[12:15], s31 offen offset:1024 lds
    s_add_u32 s31, s31, s34
    v_mfma_f32_16x16x32_bf16 a[60:63], v[48:51], v[32:35], a[60:63]
    ds_read_b128 v[80:83], v13 offset:19456
    s_waitcnt lgkmcnt(0)
    v_mfma_f32_16x16x32_bf16 a[0:3], v[68:71], v[52:55], a[0:3]
    s_waitcnt vmcnt(24)
    s_barrier
    ds_read_b64_tr_b16 v[20:21], v16 offset:32768
    v_mfma_f32_16x16x32_bf16 a[4:7], v[72:75], v[52:55], a[4:7]
    ds_read_b64_tr_b16 v[22:23], v16 offset:34816
    v_mfma_f32_16x16x32_bf16 a[8:11], v[76:79], v[52:55], a[8:11]
    s_add_u32 m0, s39, 81920
    s_nop 0
    buffer_load_dwordx4 v8, s[8:11], s30 offen offset:0 sc1 lds
    v_mfma_f32_16x16x32_bf16 a[12:15], v[80:83], v[52:55], a[12:15]
    ds_read_b128 v[36:39], v13 offset:32768
    v_mfma_f32_16x16x32_bf16 a[16:19], v[68:71], v[56:59], a[16:19]
    ds_read_b64_tr_b16 v[24:25], v17 offset:32768
    v_mfma_f32_16x16x32_bf16 a[20:23], v[72:75], v[56:59], a[20:23]
    ds_read_b64_tr_b16 v[26:27], v17 offset:34816
    v_mfma_f32_16x16x32_bf16 a[24:27], v[76:79], v[56:59], a[24:27]
    buffer_load_dwordx4 v9, s[8:11], s30 offen offset:1024 sc1 lds
    v_mfma_f32_16x16x32_bf16 a[28:31], v[80:83], v[56:59], a[28:31]
    ds_read_b128 v[40:43], v13 offset:33792
    v_mfma_f32_16x16x32_bf16 a[32:35], v[68:71], v[60:63], a[32:35]
    ds_read_b64_tr_b16 v[28:29], v16 offset:36864
    v_mfma_f32_16x16x32_bf16 a[36:39], v[72:75], v[60:63], a[36:39]
    ds_read_b64_tr_b16 v[30:31], v16 offset:38912
    v_mfma_f32_16x16x32_bf16 a[40:43], v[76:79], v[60:63], a[40:43]
    s_add_u32 m0, s40, 81920
    s_add_u32 s30, s30, 1024
    buffer_load_dwordx4 v10, s[12:15], s31 offen offset:0 lds
    v_mfma_f32_16x16x32_bf16 a[44:47], v[80:83], v[60:63], a[44:47]
    ds_read_b128 v[44:47], v13 offset:34816
    v_mfma_f32_16x16x32_bf16 a[48:51], v[68:71], v[64:67], a[48:51]
    ds_read_b64_tr_b16 v[32:33], v17 offset:36864
    v_mfma_f32_16x16x32_bf16 a[52:55], v[72:75], v[64:67], a[52:55]
    ds_read_b64_tr_b16 v[34:35], v17 offset:38912
    v_mfma_f32_16x16x32_bf16 a[56:59], v[76:79], v[64:67], a[56:59]
    buffer_load_dwordx4 v11, s[12:15], s31 offen offset:1024 lds
    s_add_u32 s31, s31, s34
    v_mfma_f32_16x16x32_bf16 a[60:63], v[80:83], v[64:67], a[60:63]
    ds_read_b128 v[48:51], v13 offset:35840
    s_waitcnt lgkmcnt(0)
    v_mfma_f32_16x16x32_bf16 a[0:3], v[36:39], v[20:23], a[0:3]
    s_waitcnt vmcnt(24)
    s_barrier
    ds_read_b64_tr_b16 v[52:53], v16 offset:49152
    v_mfma_f32_16x16x32_bf16 a[4:7], v[40:43], v[20:23], a[4:7]
    ds_read_b64_tr_b16 v[54:55], v16 offset:51200
    v_mfma_f32_16x16x32_bf16 a[8:11], v[44:47], v[20:23], a[8:11]
    s_add_u32 m0, s39, 98304
    s_nop 0
    buffer_load_dwordx4 v8, s[8:11], s30 offen offset:0 sc1 lds
    v_mfma_f32_16x16x32_bf16 a[12:15], v[48:51], v[20:23], a[12:15]
    ds_read_b128 v[68:71], v13 offset:49152
    v_mfma_f32_16x16x32_bf16 a[16:19], v[36:39], v[24:27], a[16:19]
    ds_read_b64_tr_b16 v[56:57], v17 offset:49152
    v_mfma_f32_16x16x32_bf16 a[20:23], v[40:43], v[24:27], a[20:23]
    ds_read_b64_tr_b16 v[58:59], v17 offset:51200
    v_mfma_f32_16x16x32_bf16 a[24:27], v[44:47], v[24:27], a[24:27]
    buffer_load_dwordx4 v9, s[8:11], s30 offen offset:1024 sc1 lds
    v_mfma_f32_16x16x32_bf16 a[28:31], v[48:51], v[24:27], a[28:31]
    ds_read_b128 v[72:75], v13 offset:50176
    v_mfma_f32_16x16x32_bf16 a[32:35], v[36:39], v[28:31], a[32:35]
    ds_read_b64_tr_b16 v[60:61], v16 offset:53248
    v_mfma_f32_16x16x32_bf16 a[36:39], v[40:43], v[28:31], a[36:39]
    ds_read_b64_tr_b16 v[62:63], v16 offset:55296
    v_mfma_f32_16x16x32_bf16 a[40:43], v[44:47], v[28:31], a[40:43]
    s_add_u32 m0, s40, 98304
    s_add_u32 s30, s30, 1024
    buffer_load_dwordx4 v10, s[12:15], s31 offen offset:0 lds
    v_mfma_f32_16x16x32_bf16 a[44:47], v[48:51], v[28:31], a[44:47]
    ds_read_b128 v[76:79], v13 offset:51200
    v_mfma_f32_16x16x32_bf16 a[48:51], v[36:39], v[32:35], a[48:51]
    ds_read_b64_tr_b16 v[64:65], v17 offset:53248
    v_mfma_f32_16x16x32_bf16 a[52:55], v[40:43], v[32:35], a[52:55]
    ds_read_b64_tr_b16 v[66:67], v17 offset:55296
    v_mfma_f32_16x16x32_bf16 a[56:59], v[44:47], v[32:35], a[56:59]
    buffer_load_dwordx4 v11, s[12:15], s31 offen offset:1024 lds
    s_add_u32 s31, s31, s34
    v_mfma_f32_16x16x32_bf16 a[60:63], v[48:51], v[32:35], a[60:63]
    ds_read_b128 v[80:83], v13 offset:52224
    s_waitcnt lgkmcnt(0)
    v_mfma_f32_16x16x32_bf16 a[0:3], v[68:71], v[52:55], a[0:3]
    s_waitcnt vmcnt(24)
    s_barrier
    ds_read_b64_tr_b16 v[20:21], v14 offset:0
    v_mfma_f32_16x16x32_bf16 a[4:7], v[72:75], v[52:55], a[4:7]
    ds_read_b64_tr_b16 v[22:23], v14 offset:2048
    v_mfma_f32_16x16x32_bf16 a[8:11], v[76:79], v[52:55], a[8:11]
    s_add_u32 m0, s39, 114688
    s_nop 0
    buffer_load_dwordx4 v8, s[8:11], s30 offen offset:0 sc1 lds
    v_mfma_f32_16x16x32_bf16 a[12:15], v[80:83], v[52:55], a[12:15]
    ds_read_b128 v[36:39], v12 offset:0
    v_mfma_f32_16x16x32_bf16 a[16:19], v[68:71], v[56:59], a[16:19]
    ds_read_b64_tr_b16 v[24:25], v15 offset:0
    v_mfma_f32_16x16x32_bf16 a[20:23], v[72:75], v[56:59], a[20:23]
    ds_read_b64_tr_b16 v[26:27], v15 offset:2048
    v_mfma_f32_16x16x32_bf16 a[24:27], v[76:79], v[56:59], a[24:27]
    buffer_load_dwordx4 v9, s[8:11], s30 offen offset:1024 sc1 lds
    v_mfma_f32_16x16x32_bf16 a[28:31], v[80:83], v[56:59], a[28:31]
    ds_read_b128 v[40:43], v12 offset:1024
    v_mfma_f32_16x16x32_bf16 a[32:35], v[68:71], v[60:63], a[32:35]
    ds_read_b64_tr_b16 v[28:29], v14 offset:4096
    v_mfma_f32_16x16x32_bf16 a[36:39], v[72:75], v[60:63], a[36:39]
    ds_read_b64_tr_b16 v[30:31], v14 offset:6144
    v_mfma_f32_16x16x32_bf16 a[40:43], v[76:79], v[60:63], a[40:43]
    s_add_u32 m0, s40, 114688
    s_add_u32 s30, s30, 1024
    buffer_load_dwordx4 v10, s[12:15], s31 offen offset:0 lds
    v_mfma_f32_16x16x32_bf16 a[44:47], v[80:83], v[60:63], a[44:47]
    ds_read_b128 v[44:47], v12 offset:2048
    v_mfma_f32_16x16x32_bf16 a[48:51], v[68:71], v[64:67], a[48:51]
    ds_read_b64_tr_b16 v[32:33], v15 offset:4096
    v_mfma_f32_16x16x32_bf16 a[52:55], v[72:75], v[64:67], a[52:55]
    ds_read_b64_tr_b16 v[34:35], v15 offset:6144
    v_mfma_f32_16x16x32_bf16 a[56:59], v[76:79], v[64:67], a[56:59]
    buffer_load_dwordx4 v11, s[12:15], s31 offen offset:1024 lds
    s_add_u32 s31, s31, s34
    v_mfma_f32_16x16x32_bf16 a[60:63], v[80:83], v[64:67], a[60:63]
    ds_read_b128 v[48:51], v12 offset:3072
    s_sub_u32 s35, s35, 1
    s_cmp_lg_u32 s35, 0
    s_cbranch_scc1 L_gbs_loop
    s_waitcnt lgkmcnt(0)
    s_nop 7
    s_cmp_eq_u32 s36, 0
    s_cbranch_scc1 L_nbs_n
    s_cmp_lg_u32 s63, -1
    s_cbranch_scc1 L_nbs_c
    v_mov_b32 v4, 192
L_nbs_p:
    buffer_load_dword v5, v4, s[16:19], 0 offen sc1
    s_sub_u32 s62, s62, 1
    s_cbranch_scc1 L_w_fail
    s_waitcnt vmcnt(0)
    v_readfirstlane_b32 s4, v5
    s_and_b32 s5, s4, 0xffff
    s_cmp_lt_u32 s5, 8
    s_cbranch_scc1 L_nbs_p
    s_lshr_b32 s4, s4, 16
    s_cmp_ge_u32 s4, 4
    s_cselect_b32 s63, 8192, 0
L_nbs_c:
    s_lshl_b32 s4, s55, 13
    s_xor_b32 s4, s4, s63
    s_and_b32 s4, s4, 8192
    s_add_u32 s37, s37, s4
L_nbs_n:
    s_lshr_b32 s4, s21, 1
    s_mul_i32 s4, s4, 2
    s_mul_i32 s4, s4, s38
    s_add_u32 s4, s4, s37
    s_and_b32 s5, s21, 1
    s_mul_i32 s5, s5, 2048
    s_add_u32 s4, s4, s5
    s_add_u32 s5, s4, s41
    v_accvgpr_read_b32 v24, a0
    v_accvgpr_read_b32 v25, a1
    v_accvgpr_read_b32 v26, a2
    v_accvgpr_read_b32 v27, a3
    v_accvgpr_read_b32 v28, a4
    v_accvgpr_read_b32 v29, a5
    v_accvgpr_read_b32 v30, a6
    v_accvgpr_read_b32 v31, a7
    v_cvt_pk_bf16_f32 v20, v24, v25
    v_cvt_pk_bf16_f32 v21, v26, v27
    v_cvt_pk_bf16_f32 v22, v28, v29
    v_cvt_pk_bf16_f32 v23, v30, v31
    buffer_store_dwordx4 v[20:23], v2, s[8:11], s4 offen offset:0 sc1
    v_accvgpr_read_b32 v36, a16
    v_accvgpr_read_b32 v37, a17
    v_accvgpr_read_b32 v38, a18
    v_accvgpr_read_b32 v39, a19
    v_accvgpr_read_b32 v40, a20
    v_accvgpr_read_b32 v41, a21
    v_accvgpr_read_b32 v42, a22
    v_accvgpr_read_b32 v43, a23
    v_cvt_pk_bf16_f32 v32, v36, v37
    v_cvt_pk_bf16_f32 v33, v38, v39
    v_cvt_pk_bf16_f32 v34, v40, v41
    v_cvt_pk_bf16_f32 v35, v42, v43
    buffer_store_dwordx4 v[32:35], v2, s[8:11], s4 offen offset:1024 sc1
    v_accvgpr_read_b32 v48, a32
    v_accvgpr_read_b32 v49, a33
    v_accvgpr_read_b32 v50, a34
    v_accvgpr_read_b32 v51, a35
    v_accvgpr_read_b32 v52, a36
    v_accvgpr_read_b32 v53, a37
    v_accvgpr_read_b32 v54, a38
    v_accvgpr_read_b32 v55, a39
    v_cvt_pk_bf16_f32 v44, v48, v49
    v_cvt_pk_bf16_f32 v45, v50, v51
    v_cvt_pk_bf16_f32 v46, v52, v53
    v_cvt_pk_bf16_f32 v47, v54, v55
    buffer_store_dwordx4 v[44:47], v2, s[8:11], s5 offen offset:0 sc1
    v_accvgpr_read_b32 v60, a48
    v_accvgpr_read_b32 v61, a49
    v_accvgpr_read_b32 v62, a50
    v_accvgpr_read_b32 v63, a51
    v_accvgpr_read_b32 v64, a52
    v_accvgpr_read_b32 v65, a53
    v_accvgpr_read_b32 v66, a54
    v_accvgpr_read_b32 v67, a55
    v_cvt_pk_bf16_f32 v56, v60, v61
    v_cvt_pk_bf16_f32 v57, v62, v63
    v_cvt_pk_bf16_f32 v58, v64, v65
    v_cvt_pk_bf16_f32 v59, v66, v67
    buffer_store_dwordx4 v[56:59], v2, s[8:11], s5 offen offset:1024 sc1
    s_add_u32 s4, s4, s38
    s_add_u32 s5, s4, s41
    v_accvgpr_read_b32 v24, a8
    v_accvgpr_read_b32 v25, a9
    v_accvgpr_read_b32 v26, a10
    v_accvgpr_read_b32 v27, a11
    v_accvgpr_read_b32 v28, a12
    v_accvgpr_read_b32 v29, a13
    v_accvgpr_read_b32 v30, a14
    v_accvgpr_read_b32 v31, a15
    v_cvt_pk_bf16_f32 v20, v24, v25
    v_cvt_pk_bf16_f32 v21, v26, v27
    v_cvt_pk_bf16_f32 v22, v28, v29
    v_cvt_pk_bf16_f32 v23, v30, v31
    buffer_store_dwordx4 v[20:23], v2, s[8:11], s4 offen offset:0 sc1
    v_accvgpr_read_b32 v36, a24
    v_accvgpr_read_b32 v37, a25
    v_accvgpr_read_b32 v38, a26
    v_accvgpr_read_b32 v39, a27
    v_accvgpr_read_b32 v40, a28
    v_accvgpr_read_b32 v41, a29
    v_accvgpr_read_b32 v42, a30
    v_accvgpr_read_b32 v43, a31
    v_cvt_pk_bf16_f32 v32, v36, v37
    v_cvt_pk_bf16_f32 v33, v38, v39
    v_cvt_pk_bf16_f32 v34, v40, v41
    v_cvt_pk_bf16_f32 v35, v42, v43
    buffer_store_dwordx4 v[32:35], v2, s[8:11], s4 offen offset:1024 sc1
    v_accvgpr_read_b32 v48, a40
    v_accvgpr_read_b32 v49, a41
    v_accvgpr_read_b32 v50, a42
    v_accvgpr_read_b32 v51, a43
    v_accvgpr_read_b32 v52, a44
    v_accvgpr_read_b32 v53, a45
    v_accvgpr_read_b32 v54, a46
    v_accvgpr_read_b32 v55, a47
    v_cvt_pk_bf16_f32 v44, v48, v49
    v_cvt_pk_bf16_f32 v45, v50, v51
    v_cvt_pk_bf16_f32 v46, v52, v53
    v_cvt_pk_bf16_f32 v47, v54, v55
    buffer_store_dwordx4 v[44:47], v2, s[8:11], s5 offen offset:0 sc1
    v_accvgpr_read_b32 v60, a56
    v_accvgpr_read_b32 v61, a57
    v_accvgpr_read_b32 v62, a58
    v_accvgpr_read_b32 v63, a59
    v_accvgpr_read_b32 v64, a60
    v_accvgpr_read_b32 v65, a61
    v_accvgpr_read_b32 v66, a62
    v_accvgpr_read_b32 v67, a63
    v_cvt_pk_bf16_f32 v56, v60, v61
    v_cvt_pk_bf16_f32 v57, v62, v63
    v_cvt_pk_bf16_f32 v58, v64, v65
    v_cvt_pk_bf16_f32 v59, v66, v67
    buffer_store_dwordx4 v[56:59], v2, s[8:11], s5 offen offset:1024 sc1
    s_add_u32 s4, s4, s38
    s_branch L_w_done
L_gb:
    s_mul_i32 s4, s21, 2
    s_mul_i32 s4, s4, s32
    s_sub_u32 s5, s32, 1024
    v_add_u32 v8, s4, v2
    s_add_u32 s4, s4, s5
    v_add_u32 v9, s4, v2
    v_lshrrev_b32 v4, 3, v1
    v_and_b32 v5, 7, v1
    s_and_b32 s6, s21, 1
    s_lshl_b32 s4, s6, 4
    s_add_u32 s5, s4, 0
    v_add_u32 v6, s5, v4
    v_bfe_u32 v7, v6, 1, 2
    v_lshlrev_b32 v7, 1, v7
    v_xor_b32 v7, v7, v5
    v_lshlrev_b32 v7, 4, v7
    v_mul_lo_u32 v6, v6, s33
    v_add_u32 v6, v6, v7
    v_subrev_u32 v10, 0, v6
    s_add_u32 s5, s4, 8
    v_add_u32 v6, s5, v4
    v_bfe_u32 v7, v6, 1, 2
    v_lshlrev_b32 v7, 1, v7
    v_xor_b32 v7, v7, v5
    v_lshlrev_b32 v7, 4, v7
    v_mul_lo_u32 v6, v6, s33
    v_add_u32 v6, v6, v7
    v_subrev_u32 v11, 1024, v6
    s_lshr_b32 s7, s21, 1
    s_mul_i32 s4, s7, 4096
    s_add_u32 s5, s4, 0
    v_add_u32 v12, s5, v2
    s_add_u32 s5, s4, 65536
    v_add_u32 v13, s5, v2
    v_lshrrev_b32 v5, 2, v1
    v_bfe_u32 v4, v5, 1, 2
    v_mul_u32_u24 v5, 128, v5
    v_and_b32 v6, 3, v1
    v_lshl_add_u32 v5, v6, 3, v5
    s_mul_i32 s4, s6, 2
    s_add_u32 s4, s4, 0
    v_xor_b32 v6, s4, v4
    v_lshl_add_u32 v6, v6, 5, v5
    v_add_u32 v14, 8192, v6
    v_add_u32 v16, 73728, v6
    s_mul_i32 s4, s6, 2
    s_add_u32 s4, s4, 1
    v_xor_b32 v6, s4, v4
    v_lshl_add_u32 v6, v6, 5, v5
    v_add_u32 v15, 8192, v6
    v_add_u32 v17, 73728, v6
    s_mul_i32 s39, s21, 2048
    s_mul_i32 s40, s21, 2048
    s_add_u32 s40, s40, 8192
    s_lshl_b32 s34, s33, 5
    s_add_u32 m0, s39, 0
    s_nop 0
    buffer_load_dwordx4 v8, s[8:11], s30 offen offset:0 sc1 lds
    buffer_load_dwordx4 v9, s[8:11], s30 offen offset:1024 sc1 lds
    s_add_u32 m0, s40, 0
    s_add_u32 s30, s30, 1024
    buffer_load_dwordx4 v10, s[12:15], s31 offen offset:0 lds
    buffer_load_dwordx4 v11, s[12:15], s31 offen offset:1024 lds
    s_add_u32 s31, s31, s34
    s_add_u32 m0, s39, 16384
    s_nop 0
    buffer_load_dwordx4 v8, s[8:11], s30 offen offset:0 sc1 lds
    buffer_load_dwordx4 v9, s[8:11], s30 offen offset:1024 sc1 lds
    s_add_u32 m0, s40, 16384
    s_add_u32 s30, s30, 1024
    buffer_load_dwordx4 v10, s[12:15], s31 offen offset:0 lds
    buffer_load_dwordx4 v11, s[12:15], s31 offen offset:1024 lds
    s_add_u32 s31, s31, s34
    s_add_u32 m0, s39, 32768
    s_nop 0
    buffer_load_dwordx4 v8, s[8:11], s30 offen offset:0 sc1 lds
    buffer_load_dwordx4 v9, s[8:11], s30 offen offset:1024 sc1 lds
    s_add_u32 m0, s40, 32768
    s_add_u32 s30, s30, 1024
    buffer_load_dwordx4 v10, s[12:15], s31 offen offset:0 lds
    buffer_load_dwordx4 v11, s[12:15], s31 offen offset:1024 lds
    s_add_u32 s31, s31, s34
    s_add_u32 m0, s39, 49152
    s_nop 0
    buffer_load_dwordx4 v8, s[8:11], s30 offen offset:0 sc1 lds
    buffer_load_dwordx4 v9, s[8:11], s30 offen offset:1024 sc1 lds
    s_add_u32 m0, s40, 49152
    s_add_u32 s30, s30, 1024
    buffer_load_dwordx4 v10, s[12:15], s31 offen offset:0 lds
    buffer_load_dwordx4 v11, s[12:15], s31 offen offset:1024 lds
    s_add_u32 s31, s31, s34
    s_add_u32 m0, s39, 65536
    s_nop 0
    buffer_load_dwordx4 v8, s[8:11], s30 offen offset:0 sc1 lds
    buffer_load_dwordx4 v9, s[8:11], s30 offen offset:1024 sc1 lds
    s_add_u32 m0, s40, 65536
    s_add_u32 s30, s30, 1024
    buffer_load_dwordx4 v10, s[12:15], s31 offen offset:0 lds
    buffer_load_dwordx4 v11, s[12:15], s31 offen offset:1024 lds
    s_add_u32 s31, s31, s34
    s_add_u32 m0, s39, 81920
    s_nop 0
    buffer_load_dwordx4 v8, s[8:11], s30 offen offset:0 sc1 lds
    buffer_load_dwordx4 v9, s[8:11], s30 offen offset:1024 sc1 lds
    s_add_u32 m0, s40, 81920
    s_add_u32 s30, s30, 1024
    buffer_load_dwordx4 v10, s[12:15], s31 offen offset:0 lds
    buffer_load_dwordx4 v11, s[12:15], s31 offen offset:1024 lds
    s_add_u32 s31, s31, s34
    s_add_u32 m0, s39, 98304
    s_nop 0
    buffer_load_dwordx4 v8, s[8:11], s30 offen offset:0 sc1 lds
    buffer_load_dwordx4 v9, s[8:11], s30 offen offset:1024 sc1 lds
    s_add_u32 m0, s40, 98304
    s_add_u32 s30, s30, 1024
    buffer_load_dwordx4 v10, s[12:15], s31 offen offset:0 lds
    buffer_load_dwordx4 v11, s[12:15], s31 offen offset:1024 lds
    s_add_u32 s31, s31, s34
    s_add_u32 m0, s39, 114688
    s_nop 0
    buffer_load_dwordx4 v8, s[8:11], s30 offen offset:0 sc1 lds
    buffer_load_dwordx4 v9, s[8:11], s30 offen offset:1024 sc1 lds
    s_add_u32 m0, s40, 114688
    s_add_u32 s30, s30, 1024
    buffer_load_dwordx4 v10, s[12:15], s31 offen offset:0 lds
    buffer_load_dwordx4 v11, s[12:15], s31 offen offset:1024 lds
    s_add_u32 s31, s31, s34
    s_waitcnt vmcnt(28)
    s_barrier
    ds_read_b64_tr_b16 v[20:21], v14 offset:0
    ds_read_b64_tr_b16 v[22:23], v14 offset:2048
    ds_read_b128 v[36:39], v12 offset:0
    ds_read_b64_tr_b16 v[24:25], v15 offset:0
    ds_read_b64_tr_b16 v[26:27], v15 offset:2048
    ds_read_b128 v[40:43], v12 offset:1024
    ds_read_b64_tr_b16 v[28:29], v14 offset:4096
    ds_read_b64_tr_b16 v[30:31], v14 offset:6144
    ds_read_b128 v[44:47], v12 offset:2048
    ds_read_b64_tr_b16 v[32:33], v15 offset:4096
    ds_read_b64_tr_b16 v[34:35], v15 offset:6144
    ds_read_b128 v[48:51], v12 offset:3072
    s_waitcnt lgkmcnt(0)
    v_mfma_f32_16x16x32_bf16 a[0:3], v[20:23], v[36:39], 0
    s_waitcnt vmcnt(24)
    s_barrier
    ds_read_b64_tr_b16 v[52:53], v14 offset:16384
    v_mfma_f32_16x16x32_bf16 a[4:7], v[20:23], v[40:43], 0
    ds_read_b64_tr_b16 v[54:55], v14 offset:18432
    v_mfma_f32_16x16x32_bf16 a[8:11], v[20:23], v[44:47], 0
    s_add_u32 m0, s39, 0
    s_nop 0
    buffer_load_dwordx4 v8, s[8:11], s30 offen offset:0 sc1 lds
    v_mfma_f32_16x16x32_bf16 a[12:15], v[20:23], v[48:51], 0
    ds_read_b128 v[68:71], v12 offset:16384
    v_mfma_f32_16x16x32_bf16 a[16:19], v[24:27], v[36:39], 0
    ds_read_b64_tr_b16 v[56:57], v15 offset:16384
    v_mfma_f32_16x16x32_bf16 a[20:23], v[24:27], v[40:43], 0
    ds_read_b64_tr_b16 v[58:59], v15 offset:18432
    v_mfma_f32_16x16x32_bf16 a[24:27], v[24:27], v[44:47], 0
    buffer_load_dwordx4 v9, s[8:11], s30 offen offset:1024 sc1 lds
    v_mfma_f32_16x16x32_bf16 a[28:31], v[24:27], v[48:51], 0
    ds_read_b128 v[72:75], v12 offset:17408
    v_mfma_f32_16x16x32_bf16 a[32:35], v[28:31], v[36:39], 0
    ds_read_b64_tr_b16 v[60:61], v14 offset:20480
    v_mfma_f32_16x16x32_bf16 a[36:39], v[28:31], v[40:43], 0
    ds_read_b64_tr_b16 v[62:63], v14 offset:22528
    v_mfma_f32_16x16x32_bf16 a[40:43], v[28:31], v[44:47], 0
    s_add_u32 m0, s40, 0
    s_add_u32 s30, s30, 1024
    buffer_load_dwordx4 v10, s[12:15], s31 offen offset:0 lds
    v_mfma_f32_16x16x32_bf16 a[44:47], v[28:31], v[48:51], 0
    ds_read_b128 v[76:79], v12 offset:18432
    v_mfma_f32_16x16x32_bf16 a[48:51], v[32:35], v[36:39], 0
    ds_read_b64_tr_b16 v[64:65], v15 offset:20480
    v_mfma_f32_16x16x32_bf16 a[52:55], v[32:35], v[40:43], 0
    ds_read_b64_tr_b16 v[66:67], v15 offset:22528
    v_mfma_f32_16x16x32_bf16 a[56:59], v[32:35], v[44:47], 0
    buffer_load_dwordx4 v11, s[12:15], s31 offen offset:1024 lds
    s_add_u32 s31, s31, s34
    v_mfma_f32_16x16x32_bf16 a[60:63], v[32:35], v[48:51], 0
    ds_read_b128 v[80:83], v12 offset:19456
    s_branch L_gb_s1
L_gb_loop:
    s_cmp_eq_u32 s35, 1
    s_cselect_b32 s30, 0x80000000, s30
    s_cselect_b32 s31, 0x80000000, s31
    s_waitcnt lgkmcnt(0)
    v_mfma_f32_16x16x32_bf16 a[0:3], v[20:23], v[36:39], a[0:3]
    s_waitcnt vmcnt(24)
    s_barrier
    ds_read_b64_tr_b16 v[52:53], v14 offset:16384
    v_mfma_f32_16x16x32_bf16 a[4:7], v[20:23], v[40:43], a[4:7]
    ds_read_b64_tr_b16 v[54:55], v14 offset:18432
    v_mfma_f32_16x16x32_bf16 a[8:11], v[20:23], v[44:47], a[8:11]
    s_add_u32 m0, s39, 0
    s_nop 0
    buffer_load_dwordx4 v8, s[8:11], s30 offen offset:0 sc1 lds
    v_mfma_f32_16x16x32_bf16 a[12:15], v[20:23], v[48:51], a[12:15]
    ds_read_b128 v[68:71], v12 offset:16384
    v_mfma_f32_16x16x32_bf16 a[16:19], v[24:27], v[36:39], a[16:19]
    ds_read_b64_tr_b16 v[56:57], v15 offset:16384
    v_mfma_f32_16x16x32_bf16 a[20:23], v[24:27], v[40:43], a[20:23]
    ds_read_b64_tr_b16 v[58:59], v15 offset:18432
    v_mfma_f32_16x16x32_bf16 a[24:27], v[24:27], v[44:47], a[24:27]
    buffer_load_dwordx4 v9, s[8:11], s30 offen offset:1024 sc1 lds
    v_mfma_f32_16x16x32_bf16 a[28:31], v[24:27], v[48:51], a[28:31]
    ds_read_b128 v[72:75], v12 offset:17408
    v_mfma_f32_16x16x32_bf16 a[32:35], v[28:31], v[36:39], a[32:35]
    ds_read_b64_tr_b16 v[60:61], v14 offset:20480
    v_mfma_f32_16x16x32_bf16 a[36:39], v[28:31], v[40:43], a[36:39]
    ds_read_b64_tr_b16 v[62:63], v14 offset:22528
    v_mfma_f32_16x16x32_bf16 a[40:43], v[28:31], v[44:47], a[40:43]
    s_add_u32 m0, s40, 0
    s_add_u32 s30, s30, 1024
    buffer_load_dwordx4 v10, s[12:15], s31 offen offset:0 lds
    v_mfma_f32_16x16x32_bf16 a[44:47], v[28:31], v[48:51], a[44:47]
    ds_read_b128 v[76:79], v12 offset:18432
    v_mfma_f32_16x16x32_bf16 a[48:51], v[32:35], v[36:39], a[48:51]
    ds_read_b64_tr_b16 v[64:65], v15 offset:20480
    v_mfma_f32_16x16x32_bf16 a[52:55], v[32:35], v[40:43], a[52:55]
    ds_read_b64_tr_b16 v[66:67], v15 offset:22528
    v_mfma_f32_16x16x32_bf16 a[56:59], v[32:35], v[44:47], a[56:59]
    buffer_load_dwordx4 v11, s[12:15], s31 offen offset:1024 lds
    s_add_u32 s31, s31, s34
    v_mfma_f32_16x16x32_bf16 a[60:63], v[32:35], v[48:51], a[60:63]
    ds_read_b128 v[80:83], v12 offset:19456
L_gb_s1:
    s_waitcnt lgkmcnt(0)
    v_mfma_f32_16x16x32_bf16 a[0:3], v[52:55], v[68:71], a[0:3]
    s_waitcnt vmcnt(24)
    s_barrier
    ds_read_b64_tr_b16 v[20:21], v14 offset:32768
    v_mfma_f32_16x16x32_bf16 a[4:7], v[52:55], v[72:75], a[4:7]
    ds_read_b64_tr_b16 v[22:23], v14 offset:34816
    v_mfma_f32_16x16x32_bf16 a[8:11], v[52:55], v[76:79], a[8:11]
    s_add_u32 m0, s39, 16384
    s_nop 0
    buffer_load_dwordx4 v8, s[8:11], s30 offen offset:0 sc1 lds
    v_mfma_f32_16x16x32_bf16 a[12:15], v[52:55], v[80:83], a[12:15]
    ds_read_b128 v[36:39], v12 offset:32768
    v_mfma_f32_16x16x32_bf16 a[16:19], v[56:59], v[68:71], a[16:19]
    ds_read_b64_tr_b16 v[24:25], v15 offset:32768
    v_mfma_f32_16x16x32_bf16 a[20:23], v[56:59], v[72:75], a[20:23]
    ds_read_b64_tr_b16 v[26:27], v15 offset:34816
    v_mfma_f32_16x16x32_bf16 a[24:27], v[56:59], v[76:79], a[24:27]
    buffer_load_dwordx4 v9, s[8:11], s30 offen offset:1024 sc1 lds
    v_mfma_f32_16x16x32_bf16 a[28:31], v[56:59], v[80:83], a[28:31]
    ds_read_b128 v[40:43], v12 offset:33792
    v_mfma_f32_16x16x32_bf16 a[32:35], v[60:63], v[68:71], a[32:35]
    ds_read_b64_tr_b16 v[28:29], v14 offset:36864
    v_mfma_f32_16x16x32_bf16 a[36:39], v[60:63], v[72:75], a[36:39]
    ds_read_b64_tr_b16 v[30:31], v14 offset:38912
    v_mfma_f32_16x16x32_bf16 a[40:43], v[60:63], v[76:79], a[40:43]
    s_add_u32 m0, s40, 16384
    s_add_u32 s30, s30, 1024
    buffer_load_dwordx4 v10, s[12:15], s31 offen offset:0 lds
    v_mfma_f32_16x16x32_bf16 a[44:47], v[60:63], v[80:83], a[44:47]
    ds_read_b128 v[44:47], v12 offset:34816
    v_mfma_f32_16x16x32_bf16 a[48:51], v[64:67], v[68:71], a[48:51]
    ds_read_b64_tr_b16 v[32:33], v15 offset:36864
    v_mfma_f32_16x16x32_bf16 a[52:55], v[64:67], v[72:75], a[52:55]
    ds_read_b64_tr_b16 v[34:35], v15 offset:38912
    v_mfma_f32_16x16x32_bf16 a[56:59], v[64:67], v[76:79], a[56:59]
    buffer_load_dwordx4 v11, s[12:15], s31 offen offset:1024 lds
    s_add_u32 s31, s31, s34
    v_mfma_f32_16x16x32_bf16 a[60:63], v[64:67], v[80:83], a[60:63]
    ds_read_b128 v[48:51], v12 offset:35840
    s_waitcnt lgkmcnt(0)
    v_mfma_f32_16x16x32_bf16 a[0:3], v[20:23], v[36:39], a[0:3]
    s_waitcnt vmcnt(24)
    s_barrier
    ds_read_b64_tr_b16 v[52:53], v14 offset:49152
    v_mfma_f32_16x16x32_bf16 a[4:7], v[20:23], v[40:43], a[4:7]
    ds_read_b64_tr_b16 v[54:55], v14 offset:51200
    v_mfma_f32_16x16x32_bf16 a[8:11], v[20:23], v[44:47], a[8:11]
    s_add_u32 m0, s39, 32768
    s_nop 0
    buffer_load_dwordx4 v8, s[8:11], s30 offen offset:0 sc1 lds
    v_mfma_f32_16x16x32_bf16 a[12:15], v[20:23], v[48:51], a[12:15]
    ds_read_b128 v[68:71], v12 offset:49152
    v_mfma_f32_16x16x32_bf16 a[16:19], v[24:27], v[36:39], a[16:19]
    ds_read_b64_tr_b16 v[56:57], v15 offset:49152
    v_mfma_f32_16x16x32_bf16 a[20:23], v[24:27], v[40:43], a[20:23]
    ds_read_b64_tr_b16 v[58:59], v15 offset:51200
    v_mfma_f32_16x16x32_bf16 a[24:27], v[24:27], v[44:47], a[24:27]
    buffer_load_dwordx4 v9, s[8:11], s30 offen offset:1024 sc1 lds
    v_mfma_f32_16x16x32_bf16 a[28:31], v[24:27], v[48:51], a[28:31]
    ds_read_b128 v[72:75], v12 offset:50176
    v_mfma_f32_16x16x32_bf16 a[32:35], v[28:31], v[36:39], a[32:35]
    ds_read_b64_tr_b16 v[60:61], v14 offset:53248
    v_mfma_f32_16x16x32_bf16 a[36:39], v[28:31], v[40:43], a[36:39]
    ds_read_b64_tr_b16 v[62:63], v14 offset:55296
    v_mfma_f32_16x16x32_bf16 a[40:43], v[28:31], v[44:47], a[40:43]
    s_add_u32 m0, s40, 32768
    s_add_u32 s30, s30, 1024
    buffer_load_dwordx4 v10, s[12:15], s31 offen offset:0 lds
    v_mfma_f32_16x16x32_bf16 a[44:47], v[28:31], v[48:51], a[44:47]
    ds_read_b128 v[76:79], v12 offset:51200
    v_mfma_f32_16x16x32_bf16 a[48:51], v[32:35], v[36:39], a[48:51]
    ds_read_b64_tr_b16 v[64:65], v15 offset:53248
    v_mfma_f32_16x16x32_bf16 a[52:55], v[32:35], v[40:43], a[52:55]
    ds_read_b64_tr_b16 v[66:67], v15 offset:55296
    v_mfma_f32_16x16x32_bf16 a[56:59], v[32:35], v[44:47], a[56:59]
    buffer_load_dwordx4 v11, s[12:15], s31 offen offset:1024 lds
    s_add_u32 s31, s31, s34
    v_mfma_f32_16x16x32_bf16 a[60:63], v[32:35], v[48:51], a[60:63]
    ds_read_b128 v[80:83], v12 offset:52224
    s_waitcnt lgkmcnt(0)
    v_mfma_f32_16x16x32_bf16 a[0:3], v[52:55], v[68:71], a[0:3]
    s_waitcnt vmcnt(24)
    s_barrier
    ds_read_b64_tr_b16 v[20:21], v16 offset:0
    v_mfma_f32_16x16x32_bf16 a[4:7], v[52:55], v[72:75], a[4:7]
    ds_read_b64_tr_b16 v[22:23], v16 offset:2048
    v_mfma_f32_16x16x32_bf16 a[8:11], v[52:55], v[76:79], a[8:11]
    s_add_u32 m0, s39, 49152
    s_nop 0
    buffer_load_dwordx4 v8, s[8:11], s30 offen offset:0 sc1 lds
    v_mfma_f32_16x16x32_bf16 a[12:15], v[52:55], v[80:83], a[12:15]
    ds_read_b128 v[36:39], v13 offset:0
    v_mfma_f32_16x16x32_bf16 a[16:19], v[56:59], v[68:71], a[16:19]
    ds_read_b64_tr_b16 v[24:25], v17 offset:0
    v_mfma_f32_16x16x32_bf16 a[20:23], v[56:59], v[72:75], a[20:23]
    ds_read_b64_tr_b16 v[26:27], v17 offset:2048
    v_mfma_f32_16x16x32_bf16 a[24:27], v[56:59], v[76:79], a[24:27]
    buffer_load_dwordx4 v9, s[8:11], s30 offen offset:1024 sc1 lds
    v_mfma_f32_16x16x32_bf16 a[28:31], v[56:59], v[80:83], a[28:31]
    ds_read_b128 v[40:43], v13 offset:1024
    v_mfma_f32_16x16x32_bf16 a[32:35], v[60:63], v[68:71], a[32:35]
    ds_read_b64_tr_b16 v[28:29], v16 offset:4096
    v_mfma_f32_16x16x32_bf16 a[36:39], v[60:63], v[72:75], a[36:39]
    ds_read_b64_tr_b16 v[30:31], v16 offset:6144
    v_mfma_f32_16x16x32_bf16 a[40:43], v[60:63], v[76:79], a[40:43]
    s_add_u32 m0, s40, 49152
    s_add_u32 s30, s30, 1024
    buffer_load_dwordx4 v10, s[12:15], s31 offen offset:0 lds
    v_mfma_f32_16x16x32_bf16 a[44:47], v[60:63], v[80:83], a[44:47]
    ds_read_b128 v[44:47], v13 offset:2048
    v_mfma_f32_16x16x32_bf16 a[48:51], v[64:67], v[68:71], a[48:51]
    ds_read_b64_tr_b16 v[32:33], v17 offset:4096
    v_mfma_f32_16x16x32_bf16 a[52:55], v[64:67], v[72:75], a[52:55]
    ds_read_b64_tr_b16 v[34:35], v17 offset:6144
    v_mfma_f32_16x16x32_bf16 a[56:59], v[64:67], v[76:79], a[56:59]
    buffer_load_dwordx4 v11, s[12:15], s31 offen offset:1024 lds
    s_add_u32 s31, s31, s34
    v_mfma_f32_16x16x32_bf16 a[60:63], v[64:67], v[80:83], a[60:63]
    ds_read_b128 v[48:51], v13 offset:3072
    s_waitcnt lgkmcnt(0)
    v_mfma_f32_16x16x32_bf16 a[0:3], v[20:23], v[36:39], a[0:3]
    s_waitcnt vmcnt(24)
    s_barrier
    ds_read_b64_tr_b16 v[52:53], v16 offset:16384
    v_mfma_f32_16x16x32_bf16 a[4:7], v[20:23], v[40:43], a[4:7]
    ds_read_b64_tr_b16 v[54:55], v16 offset:18432
    v_mfma_f32_16x16x32_bf16 a[8:11], v[20:23], v[44:47], a[8:11]
    s_add_u32 m0, s39, 65536
    s_nop 0
    buffer_load_dwordx4 v8, s[8:11], s30 offen offset:0 sc1 lds
    v_mfma_f32_16x16x32_bf16 a[12:15], v[20:23], v[48:51], a[12:15]
    ds_read_b128 v[68:71], v13 offset:16384
    v_mfma_f32_16x16x32_bf16 a[16:19], v[24:27], v[36:39], a[16:19]
    ds_read_b64_tr_b16 v[56:57], v17 offset:16384
    v_mfma_f32_16x16x32_bf16 a[20:23], v[24:27], v[40:43], a[20:23]
    ds_read_b64_tr_b16 v[58:59], v17 offset:18432
    v_mfma_f32_16x16x32_bf16 a[24:27], v[24:27], v[44:47], a[24:27]
    buffer_load_dwordx4 v9, s[8:11], s30 offen offset:1024 sc1 lds
    v_mfma_f32_16x16x32_bf16 a[28:31], v[24:27], v[48:51], a[28:31]
    ds_read_b128 v[72:75], v13 offset:17408
    v_mfma_f32_16x16x32_bf16 a[32:35], v[28:31], v[36:39], a[32:35]
    ds_read_b64_tr_b16 v[60:61], v16 offset:20480
    v_mfma_f32_16x16x32_bf16 a[36:39], v[28:31], v[40:43], a[36:39]
    ds_read_b64_tr_b16 v[62:63], v16 offset:22528
    v_mfma_f32_16x16x32_bf16 a[40:43], v[28:31], v[44:47], a[40:43]
    s_add_u32 m0, s40, 65536
    s_add_u32 s30, s30, 1024
    buffer_load_dwordx4 v10, s[12:15], s31 offen offset:0 lds
    v_mfma_f32_16x16x32_bf16 a[44:47], v[28:31], v[48:51], a[44:47]
    ds_read_b128 v[76:79], v13 offset:18432
    v_mfma_f32_16x16x32_bf16 a[48:51], v[32:35], v[36:39], a[48:51]
    ds_read_b64_tr_b16 v[64:65], v17 offset:20480
    v_mfma_f32_16x16x32_bf16 a[52:55], v[32:35], v[40:43], a[52:55]
    ds_read_b64_tr_b16 v[66:67], v17 offset:22528
    v_mfma_f32_16x16x32_bf16 a[56:59], v[32:35], v[44:47], a[56:59]
    buffer_load_dwordx4 v11, s[12:15], s31 offen offset:1024 lds
    s_add_u32 s31, s31, s34
    v_mfma_f32_16x16x32_bf16 a[60:63], v[32:35], v[48:51], a[60:63]
    ds_read_b128 v[80:83], v13 offset:19456
    s_waitcnt lgkmcnt(0)
    v_mfma_f32_16x16x32_bf16 a[0:3], v[52:55], v[68:71], a[0:3]
    s_waitcnt vmcnt(24)
    s_barrier
    ds_read_b64_tr_b16 v[20:21], v16 offset:32768
    v_mfma_f32_16x16x32_bf16 a[4:7], v[52:55], v[72:75], a[4:7]
    ds_read_b64_tr_b16 v[22:23], v16 offset:34816
    v_mfma_f32_16x16x32_bf16 a[8:11], v[52:55], v[76:79], a[8:11]
    s_add_u32 m0, s39, 81920
    s_nop 0
    buffer_load_dwordx4 v8, s[8:11], s30 offen offset:0 sc1 lds
    v_mfma_f32_16x16x32_bf16 a[12:15], v[52:55], v[80:83], a[12:15]
    ds_read_b128 v[36:39], v13 offset:32768
    v_mfma_f32_16x16x32_bf16 a[16:19], v[56:59], v[68:71], a[16:19]
    ds_read_b64_tr_b16 v[24:25], v17 offset:32768
    v_mfma_f32_16x16x32_bf16 a[20:23], v[56:59], v[72:75], a[20:23]
    ds_read_b64_tr_b16 v[26:27], v17 offset:34816
    v_mfma_f32_16x16x32_bf16 a[24:27], v[56:59], v[76:79], a[24:27]
    buffer_load_dwordx4 v9, s[8:11], s30 offen offset:1024 sc1 lds
    v_mfma_f32_16x16x32_bf16 a[28:31], v[56:59], v[80:83], a[28:31]
    ds_read_b128 v[40:43], v13 offset:33792
    v_mfma_f32_16x16x32_bf16 a[32:35], v[60:63], v[68:71], a[32:35]
    ds_read_b64_tr_b16 v[28:29], v16 offset:36864
    v_mfma_f32_16x16x32_bf16 a[36:39], v[60:63], v[72:75], a[36:39]
    ds_read_b64_tr_b16 v[30:31], v16 offset:38912
    v_mfma_f32_16x16x32_bf16 a[40:43], v[60:63], v[76:79], a[40:43]
    s_add_u32 m0, s40, 81920
    s_add_u32 s30, s30, 1024
    buffer_load_dwordx4 v10, s[12:15], s31 offen offset:0 lds
    v_mfma_f32_16x16x32_bf16 a[44:47], v[60:63], v[80:83], a[44:47]
    ds_read_b128 v[44:47], v13 offset:34816
    v_mfma_f32_16x16x32_bf16 a[48:51], v[64:67], v[68:71], a[48:51]
    ds_read_b64_tr_b16 v[32:33], v17 offset:36864
    v_mfma_f32_16x16x32_bf16 a[52:55], v[64:67], v[72:75], a[52:55]
    ds_read_b64_tr_b16 v[34:35], v17 offset:38912
    v_mfma_f32_16x16x32_bf16 a[56:59], v[64:67], v[76:79], a[56:59]
    buffer_load_dwordx4 v11, s[12:15], s31 offen offset:1024 lds
    s_add_u32 s31, s31, s34
    v_mfma_f32_16x16x32_bf16 a[60:63], v[64:67], v[80:83], a[60:63]
    ds_read_b128 v[48:51], v13 offset:35840
    s_waitcnt lgkmcnt(0)
    v_mfma_f32_16x16x32_bf16 a[0:3], v[20:23], v[36:39], a[0:3]
    s_waitcnt vmcnt(24)
    s_barrier
    ds_read_b64_tr_b16 v[52:53], v16 offset:49152
    v_mfma_f32_16x16x32_bf16 a[4:7], v[20:23], v[40:43], a[4:7]
    ds_read_b64_tr_b16 v[54:55], v16 offset:51200
    v_mfma_f32_16x16x32_bf16 a[8:11], v[20:23], v[44:47], a[8:11]
    s_add_u32 m0, s39, 98304
    s_nop 0
    buffer_load_dwordx4 v8, s[8:11], s30 offen offset:0 sc1 lds
    v_mfma_f32_16x16x32_bf16 a[12:15], v[20:23], v[48:51], a[12:15]
    ds_read_b128 v[68:71], v13 offset:49152
    v_mfma_f32_16x16x32_bf16 a[16:19], v[24:27], v[36:39], a[16:19]
    ds_read_b64_tr_b16 v[56:57], v17 offset:49152
    v_mfma_f32_16x16x32_bf16 a[20:23], v[24:27], v[40:43], a[20:23]
    ds_read_b64_tr_b16 v[58:59], v17 offset:51200
    v_mfma_f32_16x16x32_bf16 a[24:27], v[24:27], v[44:47], a[24:27]
    buffer_load_dwordx4 v9, s[8:11], s30 offen offset:1024 sc1 lds
    v_mfma_f32_16x16x32_bf16 a[28:31], v[24:27], v[48:51], a[28:31]
    ds_read_b128 v[72:75], v13 offset:50176
    v_mfma_f32_16x16x32_bf16 a[32:35], v[28:31], v[36:39], a[32:35]
    ds_read_b64_tr_b16 v[60:61], v16 offset:53248
    v_mfma_f32_16x16x32_bf16 a[36:39], v[28:31], v[40:43], a[36:39]
    ds_read_b64_tr_b16 v[62:63], v16 offset:55296
    v_mfma_f32_16x16x32_bf16 a[40:43], v[28:31], v[44:47], a[40:43]
    s_add_u32 m0, s40, 98304
    s_add_u32 s30, s30, 1024
    buffer_load_dwordx4 v10, s[12:15], s31 offen offset:0 lds
    v_mfma_f32_16x16x32_bf16 a[44:47], v[28:31], v[48:51], a[44:47]
    ds_read_b128 v[76:79], v13 offset:51200
    v_mfma_f32_16x16x32_bf16 a[48:51], v[32:35], v[36:39], a[48:51]
    ds_read_b64_tr_b16 v[64:65], v17 offset:53248
    v_mfma_f32_16x16x32_bf16 a[52:55], v[32:35], v[40:43], a[52:55]
    ds_read_b64_tr_b16 v[66:67], v17 offset:55296
    v_mfma_f32_16x16x32_bf16 a[56:59], v[32:35], v[44:47], a[56:59]
    buffer_load_dwordx4 v11, s[12:15], s31 offen offset:1024 lds
    s_add_u32 s31, s31, s34
    v_mfma_f32_16x16x32_bf16 a[60:63], v[32:35], v[48:51], a[60:63]
    ds_read_b128 v[80:83], v13 offset:52224
    s_waitcnt lgkmcnt(0)
    v_mfma_f32_16x16x32_bf16 a[0:3], v[52:55], v[68:71], a[0:3]
    s_waitcnt vmcnt(24)
    s_barrier
    ds_read_b64_tr_b16 v[20:21], v14 offset:0
    v_mfma_f32_16x16x32_bf16 a[4:7], v[52:55], v[72:75], a[4:7]
    ds_read_b64_tr_b16 v[22:23], v14 offset:2048
    v_mfma_f32_16x16x32_bf16 a[8:11], v[52:55], v[76:79], a[8:11]
    s_add_u32 m0, s39, 114688
    s_nop 0
    buffer_load_dwordx4 v8, s[8:11], s30 offen offset:0 sc1 lds
    v_mfma_f32_16x16x32_bf16 a[12:15], v[52:55], v[80:83], a[12:15]
    ds_read_b128 v[36:39], v12 offset:0
    v_mfma_f32_16x16x32_bf16 a[16:19], v[56:59], v[68:71], a[16:19]
    ds_read_b64_tr_b16 v[24:25], v15 offset:0
    v_mfma_f32_16x16x32_bf16 a[20:23], v[56:59], v[72:75], a[20:23]
    ds_read_b64_tr_b16 v[26:27], v15 offset:2048
    v_mfma_f32_16x16x32_bf16 a[24:27], v[56:59], v[76:79], a[24:27]
    buffer_load_dwordx4 v9, s[8:11], s30 offen offset:1024 sc1 lds
    v_mfma_f32_16x16x32_bf16 a[28:31], v[56:59], v[80:83], a[28:31]
    ds_read_b128 v[40:43], v12 offset:1024
    v_mfma_f32_16x16x32_bf16 a[32:35], v[60:63], v[68:71], a[32:35]
    ds_read_b64_tr_b16 v[28:29], v14 offset:4096
    v_mfma_f32_16x16x32_bf16 a[36:39], v[60:63], v[72:75], a[36:39]
    ds_read_b64_tr_b16 v[30:31], v14 offset:6144
    v_mfma_f32_16x16x32_bf16 a[40:43], v[60:63], v[76:79], a[40:43]
    s_add_u32 m0, s40, 114688
    s_add_u32 s30, s30, 1024
    buffer_load_dwordx4 v10, s[12:15], s31 offen offset:0 lds
    v_mfma_f32_16x16x32_bf16 a[44:47], v[60:63], v[80:83], a[44:47]
    ds_read_b128 v[44:47], v12 offset:2048
    v_mfma_f32_16x16x32_bf16 a[48:51], v[64:67], v[68:71], a[48:51]
    ds_read_b64_tr_b16 v[32:33], v15 offset:4096
    v_mfma_f32_16x16x32_bf16 a[52:55], v[64:67], v[72:75], a[52:55]
    ds_read_b64_tr_b16 v[34:35], v15 offset:6144
    v_mfma_f32_16x16x32_bf16 a[56:59], v[64:67], v[76:79], a[56:59]
    buffer_load_dwordx4 v11, s[12:15], s31 offen offset:1024 lds
    s_add_u32 s31, s31, s34
    v_mfma_f32_16x16x32_bf16 a[60:63], v[64:67], v[80:83], a[60:63]
    ds_read_b128 v[48:51], v12 offset:3072
    s_sub_u32 s35, s35, 1
    s_cmp_lg_u32 s35, 0
    s_cbranch_scc1 L_gb_loop
    s_waitcnt lgkmcnt(0)
    s_nop 7
    s_cmp_eq_u32 s36, 0
    s_cbranch_scc1 L_nb_n
    s_cmp_lg_u32 s63, -1
    s_cbranch_scc1 L_nb_c
    v_mov_b32 v4, 192
L_nb_p:
    buffer_load_dword v5, v4, s[16:19], 0 offen sc1
    s_sub_u32 s62, s62, 1
    s_cbranch_scc1 L_w_fail
    s_waitcnt vmcnt(0)
    v_readfirstlane_b32 s4, v5
    s_and_b32 s5, s4, 0xffff
    s_cmp_lt_u32 s5, 8
    s_cbranch_scc1 L_nb_p
    s_lshr_b32 s4, s4, 16
    s_cmp_ge_u32 s4, 4
    s_cselect_b32 s63, 8192, 0
L_nb_c:
    s_lshl_b32 s4, s55, 13
    s_xor_b32 s4, s4, s63
    s_and_b32 s4, s4, 8192
    s_add_u32 s37, s37, s4
L_nb_n:
    s_lshr_b32 s4, s21, 1
    s_mul_i32 s4, s4, 4
    s_mul_i32 s4, s4, s38
    s_add_u32 s4, s4, s37
    s_and_b32 s5, s21, 1
    s_mul_i32 s5, s5, 1024
    s_add_u32 s4, s4, s5
    s_add_u32 s5, s4, s41
    v_accvgpr_read_b32 v24, a0
    v_accvgpr_read_b32 v25, a1
    v_accvgpr_read_b32 v26, a2
    v_accvgpr_read_b32 v27, a3
    v_accvgpr_read_b32 v28, a16
    v_accvgpr_read_b32 v29, a17
    v_accvgpr_read_b32 v30, a18
    v_accvgpr_read_b32 v31, a19
    v_cvt_pk_bf16_f32 v20, v24, v25
    v_cvt_pk_bf16_f32 v21, v26, v27
    v_cvt_pk_bf16_f32 v22, v28, v29
    v_cvt_pk_bf16_f32 v23, v30, v31
    buffer_store_dwordx4 v[20:23], v2, s[8:11], s4 offen offset:0 sc1
    v_accvgpr_read_b32 v36, a32
    v_accvgpr_read_b32 v37, a33
    v_accvgpr_read_b32 v38, a34
    v_accvgpr_read_b32 v39, a35
    v_accvgpr_read_b32 v40, a48
    v_accvgpr_read_b32 v41, a49
    v_accvgpr_read_b32 v42, a50
    v_accvgpr_read_b32 v43, a51
    v_cvt_pk_bf16_f32 v32, v36, v37
    v_cvt_pk_bf16_f32 v33, v38, v39
    v_cvt_pk_bf16_f32 v34, v40, v41
    v_cvt_pk_bf16_f32 v35, v42, v43
    buffer_store_dwordx4 v[32:35], v2, s[8:11], s5 offen offset:0 sc1
    s_add_u32 s4, s4, s38
    s_add_u32 s5, s4, s41
    v_accvgpr_read_b32 v48, a4
    v_accvgpr_read_b32 v49, a5
    v_accvgpr_read_b32 v50, a6
    v_accvgpr_read_b32 v51, a7
    v_accvgpr_read_b32 v52, a20
    v_accvgpr_read_b32 v53, a21
    v_accvgpr_read_b32 v54, a22
    v_accvgpr_read_b32 v55, a23
    v_cvt_pk_bf16_f32 v44, v48, v49
    v_cvt_pk_bf16_f32 v45, v50, v51
    v_cvt_pk_bf16_f32 v46, v52, v53
    v_cvt_pk_bf16_f32 v47, v54, v55
    buffer_store_dwordx4 v[44:47], v2, s[8:11], s4 offen offset:0 sc1
    v_accvgpr_read_b32 v60, a36
    v_accvgpr_read_b32 v61, a37
    v_accvgpr_read_b32 v62, a38
    v_accvgpr_read_b32 v63, a39
    v_accvgpr_read_b32 v64, a52
    v_accvgpr_read_b32 v65, a53
    v_accvgpr_read_b32 v66, a54
    v_accvgpr_read_b32 v67, a55
    v_cvt_pk_bf16_f32 v56, v60, v61
    v_cvt_pk_bf16_f32 v57, v62, v63
    v_cvt_pk_bf16_f32 v58, v64, v65
    v_cvt_pk_bf16_f32 v59, v66, v67
    buffer_store_dwordx4 v[56:59], v2, s[8:11], s5 offen offset:0 sc1
    s_add_u32 s4, s4, s38
    s_add_u32 s5, s4, s41
    v_accvgpr_read_b32 v24, a8
    v_accvgpr_read_b32 v25, a9
    v_accvgpr_read_b32 v26, a10
    v_accvgpr_read_b32 v27, a11
    v_accvgpr_read_b32 v28, a24
    v_accvgpr_read_b32 v29, a25
    v_accvgpr_read_b32 v30, a26
    v_accvgpr_read_b32 v31, a27
    v_cvt_pk_bf16_f32 v20, v24, v25
    v_cvt_pk_bf16_f32 v21, v26, v27
    v_cvt_pk_bf16_f32 v22, v28, v29
    v_cvt_pk_bf16_f32 v23, v30, v31
    buffer_store_dwordx4 v[20:23], v2, s[8:11], s4 offen offset:0 sc1
    v_accvgpr_read_b32 v36, a40
    v_accvgpr_read_b32 v37, a41
    v_accvgpr_read_b32 v38, a42
    v_accvgpr_read_b32 v39, a43
    v_accvgpr_read_b32 v40, a56
    v_accvgpr_read_b32 v41, a57
    v_accvgpr_read_b32 v42, a58
    v_accvgpr_read_b32 v43, a59
    v_cvt_pk_bf16_f32 v32, v36, v37
    v_cvt_pk_bf16_f32 v33, v38, v39
    v_cvt_pk_bf16_f32 v34, v40, v41
    v_cvt_pk_bf16_f32 v35, v42, v43
    buffer_store_dwordx4 v[32:35], v2, s[8:11], s5 offen offset:0 sc1
    s_add_u32 s4, s4, s38
    s_add_u32 s5, s4, s41
    v_accvgpr_read_b32 v48, a12
    v_accvgpr_read_b32 v49, a13
    v_accvgpr_read_b32 v50, a14
    v_accvgpr_read_b32 v51, a15
    v_accvgpr_read_b32 v52, a28
    v_accvgpr_read_b32 v53, a29
    v_accvgpr_read_b32 v54, a30
    v_accvgpr_read_b32 v55, a31
    v_cvt_pk_bf16_f32 v44, v48, v49
    v_cvt_pk_bf16_f32 v45, v50, v51
    v_cvt_pk_bf16_f32 v46, v52, v53
    v_cvt_pk_bf16_f32 v47, v54, v55
    buffer_store_dwordx4 v[44:47], v2, s[8:11], s4 offen offset:0 sc1
    v_accvgpr_read_b32 v60, a44
    v_accvgpr_read_b32 v61, a45
    v_accvgpr_read_b32 v62, a46
    v_accvgpr_read_b32 v63, a47
    v_accvgpr_read_b32 v64, a60
    v_accvgpr_read_b32 v65, a61
    v_accvgpr_read_b32 v66, a62
    v_accvgpr_read_b32 v67, a63
    v_cvt_pk_bf16_f32 v56, v60, v61
    v_cvt_pk_bf16_f32 v57, v62, v63
    v_cvt_pk_bf16_f32 v58, v64, v65
    v_cvt_pk_bf16_f32 v59, v66, v67
    buffer_store_dwordx4 v[56:59], v2, s[8:11], s5 offen offset:0 sc1
    s_add_u32 s4, s4, s38
    s_branch L_w_done
L_t12:
    s_cmp_eq_u32 s52, 0
    s_cselect_b32 s12, s74, s68
    s_cselect_b32 s13, s75, s69
    s_mov_b32 s14, 0x800000
    s_mov_b32 s15, 0x00020000
    s_lshl_b32 s4, s21, 14
    s_add_u32 s53, s53, s4
L_pf:
    s_mov_b32 s4, s53
    buffer_load_dwordx4 v[8:11], v2, s[12:15], s4 offen offset:0
    buffer_load_dwordx4 v[8:11], v2, s[12:15], s4 offen offset:1024
    buffer_load_dwordx4 v[8:11], v2, s[12:15], s4 offen offset:2048
    buffer_load_dwordx4 v[8:11], v2, s[12:15], s4 offen offset:3072
    s_add_u32 s4, s4, 4096
    buffer_load_dwordx4 v[8:11], v2, s[12:15], s4 offen offset:0
    buffer_load_dwordx4 v[8:11], v2, s[12:15], s4 offen offset:1024
    buffer_load_dwordx4 v[8:11], v2, s[12:15], s4 offen offset:2048
    buffer_load_dwordx4 v[8:11], v2, s[12:15], s4 offen offset:3072
    s_add_u32 s4, s4, 4096
    buffer_load_dwordx4 v[8:11], v2, s[12:15], s4 offen offset:0
    buffer_load_dwordx4 v[8:11], v2, s[12:15], s4 offen offset:1024
    buffer_load_dwordx4 v[8:11], v2, s[12:15], s4 offen offset:2048
    buffer_load_dwordx4 v[8:11], v2, s[12:15], s4 offen offset:3072
    s_add_u32 s4, s4, 4096
    buffer_load_dwordx4 v[8:11], v2, s[12:15], s4 offen offset:0
    buffer_load_dwordx4 v[8:11], v2, s[12:15], s4 offen offset:1024
    buffer_load_dwordx4 v[8:11], v2, s[12:15], s4 offen offset:2048
    buffer_load_dwordx4 v[8:11], v2, s[12:15], s4 offen offset:3072
    s_add_u32 s4, s4, 4096
    s_waitcnt vmcnt(32)
    s_add_u32 s53, s53, 65536
    s_sub_u32 s54, s54, 1
    s_cmp_lg_u32 s54, 0
    s_cbranch_scc1 L_pf
    s_branch L_w_done
L_t0:
    s_branch L_w_done
L_so:
    s_and_b32 s41, s55, 2047
    s_add_u32 s41, s41, 243318784
    s_bfe_u32 s35, s55, 0xb000b
    s_add_u32 s35, s35, 243318784
    s_lshr_b32 s36, s55, 22
    v_lshrrev_b32 v4, 3, v1
    v_mul_lo_u32 v4, v4, s33
    v_and_b32 v5, 7, v1
    v_lshl_add_u32 v8, v5, 4, v4
    s_and_b32 s6, s21, 1
    s_lshl_b32 s4, s6, 6
    s_mul_i32 s4, s4, s33
    s_add_u32 s31, s31, s4
    v_lshrrev_b32 v4, 2, v1
    v_lshlrev_b32 v4, 7, v4
    v_and_b32 v5, 3, v1
    v_lshl_add_u32 v4, v5, 3, v4
    s_lshr_b32 s4, s21, 1
    s_lshl_b32 s4, s4, 14
    s_lshl_b32 s5, s6, 6
    s_add_u32 s4, s4, s5
    s_add_u32 s5, s4, 32
    v_add_u32 v9, s4, v4
    v_add_u32 v10, s5, v4
    s_lshl_b32 s40, s21, 13
    s_lshl_b32 s34, s33, 3
    s_mul_i32 s7, s33, 72
    s_add_u32 m0, s40, 0
    s_nop 0
    buffer_load_dwordx4 v8, s[12:15], s31 offen nt lds
    s_add_u32 s31, s31, s34
    s_add_u32 m0, s40, 1024
    s_nop 0
    buffer_load_dwordx4 v8, s[12:15], s31 offen nt lds
    s_add_u32 s31, s31, s34
    s_add_u32 m0, s40, 2048
    s_nop 0
    buffer_load_dwordx4 v8, s[12:15], s31 offen nt lds
    s_add_u32 s31, s31, s34
    s_add_u32 m0, s40, 3072
    s_nop 0
    buffer_load_dwordx4 v8, s[12:15], s31 offen nt lds
    s_add_u32 s31, s31, s34
    s_add_u32 m0, s40, 4096
    s_nop 0
    buffer_load_dwordx4 v8, s[12:15], s31 offen nt lds
    s_add_u32 s31, s31, s34
    s_add_u32 m0, s40, 5120
    s_nop 0
    buffer_load_dwordx4 v8, s[12:15], s31 offen nt lds
    s_add_u32 s31, s31, s34
    s_add_u32 m0, s40, 6144
    s_nop 0
    buffer_load_dwordx4 v8, s[12:15], s31 offen nt lds
    s_add_u32 s31, s31, s34
    s_add_u32 m0, s40, 7168
    s_nop 0
    buffer_load_dwordx4 v8, s[12:15], s31 offen nt lds
    s_add_u32 s31, s31, s7
    s_add_u32 m0, s40, 32768
    s_nop 0
    buffer_load_dwordx4 v8, s[12:15], s31 offen nt lds
    s_add_u32 s31, s31, s34
    s_add_u32 m0, s40, 33792
    s_nop 0
    buffer_load_dwordx4 v8, s[12:15], s31 offen nt lds
    s_add_u32 s31, s31, s34
    s_add_u32 m0, s40, 34816
    s_nop 0
    buffer_load_dwordx4 v8, s[12:15], s31 offen nt lds
    s_add_u32 s31, s31, s34
    s_add_u32 m0, s40, 35840
    s_nop 0
    buffer_load_dwordx4 v8, s[12:15], s31 offen nt lds
    s_add_u32 s31, s31, s34
    s_add_u32 m0, s40, 36864
    s_nop 0
    buffer_load_dwordx4 v8, s[12:15], s31 offen nt lds
    s_add_u32 s31, s31, s34
    s_add_u32 m0, s40, 37888
    s_nop 0
    buffer_load_dwordx4 v8, s[12:15], s31 offen nt lds
    s_add_u32 s31, s31, s34
    s_add_u32 m0, s40, 38912
    s_nop 0
    buffer_load_dwordx4 v8, s[12:15], s31 offen nt lds
    s_add_u32 s31, s31, s34
    s_add_u32 m0, s40, 39936
    s_nop 0
    buffer_load_dwordx4 v8, s[12:15], s31 offen nt lds
    s_add_u32 s31, s31, s7
    s_add_u32 m0, s40, 65536
    s_nop 0
    buffer_load_dwordx4 v8, s[12:15], s31 offen nt lds
    s_add_u32 s31, s31, s34
    s_add_u32 m0, s40, 66560
    s_nop 0
    buffer_load_dwordx4 v8, s[12:15], s31 offen nt lds
    s_add_u32 s31, s31, s34
    s_add_u32 m0, s40, 67584
    s_nop 0
    buffer_load_dwordx4 v8, s[12:15], s31 offen nt lds
    s_add_u32 s31, s31, s34
    s_add_u32 m0, s40, 68608
    s_nop 0
    buffer_load_dwordx4 v8, s[12:15], s31 offen nt lds
    s_add_u32 s31, s31, s34
    s_add_u32 m0, s40, 69632
    s_nop 0
    buffer_load_dwordx4 v8, s[12:15], s31 offen nt lds
    s_add_u32 s31, s31, s34
    s_add_u32 m0, s40, 70656
    s_nop 0
    buffer_load_dwordx4 v8, s[12:15], s31 offen nt lds
    s_add_u32 s31, s31, s34
    s_add_u32 m0, s40, 71680
    s_nop 0
    buffer_load_dwordx4 v8, s[12:15], s31 offen nt lds
    s_add_u32 s31, s31, s34
    s_add_u32 m0, s40, 72704
    s_nop 0
    buffer_load_dwordx4 v8, s[12:15], s31 offen nt lds
    s_add_u32 s31, s31, s7
    s_add_u32 m0, s40, 98304
    s_nop 0
    buffer_load_dwordx4 v8, s[12:15], s31 offen nt lds
    s_add_u32 s31, s31, s34
    s_add_u32 m0, s40, 99328
    s_nop 0
    buffer_load_dwordx4 v8, s[12:15], s31 offen nt lds
    s_add_u32 s31, s31, s34
    s_add_u32 m0, s40, 100352
    s_nop 0
    buffer_load_dwordx4 v8, s[12:15], s31 offen nt lds
    s_add_u32 s31, s31, s34
    s_add_u32 m0, s40, 101376
    s_nop 0
    buffer_load_dwordx4 v8, s[12:15], s31 offen nt lds
    s_add_u32 s31, s31, s34
    s_add_u32 m0, s40, 102400
    s_nop 0
    buffer_load_dwordx4 v8, s[12:15], s31 offen nt lds
    s_add_u32 s31, s31, s34
    s_add_u32 m0, s40, 103424
    s_nop 0
    buffer_load_dwordx4 v8, s[12:15], s31 offen nt lds
    s_add_u32 s31, s31, s34
    s_add_u32 m0, s40, 104448
    s_nop 0
    buffer_load_dwordx4 v8, s[12:15], s31 offen nt lds
    s_add_u32 s31, s31, s34
    s_add_u32 m0, s40, 105472
    s_nop 0
    buffer_load_dwordx4 v8, s[12:15], s31 offen nt lds
    s_add_u32 s31, s31, s7
    s_waitcnt vmcnt(24)
    s_barrier
    v_add_u32 v4, 0, v9
    v_add_u32 v5, 0, v10
    ds_read_b64_tr_b16 a[0:1], v4 offset:0
    ds_read_b64_tr_b16 a[2:3], v4 offset:2048
    ds_read_b64_tr_b16 a[4:5], v5 offset:0
    ds_read_b64_tr_b16 a[6:7], v5 offset:2048
    ds_read_b64_tr_b16 a[8:9], v4 offset:4096
    ds_read_b64_tr_b16 a[10:11], v4 offset:6144
    ds_read_b64_tr_b16 a[12:13], v5 offset:4096
    ds_read_b64_tr_b16 a[14:15], v5 offset:6144
    ds_read_b64_tr_b16 a[16:17], v4 offset:8192
    ds_read_b64_tr_b16 a[18:19], v4 offset:10240
    ds_read_b64_tr_b16 a[20:21], v5 offset:8192
    ds_read_b64_tr_b16 a[22:23], v5 offset:10240
    ds_read_b64_tr_b16 a[24:25], v4 offset:12288
    ds_read_b64_tr_b16 a[26:27], v4 offset:14336
    ds_read_b64_tr_b16 a[28:29], v5 offset:12288
    ds_read_b64_tr_b16 a[30:31], v5 offset:14336
    s_waitcnt lgkmcnt(0)
    s_barrier
    s_add_u32 m0, s40, 0
    s_nop 0
    buffer_load_dwordx4 v8, s[12:15], s31 offen nt lds
    s_add_u32 s31, s31, s34
    s_add_u32 m0, s40, 1024
    s_nop 0
    buffer_load_dwordx4 v8, s[12:15], s31 offen nt lds
    s_add_u32 s31, s31, s34
    s_add_u32 m0, s40, 2048
    s_nop 0
    buffer_load_dwordx4 v8, s[12:15], s31 offen nt lds
    s_add_u32 s31, s31, s34
    s_add_u32 m0, s40, 3072
    s_nop 0
    buffer_load_dwordx4 v8, s[12:15], s31 offen nt lds
    s_add_u32 s31, s31, s34
    s_add_u32 m0, s40, 4096
    s_nop 0
    buffer_load_dwordx4 v8, s[12:15], s31 offen nt lds
    s_add_u32 s31, s31, s34
    s_add_u32 m0, s40, 5120
    s_nop 0
    buffer_load_dwordx4 v8, s[12:15], s31 offen nt lds
    s_add_u32 s31, s31, s34
    s_add_u32 m0, s40, 6144
    s_nop 0
    buffer_load_dwordx4 v8, s[12:15], s31 offen nt lds
    s_add_u32 s31, s31, s34
    s_add_u32 m0, s40, 7168
    s_nop 0
    buffer_load_dwordx4 v8, s[12:15], s31 offen nt lds
    s_add_u32 s31, s31, s7
    s_waitcnt vmcnt(24)
    s_barrier
    v_add_u32 v4, 32768, v9
    v_add_u32 v5, 32768, v10
    ds_read_b64_tr_b16 a[32:33], v4 offset:0
    ds_read_b64_tr_b16 a[34:35], v4 offset:2048
    ds_read_b64_tr_b16 a[36:37], v5 offset:0
    ds_read_b64_tr_b16 a[38:39], v5 offset:2048
    ds_read_b64_tr_b16 a[40:41], v4 offset:4096
    ds_read_b64_tr_b16 a[42:43], v4 offset:6144
    ds_read_b64_tr_b16 a[44:45], v5 offset:4096
    ds_read_b64_tr_b16 a[46:47], v5 offset:6144
    ds_read_b64_tr_b16 a[48:49], v4 offset:8192
    ds_read_b64_tr_b16 a[50:51], v4 offset:10240
    ds_read_b64_tr_b16 a[52:53], v5 offset:8192
    ds_read_b64_tr_b16 a[54:55], v5 offset:10240
    ds_read_b64_tr_b16 a[56:57], v4 offset:12288
    ds_read_b64_tr_b16 a[58:59], v4 offset:14336
    ds_read_b64_tr_b16 a[60:61], v5 offset:12288
    ds_read_b64_tr_b16 a[62:63], v5 offset:14336
    s_waitcnt lgkmcnt(0)
    s_barrier
    s_add_u32 m0, s40, 32768
    s_nop 0
    buffer_load_dwordx4 v8, s[12:15], s31 offen nt lds
    s_add_u32 s31, s31, s34
    s_add_u32 m0, s40, 33792
    s_nop 0
    buffer_load_dwordx4 v8, s[12:15], s31 offen nt lds
    s_add_u32 s31, s31, s34
    s_add_u32 m0, s40, 34816
    s_nop 0
    buffer_load_dwordx4 v8, s[12:15], s31 offen nt lds
    s_add_u32 s31, s31, s34
    s_add_u32 m0, s40, 35840
    s_nop 0
    buffer_load_dwordx4 v8, s[12:15], s31 offen nt lds
    s_add_u32 s31, s31, s34
    s_add_u32 m0, s40, 36864
    s_nop 0
    buffer_load_dwordx4 v8, s[12:15], s31 offen nt lds
    s_add_u32 s31, s31, s34
    s_add_u32 m0, s40, 37888
    s_nop 0
    buffer_load_dwordx4 v8, s[12:15], s31 offen nt lds
    s_add_u32 s31, s31, s34
    s_add_u32 m0, s40, 38912
    s_nop 0
    buffer_load_dwordx4 v8, s[12:15], s31 offen nt lds
    s_add_u32 s31, s31, s34
    s_add_u32 m0, s40, 39936
    s_nop 0
    buffer_load_dwordx4 v8, s[12:15], s31 offen nt lds
    s_add_u32 s31, s31, s7
    s_waitcnt vmcnt(24)
    s_barrier
    v_add_u32 v4, 65536, v9
    v_add_u32 v5, 65536, v10
    ds_read_b64_tr_b16 a[64:65], v4 offset:0
    ds_read_b64_tr_b16 a[66:67], v4 offset:2048
    ds_read_b64_tr_b16 a[68:69], v5 offset:0
    ds_read_b64_tr_b16 a[70:71], v5 offset:2048
    ds_read_b64_tr_b16 a[72:73], v4 offset:4096
    ds_read_b64_tr_b16 a[74:75], v4 offset:6144
    ds_read_b64_tr_b16 a[76:77], v5 offset:4096
    ds_read_b64_tr_b16 a[78:79], v5 offset:6144
    ds_read_b64_tr_b16 a[80:81], v4 offset:8192
    ds_read_b64_tr_b16 a[82:83], v4 offset:10240
    ds_read_b64_tr_b16 a[84:85], v5 offset:8192
    ds_read_b64_tr_b16 a[86:87], v5 offset:10240
    ds_read_b64_tr_b16 a[88:89], v4 offset:12288
    ds_read_b64_tr_b16 a[90:91], v4 offset:14336
    ds_read_b64_tr_b16 a[92:93], v5 offset:12288
    ds_read_b64_tr_b16 a[94:95], v5 offset:14336
    s_waitcnt lgkmcnt(0)
    s_barrier
    s_add_u32 m0, s40, 65536
    s_nop 0
    buffer_load_dwordx4 v8, s[12:15], s31 offen nt lds
    s_add_u32 s31, s31, s34
    s_add_u32 m0, s40, 66560
    s_nop 0
    buffer_load_dwordx4 v8, s[12:15], s31 offen nt lds
    s_add_u32 s31, s31, s34
    s_add_u32 m0, s40, 67584
    s_nop 0
    buffer_load_dwordx4 v8, s[12:15], s31 offen nt lds
    s_add_u32 s31, s31, s34
    s_add_u32 m0, s40, 68608
    s_nop 0
    buffer_load_dwordx4 v8, s[12:15], s31 offen nt lds
    s_add_u32 s31, s31, s34
    s_add_u32 m0, s40, 69632
    s_nop 0
    buffer_load_dwordx4 v8, s[12:15], s31 offen nt lds
    s_add_u32 s31, s31, s34
    s_add_u32 m0, s40, 70656
    s_nop 0
    buffer_load_dwordx4 v8, s[12:15], s31 offen nt lds
    s_add_u32 s31, s31, s34
    s_add_u32 m0, s40, 71680
    s_nop 0
    buffer_load_dwordx4 v8, s[12:15], s31 offen nt lds
    s_add_u32 s31, s31, s34
    s_add_u32 m0, s40, 72704
    s_nop 0
    buffer_load_dwordx4 v8, s[12:15], s31 offen nt lds
    s_add_u32 s31, s31, s7
    s_waitcnt vmcnt(24)
    s_barrier
    v_add_u32 v4, 98304, v9
    v_add_u32 v5, 98304, v10
    ds_read_b64_tr_b16 a[96:97], v4 offset:0
    ds_read_b64_tr_b16 a[98:99], v4 offset:2048
    ds_read_b64_tr_b16 a[100:101], v5 offset:0
    ds_read_b64_tr_b16 a[102:103], v5 offset:2048
    ds_read_b64_tr_b16 a[104:105], v4 offset:4096
    ds_read_b64_tr_b16 a[106:107], v4 offset:6144
    ds_read_b64_tr_b16 a[108:109], v5 offset:4096
    ds_read_b64_tr_b16 a[110:111], v5 offset:6144
    ds_read_b64_tr_b16 a[112:113], v4 offset:8192
    ds_read_b64_tr_b16 a[114:115], v4 offset:10240
    ds_read_b64_tr_b16 a[116:117], v5 offset:8192
    ds_read_b64_tr_b16 a[118:119], v5 offset:10240
    ds_read_b64_tr_b16 a[120:121], v4 offset:12288
    ds_read_b64_tr_b16 a[122:123], v4 offset:14336
    ds_read_b64_tr_b16 a[124:125], v5 offset:12288
    ds_read_b64_tr_b16 a[126:127], v5 offset:14336
    s_waitcnt lgkmcnt(0)
    s_barrier
    s_add_u32 m0, s40, 98304
    s_nop 0
    buffer_load_dwordx4 v8, s[12:15], s31 offen nt lds
    s_add_u32 s31, s31, s34
    s_add_u32 m0, s40, 99328
    s_nop 0
    buffer_load_dwordx4 v8, s[12:15], s31 offen nt lds
    s_add_u32 s31, s31, s34
    s_add_u32 m0, s40, 100352
    s_nop 0
    buffer_load_dwordx4 v8, s[12:15], s31 offen nt lds
    s_add_u32 s31, s31, s34
    s_add_u32 m0, s40, 101376
    s_nop 0
    buffer_load_dwordx4 v8, s[12:15], s31 offen nt lds
    s_add_u32 s31, s31, s34
    s_add_u32 m0, s40, 102400
    s_nop 0
    buffer_load_dwordx4 v8, s[12:15], s31 offen nt lds
    s_add_u32 s31, s31, s34
    s_add_u32 m0, s40, 103424
    s_nop 0
    buffer_load_dwordx4 v8, s[12:15], s31 offen nt lds
    s_add_u32 s31, s31, s34
    s_add_u32 m0, s40, 104448
    s_nop 0
    buffer_load_dwordx4 v8, s[12:15], s31 offen nt lds
    s_add_u32 s31, s31, s34
    s_add_u32 m0, s40, 105472
    s_nop 0
    buffer_load_dwordx4 v8, s[12:15], s31 offen nt lds
    s_add_u32 s31, s31, s7
    s_waitcnt vmcnt(24)
    s_barrier
    v_add_u32 v4, 0, v9
    v_add_u32 v5, 0, v10
    ds_read_b64_tr_b16 a[128:129], v4 offset:0
    ds_read_b64_tr_b16 a[130:131], v4 offset:2048
    ds_read_b64_tr_b16 a[132:133], v5 offset:0
    ds_read_b64_tr_b16 a[134:135], v5 offset:2048
    ds_read_b64_tr_b16 a[136:137], v4 offset:4096
    ds_read_b64_tr_b16 a[138:139], v4 offset:6144
    ds_read_b64_tr_b16 a[140:141], v5 offset:4096
    ds_read_b64_tr_b16 a[142:143], v5 offset:6144
    ds_read_b64_tr_b16 a[144:145], v4 offset:8192
    ds_read_b64_tr_b16 a[146:147], v4 offset:10240
    ds_read_b64_tr_b16 a[148:149], v5 offset:8192
    ds_read_b64_tr_b16 a[150:151], v5 offset:10240
    ds_read_b64_tr_b16 a[152:153], v4 offset:12288
    ds_read_b64_tr_b16 a[154:155], v4 offset:14336
    ds_read_b64_tr_b16 a[156:157], v5 offset:12288
    ds_read_b64_tr_b16 a[158:159], v5 offset:14336
    s_waitcnt lgkmcnt(0)
    s_barrier
    s_waitcnt vmcnt(16)
    s_barrier
    v_add_u32 v4, 32768, v9
    v_add_u32 v5, 32768, v10
    ds_read_b64_tr_b16 a[160:161], v4 offset:0
    ds_read_b64_tr_b16 a[162:163], v4 offset:2048
    ds_read_b64_tr_b16 a[164:165], v5 offset:0
    ds_read_b64_tr_b16 a[166:167], v5 offset:2048
    ds_read_b64_tr_b16 a[168:169], v4 offset:4096
    ds_read_b64_tr_b16 a[170:171], v4 offset:6144
    ds_read_b64_tr_b16 a[172:173], v5 offset:4096
    ds_read_b64_tr_b16 a[174:175], v5 offset:6144
    ds_read_b64_tr_b16 a[176:177], v4 offset:8192
    ds_read_b64_tr_b16 a[178:179], v4 offset:10240
    ds_read_b64_tr_b16 a[180:181], v5 offset:8192
    ds_read_b64_tr_b16 a[182:183], v5 offset:10240
    ds_read_b64_tr_b16 a[184:185], v4 offset:12288
    ds_read_b64_tr_b16 a[186:187], v4 offset:14336
    ds_read_b64_tr_b16 a[188:189], v5 offset:12288
    ds_read_b64_tr_b16 a[190:191], v5 offset:14336
    s_waitcnt lgkmcnt(0)
    s_barrier
    s_waitcnt vmcnt(8)
    s_barrier
    v_add_u32 v4, 65536, v9
    v_add_u32 v5, 65536, v10
    ds_read_b64_tr_b16 a[192:193], v4 offset:0
    ds_read_b64_tr_b16 a[194:195], v4 offset:2048
    ds_read_b64_tr_b16 a[196:197], v5 offset:0
    ds_read_b64_tr_b16 a[198:199], v5 offset:2048
    ds_read_b64_tr_b16 a[200:201], v4 offset:4096
    ds_read_b64_tr_b16 a[202:203], v4 offset:6144
    ds_read_b64_tr_b16 a[204:205], v5 offset:4096
    ds_read_b64_tr_b16 a[206:207], v5 offset:6144
    ds_read_b64_tr_b16 a[208:209], v4 offset:8192
    ds_read_b64_tr_b16 a[210:211], v4 offset:10240
    ds_read_b64_tr_b16 a[212:213], v5 offset:8192
    ds_read_b64_tr_b16 a[214:215], v5 offset:10240
    ds_read_b64_tr_b16 a[216:217], v4 offset:12288
    ds_read_b64_tr_b16 a[218:219], v4 offset:14336
    ds_read_b64_tr_b16 a[220:221], v5 offset:12288
    ds_read_b64_tr_b16 a[222:223], v5 offset:14336
    s_waitcnt lgkmcnt(0)
    s_barrier
    s_waitcnt vmcnt(0)
    s_barrier
    v_add_u32 v4, 98304, v9
    v_add_u32 v5, 98304, v10
    ds_read_b64_tr_b16 a[224:225], v4 offset:0
    ds_read_b64_tr_b16 a[226:227], v4 offset:2048
    ds_read_b64_tr_b16 a[228:229], v5 offset:0
    ds_read_b64_tr_b16 a[230:231], v5 offset:2048
    ds_read_b64_tr_b16 a[232:233], v4 offset:4096
    ds_read_b64_tr_b16 a[234:235], v4 offset:6144
    ds_read_b64_tr_b16 a[236:237], v5 offset:4096
    ds_read_b64_tr_b16 a[238:239], v5 offset:6144
    ds_read_b64_tr_b16 a[240:241], v4 offset:8192
    ds_read_b64_tr_b16 a[242:243], v4 offset:10240
    ds_read_b64_tr_b16 a[244:245], v5 offset:8192
    ds_read_b64_tr_b16 a[246:247], v5 offset:10240
    ds_read_b64_tr_b16 a[248:249], v4 offset:12288
    ds_read_b64_tr_b16 a[250:251], v4 offset:14336
    ds_read_b64_tr_b16 a[252:253], v5 offset:12288
    ds_read_b64_tr_b16 a[254:255], v5 offset:14336
    s_waitcnt lgkmcnt(0)
    s_barrier
    s_mul_i32 s4, s6, s32
    s_lshr_b32 s5, s21, 1
    s_lshl_b32 s5, s5, 10
    s_add_u32 s4, s4, s5
    v_add_u32 v11, s4, v2
    s_lshl_b32 s40, s21, 10
    v_lshlrev_b32 v14, 3, v1
    v_mov_b32 v12, v2
    v_mov_b32 v13, 159232
    s_lshl_b32 s45, s32, 1
    s_lshl_b32 s46, s38, 1
    s_lshl_b32 s4, s21, 10
    s_add_u32 s37, s37, s4
    s_mov_b32 s43, 0
    s_cmp_eq_u32 s21, 0
    s_cselect_b32 s4, 0, 0x80000000
    v_mov_b32 v15, 0x80000000
    v_writelane_b32 v15, s4, 0
    s_add_u32 s4, s4, 2048
    v_writelane_b32 v15, s4, 1
    v_lshl_add_u32 v13, v1, 2, v13
    s_and_b32 s4, s49, 15
    s_lshr_b32 s5, s49, 4
    s_mul_i32 s5, s5, s21
    s_add_u32 s4, s4, s5
    s_sub_u32 s4, 15, s4
    s_cselect_b32 s5, 0x80000000, 0
    s_lshl_b32 s4, s4, 11
    s_and_b32 s4, s4, 0xffff
    s_or_b32 s4, s4, s5
    v_and_b32 v4, 15, v1
    v_lshlrev_b32 v4, 6, v4
    v_lshrrev_b32 v5, 5, v1
    v_lshl_add_u32 v4, v5, 10, v4
    v_bfe_u32 v5, v1, 4, 1
    v_mul_lo_u32 v5, v5, s32
    v_add3_u32 v3, v4, v5, s4
L_so_L:
    s_cmp_lg_u32 s21, 0
    s_cbranch_scc1 L_so_Lw
    v_mov_b32 v4, 0
    s_mov_b64 exec, 1
L_so_p:
    v_mov_b32 v5, 0
    buffer_atomic_add v5, v4, s[8:11], s41 offen sc0
    s_sub_u32 s62, s62, 1
    s_cbranch_scc1 L_w_fail
    s_waitcnt vmcnt(0)
    v_cmp_gt_u32 vcc, s36, v5
    s_cbranch_vccz L_so_p_ok
    s_sleep 1
    s_branch L_so_p
L_so_p_ok:
    s_mov_b64 exec, -1
L_so_Lw:
    s_barrier
    s_add_u32 m0, s40, 0
    s_add_u32 s47, s30, 0
    buffer_load_dwordx4 v11, s[8:11], s47 offen sc1 lds
    s_add_u32 m0, s40, 4096
    s_add_u32 s47, s30, 2048
    buffer_load_dwordx4 v11, s[8:11], s47 offen sc1 lds
    s_add_u32 m0, s40, 8192
    s_add_u32 s47, s30, 4096
    buffer_load_dwordx4 v11, s[8:11], s47 offen sc1 lds
    s_add_u32 m0, s40, 12288
    s_add_u32 s47, s30, 6144
    buffer_load_dwordx4 v11, s[8:11], s47 offen sc1 lds
    s_add_u32 m0, s40, 16384
    s_add_u32 s47, s30, 8192
    buffer_load_dwordx4 v11, s[8:11], s47 offen sc1 lds
    s_add_u32 m0, s40, 20480
    s_add_u32 s47, s30, 10240
    buffer_load_dwordx4 v11, s[8:11], s47 offen sc1 lds
    s_add_u32 m0, s40, 24576
    s_add_u32 s47, s30, 12288
    buffer_load_dwordx4 v11, s[8:11], s47 offen sc1 lds
    s_add_u32 m0, s40, 28672
    s_add_u32 s47, s30, 14336
    buffer_load_dwordx4 v11, s[8:11], s47 offen sc1 lds
    s_add_u32 m0, s40, 32768
    s_add_u32 s47, s30, 16384
    buffer_load_dwordx4 v11, s[8:11], s47 offen sc1 lds
    s_add_u32 m0, s40, 36864
    s_add_u32 s47, s30, 18432
    buffer_load_dwordx4 v11, s[8:11], s47 offen sc1 lds
    s_add_u32 m0, s40, 40960
    s_add_u32 s47, s30, 20480
    buffer_load_dwordx4 v11, s[8:11], s47 offen sc1 lds
    s_add_u32 m0, s40, 45056
    s_add_u32 s47, s30, 22528
    buffer_load_dwordx4 v11, s[8:11], s47 offen sc1 lds
    s_add_u32 m0, s40, 49152
    s_add_u32 s47, s30, 24576
    buffer_load_dwordx4 v11, s[8:11], s47 offen sc1 lds
    s_add_u32 m0, s40, 53248
    s_add_u32 s47, s30, 26624
    buffer_load_dwordx4 v11, s[8:11], s47 offen sc1 lds
    s_add_u32 m0, s40, 57344
    s_add_u32 s47, s30, 28672
    buffer_load_dwordx4 v11, s[8:11], s47 offen sc1 lds
    s_add_u32 m0, s40, 61440
    s_add_u32 s47, s30, 30720
    buffer_load_dwordx4 v11, s[8:11], s47 offen sc1 lds
    s_xor_b32 s40, s40, 65536
    s_add_u32 s30, s30, s45
L_so_L2:
    s_waitcnt vmcnt(12)
    s_barrier
    ds_read_b128 v[16:19], v12 offset:0
    ds_read_b128 v[20:23], v12 offset:1024
    ds_read_b128 v[24:27], v12 offset:2048
    ds_read_b128 v[28:31], v12 offset:3072
    ds_read_b128 v[32:35], v12 offset:4096
    ds_read_b128 v[36:39], v12 offset:5120
    s_waitcnt lgkmcnt(5)
    v_mfma_f32_16x16x32_bf16 v[64:67], a[0:3], v[16:19], 0
    ds_read_b128 v[40:43], v12 offset:6144
    v_mfma_f32_16x16x32_bf16 v[68:71], a[4:7], v[16:19], 0
    s_waitcnt lgkmcnt(5)
    v_mfma_f32_16x16x32_bf16 v[72:75], a[0:3], v[20:23], 0
    ds_read_b128 v[44:47], v12 offset:7168
    v_mfma_f32_16x16x32_bf16 v[76:79], a[4:7], v[20:23], 0
    s_waitcnt lgkmcnt(5)
    v_mfma_f32_16x16x32_bf16 v[64:67], a[8:11], v[24:27], v[64:67]
    ds_read_b128 v[48:51], v12 offset:8192
    v_mfma_f32_16x16x32_bf16 v[68:71], a[12:15], v[24:27], v[68:71]
    s_waitcnt lgkmcnt(5)
    v_mfma_f32_16x16x32_bf16 v[72:75], a[8:11], v[28:31], v[72:75]
    ds_read_b128 v[52:55], v12 offset:9216
    v_mfma_f32_16x16x32_bf16 v[76:79], a[12:15], v[28:31], v[76:79]
    s_waitcnt lgkmcnt(5)
    v_mfma_f32_16x16x32_bf16 v[64:67], a[16:19], v[32:35], v[64:67]
    ds_read_b128 v[56:59], v12 offset:10240
    v_mfma_f32_16x16x32_bf16 v[68:71], a[20:23], v[32:35], v[68:71]
    s_waitcnt lgkmcnt(5)
    v_mfma_f32_16x16x32_bf16 v[72:75], a[16:19], v[36:39], v[72:75]
    ds_read_b128 v[60:63], v12 offset:11264
    v_mfma_f32_16x16x32_bf16 v[76:79], a[20:23], v[36:39], v[76:79]
    s_waitcnt lgkmcnt(5)
    v_mfma_f32_16x16x32_bf16 v[64:67], a[24:27], v[40:43], v[64:67]
    ds_read_b128 v[16:19], v12 offset:12288
    v_mfma_f32_16x16x32_bf16 v[68:71], a[28:31], v[40:43], v[68:71]
    s_waitcnt lgkmcnt(5)
    v_mfma_f32_16x16x32_bf16 v[72:75], a[24:27], v[44:47], v[72:75]
    ds_read_b128 v[20:23], v12 offset:13312
    v_mfma_f32_16x16x32_bf16 v[76:79], a[28:31], v[44:47], v[76:79]
    s_waitcnt lgkmcnt(5)
    v_mfma_f32_16x16x32_bf16 v[64:67], a[32:35], v[48:51], v[64:67]
    ds_read_b128 v[24:27], v12 offset:14336
    v_mfma_f32_16x16x32_bf16 v[68:71], a[36:39], v[48:51], v[68:71]
    s_waitcnt lgkmcnt(5)
    v_mfma_f32_16x16x32_bf16 v[72:75], a[32:35], v[52:55], v[72:75]
    ds_read_b128 v[28:31], v12 offset:15360
    v_mfma_f32_16x16x32_bf16 v[76:79], a[36:39], v[52:55], v[76:79]
    s_waitcnt lgkmcnt(5)
    v_mfma_f32_16x16x32_bf16 v[64:67], a[40:43], v[56:59], v[64:67]
    s_waitcnt vmcnt(8)
    s_barrier
    ds_read_b128 v[32:35], v12 offset:16384
    v_mfma_f32_16x16x32_bf16 v[68:71], a[44:47], v[56:59], v[68:71]
    s_waitcnt lgkmcnt(5)
    v_mfma_f32_16x16x32_bf16 v[72:75], a[40:43], v[60:63], v[72:75]
    ds_read_b128 v[36:39], v12 offset:17408
    v_mfma_f32_16x16x32_bf16 v[76:79], a[44:47], v[60:63], v[76:79]
    s_waitcnt lgkmcnt(5)
    v_mfma_f32_16x16x32_bf16 v[64:67], a[48:51], v[16:19], v[64:67]
    ds_read_b128 v[40:43], v12 offset:18432
    v_mfma_f32_16x16x32_bf16 v[68:71], a[52:55], v[16:19], v[68:71]
    s_waitcnt lgkmcnt(5)
    v_mfma_f32_16x16x32_bf16 v[72:75], a[48:51], v[20:23], v[72:75]
    ds_read_b128 v[44:47], v12 offset:19456
    v_mfma_f32_16x16x32_bf16 v[76:79], a[52:55], v[20:23], v[76:79]
    s_waitcnt lgkmcnt(5)
    v_mfma_f32_16x16x32_bf16 v[64:67], a[56:59], v[24:27], v[64:67]
    ds_read_b128 v[48:51], v12 offset:20480
    v_mfma_f32_16x16x32_bf16 v[68:71], a[60:63], v[24:27], v[68:71]
    s_waitcnt lgkmcnt(5)
    v_mfma_f32_16x16x32_bf16 v[72:75], a[56:59], v[28:31], v[72:75]
    ds_read_b128 v[52:55], v12 offset:21504
    v_mfma_f32_16x16x32_bf16 v[76:79], a[60:63], v[28:31], v[76:79]
    s_waitcnt lgkmcnt(5)
    v_mfma_f32_16x16x32_bf16 v[64:67], a[64:67], v[32:35], v[64:67]
    ds_read_b128 v[56:59], v12 offset:22528
    v_mfma_f32_16x16x32_bf16 v[68:71], a[68:71], v[32:35], v[68:71]
    s_waitcnt lgkmcnt(5)
    v_mfma_f32_16x16x32_bf16 v[72:75], a[64:67], v[36:39], v[72:75]
    ds_read_b128 v[60:63], v12 offset:23552
    v_mfma_f32_16x16x32_bf16 v[76:79], a[68:71], v[36:39], v[76:79]
    s_waitcnt lgkmcnt(5)
    v_mfma_f32_16x16x32_bf16 v[64:67], a[72:75], v[40:43], v[64:67]
    ds_read_b128 v[16:19], v12 offset:24576
    v_mfma_f32_16x16x32_bf16 v[68:71], a[76:79], v[40:43], v[68:71]
    s_waitcnt lgkmcnt(5)
    v_mfma_f32_16x16x32_bf16 v[72:75], a[72:75], v[44:47], v[72:75]
    ds_read_b128 v[20:23], v12 offset:25600
    v_mfma_f32_16x16x32_bf16 v[76:79], a[76:79], v[44:47], v[76:79]
    s_waitcnt lgkmcnt(5)
    v_mfma_f32_16x16x32_bf16 v[64:67], a[80:83], v[48:51], v[64:67]
    ds_read_b128 v[24:27], v12 offset:26624
    v_mfma_f32_16x16x32_bf16 v[68:71], a[84:87], v[48:51], v[68:71]
    s_waitcnt lgkmcnt(5)
    v_mfma_f32_16x16x32_bf16 v[72:75], a[80:83], v[52:55], v[72:75]
    ds_read_b128 v[28:31], v12 offset:27648
    v_mfma_f32_16x16x32_bf16 v[76:79], a[84:87], v[52:55], v[76:79]
    s_waitcnt lgkmcnt(5)
    v_mfma_f32_16x16x32_bf16 v[64:67], a[88:91], v[56:59], v[64:67]
    ds_read_b128 v[32:35], v12 offset:28672
    v_mfma_f32_16x16x32_bf16 v[68:71], a[92:95], v[56:59], v[68:71]
    s_waitcnt lgkmcnt(5)
    v_mfma_f32_16x16x32_bf16 v[72:75], a[88:91], v[60:63], v[72:75]
    ds_read_b128 v[36:39], v12 offset:29696
    v_mfma_f32_16x16x32_bf16 v[76:79], a[92:95], v[60:63], v[76:79]
    s_waitcnt lgkmcnt(5)
    v_mfma_f32_16x16x32_bf16 v[64:67], a[96:99], v[16:19], v[64:67]
    ds_read_b128 v[40:43], v12 offset:30720
    v_mfma_f32_16x16x32_bf16 v[68:71], a[100:103], v[16:19], v[68:71]
    s_waitcnt lgkmcnt(5)
    v_mfma_f32_16x16x32_bf16 v[72:75], a[96:99], v[20:23], v[72:75]
    ds_read_b128 v[44:47], v12 offset:31744
    v_mfma_f32_16x16x32_bf16 v[76:79], a[100:103], v[20:23], v[76:79]
    s_waitcnt lgkmcnt(5)
    v_mfma_f32_16x16x32_bf16 v[64:67], a[104:107], v[24:27], v[64:67]
    s_waitcnt vmcnt(4)
    s_barrier
    ds_read_b128 v[48:51], v12 offset:32768
    v_mfma_f32_16x16x32_bf16 v[68:71], a[108:111], v[24:27], v[68:71]
    s_waitcnt lgkmcnt(5)
    v_mfma_f32_16x16x32_bf16 v[72:75], a[104:107], v[28:31], v[72:75]
    ds_read_b128 v[52:55], v12 offset:33792
    v_mfma_f32_16x16x32_bf16 v[76:79], a[108:111], v[28:31], v[76:79]
    s_waitcnt lgkmcnt(5)
    v_mfma_f32_16x16x32_bf16 v[64:67], a[112:115], v[32:35], v[64:67]
    ds_read_b128 v[56:59], v12 offset:34816
    v_mfma_f32_16x16x32_bf16 v[68:71], a[116:119], v[32:35], v[68:71]
    s_waitcnt lgkmcnt(5)
    v_mfma_f32_16x16x32_bf16 v[72:75], a[112:115], v[36:39], v[72:75]
    ds_read_b128 v[60:63], v12 offset:35840
    v_mfma_f32_16x16x32_bf16 v[76:79], a[116:119], v[36:39], v[76:79]
    s_waitcnt lgkmcnt(5)
    v_mfma_f32_16x16x32_bf16 v[64:67], a[120:123], v[40:43], v[64:67]
    ds_read_b128 v[16:19], v12 offset:36864
    v_mfma_f32_16x16x32_bf16 v[68:71], a[124:127], v[40:43], v[68:71]
    s_waitcnt lgkmcnt(5)
    v_mfma_f32_16x16x32_bf16 v[72:75], a[120:123], v[44:47], v[72:75]
    ds_read_b128 v[20:23], v12 offset:37888
    v_mfma_f32_16x16x32_bf16 v[76:79], a[124:127], v[44:47], v[76:79]
    s_waitcnt lgkmcnt(5)
    v_mfma_f32_16x16x32_bf16 v[64:67], a[128:131], v[48:51], v[64:67]
    ds_read_b128 v[24:27], v12 offset:38912
    v_mfma_f32_16x16x32_bf16 v[68:71], a[132:135], v[48:51], v[68:71]
    s_waitcnt lgkmcnt(5)
    v_mfma_f32_16x16x32_bf16 v[72:75], a[128:131], v[52:55], v[72:75]
    ds_read_b128 v[28:31], v12 offset:39936
    v_mfma_f32_16x16x32_bf16 v[76:79], a[132:135], v[52:55], v[76:79]
    s_waitcnt lgkmcnt(5)
    v_mfma_f32_16x16x32_bf16 v[64:67], a[136:139], v[56:59], v[64:67]
    ds_read_b128 v[32:35], v12 offset:40960
    v_mfma_f32_16x16x32_bf16 v[68:71], a[140:143], v[56:59], v[68:71]
    s_waitcnt lgkmcnt(5)
    v_mfma_f32_16x16x32_bf16 v[72:75], a[136:139], v[60:63], v[72:75]
    ds_read_b128 v[36:39], v12 offset:41984
    v_mfma_f32_16x16x32_bf16 v[76:79], a[140:143], v[60:63], v[76:79]
    s_waitcnt lgkmcnt(5)
    v_mfma_f32_16x16x32_bf16 v[64:67], a[144:147], v[16:19], v[64:67]
    ds_read_b128 v[40:43], v12 offset:43008
    v_mfma_f32_16x16x32_bf16 v[68:71], a[148:151], v[16:19], v[68:71]
    s_waitcnt lgkmcnt(5)
    v_mfma_f32_16x16x32_bf16 v[72:75], a[144:147], v[20:23], v[72:75]
    ds_read_b128 v[44:47], v12 offset:44032
    v_mfma_f32_16x16x32_bf16 v[76:79], a[148:151], v[20:23], v[76:79]
    s_waitcnt lgkmcnt(5)
    v_mfma_f32_16x16x32_bf16 v[64:67], a[152:155], v[24:27], v[64:67]
    ds_read_b128 v[48:51], v12 offset:45056
    v_mfma_f32_16x16x32_bf16 v[68:71], a[156:159], v[24:27], v[68:71]
    s_waitcnt lgkmcnt(5)
    v_mfma_f32_16x16x32_bf16 v[72:75], a[152:155], v[28:31], v[72:75]
    ds_read_b128 v[52:55], v12 offset:46080
    v_mfma_f32_16x16x32_bf16 v[76:79], a[156:159], v[28:31], v[76:79]
    s_waitcnt lgkmcnt(5)
    v_mfma_f32_16x16x32_bf16 v[64:67], a[160:163], v[32:35], v[64:67]
    ds_read_b128 v[56:59], v12 offset:47104
    v_mfma_f32_16x16x32_bf16 v[68:71], a[164:167], v[32:35], v[68:71]
    s_waitcnt lgkmcnt(5)
    v_mfma_f32_16x16x32_bf16 v[72:75], a[160:163], v[36:39], v[72:75]
    ds_read_b128 v[60:63], v12 offset:48128
    v_mfma_f32_16x16x32_bf16 v[76:79], a[164:167], v[36:39], v[76:79]
    s_waitcnt lgkmcnt(5)
    v_mfma_f32_16x16x32_bf16 v[64:67], a[168:171], v[40:43], v[64:67]
    s_waitcnt vmcnt(0)
    s_barrier
    s_add_u32 s4, s41, 2048
    v_mov_b32 v6, 0
    buffer_atomic_add v6, v15, s[8:11], s4 offen sc0
    ds_read_b128 v[16:19], v12 offset:49152
    v_mfma_f32_16x16x32_bf16 v[68:71], a[172:175], v[40:43], v[68:71]
    s_waitcnt lgkmcnt(5)
    v_mfma_f32_16x16x32_bf16 v[72:75], a[168:171], v[44:47], v[72:75]
    ds_read_b128 v[20:23], v12 offset:50176
    v_mfma_f32_16x16x32_bf16 v[76:79], a[172:175], v[44:47], v[76:79]
    s_waitcnt lgkmcnt(5)
    v_mfma_f32_16x16x32_bf16 v[64:67], a[176:179], v[48:51], v[64:67]
    ds_read_b128 v[24:27], v12 offset:51200
    v_mfma_f32_16x16x32_bf16 v[68:71], a[180:183], v[48:51], v[68:71]
    s_waitcnt lgkmcnt(5)
    v_mfma_f32_16x16x32_bf16 v[72:75], a[176:179], v[52:55], v[72:75]
    ds_read_b128 v[28:31], v12 offset:52224
    v_mfma_f32_16x16x32_bf16 v[76:79], a[180:183], v[52:55], v[76:79]
    s_waitcnt lgkmcnt(5)
    v_mfma_f32_16x16x32_bf16 v[64:67], a[184:187], v[56:59], v[64:67]
    ds_read_b128 v[32:35], v12 offset:53248
    v_mfma_f32_16x16x32_bf16 v[68:71], a[188:191], v[56:59], v[68:71]
    s_waitcnt lgkmcnt(5)
    v_mfma_f32_16x16x32_bf16 v[72:75], a[184:187], v[60:63], v[72:75]
    ds_read_b128 v[36:39], v12 offset:54272
    v_mfma_f32_16x16x32_bf16 v[76:79], a[188:191], v[60:63], v[76:79]
    s_waitcnt lgkmcnt(5)
    v_mfma_f32_16x16x32_bf16 v[64:67], a[192:195], v[16:19], v[64:67]
    ds_read_b128 v[40:43], v12 offset:55296
    v_mfma_f32_16x16x32_bf16 v[68:71], a[196:199], v[16:19], v[68:71]
    s_waitcnt lgkmcnt(5)
    v_mfma_f32_16x16x32_bf16 v[72:75], a[192:195], v[20:23], v[72:75]
    ds_read_b128 v[44:47], v12 offset:56320
    v_mfma_f32_16x16x32_bf16 v[76:79], a[196:199], v[20:23], v[76:79]
    s_waitcnt lgkmcnt(5)
    v_mfma_f32_16x16x32_bf16 v[64:67], a[200:203], v[24:27], v[64:67]
    ds_read_b128 v[48:51], v12 offset:57344
    v_mfma_f32_16x16x32_bf16 v[68:71], a[204:207], v[24:27], v[68:71]
    s_waitcnt lgkmcnt(5)
    v_mfma_f32_16x16x32_bf16 v[72:75], a[200:203], v[28:31], v[72:75]
    ds_read_b128 v[52:55], v12 offset:58368
    v_mfma_f32_16x16x32_bf16 v[76:79], a[204:207], v[28:31], v[76:79]
    s_waitcnt lgkmcnt(5)
    v_mfma_f32_16x16x32_bf16 v[64:67], a[208:211], v[32:35], v[64:67]
    ds_read_b128 v[56:59], v12 offset:59392
    v_mfma_f32_16x16x32_bf16 v[68:71], a[212:215], v[32:35], v[68:71]
    s_waitcnt lgkmcnt(5)
    v_mfma_f32_16x16x32_bf16 v[72:75], a[208:211], v[36:39], v[72:75]
    ds_read_b128 v[60:63], v12 offset:60416
    v_mfma_f32_16x16x32_bf16 v[76:79], a[212:215], v[36:39], v[76:79]
    s_waitcnt lgkmcnt(5)
    v_mfma_f32_16x16x32_bf16 v[64:67], a[216:219], v[40:43], v[64:67]
    ds_read_b128 v[16:19], v12 offset:61440
    v_mfma_f32_16x16x32_bf16 v[68:71], a[220:223], v[40:43], v[68:71]
    s_waitcnt lgkmcnt(5)
    v_mfma_f32_16x16x32_bf16 v[72:75], a[216:219], v[44:47], v[72:75]
    ds_read_b128 v[20:23], v12 offset:62464
    v_mfma_f32_16x16x32_bf16 v[76:79], a[220:223], v[44:47], v[76:79]
    s_waitcnt lgkmcnt(5)
    v_mfma_f32_16x16x32_bf16 v[64:67], a[224:227], v[48:51], v[64:67]
    ds_read_b128 v[24:27], v12 offset:63488
    v_mfma_f32_16x16x32_bf16 v[68:71], a[228:231], v[48:51], v[68:71]
    s_waitcnt lgkmcnt(5)
    v_mfma_f32_16x16x32_bf16 v[72:75], a[224:227], v[52:55], v[72:75]
    ds_read_b128 v[28:31], v12 offset:64512
    v_mfma_f32_16x16x32_bf16 v[76:79], a[228:231], v[52:55], v[76:79]
    s_waitcnt lgkmcnt(5)
    v_mfma_f32_16x16x32_bf16 v[64:67], a[232:235], v[56:59], v[64:67]
    v_mfma_f32_16x16x32_bf16 v[68:71], a[236:239], v[56:59], v[68:71]
    s_waitcnt lgkmcnt(4)
    v_mfma_f32_16x16x32_bf16 v[72:75], a[232:235], v[60:63], v[72:75]
    v_mfma_f32_16x16x32_bf16 v[76:79], a[236:239], v[60:63], v[76:79]
    s_waitcnt lgkmcnt(3)
    v_mfma_f32_16x16x32_bf16 v[64:67], a[240:243], v[16:19], v[64:67]
    v_mfma_f32_16x16x32_bf16 v[68:71], a[244:247], v[16:19], v[68:71]
    s_waitcnt lgkmcnt(2)
    v_mfma_f32_16x16x32_bf16 v[72:75], a[240:243], v[20:23], v[72:75]
    v_mfma_f32_16x16x32_bf16 v[76:79], a[244:247], v[20:23], v[76:79]
    s_waitcnt lgkmcnt(1)
    v_mfma_f32_16x16x32_bf16 v[64:67], a[248:251], v[24:27], v[64:67]
    v_mfma_f32_16x16x32_bf16 v[68:71], a[252:255], v[24:27], v[68:71]
    s_waitcnt lgkmcnt(0)
    v_mfma_f32_16x16x32_bf16 v[72:75], a[248:251], v[28:31], v[72:75]
    v_mfma_f32_16x16x32_bf16 v[76:79], a[252:255], v[28:31], v[76:79]
L_so_T:
    s_add_u32 s43, s43, 1
    s_add_u32 s41, s41, 2048
    v_xor_b32 v12, 65536, v12
    s_nop 6
    v_cvt_pk_bf16_f32 v80, v64, v65
    v_cvt_pk_bf16_f32 v81, v66, v67
    v_cvt_pk_bf16_f32 v82, v68, v69
    v_cvt_pk_bf16_f32 v83, v70, v71
    buffer_store_dwordx4 v[80:83], v2, s[8:11], s37 offen sc1
    s_add_u32 s5, s37, s38
    v_cvt_pk_bf16_f32 v96, v72, v73
    v_cvt_pk_bf16_f32 v97, v74, v75
    v_cvt_pk_bf16_f32 v98, v76, v77
    v_cvt_pk_bf16_f32 v99, v78, v79
    buffer_store_dwordx4 v[96:99], v2, s[8:11], s5 offen sc1
    s_add_u32 s37, s37, s46
    s_waitcnt vmcnt(2)
    s_cmp_lg_u32 s21, 0
    s_cbranch_scc1 L_bp_1
    s_mov_b64 exec, 3
    ds_write_b32 v13, v6
    s_mov_b64 exec, -1
    s_waitcnt lgkmcnt(0)
L_bp_1:
    s_barrier
    ds_read_b32 v7, v13
    v_xor_b32 v13, 256, v13
    s_waitcnt lgkmcnt(0)
    v_readlane_b32 s4, v7, 0
    v_readlane_b32 s5, v7, 1
    s_cmp_ge_u32 s4, s36
    s_cselect_b32 s44, 1, 0
    s_cmp_ge_u32 s43, 64
    s_cselect_b32 s44, 0, s44
    s_cmp_ge_u32 s5, s36
    s_cselect_b32 s39, 1, 0
    s_cmp_lg_u32 s44, 0
    s_cbranch_scc1 L_so_T1
    s_waitcnt vmcnt(0)
    s_barrier
    s_cmp_lg_u32 s21, 0
    s_cbranch_scc1 L_so_s1
    s_mov_b64 exec, 1
    v_mov_b32 v4, 0
    v_mov_b32 v5, 1
    buffer_atomic_add v5, v4, s[8:11], s35 offen
    s_mov_b64 exec, -1
L_so_s1:
    s_add_u32 s35, s35, 2048
    s_cmp_lt_u32 s43, 64
    s_cbranch_scc1 L_so_L
    s_branch L_w_done
L_so_T1:
    s_add_u32 m0, s40, 0
    s_add_u32 s47, s30, 0
    buffer_load_dwordx4 v11, s[8:11], s47 offen sc1 lds
    s_add_u32 m0, s40, 4096
    s_add_u32 s47, s30, 2048
    buffer_load_dwordx4 v11, s[8:11], s47 offen sc1 lds
    s_add_u32 m0, s40, 8192
    s_add_u32 s47, s30, 4096
    buffer_load_dwordx4 v11, s[8:11], s47 offen sc1 lds
    s_add_u32 m0, s40, 12288
    s_add_u32 s47, s30, 6144
    buffer_load_dwordx4 v11, s[8:11], s47 offen sc1 lds
    s_add_u32 m0, s40, 16384
    s_add_u32 s47, s30, 8192
    buffer_load_dwordx4 v11, s[8:11], s47 offen sc1 lds
    s_add_u32 m0, s40, 20480
    s_add_u32 s47, s30, 10240
    buffer_load_dwordx4 v11, s[8:11], s47 offen sc1 lds
    s_add_u32 m0, s40, 24576
    s_add_u32 s47, s30, 12288
    buffer_load_dwordx4 v11, s[8:11], s47 offen sc1 lds
    s_add_u32 m0, s40, 28672
    s_add_u32 s47, s30, 14336
    buffer_load_dwordx4 v11, s[8:11], s47 offen sc1 lds
    s_add_u32 m0, s40, 32768
    s_add_u32 s47, s30, 16384
    buffer_load_dwordx4 v11, s[8:11], s47 offen sc1 lds
    s_add_u32 m0, s40, 36864
    s_add_u32 s47, s30, 18432
    buffer_load_dwordx4 v11, s[8:11], s47 offen sc1 lds
    s_add_u32 m0, s40, 40960
    s_add_u32 s47, s30, 20480
    buffer_load_dwordx4 v11, s[8:11], s47 offen sc1 lds
    s_add_u32 m0, s40, 45056
    s_add_u32 s47, s30, 22528
    buffer_load_dwordx4 v11, s[8:11], s47 offen sc1 lds
    s_add_u32 m0, s40, 49152
    s_add_u32 s47, s30, 24576
    buffer_load_dwordx4 v11, s[8:11], s47 offen sc1 lds
    s_add_u32 m0, s40, 53248
    s_add_u32 s47, s30, 26624
    buffer_load_dwordx4 v11, s[8:11], s47 offen sc1 lds
    s_add_u32 m0, s40, 57344
    s_add_u32 s47, s30, 28672
    buffer_load_dwordx4 v11, s[8:11], s47 offen sc1 lds
    s_add_u32 m0, s40, 61440
    s_add_u32 s47, s30, 30720
    buffer_load_dwordx4 v11, s[8:11], s47 offen sc1 lds
    s_xor_b32 s40, s40, 65536
    s_add_u32 s30, s30, s45
    s_cmp_lg_u32 s39, 0
    s_cbranch_scc1 L_so_T2
    s_waitcnt vmcnt(16)
    s_barrier
    s_cmp_lg_u32 s21, 3
    s_cbranch_scc1 L_so_s4
    s_mov_b64 exec, 1
    v_mov_b32 v4, 0
    v_mov_b32 v5, 1
    buffer_atomic_add v5, v4, s[8:11], s35 offen
    s_mov_b64 exec, -1
L_so_s4:
    s_add_u32 s35, s35, 2048
    s_branch L_so_L2
L_so_T2:
    s_add_u32 s4, s41, 2048
    v_mov_b32 v6, 0
    buffer_atomic_add v6, v15, s[8:11], s4 offen sc0
    s_waitcnt vmcnt(0)
    s_branch L_so_B1
L_so_E:
    s_add_u32 s43, s43, 1
    s_add_u32 s41, s41, 2048
    v_xor_b32 v12, 65536, v12
    s_nop 6
    v_cvt_pk_bf16_f32 v80, v64, v65
    v_cvt_pk_bf16_f32 v81, v66, v67
    v_cvt_pk_bf16_f32 v82, v68, v69
    v_cvt_pk_bf16_f32 v83, v70, v71
    buffer_store_dwordx4 v[80:83], v2, s[8:11], s37 offen sc1
    s_add_u32 s5, s37, s38
    v_cvt_pk_bf16_f32 v96, v72, v73
    v_cvt_pk_bf16_f32 v97, v74, v75
    v_cvt_pk_bf16_f32 v98, v76, v77
    v_cvt_pk_bf16_f32 v99, v78, v79
    buffer_store_dwordx4 v[96:99], v2, s[8:11], s5 offen sc1
    s_add_u32 s37, s37, s46
    s_waitcnt vmcnt(2)
L_so_B1:
    s_cmp_lg_u32 s21, 0
    s_cbranch_scc1 L_bp_2
    s_mov_b64 exec, 3
    ds_write_b32 v13, v6
    s_mov_b64 exec, -1
    s_waitcnt lgkmcnt(0)
L_bp_2:
    s_barrier
    ds_read_b32 v7, v13
    v_xor_b32 v13, 256, v13
    s_waitcnt lgkmcnt(0)
    v_readlane_b32 s4, v7, 0
    v_readlane_b32 s5, v7, 1
    s_cmp_ge_u32 s4, s36
    s_cselect_b32 s44, 1, 0
    s_cmp_ge_u32 s43, 63
    s_cselect_b32 s44, 0, s44
    s_cmp_ge_u32 s5, s36
    s_cselect_b32 s39, 1, 0
    s_cmp_eq_u32 s44, 0
    s_cbranch_scc1 L_so_B0
    ds_read_b128 v[16:19], v12 offset:0
    ds_read_b128 v[20:23], v12 offset:1024
    ds_read_b128 v[24:27], v12 offset:2048
    ds_read_b128 v[28:31], v12 offset:3072
    ds_read_b128 v[32:35], v12 offset:4096
    ds_read_b128 v[36:39], v12 offset:5120
    s_waitcnt lgkmcnt(5)
    v_mfma_f32_16x16x32_bf16 v[64:67], a[0:3], v[16:19], 0
    ds_read_b128 v[40:43], v12 offset:6144
    v_mfma_f32_16x16x32_bf16 v[68:71], a[4:7], v[16:19], 0
    s_waitcnt lgkmcnt(5)
    v_mfma_f32_16x16x32_bf16 v[72:75], a[0:3], v[20:23], 0
    ds_read_b128 v[44:47], v12 offset:7168
    v_mfma_f32_16x16x32_bf16 v[76:79], a[4:7], v[20:23], 0
    s_waitcnt lgkmcnt(5)
    v_mfma_f32_16x16x32_bf16 v[64:67], a[8:11], v[24:27], v[64:67]
    ds_read_b128 v[48:51], v12 offset:8192
    v_mfma_f32_16x16x32_bf16 v[68:71], a[12:15], v[24:27], v[68:71]
    s_waitcnt lgkmcnt(5)
    v_mfma_f32_16x16x32_bf16 v[72:75], a[8:11], v[28:31], v[72:75]
    ds_read_b128 v[52:55], v12 offset:9216
    v_mfma_f32_16x16x32_bf16 v[76:79], a[12:15], v[28:31], v[76:79]
    s_waitcnt lgkmcnt(5)
    v_mfma_f32_16x16x32_bf16 v[64:67], a[16:19], v[32:35], v[64:67]
    ds_read_b128 v[56:59], v12 offset:10240
    v_mfma_f32_16x16x32_bf16 v[68:71], a[20:23], v[32:35], v[68:71]
    s_waitcnt lgkmcnt(5)
    v_mfma_f32_16x16x32_bf16 v[72:75], a[16:19], v[36:39], v[72:75]
    ds_read_b128 v[60:63], v12 offset:11264
    v_mfma_f32_16x16x32_bf16 v[76:79], a[20:23], v[36:39], v[76:79]
    s_waitcnt lgkmcnt(5)
    v_mfma_f32_16x16x32_bf16 v[64:67], a[24:27], v[40:43], v[64:67]
    ds_read_b128 v[16:19], v12 offset:12288
    v_mfma_f32_16x16x32_bf16 v[68:71], a[28:31], v[40:43], v[68:71]
    s_waitcnt lgkmcnt(5)
    v_mfma_f32_16x16x32_bf16 v[72:75], a[24:27], v[44:47], v[72:75]
    ds_read_b128 v[20:23], v12 offset:13312
    v_mfma_f32_16x16x32_bf16 v[76:79], a[28:31], v[44:47], v[76:79]
    s_waitcnt lgkmcnt(5)
    v_mfma_f32_16x16x32_bf16 v[64:67], a[32:35], v[48:51], v[64:67]
    ds_read_b128 v[24:27], v12 offset:14336
    v_mfma_f32_16x16x32_bf16 v[68:71], a[36:39], v[48:51], v[68:71]
    s_add_u32 m0, s40, 0
    s_add_u32 s47, s30, 0
    buffer_load_dwordx4 v11, s[8:11], s47 offen sc1 lds
    s_waitcnt lgkmcnt(5)
    v_mfma_f32_16x16x32_bf16 v[72:75], a[32:35], v[52:55], v[72:75]
    ds_read_b128 v[28:31], v12 offset:15360
    v_mfma_f32_16x16x32_bf16 v[76:79], a[36:39], v[52:55], v[76:79]
    s_waitcnt lgkmcnt(5)
    v_mfma_f32_16x16x32_bf16 v[64:67], a[40:43], v[56:59], v[64:67]
    ds_read_b128 v[32:35], v12 offset:16384
    v_mfma_f32_16x16x32_bf16 v[68:71], a[44:47], v[56:59], v[68:71]
    s_add_u32 m0, s40, 4096
    s_add_u32 s47, s30, 2048
    buffer_load_dwordx4 v11, s[8:11], s47 offen sc1 lds
    s_waitcnt lgkmcnt(5)
    v_mfma_f32_16x16x32_bf16 v[72:75], a[40:43], v[60:63], v[72:75]
    ds_read_b128 v[36:39], v12 offset:17408
    v_mfma_f32_16x16x32_bf16 v[76:79], a[44:47], v[60:63], v[76:79]
    s_waitcnt lgkmcnt(5)
    v_mfma_f32_16x16x32_bf16 v[64:67], a[48:51], v[16:19], v[64:67]
    ds_read_b128 v[40:43], v12 offset:18432
    v_mfma_f32_16x16x32_bf16 v[68:71], a[52:55], v[16:19], v[68:71]
    s_add_u32 m0, s40, 8192
    s_add_u32 s47, s30, 4096
    buffer_load_dwordx4 v11, s[8:11], s47 offen sc1 lds
    s_waitcnt lgkmcnt(5)
    v_mfma_f32_16x16x32_bf16 v[72:75], a[48:51], v[20:23], v[72:75]
    ds_read_b128 v[44:47], v12 offset:19456
    v_mfma_f32_16x16x32_bf16 v[76:79], a[52:55], v[20:23], v[76:79]
    s_waitcnt vmcnt(3)
    s_barrier
    s_cmp_lg_u32 s21, 0
    s_cbranch_scc1 L_so_s2
    s_mov_b64 exec, 1
    v_mov_b32 v4, 0
    v_mov_b32 v5, 1
    buffer_atomic_add v5, v4, s[8:11], s35 offen
    s_mov_b64 exec, -1
L_so_s2:
    s_add_u32 s35, s35, 2048
    s_waitcnt lgkmcnt(5)
    v_mfma_f32_16x16x32_bf16 v[64:67], a[56:59], v[24:27], v[64:67]
    ds_read_b128 v[48:51], v12 offset:20480
    v_mfma_f32_16x16x32_bf16 v[68:71], a[60:63], v[24:27], v[68:71]
    s_add_u32 m0, s40, 12288
    s_add_u32 s47, s30, 6144
    buffer_load_dwordx4 v11, s[8:11], s47 offen sc1 lds
    s_waitcnt lgkmcnt(5)
    v_mfma_f32_16x16x32_bf16 v[72:75], a[56:59], v[28:31], v[72:75]
    ds_read_b128 v[52:55], v12 offset:21504
    v_mfma_f32_16x16x32_bf16 v[76:79], a[60:63], v[28:31], v[76:79]
    s_waitcnt lgkmcnt(5)
    v_mfma_f32_16x16x32_bf16 v[64:67], a[64:67], v[32:35], v[64:67]
    ds_read_b128 v[56:59], v12 offset:22528
    v_mfma_f32_16x16x32_bf16 v[68:71], a[68:71], v[32:35], v[68:71]
    s_add_u32 m0, s40, 16384
    s_add_u32 s47, s30, 8192
    buffer_load_dwordx4 v11, s[8:11], s47 offen sc1 lds
    s_waitcnt lgkmcnt(5)
    v_mfma_f32_16x16x32_bf16 v[72:75], a[64:67], v[36:39], v[72:75]
    ds_read_b128 v[60:63], v12 offset:23552
    v_mfma_f32_16x16x32_bf16 v[76:79], a[68:71], v[36:39], v[76:79]
    s_waitcnt lgkmcnt(5)
    v_mfma_f32_16x16x32_bf16 v[64:67], a[72:75], v[40:43], v[64:67]
    ds_read_b128 v[16:19], v12 offset:24576
    v_mfma_f32_16x16x32_bf16 v[68:71], a[76:79], v[40:43], v[68:71]
    s_add_u32 m0, s40, 20480
    s_add_u32 s47, s30, 10240
    buffer_load_dwordx4 v11, s[8:11], s47 offen sc1 lds
    s_waitcnt lgkmcnt(5)
    v_mfma_f32_16x16x32_bf16 v[72:75], a[72:75], v[44:47], v[72:75]
    ds_read_b128 v[20:23], v12 offset:25600
    v_mfma_f32_16x16x32_bf16 v[76:79], a[76:79], v[44:47], v[76:79]
    s_waitcnt lgkmcnt(5)
    v_mfma_f32_16x16x32_bf16 v[64:67], a[80:83], v[48:51], v[64:67]
    ds_read_b128 v[24:27], v12 offset:26624
    v_mfma_f32_16x16x32_bf16 v[68:71], a[84:87], v[48:51], v[68:71]
    s_add_u32 m0, s40, 24576
    s_add_u32 s47, s30, 12288
    buffer_load_dwordx4 v11, s[8:11], s47 offen sc1 lds
    s_waitcnt lgkmcnt(5)
    v_mfma_f32_16x16x32_bf16 v[72:75], a[80:83], v[52:55], v[72:75]
    ds_read_b128 v[28:31], v12 offset:27648
    v_mfma_f32_16x16x32_bf16 v[76:79], a[84:87], v[52:55], v[76:79]
    s_waitcnt lgkmcnt(5)
    v_mfma_f32_16x16x32_bf16 v[64:67], a[88:91], v[56:59], v[64:67]
    ds_read_b128 v[32:35], v12 offset:28672
    v_mfma_f32_16x16x32_bf16 v[68:71], a[92:95], v[56:59], v[68:71]
    s_add_u32 m0, s40, 28672
    s_add_u32 s47, s30, 14336
    buffer_load_dwordx4 v11, s[8:11], s47 offen sc1 lds
    s_waitcnt lgkmcnt(5)
    v_mfma_f32_16x16x32_bf16 v[72:75], a[88:91], v[60:63], v[72:75]
    ds_read_b128 v[36:39], v12 offset:29696
    v_mfma_f32_16x16x32_bf16 v[76:79], a[92:95], v[60:63], v[76:79]
    s_waitcnt lgkmcnt(5)
    v_mfma_f32_16x16x32_bf16 v[64:67], a[96:99], v[16:19], v[64:67]
    ds_read_b128 v[40:43], v12 offset:30720
    v_mfma_f32_16x16x32_bf16 v[68:71], a[100:103], v[16:19], v[68:71]
    s_add_u32 m0, s40, 32768
    s_add_u32 s47, s30, 16384
    buffer_load_dwordx4 v11, s[8:11], s47 offen sc1 lds
    s_waitcnt lgkmcnt(5)
    v_mfma_f32_16x16x32_bf16 v[72:75], a[96:99], v[20:23], v[72:75]
    ds_read_b128 v[44:47], v12 offset:31744
    v_mfma_f32_16x16x32_bf16 v[76:79], a[100:103], v[20:23], v[76:79]
    s_waitcnt lgkmcnt(5)
    v_mfma_f32_16x16x32_bf16 v[64:67], a[104:107], v[24:27], v[64:67]
    ds_read_b128 v[48:51], v12 offset:32768
    v_mfma_f32_16x16x32_bf16 v[68:71], a[108:111], v[24:27], v[68:71]
    s_add_u32 m0, s40, 36864
    s_add_u32 s47, s30, 18432
    buffer_load_dwordx4 v11, s[8:11], s47 offen sc1 lds
    s_waitcnt lgkmcnt(5)
    v_mfma_f32_16x16x32_bf16 v[72:75], a[104:107], v[28:31], v[72:75]
    ds_read_b128 v[52:55], v12 offset:33792
    v_mfma_f32_16x16x32_bf16 v[76:79], a[108:111], v[28:31], v[76:79]
    s_waitcnt lgkmcnt(5)
    v_mfma_f32_16x16x32_bf16 v[64:67], a[112:115], v[32:35], v[64:67]
    ds_read_b128 v[56:59], v12 offset:34816
    v_mfma_f32_16x16x32_bf16 v[68:71], a[116:119], v[32:35], v[68:71]
    s_add_u32 m0, s40, 40960
    s_add_u32 s47, s30, 20480
    buffer_load_dwordx4 v11, s[8:11], s47 offen sc1 lds
    s_waitcnt lgkmcnt(5)
    v_mfma_f32_16x16x32_bf16 v[72:75], a[112:115], v[36:39], v[72:75]
    ds_read_b128 v[60:63], v12 offset:35840
    v_mfma_f32_16x16x32_bf16 v[76:79], a[116:119], v[36:39], v[76:79]
    s_waitcnt lgkmcnt(5)
    v_mfma_f32_16x16x32_bf16 v[64:67], a[120:123], v[40:43], v[64:67]
    ds_read_b128 v[16:19], v12 offset:36864
    v_mfma_f32_16x16x32_bf16 v[68:71], a[124:127], v[40:43], v[68:71]
    s_add_u32 m0, s40, 45056
    s_add_u32 s47, s30, 22528
    buffer_load_dwordx4 v11, s[8:11], s47 offen sc1 lds
    s_waitcnt lgkmcnt(5)
    v_mfma_f32_16x16x32_bf16 v[72:75], a[120:123], v[44:47], v[72:75]
    ds_read_b128 v[20:23], v12 offset:37888
    v_mfma_f32_16x16x32_bf16 v[76:79], a[124:127], v[44:47], v[76:79]
    s_waitcnt lgkmcnt(5)
    v_mfma_f32_16x16x32_bf16 v[64:67], a[128:131], v[48:51], v[64:67]
    ds_read_b128 v[24:27], v12 offset:38912
    v_mfma_f32_16x16x32_bf16 v[68:71], a[132:135], v[48:51], v[68:71]
    s_add_u32 m0, s40, 49152
    s_add_u32 s47, s30, 24576
    buffer_load_dwordx4 v11, s[8:11], s47 offen sc1 lds
    s_waitcnt lgkmcnt(5)
    v_mfma_f32_16x16x32_bf16 v[72:75], a[128:131], v[52:55], v[72:75]
    ds_read_b128 v[28:31], v12 offset:39936
    v_mfma_f32_16x16x32_bf16 v[76:79], a[132:135], v[52:55], v[76:79]
    s_waitcnt lgkmcnt(5)
    v_mfma_f32_16x16x32_bf16 v[64:67], a[136:139], v[56:59], v[64:67]
    ds_read_b128 v[32:35], v12 offset:40960
    v_mfma_f32_16x16x32_bf16 v[68:71], a[140:143], v[56:59], v[68:71]
    s_add_u32 m0, s40, 53248
    s_add_u32 s47, s30, 26624
    buffer_load_dwordx4 v11, s[8:11], s47 offen sc1 lds
    s_waitcnt lgkmcnt(5)
    v_mfma_f32_16x16x32_bf16 v[72:75], a[136:139], v[60:63], v[72:75]
    ds_read_b128 v[36:39], v12 offset:41984
    v_mfma_f32_16x16x32_bf16 v[76:79], a[140:143], v[60:63], v[76:79]
    s_waitcnt lgkmcnt(5)
    v_mfma_f32_16x16x32_bf16 v[64:67], a[144:147], v[16:19], v[64:67]
    ds_read_b128 v[40:43], v12 offset:43008
    v_mfma_f32_16x16x32_bf16 v[68:71], a[148:151], v[16:19], v[68:71]
    s_add_u32 m0, s40, 57344
    s_add_u32 s47, s30, 28672
    buffer_load_dwordx4 v11, s[8:11], s47 offen sc1 lds
    s_waitcnt lgkmcnt(5)
    v_mfma_f32_16x16x32_bf16 v[72:75], a[144:147], v[20:23], v[72:75]
    ds_read_b128 v[44:47], v12 offset:44032
    v_mfma_f32_16x16x32_bf16 v[76:79], a[148:151], v[20:23], v[76:79]
    s_waitcnt lgkmcnt(5)
    v_mfma_f32_16x16x32_bf16 v[64:67], a[152:155], v[24:27], v[64:67]
    ds_read_b128 v[48:51], v12 offset:45056
    v_mfma_f32_16x16x32_bf16 v[68:71], a[156:159], v[24:27], v[68:71]
    s_add_u32 m0, s40, 61440
    s_add_u32 s47, s30, 30720
    buffer_load_dwordx4 v11, s[8:11], s47 offen sc1 lds
    s_xor_b32 s40, s40, 65536
    s_add_u32 s30, s30, s45
    s_waitcnt lgkmcnt(5)
    v_mfma_f32_16x16x32_bf16 v[72:75], a[152:155], v[28:31], v[72:75]
    ds_read_b128 v[52:55], v12 offset:46080
    v_mfma_f32_16x16x32_bf16 v[76:79], a[156:159], v[28:31], v[76:79]
    s_waitcnt lgkmcnt(5)
    v_mfma_f32_16x16x32_bf16 v[64:67], a[160:163], v[32:35], v[64:67]
    ds_read_b128 v[56:59], v12 offset:47104
    v_mfma_f32_16x16x32_bf16 v[68:71], a[164:167], v[32:35], v[68:71]
    s_waitcnt lgkmcnt(5)
    v_mfma_f32_16x16x32_bf16 v[72:75], a[160:163], v[36:39], v[72:75]
    ds_read_b128 v[60:63], v12 offset:48128
    v_mfma_f32_16x16x32_bf16 v[76:79], a[164:167], v[36:39], v[76:79]
    s_waitcnt lgkmcnt(5)
    v_mfma_f32_16x16x32_bf16 v[64:67], a[168:171], v[40:43], v[64:67]
    s_add_u32 s4, s41, 4096
    v_mov_b32 v6, 0
    buffer_atomic_add v6, v15, s[8:11], s4 offen sc0
    ds_read_b128 v[16:19], v12 offset:49152
    v_mfma_f32_16x16x32_bf16 v[68:71], a[172:175], v[40:43], v[68:71]
    s_waitcnt lgkmcnt(5)
    v_mfma_f32_16x16x32_bf16 v[72:75], a[168:171], v[44:47], v[72:75]
    ds_read_b128 v[20:23], v12 offset:50176
    v_mfma_f32_16x16x32_bf16 v[76:79], a[172:175], v[44:47], v[76:79]
    s_waitcnt lgkmcnt(5)
    v_mfma_f32_16x16x32_bf16 v[64:67], a[176:179], v[48:51], v[64:67]
    ds_read_b128 v[24:27], v12 offset:51200
    v_mfma_f32_16x16x32_bf16 v[68:71], a[180:183], v[48:51], v[68:71]
    s_waitcnt lgkmcnt(5)
    v_mfma_f32_16x16x32_bf16 v[72:75], a[176:179], v[52:55], v[72:75]
    ds_read_b128 v[28:31], v12 offset:52224
    v_mfma_f32_16x16x32_bf16 v[76:79], a[180:183], v[52:55], v[76:79]
    s_waitcnt lgkmcnt(5)
    v_mfma_f32_16x16x32_bf16 v[64:67], a[184:187], v[56:59], v[64:67]
    ds_read_b128 v[32:35], v12 offset:53248
    v_mfma_f32_16x16x32_bf16 v[68:71], a[188:191], v[56:59], v[68:71]
    s_waitcnt lgkmcnt(5)
    v_mfma_f32_16x16x32_bf16 v[72:75], a[184:187], v[60:63], v[72:75]
    ds_read_b128 v[36:39], v12 offset:54272
    v_mfma_f32_16x16x32_bf16 v[76:79], a[188:191], v[60:63], v[76:79]
    s_waitcnt lgkmcnt(5)
    v_mfma_f32_16x16x32_bf16 v[64:67], a[192:195], v[16:19], v[64:67]
    ds_read_b128 v[40:43], v12 offset:55296
    v_mfma_f32_16x16x32_bf16 v[68:71], a[196:199], v[16:19], v[68:71]
    s_waitcnt lgkmcnt(5)
    v_mfma_f32_16x16x32_bf16 v[72:75], a[192:195], v[20:23], v[72:75]
    ds_read_b128 v[44:47], v12 offset:56320
    v_mfma_f32_16x16x32_bf16 v[76:79], a[196:199], v[20:23], v[76:79]
    s_waitcnt lgkmcnt(5)
    v_mfma_f32_16x16x32_bf16 v[64:67], a[200:203], v[24:27], v[64:67]
    ds_read_b128 v[48:51], v12 offset:57344
    v_mfma_f32_16x16x32_bf16 v[68:71], a[204:207], v[24:27], v[68:71]
    s_waitcnt lgkmcnt(5)
    v_mfma_f32_16x16x32_bf16 v[72:75], a[200:203], v[28:31], v[72:75]
    ds_read_b128 v[52:55], v12 offset:58368
    v_mfma_f32_16x16x32_bf16 v[76:79], a[204:207], v[28:31], v[76:79]
    s_waitcnt lgkmcnt(5)
    v_mfma_f32_16x16x32_bf16 v[64:67], a[208:211], v[32:35], v[64:67]
    ds_read_b128 v[56:59], v12 offset:59392
    v_mfma_f32_16x16x32_bf16 v[68:71], a[212:215], v[32:35], v[68:71]
    s_waitcnt lgkmcnt(5)
    v_mfma_f32_16x16x32_bf16 v[72:75], a[208:211], v[36:39], v[72:75]
    ds_read_b128 v[60:63], v12 offset:60416
    v_mfma_f32_16x16x32_bf16 v[76:79], a[212:215], v[36:39], v[76:79]
    s_waitcnt lgkmcnt(5)
    v_mfma_f32_16x16x32_bf16 v[64:67], a[216:219], v[40:43], v[64:67]
    ds_read_b128 v[16:19], v12 offset:61440
    v_mfma_f32_16x16x32_bf16 v[68:71], a[220:223], v[40:43], v[68:71]
    s_waitcnt lgkmcnt(5)
    v_mfma_f32_16x16x32_bf16 v[72:75], a[216:219], v[44:47], v[72:75]
    ds_read_b128 v[20:23], v12 offset:62464
    v_mfma_f32_16x16x32_bf16 v[76:79], a[220:223], v[44:47], v[76:79]
    s_waitcnt lgkmcnt(5)
    v_mfma_f32_16x16x32_bf16 v[64:67], a[224:227], v[48:51], v[64:67]
    ds_read_b128 v[24:27], v12 offset:63488
    v_mfma_f32_16x16x32_bf16 v[68:71], a[228:231], v[48:51], v[68:71]
    s_waitcnt lgkmcnt(5)
    v_mfma_f32_16x16x32_bf16 v[72:75], a[224:227], v[52:55], v[72:75]
    ds_read_b128 v[28:31], v12 offset:64512
    v_mfma_f32_16x16x32_bf16 v[76:79], a[228:231], v[52:55], v[76:79]
    s_waitcnt lgkmcnt(5)
    v_mfma_f32_16x16x32_bf16 v[64:67], a[232:235], v[56:59], v[64:67]
    v_mfma_f32_16x16x32_bf16 v[68:71], a[236:239], v[56:59], v[68:71]
    s_waitcnt lgkmcnt(4)
    v_mfma_f32_16x16x32_bf16 v[72:75], a[232:235], v[60:63], v[72:75]
    v_mfma_f32_16x16x32_bf16 v[76:79], a[236:239], v[60:63], v[76:79]
    s_waitcnt lgkmcnt(3)
    v_mfma_f32_16x16x32_bf16 v[64:67], a[240:243], v[16:19], v[64:67]
    v_mfma_f32_16x16x32_bf16 v[68:71], a[244:247], v[16:19], v[68:71]
    s_waitcnt lgkmcnt(2)
    v_mfma_f32_16x16x32_bf16 v[72:75], a[240:243], v[20:23], v[72:75]
    v_mfma_f32_16x16x32_bf16 v[76:79], a[244:247], v[20:23], v[76:79]
    s_waitcnt lgkmcnt(1)
    v_mfma_f32_16x16x32_bf16 v[64:67], a[248:251], v[24:27], v[64:67]
    v_mfma_f32_16x16x32_bf16 v[68:71], a[252:255], v[24:27], v[68:71]
    s_waitcnt lgkmcnt(0)
    v_mfma_f32_16x16x32_bf16 v[72:75], a[248:251], v[28:31], v[72:75]
    v_mfma_f32_16x16x32_bf16 v[76:79], a[252:255], v[28:31], v[76:79]
    s_branch L_so_E
L_so_B0:
    ds_read_b128 v[16:19], v12 offset:0
    ds_read_b128 v[20:23], v12 offset:1024
    ds_read_b128 v[24:27], v12 offset:2048
    ds_read_b128 v[28:31], v12 offset:3072
    ds_read_b128 v[32:35], v12 offset:4096
    ds_read_b128 v[36:39], v12 offset:5120
    s_waitcnt lgkmcnt(5)
    v_mfma_f32_16x16x32_bf16 v[64:67], a[0:3], v[16:19], 0
    ds_read_b128 v[40:43], v12 offset:6144
    v_mfma_f32_16x16x32_bf16 v[68:71], a[4:7], v[16:19], 0
    s_waitcnt lgkmcnt(5)
    v_mfma_f32_16x16x32_bf16 v[72:75], a[0:3], v[20:23], 0
    ds_read_b128 v[44:47], v12 offset:7168
    v_mfma_f32_16x16x32_bf16 v[76:79], a[4:7], v[20:23], 0
    s_waitcnt lgkmcnt(5)
    v_mfma_f32_16x16x32_bf16 v[64:67], a[8:11], v[24:27], v[64:67]
    ds_read_b128 v[48:51], v12 offset:8192
    v_mfma_f32_16x16x32_bf16 v[68:71], a[12:15], v[24:27], v[68:71]
    s_waitcnt lgkmcnt(5)
    v_mfma_f32_16x16x32_bf16 v[72:75], a[8:11], v[28:31], v[72:75]
    ds_read_b128 v[52:55], v12 offset:9216
    v_mfma_f32_16x16x32_bf16 v[76:79], a[12:15], v[28:31], v[76:79]
    s_waitcnt lgkmcnt(5)
    v_mfma_f32_16x16x32_bf16 v[64:67], a[16:19], v[32:35], v[64:67]
    ds_read_b128 v[56:59], v12 offset:10240
    v_mfma_f32_16x16x32_bf16 v[68:71], a[20:23], v[32:35], v[68:71]
    s_waitcnt lgkmcnt(5)
    v_mfma_f32_16x16x32_bf16 v[72:75], a[16:19], v[36:39], v[72:75]
    ds_read_b128 v[60:63], v12 offset:11264
    v_mfma_f32_16x16x32_bf16 v[76:79], a[20:23], v[36:39], v[76:79]
    s_waitcnt lgkmcnt(5)
    v_mfma_f32_16x16x32_bf16 v[64:67], a[24:27], v[40:43], v[64:67]
    ds_read_b128 v[16:19], v12 offset:12288
    v_mfma_f32_16x16x32_bf16 v[68:71], a[28:31], v[40:43], v[68:71]
    s_waitcnt lgkmcnt(5)
    v_mfma_f32_16x16x32_bf16 v[72:75], a[24:27], v[44:47], v[72:75]
    ds_read_b128 v[20:23], v12 offset:13312
    v_mfma_f32_16x16x32_bf16 v[76:79], a[28:31], v[44:47], v[76:79]
    s_waitcnt lgkmcnt(5)
    v_mfma_f32_16x16x32_bf16 v[64:67], a[32:35], v[48:51], v[64:67]
    ds_read_b128 v[24:27], v12 offset:14336
    v_mfma_f32_16x16x32_bf16 v[68:71], a[36:39], v[48:51], v[68:71]
    s_waitcnt vmcnt(0)
    s_barrier
    s_cmp_lg_u32 s21, 0
    s_cbranch_scc1 L_so_s3
    s_mov_b64 exec, 1
    v_mov_b32 v4, 0
    v_mov_b32 v5, 1
    buffer_atomic_add v5, v4, s[8:11], s35 offen
    s_mov_b64 exec, -1
L_so_s3:
    s_add_u32 s35, s35, 2048
    s_waitcnt lgkmcnt(5)
    v_mfma_f32_16x16x32_bf16 v[72:75], a[32:35], v[52:55], v[72:75]
    ds_read_b128 v[28:31], v12 offset:15360
    v_mfma_f32_16x16x32_bf16 v[76:79], a[36:39], v[52:55], v[76:79]
    s_waitcnt lgkmcnt(5)
    v_mfma_f32_16x16x32_bf16 v[64:67], a[40:43], v[56:59], v[64:67]
    ds_read_b128 v[32:35], v12 offset:16384
    v_mfma_f32_16x16x32_bf16 v[68:71], a[44:47], v[56:59], v[68:71]
    s_waitcnt lgkmcnt(5)
    v_mfma_f32_16x16x32_bf16 v[72:75], a[40:43], v[60:63], v[72:75]
    ds_read_b128 v[36:39], v12 offset:17408
    v_mfma_f32_16x16x32_bf16 v[76:79], a[44:47], v[60:63], v[76:79]
    s_waitcnt lgkmcnt(5)
    v_mfma_f32_16x16x32_bf16 v[64:67], a[48:51], v[16:19], v[64:67]
    ds_read_b128 v[40:43], v12 offset:18432
    v_mfma_f32_16x16x32_bf16 v[68:71], a[52:55], v[16:19], v[68:71]
    s_waitcnt lgkmcnt(5)
    v_mfma_f32_16x16x32_bf16 v[72:75], a[48:51], v[20:23], v[72:75]
    ds_read_b128 v[44:47], v12 offset:19456
    v_mfma_f32_16x16x32_bf16 v[76:79], a[52:55], v[20:23], v[76:79]
    s_waitcnt lgkmcnt(5)
    v_mfma_f32_16x16x32_bf16 v[64:67], a[56:59], v[24:27], v[64:67]
    ds_read_b128 v[48:51], v12 offset:20480
    v_mfma_f32_16x16x32_bf16 v[68:71], a[60:63], v[24:27], v[68:71]
    s_waitcnt lgkmcnt(5)
    v_mfma_f32_16x16x32_bf16 v[72:75], a[56:59], v[28:31], v[72:75]
    ds_read_b128 v[52:55], v12 offset:21504
    v_mfma_f32_16x16x32_bf16 v[76:79], a[60:63], v[28:31], v[76:79]
    s_waitcnt lgkmcnt(5)
    v_mfma_f32_16x16x32_bf16 v[64:67], a[64:67], v[32:35], v[64:67]
    ds_read_b128 v[56:59], v12 offset:22528
    v_mfma_f32_16x16x32_bf16 v[68:71], a[68:71], v[32:35], v[68:71]
    s_waitcnt lgkmcnt(5)
    v_mfma_f32_16x16x32_bf16 v[72:75], a[64:67], v[36:39], v[72:75]
    ds_read_b128 v[60:63], v12 offset:23552
    v_mfma_f32_16x16x32_bf16 v[76:79], a[68:71], v[36:39], v[76:79]
    s_waitcnt lgkmcnt(5)
    v_mfma_f32_16x16x32_bf16 v[64:67], a[72:75], v[40:43], v[64:67]
    ds_read_b128 v[16:19], v12 offset:24576
    v_mfma_f32_16x16x32_bf16 v[68:71], a[76:79], v[40:43], v[68:71]
    s_waitcnt lgkmcnt(5)
    v_mfma_f32_16x16x32_bf16 v[72:75], a[72:75], v[44:47], v[72:75]
    ds_read_b128 v[20:23], v12 offset:25600
    v_mfma_f32_16x16x32_bf16 v[76:79], a[76:79], v[44:47], v[76:79]
    s_waitcnt lgkmcnt(5)
    v_mfma_f32_16x16x32_bf16 v[64:67], a[80:83], v[48:51], v[64:67]
    ds_read_b128 v[24:27], v12 offset:26624
    v_mfma_f32_16x16x32_bf16 v[68:71], a[84:87], v[48:51], v[68:71]
    s_waitcnt lgkmcnt(5)
    v_mfma_f32_16x16x32_bf16 v[72:75], a[80:83], v[52:55], v[72:75]
    ds_read_b128 v[28:31], v12 offset:27648
    v_mfma_f32_16x16x32_bf16 v[76:79], a[84:87], v[52:55], v[76:79]
    s_waitcnt lgkmcnt(5)
    v_mfma_f32_16x16x32_bf16 v[64:67], a[88:91], v[56:59], v[64:67]
    ds_read_b128 v[32:35], v12 offset:28672
    v_mfma_f32_16x16x32_bf16 v[68:71], a[92:95], v[56:59], v[68:71]
    s_waitcnt lgkmcnt(5)
    v_mfma_f32_16x16x32_bf16 v[72:75], a[88:91], v[60:63], v[72:75]
    ds_read_b128 v[36:39], v12 offset:29696
    v_mfma_f32_16x16x32_bf16 v[76:79], a[92:95], v[60:63], v[76:79]
    s_waitcnt lgkmcnt(5)
    v_mfma_f32_16x16x32_bf16 v[64:67], a[96:99], v[16:19], v[64:67]
    ds_read_b128 v[40:43], v12 offset:30720
    v_mfma_f32_16x16x32_bf16 v[68:71], a[100:103], v[16:19], v[68:71]
    s_waitcnt lgkmcnt(5)
    v_mfma_f32_16x16x32_bf16 v[72:75], a[96:99], v[20:23], v[72:75]
    ds_read_b128 v[44:47], v12 offset:31744
    v_mfma_f32_16x16x32_bf16 v[76:79], a[100:103], v[20:23], v[76:79]
    s_waitcnt lgkmcnt(5)
    v_mfma_f32_16x16x32_bf16 v[64:67], a[104:107], v[24:27], v[64:67]
    ds_read_b128 v[48:51], v12 offset:32768
    v_mfma_f32_16x16x32_bf16 v[68:71], a[108:111], v[24:27], v[68:71]
    s_waitcnt lgkmcnt(5)
    v_mfma_f32_16x16x32_bf16 v[72:75], a[104:107], v[28:31], v[72:75]
    ds_read_b128 v[52:55], v12 offset:33792
    v_mfma_f32_16x16x32_bf16 v[76:79], a[108:111], v[28:31], v[76:79]
    s_waitcnt lgkmcnt(5)
    v_mfma_f32_16x16x32_bf16 v[64:67], a[112:115], v[32:35], v[64:67]
    ds_read_b128 v[56:59], v12 offset:34816
    v_mfma_f32_16x16x32_bf16 v[68:71], a[116:119], v[32:35], v[68:71]
    s_waitcnt lgkmcnt(5)
    v_mfma_f32_16x16x32_bf16 v[72:75], a[112:115], v[36:39], v[72:75]
    ds_read_b128 v[60:63], v12 offset:35840
    v_mfma_f32_16x16x32_bf16 v[76:79], a[116:119], v[36:39], v[76:79]
    s_waitcnt lgkmcnt(5)
    v_mfma_f32_16x16x32_bf16 v[64:67], a[120:123], v[40:43], v[64:67]
    ds_read_b128 v[16:19], v12 offset:36864
    v_mfma_f32_16x16x32_bf16 v[68:71], a[124:127], v[40:43], v[68:71]
    s_waitcnt lgkmcnt(5)
    v_mfma_f32_16x16x32_bf16 v[72:75], a[120:123], v[44:47], v[72:75]
    ds_read_b128 v[20:23], v12 offset:37888
    v_mfma_f32_16x16x32_bf16 v[76:79], a[124:127], v[44:47], v[76:79]
    s_waitcnt lgkmcnt(5)
    v_mfma_f32_16x16x32_bf16 v[64:67], a[128:131], v[48:51], v[64:67]
    ds_read_b128 v[24:27], v12 offset:38912
    v_mfma_f32_16x16x32_bf16 v[68:71], a[132:135], v[48:51], v[68:71]
    s_waitcnt lgkmcnt(5)
    v_mfma_f32_16x16x32_bf16 v[72:75], a[128:131], v[52:55], v[72:75]
    ds_read_b128 v[28:31], v12 offset:39936
    v_mfma_f32_16x16x32_bf16 v[76:79], a[132:135], v[52:55], v[76:79]
    s_waitcnt lgkmcnt(5)
    v_mfma_f32_16x16x32_bf16 v[64:67], a[136:139], v[56:59], v[64:67]
    ds_read_b128 v[32:35], v12 offset:40960
    v_mfma_f32_16x16x32_bf16 v[68:71], a[140:143], v[56:59], v[68:71]
    s_waitcnt lgkmcnt(5)
    v_mfma_f32_16x16x32_bf16 v[72:75], a[136:139], v[60:63], v[72:75]
    ds_read_b128 v[36:39], v12 offset:41984
    v_mfma_f32_16x16x32_bf16 v[76:79], a[140:143], v[60:63], v[76:79]
    s_waitcnt lgkmcnt(5)
    v_mfma_f32_16x16x32_bf16 v[64:67], a[144:147], v[16:19], v[64:67]
    ds_read_b128 v[40:43], v12 offset:43008
    v_mfma_f32_16x16x32_bf16 v[68:71], a[148:151], v[16:19], v[68:71]
    s_waitcnt lgkmcnt(5)
    v_mfma_f32_16x16x32_bf16 v[72:75], a[144:147], v[20:23], v[72:75]
    ds_read_b128 v[44:47], v12 offset:44032
    v_mfma_f32_16x16x32_bf16 v[76:79], a[148:151], v[20:23], v[76:79]
    s_waitcnt lgkmcnt(5)
    v_mfma_f32_16x16x32_bf16 v[64:67], a[152:155], v[24:27], v[64:67]
    ds_read_b128 v[48:51], v12 offset:45056
    v_mfma_f32_16x16x32_bf16 v[68:71], a[156:159], v[24:27], v[68:71]
    s_waitcnt lgkmcnt(5)
    v_mfma_f32_16x16x32_bf16 v[72:75], a[152:155], v[28:31], v[72:75]
    ds_read_b128 v[52:55], v12 offset:46080
    v_mfma_f32_16x16x32_bf16 v[76:79], a[156:159], v[28:31], v[76:79]
    s_waitcnt lgkmcnt(5)
    v_mfma_f32_16x16x32_bf16 v[64:67], a[160:163], v[32:35], v[64:67]
    ds_read_b128 v[56:59], v12 offset:47104
    v_mfma_f32_16x16x32_bf16 v[68:71], a[164:167], v[32:35], v[68:71]
    s_waitcnt lgkmcnt(5)
    v_mfma_f32_16x16x32_bf16 v[72:75], a[160:163], v[36:39], v[72:75]
    ds_read_b128 v[60:63], v12 offset:48128
    v_mfma_f32_16x16x32_bf16 v[76:79], a[164:167], v[36:39], v[76:79]
    s_waitcnt lgkmcnt(5)
    v_mfma_f32_16x16x32_bf16 v[64:67], a[168:171], v[40:43], v[64:67]
    s_add_u32 s4, s41, 2048
    v_mov_b32 v6, 0
    buffer_atomic_add v6, v15, s[8:11], s4 offen sc0
    ds_read_b128 v[16:19], v12 offset:49152
    v_mfma_f32_16x16x32_bf16 v[68:71], a[172:175], v[40:43], v[68:71]
    s_waitcnt lgkmcnt(5)
    v_mfma_f32_16x16x32_bf16 v[72:75], a[168:171], v[44:47], v[72:75]
    ds_read_b128 v[20:23], v12 offset:50176
    v_mfma_f32_16x16x32_bf16 v[76:79], a[172:175], v[44:47], v[76:79]
    s_waitcnt lgkmcnt(5)
    v_mfma_f32_16x16x32_bf16 v[64:67], a[176:179], v[48:51], v[64:67]
    ds_read_b128 v[24:27], v12 offset:51200
    v_mfma_f32_16x16x32_bf16 v[68:71], a[180:183], v[48:51], v[68:71]
    s_waitcnt lgkmcnt(5)
    v_mfma_f32_16x16x32_bf16 v[72:75], a[176:179], v[52:55], v[72:75]
    ds_read_b128 v[28:31], v12 offset:52224
    v_mfma_f32_16x16x32_bf16 v[76:79], a[180:183], v[52:55], v[76:79]
    s_waitcnt lgkmcnt(5)
    v_mfma_f32_16x16x32_bf16 v[64:67], a[184:187], v[56:59], v[64:67]
    ds_read_b128 v[32:35], v12 offset:53248
    v_mfma_f32_16x16x32_bf16 v[68:71], a[188:191], v[56:59], v[68:71]
    s_waitcnt lgkmcnt(5)
    v_mfma_f32_16x16x32_bf16 v[72:75], a[184:187], v[60:63], v[72:75]
    ds_read_b128 v[36:39], v12 offset:54272
    v_mfma_f32_16x16x32_bf16 v[76:79], a[188:191], v[60:63], v[76:79]
    s_waitcnt lgkmcnt(5)
    v_mfma_f32_16x16x32_bf16 v[64:67], a[192:195], v[16:19], v[64:67]
    ds_read_b128 v[40:43], v12 offset:55296
    v_mfma_f32_16x16x32_bf16 v[68:71], a[196:199], v[16:19], v[68:71]
    s_waitcnt lgkmcnt(5)
    v_mfma_f32_16x16x32_bf16 v[72:75], a[192:195], v[20:23], v[72:75]
    ds_read_b128 v[44:47], v12 offset:56320
    v_mfma_f32_16x16x32_bf16 v[76:79], a[196:199], v[20:23], v[76:79]
    s_waitcnt lgkmcnt(5)
    v_mfma_f32_16x16x32_bf16 v[64:67], a[200:203], v[24:27], v[64:67]
    ds_read_b128 v[48:51], v12 offset:57344
    v_mfma_f32_16x16x32_bf16 v[68:71], a[204:207], v[24:27], v[68:71]
    s_waitcnt lgkmcnt(5)
    v_mfma_f32_16x16x32_bf16 v[72:75], a[200:203], v[28:31], v[72:75]
    ds_read_b128 v[52:55], v12 offset:58368
    v_mfma_f32_16x16x32_bf16 v[76:79], a[204:207], v[28:31], v[76:79]
    s_waitcnt lgkmcnt(5)
    v_mfma_f32_16x16x32_bf16 v[64:67], a[208:211], v[32:35], v[64:67]
    ds_read_b128 v[56:59], v12 offset:59392
    v_mfma_f32_16x16x32_bf16 v[68:71], a[212:215], v[32:35], v[68:71]
    s_waitcnt lgkmcnt(5)
    v_mfma_f32_16x16x32_bf16 v[72:75], a[208:211], v[36:39], v[72:75]
    ds_read_b128 v[60:63], v12 offset:60416
    v_mfma_f32_16x16x32_bf16 v[76:79], a[212:215], v[36:39], v[76:79]
    s_waitcnt lgkmcnt(5)
    v_mfma_f32_16x16x32_bf16 v[64:67], a[216:219], v[40:43], v[64:67]
    ds_read_b128 v[16:19], v12 offset:61440
    v_mfma_f32_16x16x32_bf16 v[68:71], a[220:223], v[40:43], v[68:71]
    s_waitcnt lgkmcnt(5)
    v_mfma_f32_16x16x32_bf16 v[72:75], a[216:219], v[44:47], v[72:75]
    ds_read_b128 v[20:23], v12 offset:62464
    v_mfma_f32_16x16x32_bf16 v[76:79], a[220:223], v[44:47], v[76:79]
    s_waitcnt lgkmcnt(5)
    v_mfma_f32_16x16x32_bf16 v[64:67], a[224:227], v[48:51], v[64:67]
    ds_read_b128 v[24:27], v12 offset:63488
    v_mfma_f32_16x16x32_bf16 v[68:71], a[228:231], v[48:51], v[68:71]
    s_waitcnt lgkmcnt(5)
    v_mfma_f32_16x16x32_bf16 v[72:75], a[224:227], v[52:55], v[72:75]
    ds_read_b128 v[28:31], v12 offset:64512
    v_mfma_f32_16x16x32_bf16 v[76:79], a[228:231], v[52:55], v[76:79]
    s_waitcnt lgkmcnt(5)
    v_mfma_f32_16x16x32_bf16 v[64:67], a[232:235], v[56:59], v[64:67]
    v_mfma_f32_16x16x32_bf16 v[68:71], a[236:239], v[56:59], v[68:71]
    s_waitcnt lgkmcnt(4)
    v_mfma_f32_16x16x32_bf16 v[72:75], a[232:235], v[60:63], v[72:75]
    v_mfma_f32_16x16x32_bf16 v[76:79], a[236:239], v[60:63], v[76:79]
    s_waitcnt lgkmcnt(3)
    v_mfma_f32_16x16x32_bf16 v[64:67], a[240:243], v[16:19], v[64:67]
    v_mfma_f32_16x16x32_bf16 v[68:71], a[244:247], v[16:19], v[68:71]
    s_waitcnt lgkmcnt(2)
    v_mfma_f32_16x16x32_bf16 v[72:75], a[240:243], v[20:23], v[72:75]
    v_mfma_f32_16x16x32_bf16 v[76:79], a[244:247], v[20:23], v[76:79]
    s_waitcnt lgkmcnt(1)
    v_mfma_f32_16x16x32_bf16 v[64:67], a[248:251], v[24:27], v[64:67]
    v_mfma_f32_16x16x32_bf16 v[68:71], a[252:255], v[24:27], v[68:71]
    s_waitcnt lgkmcnt(0)
    v_mfma_f32_16x16x32_bf16 v[72:75], a[248:251], v[28:31], v[72:75]
    v_mfma_f32_16x16x32_bf16 v[76:79], a[252:255], v[28:31], v[76:79]
    s_branch L_so_T
L_sgu:
    s_and_b32 s41, s55, 2047
    s_add_u32 s41, s41, 243318784
    s_bfe_u32 s35, s55, 0xb000b
    s_add_u32 s35, s35, 243318784
    s_lshr_b32 s36, s55, 22
    v_lshrrev_b32 v4, 3, v1
    v_mul_lo_u32 v4, v4, s33
    v_and_b32 v5, 7, v1
    v_lshl_add_u32 v8, v5, 4, v4
    s_and_b32 s6, s21, 1
    s_lshl_b32 s4, s6, 6
    s_mul_i32 s4, s4, s33
    s_add_u32 s31, s31, s4
    v_lshrrev_b32 v4, 2, v1
    v_lshlrev_b32 v4, 7, v4
    v_and_b32 v5, 3, v1
    v_lshl_add_u32 v4, v5, 3, v4
    s_lshl_b32 s4, s21, 5
    s_add_u32 s5, s4, 16384
    v_add_u32 v9, s4, v4
    v_add_u32 v10, s5, v4
    s_lshl_b32 s40, s21, 13
    s_lshl_b32 s34, s33, 3
    s_mul_i32 s7, s33, 72
    s_add_u32 m0, s40, 0
    s_nop 0
    buffer_load_dwordx4 v8, s[12:15], s31 offen nt lds
    s_add_u32 s31, s31, s34
    s_add_u32 m0, s40, 1024
    s_nop 0
    buffer_load_dwordx4 v8, s[12:15], s31 offen nt lds
    s_add_u32 s31, s31, s34
    s_add_u32 m0, s40, 2048
    s_nop 0
    buffer_load_dwordx4 v8, s[12:15], s31 offen nt lds
    s_add_u32 s31, s31, s34
    s_add_u32 m0, s40, 3072
    s_nop 0
    buffer_load_dwordx4 v8, s[12:15], s31 offen nt lds
    s_add_u32 s31, s31, s34
    s_add_u32 m0, s40, 4096
    s_nop 0
    buffer_load_dwordx4 v8, s[12:15], s31 offen nt lds
    s_add_u32 s31, s31, s34
    s_add_u32 m0, s40, 5120
    s_nop 0
    buffer_load_dwordx4 v8, s[12:15], s31 offen nt lds
    s_add_u32 s31, s31, s34
    s_add_u32 m0, s40, 6144
    s_nop 0
    buffer_load_dwordx4 v8, s[12:15], s31 offen nt lds
    s_add_u32 s31, s31, s34
    s_add_u32 m0, s40, 7168
    s_nop 0
    buffer_load_dwordx4 v8, s[12:15], s31 offen nt lds
    s_add_u32 s31, s31, s7
    s_add_u32 m0, s40, 32768
    s_nop 0
    buffer_load_dwordx4 v8, s[12:15], s31 offen nt lds
    s_add_u32 s31, s31, s34
    s_add_u32 m0, s40, 33792
    s_nop 0
    buffer_load_dwordx4 v8, s[12:15], s31 offen nt lds
    s_add_u32 s31, s31, s34
    s_add_u32 m0, s40, 34816
    s_nop 0
    buffer_load_dwordx4 v8, s[12:15], s31 offen nt lds
    s_add_u32 s31, s31, s34
    s_add_u32 m0, s40, 35840
    s_nop 0
    buffer_load_dwordx4 v8, s[12:15], s31 offen nt lds
    s_add_u32 s31, s31, s34
    s_add_u32 m0, s40, 36864
    s_nop 0
    buffer_load_dwordx4 v8, s[12:15], s31 offen nt lds
    s_add_u32 s31, s31, s34
    s_add_u32 m0, s40, 37888
    s_nop 0
    buffer_load_dwordx4 v8, s[12:15], s31 offen nt lds
    s_add_u32 s31, s31, s34
    s_add_u32 m0, s40, 38912
    s_nop 0
    buffer_load_dwordx4 v8, s[12:15], s31 offen nt lds
    s_add_u32 s31, s31, s34
    s_add_u32 m0, s40, 39936
    s_nop 0
    buffer_load_dwordx4 v8, s[12:15], s31 offen nt lds
    s_add_u32 s31, s31, s7
    s_add_u32 m0, s40, 65536
    s_nop 0
    buffer_load_dwordx4 v8, s[12:15], s31 offen nt lds
    s_add_u32 s31, s31, s34
    s_add_u32 m0, s40, 66560
    s_nop 0
    buffer_load_dwordx4 v8, s[12:15], s31 offen nt lds
    s_add_u32 s31, s31, s34
    s_add_u32 m0, s40, 67584
    s_nop 0
    buffer_load_dwordx4 v8, s[12:15], s31 offen nt lds
    s_add_u32 s31, s31, s34
    s_add_u32 m0, s40, 68608
    s_nop 0
    buffer_load_dwordx4 v8, s[12:15], s31 offen nt lds
    s_add_u32 s31, s31, s34
    s_add_u32 m0, s40, 69632
    s_nop 0
    buffer_load_dwordx4 v8, s[12:15], s31 offen nt lds
    s_add_u32 s31, s31, s34
    s_add_u32 m0, s40, 70656
    s_nop 0
    buffer_load_dwordx4 v8, s[12:15], s31 offen nt lds
    s_add_u32 s31, s31, s34
    s_add_u32 m0, s40, 71680
    s_nop 0
    buffer_load_dwordx4 v8, s[12:15], s31 offen nt lds
    s_add_u32 s31, s31, s34
    s_add_u32 m0, s40, 72704
    s_nop 0
    buffer_load_dwordx4 v8, s[12:15], s31 offen nt lds
    s_add_u32 s31, s31, s7
    s_add_u32 m0, s40, 98304
    s_nop 0
    buffer_load_dwordx4 v8, s[12:15], s31 offen nt lds
    s_add_u32 s31, s31, s34
    s_add_u32 m0, s40, 99328
    s_nop 0
    buffer_load_dwordx4 v8, s[12:15], s31 offen nt lds
    s_add_u32 s31, s31, s34
    s_add_u32 m0, s40, 100352
    s_nop 0
    buffer_load_dwordx4 v8, s[12:15], s31 offen nt lds
    s_add_u32 s31, s31, s34
    s_add_u32 m0, s40, 101376
    s_nop 0
    buffer_load_dwordx4 v8, s[12:15], s31 offen nt lds
    s_add_u32 s31, s31, s34
    s_add_u32 m0, s40, 102400
    s_nop 0
    buffer_load_dwordx4 v8, s[12:15], s31 offen nt lds
    s_add_u32 s31, s31, s34
    s_add_u32 m0, s40, 103424
    s_nop 0
    buffer_load_dwordx4 v8, s[12:15], s31 offen nt lds
    s_add_u32 s31, s31, s34
    s_add_u32 m0, s40, 104448
    s_nop 0
    buffer_load_dwordx4 v8, s[12:15], s31 offen nt lds
    s_add_u32 s31, s31, s34
    s_add_u32 m0, s40, 105472
    s_nop 0
    buffer_load_dwordx4 v8, s[12:15], s31 offen nt lds
    s_add_u32 s31, s31, s7
    s_waitcnt vmcnt(24)
    s_barrier
    v_add_u32 v4, 0, v9
    v_add_u32 v5, 0, v10
    ds_read_b64_tr_b16 a[0:1], v4 offset:0
    ds_read_b64_tr_b16 a[2:3], v4 offset:2048
    ds_read_b64_tr_b16 a[4:5], v5 offset:0
    ds_read_b64_tr_b16 a[6:7], v5 offset:2048
    ds_read_b64_tr_b16 a[8:9], v4 offset:4096
    ds_read_b64_tr_b16 a[10:11], v4 offset:6144
    ds_read_b64_tr_b16 a[12:13], v5 offset:4096
    ds_read_b64_tr_b16 a[14:15], v5 offset:6144
    ds_read_b64_tr_b16 a[16:17], v4 offset:8192
    ds_read_b64_tr_b16 a[18:19], v4 offset:10240
    ds_read_b64_tr_b16 a[20:21], v5 offset:8192
    ds_read_b64_tr_b16 a[22:23], v5 offset:10240
    ds_read_b64_tr_b16 a[24:25], v4 offset:12288
    ds_read_b64_tr_b16 a[26:27], v4 offset:14336
    ds_read_b64_tr_b16 a[28:29], v5 offset:12288
    ds_read_b64_tr_b16 a[30:31], v5 offset:14336
    s_waitcnt lgkmcnt(0)
    s_barrier
    s_add_u32 m0, s40, 0
    s_nop 0
    buffer_load_dwordx4 v8, s[12:15], s31 offen nt lds
    s_add_u32 s31, s31, s34
    s_add_u32 m0, s40, 1024
    s_nop 0
    buffer_load_dwordx4 v8, s[12:15], s31 offen nt lds
    s_add_u32 s31, s31, s34
    s_add_u32 m0, s40, 2048
    s_nop 0
    buffer_load_dwordx4 v8, s[12:15], s31 offen nt lds
    s_add_u32 s31, s31, s34
    s_add_u32 m0, s40, 3072
    s_nop 0
    buffer_load_dwordx4 v8, s[12:15], s31 offen nt lds
    s_add_u32 s31, s31, s34
    s_add_u32 m0, s40, 4096
    s_nop 0
    buffer_load_dwordx4 v8, s[12:15], s31 offen nt lds
    s_add_u32 s31, s31, s34
    s_add_u32 m0, s40, 5120
    s_nop 0
    buffer_load_dwordx4 v8, s[12:15], s31 offen nt lds
    s_add_u32 s31, s31, s34
    s_add_u32 m0, s40, 6144
    s_nop 0
    buffer_load_dwordx4 v8, s[12:15], s31 offen nt lds
    s_add_u32 s31, s31, s34
    s_add_u32 m0, s40, 7168
    s_nop 0
    buffer_load_dwordx4 v8, s[12:15], s31 offen nt lds
    s_add_u32 s31, s31, s7
    s_waitcnt vmcnt(24)
    s_barrier
    v_add_u32 v4, 32768, v9
    v_add_u32 v5, 32768, v10
    ds_read_b64_tr_b16 a[32:33], v4 offset:0
    ds_read_b64_tr_b16 a[34:35], v4 offset:2048
    ds_read_b64_tr_b16 a[36:37], v5 offset:0
    ds_read_b64_tr_b16 a[38:39], v5 offset:2048
    ds_read_b64_tr_b16 a[40:41], v4 offset:4096
    ds_read_b64_tr_b16 a[42:43], v4 offset:6144
    ds_read_b64_tr_b16 a[44:45], v5 offset:4096
    ds_read_b64_tr_b16 a[46:47], v5 offset:6144
    ds_read_b64_tr_b16 a[48:49], v4 offset:8192
    ds_read_b64_tr_b16 a[50:51], v4 offset:10240
    ds_read_b64_tr_b16 a[52:53], v5 offset:8192
    ds_read_b64_tr_b16 a[54:55], v5 offset:10240
    ds_read_b64_tr_b16 a[56:57], v4 offset:12288
    ds_read_b64_tr_b16 a[58:59], v4 offset:14336
    ds_read_b64_tr_b16 a[60:61], v5 offset:12288
    ds_read_b64_tr_b16 a[62:63], v5 offset:14336
    s_waitcnt lgkmcnt(0)
    s_barrier
    s_add_u32 m0, s40, 32768
    s_nop 0
    buffer_load_dwordx4 v8, s[12:15], s31 offen nt lds
    s_add_u32 s31, s31, s34
    s_add_u32 m0, s40, 33792
    s_nop 0
    buffer_load_dwordx4 v8, s[12:15], s31 offen nt lds
    s_add_u32 s31, s31, s34
    s_add_u32 m0, s40, 34816
    s_nop 0
    buffer_load_dwordx4 v8, s[12:15], s31 offen nt lds
    s_add_u32 s31, s31, s34
    s_add_u32 m0, s40, 35840
    s_nop 0
    buffer_load_dwordx4 v8, s[12:15], s31 offen nt lds
    s_add_u32 s31, s31, s34
    s_add_u32 m0, s40, 36864
    s_nop 0
    buffer_load_dwordx4 v8, s[12:15], s31 offen nt lds
    s_add_u32 s31, s31, s34
    s_add_u32 m0, s40, 37888
    s_nop 0
    buffer_load_dwordx4 v8, s[12:15], s31 offen nt lds
    s_add_u32 s31, s31, s34
    s_add_u32 m0, s40, 38912
    s_nop 0
    buffer_load_dwordx4 v8, s[12:15], s31 offen nt lds
    s_add_u32 s31, s31, s34
    s_add_u32 m0, s40, 39936
    s_nop 0
    buffer_load_dwordx4 v8, s[12:15], s31 offen nt lds
    s_add_u32 s31, s31, s7
    s_waitcnt vmcnt(24)
    s_barrier
    v_add_u32 v4, 65536, v9
    v_add_u32 v5, 65536, v10
    ds_read_b64_tr_b16 a[64:65], v4 offset:0
    ds_read_b64_tr_b16 a[66:67], v4 offset:2048
    ds_read_b64_tr_b16 a[68:69], v5 offset:0
    ds_read_b64_tr_b16 a[70:71], v5 offset:2048
    ds_read_b64_tr_b16 a[72:73], v4 offset:4096
    ds_read_b64_tr_b16 a[74:75], v4 offset:6144
    ds_read_b64_tr_b16 a[76:77], v5 offset:4096
    ds_read_b64_tr_b16 a[78:79], v5 offset:6144
    ds_read_b64_tr_b16 a[80:81], v4 offset:8192
    ds_read_b64_tr_b16 a[82:83], v4 offset:10240
    ds_read_b64_tr_b16 a[84:85], v5 offset:8192
    ds_read_b64_tr_b16 a[86:87], v5 offset:10240
    ds_read_b64_tr_b16 a[88:89], v4 offset:12288
    ds_read_b64_tr_b16 a[90:91], v4 offset:14336
    ds_read_b64_tr_b16 a[92:93], v5 offset:12288
    ds_read_b64_tr_b16 a[94:95], v5 offset:14336
    s_waitcnt lgkmcnt(0)
    s_barrier
    s_add_u32 m0, s40, 65536
    s_nop 0
    buffer_load_dwordx4 v8, s[12:15], s31 offen nt lds
    s_add_u32 s31, s31, s34
    s_add_u32 m0, s40, 66560
    s_nop 0
    buffer_load_dwordx4 v8, s[12:15], s31 offen nt lds
    s_add_u32 s31, s31, s34
    s_add_u32 m0, s40, 67584
    s_nop 0
    buffer_load_dwordx4 v8, s[12:15], s31 offen nt lds
    s_add_u32 s31, s31, s34
    s_add_u32 m0, s40, 68608
    s_nop 0
    buffer_load_dwordx4 v8, s[12:15], s31 offen nt lds
    s_add_u32 s31, s31, s34
    s_add_u32 m0, s40, 69632
    s_nop 0
    buffer_load_dwordx4 v8, s[12:15], s31 offen nt lds
    s_add_u32 s31, s31, s34
    s_add_u32 m0, s40, 70656
    s_nop 0
    buffer_load_dwordx4 v8, s[12:15], s31 offen nt lds
    s_add_u32 s31, s31, s34
    s_add_u32 m0, s40, 71680
    s_nop 0
    buffer_load_dwordx4 v8, s[12:15], s31 offen nt lds
    s_add_u32 s31, s31, s34
    s_add_u32 m0, s40, 72704
    s_nop 0
    buffer_load_dwordx4 v8, s[12:15], s31 offen nt lds
    s_add_u32 s31, s31, s7
    s_waitcnt vmcnt(24)
    s_barrier
    v_add_u32 v4, 98304, v9
    v_add_u32 v5, 98304, v10
    ds_read_b64_tr_b16 a[96:97], v4 offset:0
    ds_read_b64_tr_b16 a[98:99], v4 offset:2048
    ds_read_b64_tr_b16 a[100:101], v5 offset:0
    ds_read_b64_tr_b16 a[102:103], v5 offset:2048
    ds_read_b64_tr_b16 a[104:105], v4 offset:4096
    ds_read_b64_tr_b16 a[106:107], v4 offset:6144
    ds_read_b64_tr_b16 a[108:109], v5 offset:4096
    ds_read_b64_tr_b16 a[110:111], v5 offset:6144
    ds_read_b64_tr_b16 a[112:113], v4 offset:8192
    ds_read_b64_tr_b16 a[114:115], v4 offset:10240
    ds_read_b64_tr_b16 a[116:117], v5 offset:8192
    ds_read_b64_tr_b16 a[118:119], v5 offset:10240
    ds_read_b64_tr_b16 a[120:121], v4 offset:12288
    ds_read_b64_tr_b16 a[122:123], v4 offset:14336
    ds_read_b64_tr_b16 a[124:125], v5 offset:12288
    ds_read_b64_tr_b16 a[126:127], v5 offset:14336
    s_waitcnt lgkmcnt(0)
    s_barrier
    s_add_u32 m0, s40, 98304
    s_nop 0
    buffer_load_dwordx4 v8, s[12:15], s31 offen nt lds
    s_add_u32 s31, s31, s34
    s_add_u32 m0, s40, 99328
    s_nop 0
    buffer_load_dwordx4 v8, s[12:15], s31 offen nt lds
    s_add_u32 s31, s31, s34
    s_add_u32 m0, s40, 100352
    s_nop 0
    buffer_load_dwordx4 v8, s[12:15], s31 offen nt lds
    s_add_u32 s31, s31, s34
    s_add_u32 m0, s40, 101376
    s_nop 0
    buffer_load_dwordx4 v8, s[12:15], s31 offen nt lds
    s_add_u32 s31, s31, s34
    s_add_u32 m0, s40, 102400
    s_nop 0
    buffer_load_dwordx4 v8, s[12:15], s31 offen nt lds
    s_add_u32 s31, s31, s34
    s_add_u32 m0, s40, 103424
    s_nop 0
    buffer_load_dwordx4 v8, s[12:15], s31 offen nt lds
    s_add_u32 s31, s31, s34
    s_add_u32 m0, s40, 104448
    s_nop 0
    buffer_load_dwordx4 v8, s[12:15], s31 offen nt lds
    s_add_u32 s31, s31, s34
    s_add_u32 m0, s40, 105472
    s_nop 0
    buffer_load_dwordx4 v8, s[12:15], s31 offen nt lds
    s_add_u32 s31, s31, s7
    s_waitcnt vmcnt(24)
    s_barrier
    v_add_u32 v4, 0, v9
    v_add_u32 v5, 0, v10
    ds_read_b64_tr_b16 a[128:129], v4 offset:0
    ds_read_b64_tr_b16 a[130:131], v4 offset:2048
    ds_read_b64_tr_b16 a[132:133], v5 offset:0
    ds_read_b64_tr_b16 a[134:135], v5 offset:2048
    ds_read_b64_tr_b16 a[136:137], v4 offset:4096
    ds_read_b64_tr_b16 a[138:139], v4 offset:6144
    ds_read_b64_tr_b16 a[140:141], v5 offset:4096
    ds_read_b64_tr_b16 a[142:143], v5 offset:6144
    ds_read_b64_tr_b16 a[144:145], v4 offset:8192
    ds_read_b64_tr_b16 a[146:147], v4 offset:10240
    ds_read_b64_tr_b16 a[148:149], v5 offset:8192
    ds_read_b64_tr_b16 a[150:151], v5 offset:10240
    ds_read_b64_tr_b16 a[152:153], v4 offset:12288
    ds_read_b64_tr_b16 a[154:155], v4 offset:14336
    ds_read_b64_tr_b16 a[156:157], v5 offset:12288
    ds_read_b64_tr_b16 a[158:159], v5 offset:14336
    s_waitcnt lgkmcnt(0)
    s_barrier
    s_waitcnt vmcnt(16)
    s_barrier
    v_add_u32 v4, 32768, v9
    v_add_u32 v5, 32768, v10
    ds_read_b64_tr_b16 a[160:161], v4 offset:0
    ds_read_b64_tr_b16 a[162:163], v4 offset:2048
    ds_read_b64_tr_b16 a[164:165], v5 offset:0
    ds_read_b64_tr_b16 a[166:167], v5 offset:2048
    ds_read_b64_tr_b16 a[168:169], v4 offset:4096
    ds_read_b64_tr_b16 a[170:171], v4 offset:6144
    ds_read_b64_tr_b16 a[172:173], v5 offset:4096
    ds_read_b64_tr_b16 a[174:175], v5 offset:6144
    ds_read_b64_tr_b16 a[176:177], v4 offset:8192
    ds_read_b64_tr_b16 a[178:179], v4 offset:10240
    ds_read_b64_tr_b16 a[180:181], v5 offset:8192
    ds_read_b64_tr_b16 a[182:183], v5 offset:10240
    ds_read_b64_tr_b16 a[184:185], v4 offset:12288
    ds_read_b64_tr_b16 a[186:187], v4 offset:14336
    ds_read_b64_tr_b16 a[188:189], v5 offset:12288
    ds_read_b64_tr_b16 a[190:191], v5 offset:14336
    s_waitcnt lgkmcnt(0)
    s_barrier
    s_waitcnt vmcnt(8)
    s_barrier
    v_add_u32 v4, 65536, v9
    v_add_u32 v5, 65536, v10
    ds_read_b64_tr_b16 a[192:193], v4 offset:0
    ds_read_b64_tr_b16 a[194:195], v4 offset:2048
    ds_read_b64_tr_b16 a[196:197], v5 offset:0
    ds_read_b64_tr_b16 a[198:199], v5 offset:2048
    ds_read_b64_tr_b16 a[200:201], v4 offset:4096
    ds_read_b64_tr_b16 a[202:203], v4 offset:6144
    ds_read_b64_tr_b16 a[204:205], v5 offset:4096
    ds_read_b64_tr_b16 a[206:207], v5 offset:6144
    ds_read_b64_tr_b16 a[208:209], v4 offset:8192
    ds_read_b64_tr_b16 a[210:211], v4 offset:10240
    ds_read_b64_tr_b16 a[212:213], v5 offset:8192
    ds_read_b64_tr_b16 a[214:215], v5 offset:10240
    ds_read_b64_tr_b16 a[216:217], v4 offset:12288
    ds_read_b64_tr_b16 a[218:219], v4 offset:14336
    ds_read_b64_tr_b16 a[220:221], v5 offset:12288
    ds_read_b64_tr_b16 a[222:223], v5 offset:14336
    s_waitcnt lgkmcnt(0)
    s_barrier
    s_waitcnt vmcnt(0)
    s_barrier
    v_add_u32 v4, 98304, v9
    v_add_u32 v5, 98304, v10
    ds_read_b64_tr_b16 a[224:225], v4 offset:0
    ds_read_b64_tr_b16 a[226:227], v4 offset:2048
    ds_read_b64_tr_b16 a[228:229], v5 offset:0
    ds_read_b64_tr_b16 a[230:231], v5 offset:2048
    ds_read_b64_tr_b16 a[232:233], v4 offset:4096
    ds_read_b64_tr_b16 a[234:235], v4 offset:6144
    ds_read_b64_tr_b16 a[236:237], v5 offset:4096
    ds_read_b64_tr_b16 a[238:239], v5 offset:6144
    ds_read_b64_tr_b16 a[240:241], v4 offset:8192
    ds_read_b64_tr_b16 a[242:243], v4 offset:10240
    ds_read_b64_tr_b16 a[244:245], v5 offset:8192
    ds_read_b64_tr_b16 a[246:247], v5 offset:10240
    ds_read_b64_tr_b16 a[248:249], v4 offset:12288
    ds_read_b64_tr_b16 a[250:251], v4 offset:14336
    ds_read_b64_tr_b16 a[252:253], v5 offset:12288
    ds_read_b64_tr_b16 a[254:255], v5 offset:14336
    s_waitcnt lgkmcnt(0)
    s_barrier
    s_mul_i32 s4, s6, s32
    s_lshr_b32 s5, s21, 1
    s_lshl_b32 s5, s5, 10
    s_add_u32 s4, s4, s5
    v_add_u32 v11, s4, v2
    s_lshl_b32 s40, s21, 10
    v_lshlrev_b32 v14, 3, v1
    v_mov_b32 v12, v2
    v_mov_b32 v13, 159232
    s_lshl_b32 s45, s32, 1
    s_lshl_b32 s46, s38, 1
    s_lshl_b32 s4, s21, 9
    s_add_u32 s37, s37, s4
    s_mov_b32 s43, 0
    s_cmp_eq_u32 s21, 0
    s_cselect_b32 s4, 0, 0x80000000
    v_mov_b32 v15, 0x80000000
    v_writelane_b32 v15, s4, 0
    s_add_u32 s4, s4, 2048
    v_writelane_b32 v15, s4, 1
    v_lshl_add_u32 v13, v1, 2, v13
    s_and_b32 s4, s49, 15
    s_lshr_b32 s5, s49, 4
    s_mul_i32 s5, s5, s21
    s_add_u32 s4, s4, s5
    s_sub_u32 s4, 15, s4
    s_cselect_b32 s5, 0x80000000, 0
    s_lshl_b32 s4, s4, 11
    s_and_b32 s4, s4, 0xffff
    s_or_b32 s4, s4, s5
    v_and_b32 v4, 15, v1
    v_lshlrev_b32 v4, 6, v4
    v_lshrrev_b32 v5, 5, v1
    v_lshl_add_u32 v4, v5, 10, v4
    v_bfe_u32 v5, v1, 4, 1
    v_mul_lo_u32 v5, v5, s32
    v_add3_u32 v3, v4, v5, s4
L_sgu_L:
    s_cmp_lg_u32 s21, 0
    s_cbranch_scc1 L_sgu_Lw
    v_mov_b32 v4, 0
L_sgu_p:
    buffer_load_dword v5, v4, s[8:11], s41 offen sc1
    s_sub_u32 s62, s62, 1
    s_cbranch_scc1 L_w_fail
    s_waitcnt vmcnt(0)
    v_cmp_gt_u32 vcc, s36, v5
    s_cbranch_vccz L_sgu_p_ok
    s_sleep 1
    s_branch L_sgu_p
L_sgu_p_ok:
L_sgu_Lw:
    s_barrier
    s_add_u32 m0, s40, 0
    s_add_u32 s47, s30, 0
    buffer_load_dwordx4 v11, s[8:11], s47 offen sc1 lds
    s_add_u32 m0, s40, 4096
    s_add_u32 s47, s30, 2048
    buffer_load_dwordx4 v11, s[8:11], s47 offen sc1 lds
    s_add_u32 m0, s40, 8192
    s_add_u32 s47, s30, 4096
    buffer_load_dwordx4 v11, s[8:11], s47 offen sc1 lds
    s_add_u32 m0, s40, 12288
    s_add_u32 s47, s30, 6144
    buffer_load_dwordx4 v11, s[8:11], s47 offen sc1 lds
    s_add_u32 m0, s40, 16384
    s_add_u32 s47, s30, 8192
    buffer_load_dwordx4 v11, s[8:11], s47 offen sc1 lds
    s_add_u32 m0, s40, 20480
    s_add_u32 s47, s30, 10240
    buffer_load_dwordx4 v11, s[8:11], s47 offen sc1 lds
    s_add_u32 m0, s40, 24576
    s_add_u32 s47, s30, 12288
    buffer_load_dwordx4 v11, s[8:11], s47 offen sc1 lds
    s_add_u32 m0, s40, 28672
    s_add_u32 s47, s30, 14336
    buffer_load_dwordx4 v11, s[8:11], s47 offen sc1 lds
    s_add_u32 m0, s40, 32768
    s_add_u32 s47, s30, 16384
    buffer_load_dwordx4 v11, s[8:11], s47 offen sc1 lds
    s_add_u32 m0, s40, 36864
    s_add_u32 s47, s30, 18432
    buffer_load_dwordx4 v11, s[8:11], s47 offen sc1 lds
    s_add_u32 m0, s40, 40960
    s_add_u32 s47, s30, 20480
    buffer_load_dwordx4 v11, s[8:11], s47 offen sc1 lds
    s_add_u32 m0, s40, 45056
    s_add_u32 s47, s30, 22528
    buffer_load_dwordx4 v11, s[8:11], s47 offen sc1 lds
    s_add_u32 m0, s40, 49152
    s_add_u32 s47, s30, 24576
    buffer_load_dwordx4 v11, s[8:11], s47 offen sc1 lds
    s_add_u32 m0, s40, 53248
    s_add_u32 s47, s30, 26624
    buffer_load_dwordx4 v11, s[8:11], s47 offen sc1 lds
    s_add_u32 m0, s40, 57344
    s_add_u32 s47, s30, 28672
    buffer_load_dwordx4 v11, s[8:11], s47 offen sc1 lds
    s_add_u32 m0, s40, 61440
    s_add_u32 s47, s30, 30720
    buffer_load_dwordx4 v11, s[8:11], s47 offen sc1 lds
    s_xor_b32 s40, s40, 65536
    s_add_u32 s30, s30, s45
L_sgu_L2:
    s_waitcnt vmcnt(12)
    s_barrier
    ds_read_b128 v[16:19], v12 offset:0
    ds_read_b128 v[20:23], v12 offset:1024
    ds_read_b128 v[24:27], v12 offset:2048
    ds_read_b128 v[28:31], v12 offset:3072
    ds_read_b128 v[32:35], v12 offset:4096
    ds_read_b128 v[36:39], v12 offset:5120
    s_waitcnt lgkmcnt(5)
    v_mfma_f32_16x16x32_bf16 v[64:67], a[0:3], v[16:19], 0
    ds_read_b128 v[40:43], v12 offset:6144
    v_mfma_f32_16x16x32_bf16 v[68:71], a[4:7], v[16:19], 0
    s_waitcnt lgkmcnt(5)
    v_mfma_f32_16x16x32_bf16 v[72:75], a[0:3], v[20:23], 0
    ds_read_b128 v[44:47], v12 offset:7168
    v_mfma_f32_16x16x32_bf16 v[76:79], a[4:7], v[20:23], 0
    s_waitcnt lgkmcnt(5)
    v_mfma_f32_16x16x32_bf16 v[64:67], a[8:11], v[24:27], v[64:67]
    ds_read_b128 v[48:51], v12 offset:8192
    v_mfma_f32_16x16x32_bf16 v[68:71], a[12:15], v[24:27], v[68:71]
    s_waitcnt lgkmcnt(5)
    v_mfma_f32_16x16x32_bf16 v[72:75], a[8:11], v[28:31], v[72:75]
    ds_read_b128 v[52:55], v12 offset:9216
    v_mfma_f32_16x16x32_bf16 v[76:79], a[12:15], v[28:31], v[76:79]
    s_waitcnt lgkmcnt(5)
    v_mfma_f32_16x16x32_bf16 v[64:67], a[16:19], v[32:35], v[64:67]
    ds_read_b128 v[56:59], v12 offset:10240
    v_mfma_f32_16x16x32_bf16 v[68:71], a[20:23], v[32:35], v[68:71]
    s_waitcnt lgkmcnt(5)
    v_mfma_f32_16x16x32_bf16 v[72:75], a[16:19], v[36:39], v[72:75]
    ds_read_b128 v[60:63], v12 offset:11264
    v_mfma_f32_16x16x32_bf16 v[76:79], a[20:23], v[36:39], v[76:79]
    s_waitcnt lgkmcnt(5)
    v_mfma_f32_16x16x32_bf16 v[64:67], a[24:27], v[40:43], v[64:67]
    ds_read_b128 v[16:19], v12 offset:12288
    v_mfma_f32_16x16x32_bf16 v[68:71], a[28:31], v[40:43], v[68:71]
    s_waitcnt lgkmcnt(5)
    v_mfma_f32_16x16x32_bf16 v[72:75], a[24:27], v[44:47], v[72:75]
    ds_read_b128 v[20:23], v12 offset:13312
    v_mfma_f32_16x16x32_bf16 v[76:79], a[28:31], v[44:47], v[76:79]
    s_waitcnt lgkmcnt(5)
    v_mfma_f32_16x16x32_bf16 v[64:67], a[32:35], v[48:51], v[64:67]
    ds_read_b128 v[24:27], v12 offset:14336
    v_mfma_f32_16x16x32_bf16 v[68:71], a[36:39], v[48:51], v[68:71]
    s_waitcnt lgkmcnt(5)
    v_mfma_f32_16x16x32_bf16 v[72:75], a[32:35], v[52:55], v[72:75]
    ds_read_b128 v[28:31], v12 offset:15360
    v_mfma_f32_16x16x32_bf16 v[76:79], a[36:39], v[52:55], v[76:79]
    s_waitcnt lgkmcnt(5)
    v_mfma_f32_16x16x32_bf16 v[64:67], a[40:43], v[56:59], v[64:67]
    s_waitcnt vmcnt(8)
    s_barrier
    ds_read_b128 v[32:35], v12 offset:16384
    v_mfma_f32_16x16x32_bf16 v[68:71], a[44:47], v[56:59], v[68:71]
    s_waitcnt lgkmcnt(5)
    v_mfma_f32_16x16x32_bf16 v[72:75], a[40:43], v[60:63], v[72:75]
    ds_read_b128 v[36:39], v12 offset:17408
    v_mfma_f32_16x16x32_bf16 v[76:79], a[44:47], v[60:63], v[76:79]
    s_waitcnt lgkmcnt(5)
    v_mfma_f32_16x16x32_bf16 v[64:67], a[48:51], v[16:19], v[64:67]
    ds_read_b128 v[40:43], v12 offset:18432
    v_mfma_f32_16x16x32_bf16 v[68:71], a[52:55], v[16:19], v[68:71]
    s_waitcnt lgkmcnt(5)
    v_mfma_f32_16x16x32_bf16 v[72:75], a[48:51], v[20:23], v[72:75]
    ds_read_b128 v[44:47], v12 offset:19456
    v_mfma_f32_16x16x32_bf16 v[76:79], a[52:55], v[20:23], v[76:79]
    s_waitcnt lgkmcnt(5)
    v_mfma_f32_16x16x32_bf16 v[64:67], a[56:59], v[24:27], v[64:67]
    ds_read_b128 v[48:51], v12 offset:20480
    v_mfma_f32_16x16x32_bf16 v[68:71], a[60:63], v[24:27], v[68:71]
    s_waitcnt lgkmcnt(5)
    v_mfma_f32_16x16x32_bf16 v[72:75], a[56:59], v[28:31], v[72:75]
    ds_read_b128 v[52:55], v12 offset:21504
    v_mfma_f32_16x16x32_bf16 v[76:79], a[60:63], v[28:31], v[76:79]
    s_waitcnt lgkmcnt(5)
    v_mfma_f32_16x16x32_bf16 v[64:67], a[64:67], v[32:35], v[64:67]
    ds_read_b128 v[56:59], v12 offset:22528
    v_mfma_f32_16x16x32_bf16 v[68:71], a[68:71], v[32:35], v[68:71]
    s_waitcnt lgkmcnt(5)
    v_mfma_f32_16x16x32_bf16 v[72:75], a[64:67], v[36:39], v[72:75]
    ds_read_b128 v[60:63], v12 offset:23552
    v_mfma_f32_16x16x32_bf16 v[76:79], a[68:71], v[36:39], v[76:79]
    s_waitcnt lgkmcnt(5)
    v_mfma_f32_16x16x32_bf16 v[64:67], a[72:75], v[40:43], v[64:67]
    ds_read_b128 v[16:19], v12 offset:24576
    v_mfma_f32_16x16x32_bf16 v[68:71], a[76:79], v[40:43], v[68:71]
    s_waitcnt lgkmcnt(5)
    v_mfma_f32_16x16x32_bf16 v[72:75], a[72:75], v[44:47], v[72:75]
    ds_read_b128 v[20:23], v12 offset:25600
    v_mfma_f32_16x16x32_bf16 v[76:79], a[76:79], v[44:47], v[76:79]
    s_waitcnt lgkmcnt(5)
    v_mfma_f32_16x16x32_bf16 v[64:67], a[80:83], v[48:51], v[64:67]
    ds_read_b128 v[24:27], v12 offset:26624
    v_mfma_f32_16x16x32_bf16 v[68:71], a[84:87], v[48:51], v[68:71]
    s_waitcnt lgkmcnt(5)
    v_mfma_f32_16x16x32_bf16 v[72:75], a[80:83], v[52:55], v[72:75]
    ds_read_b128 v[28:31], v12 offset:27648
    v_mfma_f32_16x16x32_bf16 v[76:79], a[84:87], v[52:55], v[76:79]
    s_waitcnt lgkmcnt(5)
    v_mfma_f32_16x16x32_bf16 v[64:67], a[88:91], v[56:59], v[64:67]
    ds_read_b128 v[32:35], v12 offset:28672
    v_mfma_f32_16x16x32_bf16 v[68:71], a[92:95], v[56:59], v[68:71]
    s_waitcnt lgkmcnt(5)
    v_mfma_f32_16x16x32_bf16 v[72:75], a[88:91], v[60:63], v[72:75]
    ds_read_b128 v[36:39], v12 offset:29696
    v_mfma_f32_16x16x32_bf16 v[76:79], a[92:95], v[60:63], v[76:79]
    s_waitcnt lgkmcnt(5)
    v_mfma_f32_16x16x32_bf16 v[64:67], a[96:99], v[16:19], v[64:67]
    ds_read_b128 v[40:43], v12 offset:30720
    v_mfma_f32_16x16x32_bf16 v[68:71], a[100:103], v[16:19], v[68:71]
    s_waitcnt lgkmcnt(5)
    v_mfma_f32_16x16x32_bf16 v[72:75], a[96:99], v[20:23], v[72:75]
    ds_read_b128 v[44:47], v12 offset:31744
    v_mfma_f32_16x16x32_bf16 v[76:79], a[100:103], v[20:23], v[76:79]
    s_waitcnt lgkmcnt(5)
    v_mfma_f32_16x16x32_bf16 v[64:67], a[104:107], v[24:27], v[64:67]
    s_waitcnt vmcnt(4)
    s_barrier
    ds_read_b128 v[48:51], v12 offset:32768
    v_mfma_f32_16x16x32_bf16 v[68:71], a[108:111], v[24:27], v[68:71]
    s_waitcnt lgkmcnt(5)
    v_mfma_f32_16x16x32_bf16 v[72:75], a[104:107], v[28:31], v[72:75]
    ds_read_b128 v[52:55], v12 offset:33792
    v_mfma_f32_16x16x32_bf16 v[76:79], a[108:111], v[28:31], v[76:79]
    s_waitcnt lgkmcnt(5)
    v_mfma_f32_16x16x32_bf16 v[64:67], a[112:115], v[32:35], v[64:67]
    ds_read_b128 v[56:59], v12 offset:34816
    v_mfma_f32_16x16x32_bf16 v[68:71], a[116:119], v[32:35], v[68:71]
    s_waitcnt lgkmcnt(5)
    v_mfma_f32_16x16x32_bf16 v[72:75], a[112:115], v[36:39], v[72:75]
    ds_read_b128 v[60:63], v12 offset:35840
    v_mfma_f32_16x16x32_bf16 v[76:79], a[116:119], v[36:39], v[76:79]
    s_waitcnt lgkmcnt(5)
    v_mfma_f32_16x16x32_bf16 v[64:67], a[120:123], v[40:43], v[64:67]
    ds_read_b128 v[16:19], v12 offset:36864
    v_mfma_f32_16x16x32_bf16 v[68:71], a[124:127], v[40:43], v[68:71]
    s_waitcnt lgkmcnt(5)
    v_mfma_f32_16x16x32_bf16 v[72:75], a[120:123], v[44:47], v[72:75]
    ds_read_b128 v[20:23], v12 offset:37888
    v_mfma_f32_16x16x32_bf16 v[76:79], a[124:127], v[44:47], v[76:79]
    s_waitcnt lgkmcnt(5)
    v_mfma_f32_16x16x32_bf16 v[64:67], a[128:131], v[48:51], v[64:67]
    ds_read_b128 v[24:27], v12 offset:38912
    v_mfma_f32_16x16x32_bf16 v[68:71], a[132:135], v[48:51], v[68:71]
    s_waitcnt lgkmcnt(5)
    v_mfma_f32_16x16x32_bf16 v[72:75], a[128:131], v[52:55], v[72:75]
    ds_read_b128 v[28:31], v12 offset:39936
    v_mfma_f32_16x16x32_bf16 v[76:79], a[132:135], v[52:55], v[76:79]
    s_waitcnt lgkmcnt(5)
    v_mfma_f32_16x16x32_bf16 v[64:67], a[136:139], v[56:59], v[64:67]
    ds_read_b128 v[32:35], v12 offset:40960
    v_mfma_f32_16x16x32_bf16 v[68:71], a[140:143], v[56:59], v[68:71]
    s_waitcnt lgkmcnt(5)
    v_mfma_f32_16x16x32_bf16 v[72:75], a[136:139], v[60:63], v[72:75]
    ds_read_b128 v[36:39], v12 offset:41984
    v_mfma_f32_16x16x32_bf16 v[76:79], a[140:143], v[60:63], v[76:79]
    s_waitcnt lgkmcnt(5)
    v_mfma_f32_16x16x32_bf16 v[64:67], a[144:147], v[16:19], v[64:67]
    ds_read_b128 v[40:43], v12 offset:43008
    v_mfma_f32_16x16x32_bf16 v[68:71], a[148:151], v[16:19], v[68:71]
    s_waitcnt lgkmcnt(5)
    v_mfma_f32_16x16x32_bf16 v[72:75], a[144:147], v[20:23], v[72:75]
    ds_read_b128 v[44:47], v12 offset:44032
    v_mfma_f32_16x16x32_bf16 v[76:79], a[148:151], v[20:23], v[76:79]
    s_waitcnt lgkmcnt(5)
    v_mfma_f32_16x16x32_bf16 v[64:67], a[152:155], v[24:27], v[64:67]
    ds_read_b128 v[48:51], v12 offset:45056
    v_mfma_f32_16x16x32_bf16 v[68:71], a[156:159], v[24:27], v[68:71]
    s_waitcnt lgkmcnt(5)
    v_mfma_f32_16x16x32_bf16 v[72:75], a[152:155], v[28:31], v[72:75]
    ds_read_b128 v[52:55], v12 offset:46080
    v_mfma_f32_16x16x32_bf16 v[76:79], a[156:159], v[28:31], v[76:79]
    s_waitcnt lgkmcnt(5)
    v_mfma_f32_16x16x32_bf16 v[64:67], a[160:163], v[32:35], v[64:67]
    ds_read_b128 v[56:59], v12 offset:47104
    v_mfma_f32_16x16x32_bf16 v[68:71], a[164:167], v[32:35], v[68:71]
    s_waitcnt lgkmcnt(5)
    v_mfma_f32_16x16x32_bf16 v[72:75], a[160:163], v[36:39], v[72:75]
    ds_read_b128 v[60:63], v12 offset:48128
    v_mfma_f32_16x16x32_bf16 v[76:79], a[164:167], v[36:39], v[76:79]
    s_waitcnt lgkmcnt(5)
    v_mfma_f32_16x16x32_bf16 v[64:67], a[168:171], v[40:43], v[64:67]
    s_waitcnt vmcnt(0)
    s_barrier
    s_add_u32 s4, s41, 2048
    buffer_load_dword v6, v15, s[8:11], s4 offen sc1
    ds_read_b128 v[16:19], v12 offset:49152
    v_mfma_f32_16x16x32_bf16 v[68:71], a[172:175], v[40:43], v[68:71]
    s_waitcnt lgkmcnt(5)
    v_mfma_f32_16x16x32_bf16 v[72:75], a[168:171], v[44:47], v[72:75]
    ds_read_b128 v[20:23], v12 offset:50176
    v_mfma_f32_16x16x32_bf16 v[76:79], a[172:175], v[44:47], v[76:79]
    s_waitcnt lgkmcnt(5)
    v_mfma_f32_16x16x32_bf16 v[64:67], a[176:179], v[48:51], v[64:67]
    ds_read_b128 v[24:27], v12 offset:51200
    v_mfma_f32_16x16x32_bf16 v[68:71], a[180:183], v[48:51], v[68:71]
    s_waitcnt lgkmcnt(5)
    v_mfma_f32_16x16x32_bf16 v[72:75], a[176:179], v[52:55], v[72:75]
    ds_read_b128 v[28:31], v12 offset:52224
    v_mfma_f32_16x16x32_bf16 v[76:79], a[180:183], v[52:55], v[76:79]
    s_waitcnt lgkmcnt(5)
    v_mfma_f32_16x16x32_bf16 v[64:67], a[184:187], v[56:59], v[64:67]
    ds_read_b128 v[32:35], v12 offset:53248
    v_mfma_f32_16x16x32_bf16 v[68:71], a[188:191], v[56:59], v[68:71]
    s_waitcnt lgkmcnt(5)
    v_mfma_f32_16x16x32_bf16 v[72:75], a[184:187], v[60:63], v[72:75]
    ds_read_b128 v[36:39], v12 offset:54272
    v_mfma_f32_16x16x32_bf16 v[76:79], a[188:191], v[60:63], v[76:79]
    s_waitcnt lgkmcnt(5)
    v_mfma_f32_16x16x32_bf16 v[64:67], a[192:195], v[16:19], v[64:67]
    ds_read_b128 v[40:43], v12 offset:55296
    v_mfma_f32_16x16x32_bf16 v[68:71], a[196:199], v[16:19], v[68:71]
    s_waitcnt lgkmcnt(5)
    v_mfma_f32_16x16x32_bf16 v[72:75], a[192:195], v[20:23], v[72:75]
    ds_read_b128 v[44:47], v12 offset:56320
    v_mfma_f32_16x16x32_bf16 v[76:79], a[196:199], v[20:23], v[76:79]
    s_waitcnt lgkmcnt(5)
    v_mfma_f32_16x16x32_bf16 v[64:67], a[200:203], v[24:27], v[64:67]
    ds_read_b128 v[48:51], v12 offset:57344
    v_mfma_f32_16x16x32_bf16 v[68:71], a[204:207], v[24:27], v[68:71]
    s_waitcnt lgkmcnt(5)
    v_mfma_f32_16x16x32_bf16 v[72:75], a[200:203], v[28:31], v[72:75]
    ds_read_b128 v[52:55], v12 offset:58368
    v_mfma_f32_16x16x32_bf16 v[76:79], a[204:207], v[28:31], v[76:79]
    s_waitcnt lgkmcnt(5)
    v_mfma_f32_16x16x32_bf16 v[64:67], a[208:211], v[32:35], v[64:67]
    ds_read_b128 v[56:59], v12 offset:59392
    v_mfma_f32_16x16x32_bf16 v[68:71], a[212:215], v[32:35], v[68:71]
    s_waitcnt lgkmcnt(5)
    v_mfma_f32_16x16x32_bf16 v[72:75], a[208:211], v[36:39], v[72:75]
    ds_read_b128 v[60:63], v12 offset:60416
    v_mfma_f32_16x16x32_bf16 v[76:79], a[212:215], v[36:39], v[76:79]
    s_waitcnt lgkmcnt(5)
    v_mfma_f32_16x16x32_bf16 v[64:67], a[216:219], v[40:43], v[64:67]
    ds_read_b128 v[16:19], v12 offset:61440
    v_mfma_f32_16x16x32_bf16 v[68:71], a[220:223], v[40:43], v[68:71]
    s_waitcnt lgkmcnt(5)
    v_mfma_f32_16x16x32_bf16 v[72:75], a[216:219], v[44:47], v[72:75]
    ds_read_b128 v[20:23], v12 offset:62464
    v_mfma_f32_16x16x32_bf16 v[76:79], a[220:223], v[44:47], v[76:79]
    s_waitcnt lgkmcnt(5)
    v_mfma_f32_16x16x32_bf16 v[64:67], a[224:227], v[48:51], v[64:67]
    ds_read_b128 v[24:27], v12 offset:63488
    v_mfma_f32_16x16x32_bf16 v[68:71], a[228:231], v[48:51], v[68:71]
    s_waitcnt lgkmcnt(5)
    v_mfma_f32_16x16x32_bf16 v[72:75], a[224:227], v[52:55], v[72:75]
    ds_read_b128 v[28:31], v12 offset:64512
    v_mfma_f32_16x16x32_bf16 v[76:79], a[228:231], v[52:55], v[76:79]
    s_waitcnt lgkmcnt(5)
    v_mfma_f32_16x16x32_bf16 v[64:67], a[232:235], v[56:59], v[64:67]
    v_mfma_f32_16x16x32_bf16 v[68:71], a[236:239], v[56:59], v[68:71]
    s_waitcnt lgkmcnt(4)
    v_mfma_f32_16x16x32_bf16 v[72:75], a[232:235], v[60:63], v[72:75]
    v_mfma_f32_16x16x32_bf16 v[76:79], a[236:239], v[60:63], v[76:79]
    s_waitcnt lgkmcnt(3)
    v_mfma_f32_16x16x32_bf16 v[64:67], a[240:243], v[16:19], v[64:67]
    v_mfma_f32_16x16x32_bf16 v[68:71], a[244:247], v[16:19], v[68:71]
    s_waitcnt lgkmcnt(2)
    v_mfma_f32_16x16x32_bf16 v[72:75], a[240:243], v[20:23], v[72:75]
    v_mfma_f32_16x16x32_bf16 v[76:79], a[244:247], v[20:23], v[76:79]
    s_waitcnt lgkmcnt(1)
    v_mfma_f32_16x16x32_bf16 v[64:67], a[248:251], v[24:27], v[64:67]
    v_mfma_f32_16x16x32_bf16 v[68:71], a[252:255], v[24:27], v[68:71]
    s_waitcnt lgkmcnt(0)
    v_mfma_f32_16x16x32_bf16 v[72:75], a[248:251], v[28:31], v[72:75]
    v_mfma_f32_16x16x32_bf16 v[76:79], a[252:255], v[28:31], v[76:79]
L_sgu_T:
    s_add_u32 s43, s43, 1
    s_add_u32 s41, s41, 2048
    v_xor_b32 v12, 65536, v12
    s_nop 6
    v_mul_f32 v80, 0xbfb8aa3b, v64
    v_mul_f32 v81, 0xbfb8aa3b, v65
    v_mul_f32 v82, 0xbfb8aa3b, v66
    v_mul_f32 v83, 0xbfb8aa3b, v67
    v_exp_f32 v80, v80
    v_exp_f32 v81, v81
    v_exp_f32 v82, v82
    v_exp_f32 v83, v83
    v_pk_mul_f32 v[64:65], v[64:65], v[68:69]
    v_pk_mul_f32 v[66:67], v[66:67], v[70:71]
    v_add_f32 v80, 1.0, v80
    v_add_f32 v81, 1.0, v81
    v_add_f32 v82, 1.0, v82
    v_add_f32 v83, 1.0, v83
    v_rcp_f32 v80, v80
    v_rcp_f32 v81, v81
    v_rcp_f32 v82, v82
    v_rcp_f32 v83, v83
    s_nop 0
    v_pk_mul_f32 v[64:65], v[64:65], v[80:81]
    v_pk_mul_f32 v[66:67], v[66:67], v[82:83]
    v_cvt_pk_bf16_f32 v84, v64, v65
    v_cvt_pk_bf16_f32 v85, v66, v67
    buffer_store_dwordx2 v[84:85], v14, s[8:11], s37 offen sc1
    s_add_u32 s5, s37, s38
    v_mul_f32 v96, 0xbfb8aa3b, v72
    v_mul_f32 v97, 0xbfb8aa3b, v73
    v_mul_f32 v98, 0xbfb8aa3b, v74
    v_mul_f32 v99, 0xbfb8aa3b, v75
    v_exp_f32 v96, v96
    v_exp_f32 v97, v97
    v_exp_f32 v98, v98
    v_exp_f32 v99, v99
    v_pk_mul_f32 v[72:73], v[72:73], v[76:77]
    v_pk_mul_f32 v[74:75], v[74:75], v[78:79]
    v_add_f32 v96, 1.0, v96
    v_add_f32 v97, 1.0, v97
    v_add_f32 v98, 1.0, v98
    v_add_f32 v99, 1.0, v99
    v_rcp_f32 v96, v96
    v_rcp_f32 v97, v97
    v_rcp_f32 v98, v98
    v_rcp_f32 v99, v99
    s_nop 0
    v_pk_mul_f32 v[72:73], v[72:73], v[96:97]
    v_pk_mul_f32 v[74:75], v[74:75], v[98:99]
    v_cvt_pk_bf16_f32 v100, v72, v73
    v_cvt_pk_bf16_f32 v101, v74, v75
    buffer_store_dwordx2 v[100:101], v14, s[8:11], s5 offen sc1
    s_add_u32 s37, s37, s46
    s_waitcnt vmcnt(2)
    s_cmp_lg_u32 s21, 0
    s_cbranch_scc1 L_bp_3
    s_mov_b64 exec, 3
    ds_write_b32 v13, v6
    s_mov_b64 exec, -1
    s_waitcnt lgkmcnt(0)
L_bp_3:
    s_barrier
    ds_read_b32 v7, v13
    v_xor_b32 v13, 256, v13
    s_waitcnt lgkmcnt(0)
    v_readlane_b32 s4, v7, 0
    v_readlane_b32 s5, v7, 1
    s_cmp_ge_u32 s4, s36
    s_cselect_b32 s44, 1, 0
    s_cmp_ge_u32 s43, 64
    s_cselect_b32 s44, 0, s44
    s_cmp_ge_u32 s5, s36
    s_cselect_b32 s39, 1, 0
    s_cmp_lg_u32 s44, 0
    s_cbranch_scc1 L_sgu_T1
    s_waitcnt vmcnt(0)
    s_barrier
    s_cmp_lg_u32 s21, 0
    s_cbranch_scc1 L_sgu_s1
    s_mov_b64 exec, 1
    v_mov_b32 v4, 0
    v_mov_b32 v5, 1
    buffer_atomic_add v5, v4, s[8:11], s35 offen
    s_mov_b64 exec, -1
L_sgu_s1:
    s_add_u32 s35, s35, 2048
    s_cmp_lt_u32 s43, 64
    s_cbranch_scc1 L_sgu_L
    s_branch L_w_done
L_sgu_T1:
    s_add_u32 m0, s40, 0
    s_add_u32 s47, s30, 0
    buffer_load_dwordx4 v11, s[8:11], s47 offen sc1 lds
    s_add_u32 m0, s40, 4096
    s_add_u32 s47, s30, 2048
    buffer_load_dwordx4 v11, s[8:11], s47 offen sc1 lds
    s_add_u32 m0, s40, 8192
    s_add_u32 s47, s30, 4096
    buffer_load_dwordx4 v11, s[8:11], s47 offen sc1 lds
    s_add_u32 m0, s40, 12288
    s_add_u32 s47, s30, 6144
    buffer_load_dwordx4 v11, s[8:11], s47 offen sc1 lds
    s_add_u32 m0, s40, 16384
    s_add_u32 s47, s30, 8192
    buffer_load_dwordx4 v11, s[8:11], s47 offen sc1 lds
    s_add_u32 m0, s40, 20480
    s_add_u32 s47, s30, 10240
    buffer_load_dwordx4 v11, s[8:11], s47 offen sc1 lds
    s_add_u32 m0, s40, 24576
    s_add_u32 s47, s30, 12288
    buffer_load_dwordx4 v11, s[8:11], s47 offen sc1 lds
    s_add_u32 m0, s40, 28672
    s_add_u32 s47, s30, 14336
    buffer_load_dwordx4 v11, s[8:11], s47 offen sc1 lds
    s_add_u32 m0, s40, 32768
    s_add_u32 s47, s30, 16384
    buffer_load_dwordx4 v11, s[8:11], s47 offen sc1 lds
    s_add_u32 m0, s40, 36864
    s_add_u32 s47, s30, 18432
    buffer_load_dwordx4 v11, s[8:11], s47 offen sc1 lds
    s_add_u32 m0, s40, 40960
    s_add_u32 s47, s30, 20480
    buffer_load_dwordx4 v11, s[8:11], s47 offen sc1 lds
    s_add_u32 m0, s40, 45056
    s_add_u32 s47, s30, 22528
    buffer_load_dwordx4 v11, s[8:11], s47 offen sc1 lds
    s_add_u32 m0, s40, 49152
    s_add_u32 s47, s30, 24576
    buffer_load_dwordx4 v11, s[8:11], s47 offen sc1 lds
    s_add_u32 m0, s40, 53248
    s_add_u32 s47, s30, 26624
    buffer_load_dwordx4 v11, s[8:11], s47 offen sc1 lds
    s_add_u32 m0, s40, 57344
    s_add_u32 s47, s30, 28672
    buffer_load_dwordx4 v11, s[8:11], s47 offen sc1 lds
    s_add_u32 m0, s40, 61440
    s_add_u32 s47, s30, 30720
    buffer_load_dwordx4 v11, s[8:11], s47 offen sc1 lds
    s_xor_b32 s40, s40, 65536
    s_add_u32 s30, s30, s45
    s_cmp_lg_u32 s39, 0
    s_cbranch_scc1 L_sgu_T2
    s_waitcnt vmcnt(16)
    s_barrier
    s_cmp_lg_u32 s21, 3
    s_cbranch_scc1 L_sgu_s4
    s_mov_b64 exec, 1
    v_mov_b32 v4, 0
    v_mov_b32 v5, 1
    buffer_atomic_add v5, v4, s[8:11], s35 offen
    s_mov_b64 exec, -1
L_sgu_s4:
    s_add_u32 s35, s35, 2048
    s_branch L_sgu_L2
L_sgu_T2:
    s_add_u32 s4, s41, 2048
    buffer_load_dword v6, v15, s[8:11], s4 offen sc1
    s_waitcnt vmcnt(0)
    s_branch L_sgu_B1
L_sgu_E:
    s_add_u32 s43, s43, 1
    s_add_u32 s41, s41, 2048
    v_xor_b32 v12, 65536, v12
    s_nop 6
    v_mul_f32 v80, 0xbfb8aa3b, v64
    v_mul_f32 v81, 0xbfb8aa3b, v65
    v_mul_f32 v82, 0xbfb8aa3b, v66
    v_mul_f32 v83, 0xbfb8aa3b, v67
    v_exp_f32 v80, v80
    v_exp_f32 v81, v81
    v_exp_f32 v82, v82
    v_exp_f32 v83, v83
    v_pk_mul_f32 v[64:65], v[64:65], v[68:69]
    v_pk_mul_f32 v[66:67], v[66:67], v[70:71]
    v_add_f32 v80, 1.0, v80
    v_add_f32 v81, 1.0, v81
    v_add_f32 v82, 1.0, v82
    v_add_f32 v83, 1.0, v83
    v_rcp_f32 v80, v80
    v_rcp_f32 v81, v81
    v_rcp_f32 v82, v82
    v_rcp_f32 v83, v83
    s_nop 0
    v_pk_mul_f32 v[64:65], v[64:65], v[80:81]
    v_pk_mul_f32 v[66:67], v[66:67], v[82:83]
    v_cvt_pk_bf16_f32 v84, v64, v65
    v_cvt_pk_bf16_f32 v85, v66, v67
    buffer_store_dwordx2 v[84:85], v14, s[8:11], s37 offen sc1
    s_add_u32 s5, s37, s38
    v_mul_f32 v96, 0xbfb8aa3b, v72
    v_mul_f32 v97, 0xbfb8aa3b, v73
    v_mul_f32 v98, 0xbfb8aa3b, v74
    v_mul_f32 v99, 0xbfb8aa3b, v75
    v_exp_f32 v96, v96
    v_exp_f32 v97, v97
    v_exp_f32 v98, v98
    v_exp_f32 v99, v99
    v_pk_mul_f32 v[72:73], v[72:73], v[76:77]
    v_pk_mul_f32 v[74:75], v[74:75], v[78:79]
    v_add_f32 v96, 1.0, v96
    v_add_f32 v97, 1.0, v97
    v_add_f32 v98, 1.0, v98
    v_add_f32 v99, 1.0, v99
    v_rcp_f32 v96, v96
    v_rcp_f32 v97, v97
    v_rcp_f32 v98, v98
    v_rcp_f32 v99, v99
    s_nop 0
    v_pk_mul_f32 v[72:73], v[72:73], v[96:97]
    v_pk_mul_f32 v[74:75], v[74:75], v[98:99]
    v_cvt_pk_bf16_f32 v100, v72, v73
    v_cvt_pk_bf16_f32 v101, v74, v75
    buffer_store_dwordx2 v[100:101], v14, s[8:11], s5 offen sc1
    s_add_u32 s37, s37, s46
    s_waitcnt vmcnt(2)
L_sgu_B1:
    s_cmp_lg_u32 s21, 0
    s_cbranch_scc1 L_bp_4
    s_mov_b64 exec, 3
    ds_write_b32 v13, v6
    s_mov_b64 exec, -1
    s_waitcnt lgkmcnt(0)
L_bp_4:
    s_barrier
    ds_read_b32 v7, v13
    v_xor_b32 v13, 256, v13
    s_waitcnt lgkmcnt(0)
    v_readlane_b32 s4, v7, 0
    v_readlane_b32 s5, v7, 1
    s_cmp_ge_u32 s4, s36
    s_cselect_b32 s44, 1, 0
    s_cmp_ge_u32 s43, 63
    s_cselect_b32 s44, 0, s44
    s_cmp_ge_u32 s5, s36
    s_cselect_b32 s39, 1, 0
    s_cmp_eq_u32 s44, 0
    s_cbranch_scc1 L_sgu_B0
    ds_read_b128 v[16:19], v12 offset:0
    ds_read_b128 v[20:23], v12 offset:1024
    ds_read_b128 v[24:27], v12 offset:2048
    ds_read_b128 v[28:31], v12 offset:3072
    ds_read_b128 v[32:35], v12 offset:4096
    ds_read_b128 v[36:39], v12 offset:5120
    s_waitcnt lgkmcnt(5)
    v_mfma_f32_16x16x32_bf16 v[64:67], a[0:3], v[16:19], 0
    ds_read_b128 v[40:43], v12 offset:6144
    v_mfma_f32_16x16x32_bf16 v[68:71], a[4:7], v[16:19], 0
    s_waitcnt lgkmcnt(5)
    v_mfma_f32_16x16x32_bf16 v[72:75], a[0:3], v[20:23], 0
    ds_read_b128 v[44:47], v12 offset:7168
    v_mfma_f32_16x16x32_bf16 v[76:79], a[4:7], v[20:23], 0
    s_waitcnt lgkmcnt(5)
    v_mfma_f32_16x16x32_bf16 v[64:67], a[8:11], v[24:27], v[64:67]
    ds_read_b128 v[48:51], v12 offset:8192
    v_mfma_f32_16x16x32_bf16 v[68:71], a[12:15], v[24:27], v[68:71]
    s_waitcnt lgkmcnt(5)
    v_mfma_f32_16x16x32_bf16 v[72:75], a[8:11], v[28:31], v[72:75]
    ds_read_b128 v[52:55], v12 offset:9216
    v_mfma_f32_16x16x32_bf16 v[76:79], a[12:15], v[28:31], v[76:79]
    s_waitcnt lgkmcnt(5)
    v_mfma_f32_16x16x32_bf16 v[64:67], a[16:19], v[32:35], v[64:67]
    ds_read_b128 v[56:59], v12 offset:10240
    v_mfma_f32_16x16x32_bf16 v[68:71], a[20:23], v[32:35], v[68:71]
    s_waitcnt lgkmcnt(5)
    v_mfma_f32_16x16x32_bf16 v[72:75], a[16:19], v[36:39], v[72:75]
    ds_read_b128 v[60:63], v12 offset:11264
    v_mfma_f32_16x16x32_bf16 v[76:79], a[20:23], v[36:39], v[76:79]
    s_waitcnt lgkmcnt(5)
    v_mfma_f32_16x16x32_bf16 v[64:67], a[24:27], v[40:43], v[64:67]
    ds_read_b128 v[16:19], v12 offset:12288
    v_mfma_f32_16x16x32_bf16 v[68:71], a[28:31], v[40:43], v[68:71]
    s_waitcnt lgkmcnt(5)
    v_mfma_f32_16x16x32_bf16 v[72:75], a[24:27], v[44:47], v[72:75]
    ds_read_b128 v[20:23], v12 offset:13312
    v_mfma_f32_16x16x32_bf16 v[76:79], a[28:31], v[44:47], v[76:79]
    s_waitcnt lgkmcnt(5)
    v_mfma_f32_16x16x32_bf16 v[64:67], a[32:35], v[48:51], v[64:67]
    ds_read_b128 v[24:27], v12 offset:14336
    v_mfma_f32_16x16x32_bf16 v[68:71], a[36:39], v[48:51], v[68:71]
    s_add_u32 m0, s40, 0
    s_add_u32 s47, s30, 0
    buffer_load_dwordx4 v11, s[8:11], s47 offen sc1 lds
    s_waitcnt lgkmcnt(5)
    v_mfma_f32_16x16x32_bf16 v[72:75], a[32:35], v[52:55], v[72:75]
    ds_read_b128 v[28:31], v12 offset:15360
    v_mfma_f32_16x16x32_bf16 v[76:79], a[36:39], v[52:55], v[76:79]
    s_waitcnt lgkmcnt(5)
    v_mfma_f32_16x16x32_bf16 v[64:67], a[40:43], v[56:59], v[64:67]
    ds_read_b128 v[32:35], v12 offset:16384
    v_mfma_f32_16x16x32_bf16 v[68:71], a[44:47], v[56:59], v[68:71]
    s_add_u32 m0, s40, 4096
    s_add_u32 s47, s30, 2048
    buffer_load_dwordx4 v11, s[8:11], s47 offen sc1 lds
    s_waitcnt lgkmcnt(5)
    v_mfma_f32_16x16x32_bf16 v[72:75], a[40:43], v[60:63], v[72:75]
    ds_read_b128 v[36:39], v12 offset:17408
    v_mfma_f32_16x16x32_bf16 v[76:79], a[44:47], v[60:63], v[76:79]
    s_waitcnt lgkmcnt(5)
    v_mfma_f32_16x16x32_bf16 v[64:67], a[48:51], v[16:19], v[64:67]
    ds_read_b128 v[40:43], v12 offset:18432
    v_mfma_f32_16x16x32_bf16 v[68:71], a[52:55], v[16:19], v[68:71]
    s_add_u32 m0, s40, 8192
    s_add_u32 s47, s30, 4096
    buffer_load_dwordx4 v11, s[8:11], s47 offen sc1 lds
    s_waitcnt lgkmcnt(5)
    v_mfma_f32_16x16x32_bf16 v[72:75], a[48:51], v[20:23], v[72:75]
    ds_read_b128 v[44:47], v12 offset:19456
    v_mfma_f32_16x16x32_bf16 v[76:79], a[52:55], v[20:23], v[76:79]
    s_waitcnt vmcnt(3)
    s_barrier
    s_cmp_lg_u32 s21, 0
    s_cbranch_scc1 L_sgu_s2
    s_mov_b64 exec, 1
    v_mov_b32 v4, 0
    v_mov_b32 v5, 1
    buffer_atomic_add v5, v4, s[8:11], s35 offen
    s_mov_b64 exec, -1
L_sgu_s2:
    s_add_u32 s35, s35, 2048
    s_waitcnt lgkmcnt(5)
    v_mfma_f32_16x16x32_bf16 v[64:67], a[56:59], v[24:27], v[64:67]
    ds_read_b128 v[48:51], v12 offset:20480
    v_mfma_f32_16x16x32_bf16 v[68:71], a[60:63], v[24:27], v[68:71]
    s_add_u32 m0, s40, 12288
    s_add_u32 s47, s30, 6144
    buffer_load_dwordx4 v11, s[8:11], s47 offen sc1 lds
    s_waitcnt lgkmcnt(5)
    v_mfma_f32_16x16x32_bf16 v[72:75], a[56:59], v[28:31], v[72:75]
    ds_read_b128 v[52:55], v12 offset:21504
    v_mfma_f32_16x16x32_bf16 v[76:79], a[60:63], v[28:31], v[76:79]
    s_waitcnt lgkmcnt(5)
    v_mfma_f32_16x16x32_bf16 v[64:67], a[64:67], v[32:35], v[64:67]
    ds_read_b128 v[56:59], v12 offset:22528
    v_mfma_f32_16x16x32_bf16 v[68:71], a[68:71], v[32:35], v[68:71]
    s_add_u32 m0, s40, 16384
    s_add_u32 s47, s30, 8192
    buffer_load_dwordx4 v11, s[8:11], s47 offen sc1 lds
    s_waitcnt lgkmcnt(5)
    v_mfma_f32_16x16x32_bf16 v[72:75], a[64:67], v[36:39], v[72:75]
    ds_read_b128 v[60:63], v12 offset:23552
    v_mfma_f32_16x16x32_bf16 v[76:79], a[68:71], v[36:39], v[76:79]
    s_waitcnt lgkmcnt(5)
    v_mfma_f32_16x16x32_bf16 v[64:67], a[72:75], v[40:43], v[64:67]
    ds_read_b128 v[16:19], v12 offset:24576
    v_mfma_f32_16x16x32_bf16 v[68:71], a[76:79], v[40:43], v[68:71]
    s_add_u32 m0, s40, 20480
    s_add_u32 s47, s30, 10240
    buffer_load_dwordx4 v11, s[8:11], s47 offen sc1 lds
    s_waitcnt lgkmcnt(5)
    v_mfma_f32_16x16x32_bf16 v[72:75], a[72:75], v[44:47], v[72:75]
    ds_read_b128 v[20:23], v12 offset:25600
    v_mfma_f32_16x16x32_bf16 v[76:79], a[76:79], v[44:47], v[76:79]
    s_waitcnt lgkmcnt(5)
    v_mfma_f32_16x16x32_bf16 v[64:67], a[80:83], v[48:51], v[64:67]
    ds_read_b128 v[24:27], v12 offset:26624
    v_mfma_f32_16x16x32_bf16 v[68:71], a[84:87], v[48:51], v[68:71]
    s_add_u32 m0, s40, 24576
    s_add_u32 s47, s30, 12288
    buffer_load_dwordx4 v11, s[8:11], s47 offen sc1 lds
    s_waitcnt lgkmcnt(5)
    v_mfma_f32_16x16x32_bf16 v[72:75], a[80:83], v[52:55], v[72:75]
    ds_read_b128 v[28:31], v12 offset:27648
    v_mfma_f32_16x16x32_bf16 v[76:79], a[84:87], v[52:55], v[76:79]
    s_waitcnt lgkmcnt(5)
    v_mfma_f32_16x16x32_bf16 v[64:67], a[88:91], v[56:59], v[64:67]
    ds_read_b128 v[32:35], v12 offset:28672
    v_mfma_f32_16x16x32_bf16 v[68:71], a[92:95], v[56:59], v[68:71]
    s_add_u32 m0, s40, 28672
    s_add_u32 s47, s30, 14336
    buffer_load_dwordx4 v11, s[8:11], s47 offen sc1 lds
    s_waitcnt lgkmcnt(5)
    v_mfma_f32_16x16x32_bf16 v[72:75], a[88:91], v[60:63], v[72:75]
    ds_read_b128 v[36:39], v12 offset:29696
    v_mfma_f32_16x16x32_bf16 v[76:79], a[92:95], v[60:63], v[76:79]
    s_waitcnt lgkmcnt(5)
    v_mfma_f32_16x16x32_bf16 v[64:67], a[96:99], v[16:19], v[64:67]
    ds_read_b128 v[40:43], v12 offset:30720
    v_mfma_f32_16x16x32_bf16 v[68:71], a[100:103], v[16:19], v[68:71]
    s_add_u32 m0, s40, 32768
    s_add_u32 s47, s30, 16384
    buffer_load_dwordx4 v11, s[8:11], s47 offen sc1 lds
    s_waitcnt lgkmcnt(5)
    v_mfma_f32_16x16x32_bf16 v[72:75], a[96:99], v[20:23], v[72:75]
    ds_read_b128 v[44:47], v12 offset:31744
    v_mfma_f32_16x16x32_bf16 v[76:79], a[100:103], v[20:23], v[76:79]
    s_waitcnt lgkmcnt(5)
    v_mfma_f32_16x16x32_bf16 v[64:67], a[104:107], v[24:27], v[64:67]
    ds_read_b128 v[48:51], v12 offset:32768
    v_mfma_f32_16x16x32_bf16 v[68:71], a[108:111], v[24:27], v[68:71]
    s_add_u32 m0, s40, 36864
    s_add_u32 s47, s30, 18432
    buffer_load_dwordx4 v11, s[8:11], s47 offen sc1 lds
    s_waitcnt lgkmcnt(5)
    v_mfma_f32_16x16x32_bf16 v[72:75], a[104:107], v[28:31], v[72:75]
    ds_read_b128 v[52:55], v12 offset:33792
    v_mfma_f32_16x16x32_bf16 v[76:79], a[108:111], v[28:31], v[76:79]
    s_waitcnt lgkmcnt(5)
    v_mfma_f32_16x16x32_bf16 v[64:67], a[112:115], v[32:35], v[64:67]
    ds_read_b128 v[56:59], v12 offset:34816
    v_mfma_f32_16x16x32_bf16 v[68:71], a[116:119], v[32:35], v[68:71]
    s_add_u32 m0, s40, 40960
    s_add_u32 s47, s30, 20480
    buffer_load_dwordx4 v11, s[8:11], s47 offen sc1 lds
    s_waitcnt lgkmcnt(5)
    v_mfma_f32_16x16x32_bf16 v[72:75], a[112:115], v[36:39], v[72:75]
    ds_read_b128 v[60:63], v12 offset:35840
    v_mfma_f32_16x16x32_bf16 v[76:79], a[116:119], v[36:39], v[76:79]
    s_waitcnt lgkmcnt(5)
    v_mfma_f32_16x16x32_bf16 v[64:67], a[120:123], v[40:43], v[64:67]
    ds_read_b128 v[16:19], v12 offset:36864
    v_mfma_f32_16x16x32_bf16 v[68:71], a[124:127], v[40:43], v[68:71]
    s_add_u32 m0, s40, 45056
    s_add_u32 s47, s30, 22528
    buffer_load_dwordx4 v11, s[8:11], s47 offen sc1 lds
    s_waitcnt lgkmcnt(5)
    v_mfma_f32_16x16x32_bf16 v[72:75], a[120:123], v[44:47], v[72:75]
    ds_read_b128 v[20:23], v12 offset:37888
    v_mfma_f32_16x16x32_bf16 v[76:79], a[124:127], v[44:47], v[76:79]
    s_waitcnt lgkmcnt(5)
    v_mfma_f32_16x16x32_bf16 v[64:67], a[128:131], v[48:51], v[64:67]
    ds_read_b128 v[24:27], v12 offset:38912
    v_mfma_f32_16x16x32_bf16 v[68:71], a[132:135], v[48:51], v[68:71]
    s_add_u32 m0, s40, 49152
    s_add_u32 s47, s30, 24576
    buffer_load_dwordx4 v11, s[8:11], s47 offen sc1 lds
    s_waitcnt lgkmcnt(5)
    v_mfma_f32_16x16x32_bf16 v[72:75], a[128:131], v[52:55], v[72:75]
    ds_read_b128 v[28:31], v12 offset:39936
    v_mfma_f32_16x16x32_bf16 v[76:79], a[132:135], v[52:55], v[76:79]
    s_waitcnt lgkmcnt(5)
    v_mfma_f32_16x16x32_bf16 v[64:67], a[136:139], v[56:59], v[64:67]
    ds_read_b128 v[32:35], v12 offset:40960
    v_mfma_f32_16x16x32_bf16 v[68:71], a[140:143], v[56:59], v[68:71]
    s_add_u32 m0, s40, 53248
    s_add_u32 s47, s30, 26624
    buffer_load_dwordx4 v11, s[8:11], s47 offen sc1 lds
    s_waitcnt lgkmcnt(5)
    v_mfma_f32_16x16x32_bf16 v[72:75], a[136:139], v[60:63], v[72:75]
    ds_read_b128 v[36:39], v12 offset:41984
    v_mfma_f32_16x16x32_bf16 v[76:79], a[140:143], v[60:63], v[76:79]
    s_waitcnt lgkmcnt(5)
    v_mfma_f32_16x16x32_bf16 v[64:67], a[144:147], v[16:19], v[64:67]
    ds_read_b128 v[40:43], v12 offset:43008
    v_mfma_f32_16x16x32_bf16 v[68:71], a[148:151], v[16:19], v[68:71]
    s_add_u32 m0, s40, 57344
    s_add_u32 s47, s30, 28672
    buffer_load_dwordx4 v11, s[8:11], s47 offen sc1 lds
    s_waitcnt lgkmcnt(5)
    v_mfma_f32_16x16x32_bf16 v[72:75], a[144:147], v[20:23], v[72:75]
    ds_read_b128 v[44:47], v12 offset:44032
    v_mfma_f32_16x16x32_bf16 v[76:79], a[148:151], v[20:23], v[76:79]
    s_waitcnt lgkmcnt(5)
    v_mfma_f32_16x16x32_bf16 v[64:67], a[152:155], v[24:27], v[64:67]
    ds_read_b128 v[48:51], v12 offset:45056
    v_mfma_f32_16x16x32_bf16 v[68:71], a[156:159], v[24:27], v[68:71]
    s_add_u32 m0, s40, 61440
    s_add_u32 s47, s30, 30720
    buffer_load_dwordx4 v11, s[8:11], s47 offen sc1 lds
    s_xor_b32 s40, s40, 65536
    s_add_u32 s30, s30, s45
    s_waitcnt lgkmcnt(5)
    v_mfma_f32_16x16x32_bf16 v[72:75], a[152:155], v[28:31], v[72:75]
    ds_read_b128 v[52:55], v12 offset:46080
    v_mfma_f32_16x16x32_bf16 v[76:79], a[156:159], v[28:31], v[76:79]
    s_waitcnt lgkmcnt(5)
    v_mfma_f32_16x16x32_bf16 v[64:67], a[160:163], v[32:35], v[64:67]
    ds_read_b128 v[56:59], v12 offset:47104
    v_mfma_f32_16x16x32_bf16 v[68:71], a[164:167], v[32:35], v[68:71]
    s_waitcnt lgkmcnt(5)
    v_mfma_f32_16x16x32_bf16 v[72:75], a[160:163], v[36:39], v[72:75]
    ds_read_b128 v[60:63], v12 offset:48128
    v_mfma_f32_16x16x32_bf16 v[76:79], a[164:167], v[36:39], v[76:79]
    s_waitcnt lgkmcnt(5)
    v_mfma_f32_16x16x32_bf16 v[64:67], a[168:171], v[40:43], v[64:67]
    s_add_u32 s4, s41, 4096
    buffer_load_dword v6, v15, s[8:11], s4 offen sc1
    ds_read_b128 v[16:19], v12 offset:49152
    v_mfma_f32_16x16x32_bf16 v[68:71], a[172:175], v[40:43], v[68:71]
    s_waitcnt lgkmcnt(5)
    v_mfma_f32_16x16x32_bf16 v[72:75], a[168:171], v[44:47], v[72:75]
    ds_read_b128 v[20:23], v12 offset:50176
    v_mfma_f32_16x16x32_bf16 v[76:79], a[172:175], v[44:47], v[76:79]
    s_waitcnt lgkmcnt(5)
    v_mfma_f32_16x16x32_bf16 v[64:67], a[176:179], v[48:51], v[64:67]
    ds_read_b128 v[24:27], v12 offset:51200
    v_mfma_f32_16x16x32_bf16 v[68:71], a[180:183], v[48:51], v[68:71]
    s_waitcnt lgkmcnt(5)
    v_mfma_f32_16x16x32_bf16 v[72:75], a[176:179], v[52:55], v[72:75]
    ds_read_b128 v[28:31], v12 offset:52224
    v_mfma_f32_16x16x32_bf16 v[76:79], a[180:183], v[52:55], v[76:79]
    s_waitcnt lgkmcnt(5)
    v_mfma_f32_16x16x32_bf16 v[64:67], a[184:187], v[56:59], v[64:67]
    ds_read_b128 v[32:35], v12 offset:53248
    v_mfma_f32_16x16x32_bf16 v[68:71], a[188:191], v[56:59], v[68:71]
    s_waitcnt lgkmcnt(5)
    v_mfma_f32_16x16x32_bf16 v[72:75], a[184:187], v[60:63], v[72:75]
    ds_read_b128 v[36:39], v12 offset:54272
    v_mfma_f32_16x16x32_bf16 v[76:79], a[188:191], v[60:63], v[76:79]
    s_waitcnt lgkmcnt(5)
    v_mfma_f32_16x16x32_bf16 v[64:67], a[192:195], v[16:19], v[64:67]
    ds_read_b128 v[40:43], v12 offset:55296
    v_mfma_f32_16x16x32_bf16 v[68:71], a[196:199], v[16:19], v[68:71]
    s_waitcnt lgkmcnt(5)
    v_mfma_f32_16x16x32_bf16 v[72:75], a[192:195], v[20:23], v[72:75]
    ds_read_b128 v[44:47], v12 offset:56320
    v_mfma_f32_16x16x32_bf16 v[76:79], a[196:199], v[20:23], v[76:79]
    s_waitcnt lgkmcnt(5)
    v_mfma_f32_16x16x32_bf16 v[64:67], a[200:203], v[24:27], v[64:67]
    ds_read_b128 v[48:51], v12 offset:57344
    v_mfma_f32_16x16x32_bf16 v[68:71], a[204:207], v[24:27], v[68:71]
    s_waitcnt lgkmcnt(5)
    v_mfma_f32_16x16x32_bf16 v[72:75], a[200:203], v[28:31], v[72:75]
    ds_read_b128 v[52:55], v12 offset:58368
    v_mfma_f32_16x16x32_bf16 v[76:79], a[204:207], v[28:31], v[76:79]
    s_waitcnt lgkmcnt(5)
    v_mfma_f32_16x16x32_bf16 v[64:67], a[208:211], v[32:35], v[64:67]
    ds_read_b128 v[56:59], v12 offset:59392
    v_mfma_f32_16x16x32_bf16 v[68:71], a[212:215], v[32:35], v[68:71]
    s_waitcnt lgkmcnt(5)
    v_mfma_f32_16x16x32_bf16 v[72:75], a[208:211], v[36:39], v[72:75]
    ds_read_b128 v[60:63], v12 offset:60416
    v_mfma_f32_16x16x32_bf16 v[76:79], a[212:215], v[36:39], v[76:79]
    s_waitcnt lgkmcnt(5)
    v_mfma_f32_16x16x32_bf16 v[64:67], a[216:219], v[40:43], v[64:67]
    ds_read_b128 v[16:19], v12 offset:61440
    v_mfma_f32_16x16x32_bf16 v[68:71], a[220:223], v[40:43], v[68:71]
    s_waitcnt lgkmcnt(5)
    v_mfma_f32_16x16x32_bf16 v[72:75], a[216:219], v[44:47], v[72:75]
    ds_read_b128 v[20:23], v12 offset:62464
    v_mfma_f32_16x16x32_bf16 v[76:79], a[220:223], v[44:47], v[76:79]
    s_waitcnt lgkmcnt(5)
    v_mfma_f32_16x16x32_bf16 v[64:67], a[224:227], v[48:51], v[64:67]
    ds_read_b128 v[24:27], v12 offset:63488
    v_mfma_f32_16x16x32_bf16 v[68:71], a[228:231], v[48:51], v[68:71]
    s_waitcnt lgkmcnt(5)
    v_mfma_f32_16x16x32_bf16 v[72:75], a[224:227], v[52:55], v[72:75]
    ds_read_b128 v[28:31], v12 offset:64512
    v_mfma_f32_16x16x32_bf16 v[76:79], a[228:231], v[52:55], v[76:79]
    s_waitcnt lgkmcnt(5)
    v_mfma_f32_16x16x32_bf16 v[64:67], a[232:235], v[56:59], v[64:67]
    v_mfma_f32_16x16x32_bf16 v[68:71], a[236:239], v[56:59], v[68:71]
    s_waitcnt lgkmcnt(4)
    v_mfma_f32_16x16x32_bf16 v[72:75], a[232:235], v[60:63], v[72:75]
    v_mfma_f32_16x16x32_bf16 v[76:79], a[236:239], v[60:63], v[76:79]
    s_waitcnt lgkmcnt(3)
    v_mfma_f32_16x16x32_bf16 v[64:67], a[240:243], v[16:19], v[64:67]
    v_mfma_f32_16x16x32_bf16 v[68:71], a[244:247], v[16:19], v[68:71]
    s_waitcnt lgkmcnt(2)
    v_mfma_f32_16x16x32_bf16 v[72:75], a[240:243], v[20:23], v[72:75]
    v_mfma_f32_16x16x32_bf16 v[76:79], a[244:247], v[20:23], v[76:79]
    s_waitcnt lgkmcnt(1)
    v_mfma_f32_16x16x32_bf16 v[64:67], a[248:251], v[24:27], v[64:67]
    v_mfma_f32_16x16x32_bf16 v[68:71], a[252:255], v[24:27], v[68:71]
    s_waitcnt lgkmcnt(0)
    v_mfma_f32_16x16x32_bf16 v[72:75], a[248:251], v[28:31], v[72:75]
    v_mfma_f32_16x16x32_bf16 v[76:79], a[252:255], v[28:31], v[76:79]
    s_branch L_sgu_E
L_sgu_B0:
    ds_read_b128 v[16:19], v12 offset:0
    ds_read_b128 v[20:23], v12 offset:1024
    ds_read_b128 v[24:27], v12 offset:2048
    ds_read_b128 v[28:31], v12 offset:3072
    ds_read_b128 v[32:35], v12 offset:4096
    ds_read_b128 v[36:39], v12 offset:5120
    s_waitcnt lgkmcnt(5)
    v_mfma_f32_16x16x32_bf16 v[64:67], a[0:3], v[16:19], 0
    ds_read_b128 v[40:43], v12 offset:6144
    v_mfma_f32_16x16x32_bf16 v[68:71], a[4:7], v[16:19], 0
    s_waitcnt lgkmcnt(5)
    v_mfma_f32_16x16x32_bf16 v[72:75], a[0:3], v[20:23], 0
    ds_read_b128 v[44:47], v12 offset:7168
    v_mfma_f32_16x16x32_bf16 v[76:79], a[4:7], v[20:23], 0
    s_waitcnt lgkmcnt(5)
    v_mfma_f32_16x16x32_bf16 v[64:67], a[8:11], v[24:27], v[64:67]
    ds_read_b128 v[48:51], v12 offset:8192
    v_mfma_f32_16x16x32_bf16 v[68:71], a[12:15], v[24:27], v[68:71]
    s_waitcnt lgkmcnt(5)
    v_mfma_f32_16x16x32_bf16 v[72:75], a[8:11], v[28:31], v[72:75]
    ds_read_b128 v[52:55], v12 offset:9216
    v_mfma_f32_16x16x32_bf16 v[76:79], a[12:15], v[28:31], v[76:79]
    s_waitcnt lgkmcnt(5)
    v_mfma_f32_16x16x32_bf16 v[64:67], a[16:19], v[32:35], v[64:67]
    ds_read_b128 v[56:59], v12 offset:10240
    v_mfma_f32_16x16x32_bf16 v[68:71], a[20:23], v[32:35], v[68:71]
    s_waitcnt lgkmcnt(5)
    v_mfma_f32_16x16x32_bf16 v[72:75], a[16:19], v[36:39], v[72:75]
    ds_read_b128 v[60:63], v12 offset:11264
    v_mfma_f32_16x16x32_bf16 v[76:79], a[20:23], v[36:39], v[76:79]
    s_waitcnt lgkmcnt(5)
    v_mfma_f32_16x16x32_bf16 v[64:67], a[24:27], v[40:43], v[64:67]
    ds_read_b128 v[16:19], v12 offset:12288
    v_mfma_f32_16x16x32_bf16 v[68:71], a[28:31], v[40:43], v[68:71]
    s_waitcnt lgkmcnt(5)
    v_mfma_f32_16x16x32_bf16 v[72:75], a[24:27], v[44:47], v[72:75]
    ds_read_b128 v[20:23], v12 offset:13312
    v_mfma_f32_16x16x32_bf16 v[76:79], a[28:31], v[44:47], v[76:79]
    s_waitcnt lgkmcnt(5)
    v_mfma_f32_16x16x32_bf16 v[64:67], a[32:35], v[48:51], v[64:67]
    ds_read_b128 v[24:27], v12 offset:14336
    v_mfma_f32_16x16x32_bf16 v[68:71], a[36:39], v[48:51], v[68:71]
    s_waitcnt vmcnt(0)
    s_barrier
    s_cmp_lg_u32 s21, 0
    s_cbranch_scc1 L_sgu_s3
    s_mov_b64 exec, 1
    v_mov_b32 v4, 0
    v_mov_b32 v5, 1
    buffer_atomic_add v5, v4, s[8:11], s35 offen
    s_mov_b64 exec, -1
L_sgu_s3:
    s_add_u32 s35, s35, 2048
    s_waitcnt lgkmcnt(5)
    v_mfma_f32_16x16x32_bf16 v[72:75], a[32:35], v[52:55], v[72:75]
    ds_read_b128 v[28:31], v12 offset:15360
    v_mfma_f32_16x16x32_bf16 v[76:79], a[36:39], v[52:55], v[76:79]
    s_waitcnt lgkmcnt(5)
    v_mfma_f32_16x16x32_bf16 v[64:67], a[40:43], v[56:59], v[64:67]
    ds_read_b128 v[32:35], v12 offset:16384
    v_mfma_f32_16x16x32_bf16 v[68:71], a[44:47], v[56:59], v[68:71]
    s_waitcnt lgkmcnt(5)
    v_mfma_f32_16x16x32_bf16 v[72:75], a[40:43], v[60:63], v[72:75]
    ds_read_b128 v[36:39], v12 offset:17408
    v_mfma_f32_16x16x32_bf16 v[76:79], a[44:47], v[60:63], v[76:79]
    s_waitcnt lgkmcnt(5)
    v_mfma_f32_16x16x32_bf16 v[64:67], a[48:51], v[16:19], v[64:67]
    ds_read_b128 v[40:43], v12 offset:18432
    v_mfma_f32_16x16x32_bf16 v[68:71], a[52:55], v[16:19], v[68:71]
    s_waitcnt lgkmcnt(5)
    v_mfma_f32_16x16x32_bf16 v[72:75], a[48:51], v[20:23], v[72:75]
    ds_read_b128 v[44:47], v12 offset:19456
    v_mfma_f32_16x16x32_bf16 v[76:79], a[52:55], v[20:23], v[76:79]
    s_waitcnt lgkmcnt(5)
    v_mfma_f32_16x16x32_bf16 v[64:67], a[56:59], v[24:27], v[64:67]
    ds_read_b128 v[48:51], v12 offset:20480
    v_mfma_f32_16x16x32_bf16 v[68:71], a[60:63], v[24:27], v[68:71]
    s_waitcnt lgkmcnt(5)
    v_mfma_f32_16x16x32_bf16 v[72:75], a[56:59], v[28:31], v[72:75]
    ds_read_b128 v[52:55], v12 offset:21504
    v_mfma_f32_16x16x32_bf16 v[76:79], a[60:63], v[28:31], v[76:79]
    s_waitcnt lgkmcnt(5)
    v_mfma_f32_16x16x32_bf16 v[64:67], a[64:67], v[32:35], v[64:67]
    ds_read_b128 v[56:59], v12 offset:22528
    v_mfma_f32_16x16x32_bf16 v[68:71], a[68:71], v[32:35], v[68:71]
    s_waitcnt lgkmcnt(5)
    v_mfma_f32_16x16x32_bf16 v[72:75], a[64:67], v[36:39], v[72:75]
    ds_read_b128 v[60:63], v12 offset:23552
    v_mfma_f32_16x16x32_bf16 v[76:79], a[68:71], v[36:39], v[76:79]
    s_waitcnt lgkmcnt(5)
    v_mfma_f32_16x16x32_bf16 v[64:67], a[72:75], v[40:43], v[64:67]
    ds_read_b128 v[16:19], v12 offset:24576
    v_mfma_f32_16x16x32_bf16 v[68:71], a[76:79], v[40:43], v[68:71]
    s_waitcnt lgkmcnt(5)
    v_mfma_f32_16x16x32_bf16 v[72:75], a[72:75], v[44:47], v[72:75]
    ds_read_b128 v[20:23], v12 offset:25600
    v_mfma_f32_16x16x32_bf16 v[76:79], a[76:79], v[44:47], v[76:79]
    s_waitcnt lgkmcnt(5)
    v_mfma_f32_16x16x32_bf16 v[64:67], a[80:83], v[48:51], v[64:67]
    ds_read_b128 v[24:27], v12 offset:26624
    v_mfma_f32_16x16x32_bf16 v[68:71], a[84:87], v[48:51], v[68:71]
    s_waitcnt lgkmcnt(5)
    v_mfma_f32_16x16x32_bf16 v[72:75], a[80:83], v[52:55], v[72:75]
    ds_read_b128 v[28:31], v12 offset:27648
    v_mfma_f32_16x16x32_bf16 v[76:79], a[84:87], v[52:55], v[76:79]
    s_waitcnt lgkmcnt(5)
    v_mfma_f32_16x16x32_bf16 v[64:67], a[88:91], v[56:59], v[64:67]
    ds_read_b128 v[32:35], v12 offset:28672
    v_mfma_f32_16x16x32_bf16 v[68:71], a[92:95], v[56:59], v[68:71]
    s_waitcnt lgkmcnt(5)
    v_mfma_f32_16x16x32_bf16 v[72:75], a[88:91], v[60:63], v[72:75]
    ds_read_b128 v[36:39], v12 offset:29696
    v_mfma_f32_16x16x32_bf16 v[76:79], a[92:95], v[60:63], v[76:79]
    s_waitcnt lgkmcnt(5)
    v_mfma_f32_16x16x32_bf16 v[64:67], a[96:99], v[16:19], v[64:67]
    ds_read_b128 v[40:43], v12 offset:30720
    v_mfma_f32_16x16x32_bf16 v[68:71], a[100:103], v[16:19], v[68:71]
    s_waitcnt lgkmcnt(5)
    v_mfma_f32_16x16x32_bf16 v[72:75], a[96:99], v[20:23], v[72:75]
    ds_read_b128 v[44:47], v12 offset:31744
    v_mfma_f32_16x16x32_bf16 v[76:79], a[100:103], v[20:23], v[76:79]
    s_waitcnt lgkmcnt(5)
    v_mfma_f32_16x16x32_bf16 v[64:67], a[104:107], v[24:27], v[64:67]
    ds_read_b128 v[48:51], v12 offset:32768
    v_mfma_f32_16x16x32_bf16 v[68:71], a[108:111], v[24:27], v[68:71]
    s_waitcnt lgkmcnt(5)
    v_mfma_f32_16x16x32_bf16 v[72:75], a[104:107], v[28:31], v[72:75]
    ds_read_b128 v[52:55], v12 offset:33792
    v_mfma_f32_16x16x32_bf16 v[76:79], a[108:111], v[28:31], v[76:79]
    s_waitcnt lgkmcnt(5)
    v_mfma_f32_16x16x32_bf16 v[64:67], a[112:115], v[32:35], v[64:67]
    ds_read_b128 v[56:59], v12 offset:34816
    v_mfma_f32_16x16x32_bf16 v[68:71], a[116:119], v[32:35], v[68:71]
    s_waitcnt lgkmcnt(5)
    v_mfma_f32_16x16x32_bf16 v[72:75], a[112:115], v[36:39], v[72:75]
    ds_read_b128 v[60:63], v12 offset:35840
    v_mfma_f32_16x16x32_bf16 v[76:79], a[116:119], v[36:39], v[76:79]
    s_waitcnt lgkmcnt(5)
    v_mfma_f32_16x16x32_bf16 v[64:67], a[120:123], v[40:43], v[64:67]
    ds_read_b128 v[16:19], v12 offset:36864
    v_mfma_f32_16x16x32_bf16 v[68:71], a[124:127], v[40:43], v[68:71]
    s_waitcnt lgkmcnt(5)
    v_mfma_f32_16x16x32_bf16 v[72:75], a[120:123], v[44:47], v[72:75]
    ds_read_b128 v[20:23], v12 offset:37888
    v_mfma_f32_16x16x32_bf16 v[76:79], a[124:127], v[44:47], v[76:79]
    s_waitcnt lgkmcnt(5)
    v_mfma_f32_16x16x32_bf16 v[64:67], a[128:131], v[48:51], v[64:67]
    ds_read_b128 v[24:27], v12 offset:38912
    v_mfma_f32_16x16x32_bf16 v[68:71], a[132:135], v[48:51], v[68:71]
    s_waitcnt lgkmcnt(5)
    v_mfma_f32_16x16x32_bf16 v[72:75], a[128:131], v[52:55], v[72:75]
    ds_read_b128 v[28:31], v12 offset:39936
    v_mfma_f32_16x16x32_bf16 v[76:79], a[132:135], v[52:55], v[76:79]
    s_waitcnt lgkmcnt(5)
    v_mfma_f32_16x16x32_bf16 v[64:67], a[136:139], v[56:59], v[64:67]
    ds_read_b128 v[32:35], v12 offset:40960
    v_mfma_f32_16x16x32_bf16 v[68:71], a[140:143], v[56:59], v[68:71]
    s_waitcnt lgkmcnt(5)
    v_mfma_f32_16x16x32_bf16 v[72:75], a[136:139], v[60:63], v[72:75]
    ds_read_b128 v[36:39], v12 offset:41984
    v_mfma_f32_16x16x32_bf16 v[76:79], a[140:143], v[60:63], v[76:79]
    s_waitcnt lgkmcnt(5)
    v_mfma_f32_16x16x32_bf16 v[64:67], a[144:147], v[16:19], v[64:67]
    ds_read_b128 v[40:43], v12 offset:43008
    v_mfma_f32_16x16x32_bf16 v[68:71], a[148:151], v[16:19], v[68:71]
    s_waitcnt lgkmcnt(5)
    v_mfma_f32_16x16x32_bf16 v[72:75], a[144:147], v[20:23], v[72:75]
    ds_read_b128 v[44:47], v12 offset:44032
    v_mfma_f32_16x16x32_bf16 v[76:79], a[148:151], v[20:23], v[76:79]
    s_waitcnt lgkmcnt(5)
    v_mfma_f32_16x16x32_bf16 v[64:67], a[152:155], v[24:27], v[64:67]
    ds_read_b128 v[48:51], v12 offset:45056
    v_mfma_f32_16x16x32_bf16 v[68:71], a[156:159], v[24:27], v[68:71]
    s_waitcnt lgkmcnt(5)
    v_mfma_f32_16x16x32_bf16 v[72:75], a[152:155], v[28:31], v[72:75]
    ds_read_b128 v[52:55], v12 offset:46080
    v_mfma_f32_16x16x32_bf16 v[76:79], a[156:159], v[28:31], v[76:79]
    s_waitcnt lgkmcnt(5)
    v_mfma_f32_16x16x32_bf16 v[64:67], a[160:163], v[32:35], v[64:67]
    ds_read_b128 v[56:59], v12 offset:47104
    v_mfma_f32_16x16x32_bf16 v[68:71], a[164:167], v[32:35], v[68:71]
    s_waitcnt lgkmcnt(5)
    v_mfma_f32_16x16x32_bf16 v[72:75], a[160:163], v[36:39], v[72:75]
    ds_read_b128 v[60:63], v12 offset:48128
    v_mfma_f32_16x16x32_bf16 v[76:79], a[164:167], v[36:39], v[76:79]
    s_waitcnt lgkmcnt(5)
    v_mfma_f32_16x16x32_bf16 v[64:67], a[168:171], v[40:43], v[64:67]
    s_add_u32 s4, s41, 2048
    buffer_load_dword v6, v15, s[8:11], s4 offen sc1
    ds_read_b128 v[16:19], v12 offset:49152
    v_mfma_f32_16x16x32_bf16 v[68:71], a[172:175], v[40:43], v[68:71]
    s_waitcnt lgkmcnt(5)
    v_mfma_f32_16x16x32_bf16 v[72:75], a[168:171], v[44:47], v[72:75]
    ds_read_b128 v[20:23], v12 offset:50176
    v_mfma_f32_16x16x32_bf16 v[76:79], a[172:175], v[44:47], v[76:79]
    s_waitcnt lgkmcnt(5)
    v_mfma_f32_16x16x32_bf16 v[64:67], a[176:179], v[48:51], v[64:67]
    ds_read_b128 v[24:27], v12 offset:51200
    v_mfma_f32_16x16x32_bf16 v[68:71], a[180:183], v[48:51], v[68:71]
    s_waitcnt lgkmcnt(5)
    v_mfma_f32_16x16x32_bf16 v[72:75], a[176:179], v[52:55], v[72:75]
    ds_read_b128 v[28:31], v12 offset:52224
    v_mfma_f32_16x16x32_bf16 v[76:79], a[180:183], v[52:55], v[76:79]
    s_waitcnt lgkmcnt(5)
    v_mfma_f32_16x16x32_bf16 v[64:67], a[184:187], v[56:59], v[64:67]
    ds_read_b128 v[32:35], v12 offset:53248
    v_mfma_f32_16x16x32_bf16 v[68:71], a[188:191], v[56:59], v[68:71]
    s_waitcnt lgkmcnt(5)
    v_mfma_f32_16x16x32_bf16 v[72:75], a[184:187], v[60:63], v[72:75]
    ds_read_b128 v[36:39], v12 offset:54272
    v_mfma_f32_16x16x32_bf16 v[76:79], a[188:191], v[60:63], v[76:79]
    s_waitcnt lgkmcnt(5)
    v_mfma_f32_16x16x32_bf16 v[64:67], a[192:195], v[16:19], v[64:67]
    ds_read_b128 v[40:43], v12 offset:55296
    v_mfma_f32_16x16x32_bf16 v[68:71], a[196:199], v[16:19], v[68:71]
    s_waitcnt lgkmcnt(5)
    v_mfma_f32_16x16x32_bf16 v[72:75], a[192:195], v[20:23], v[72:75]
    ds_read_b128 v[44:47], v12 offset:56320
    v_mfma_f32_16x16x32_bf16 v[76:79], a[196:199], v[20:23], v[76:79]
    s_waitcnt lgkmcnt(5)
    v_mfma_f32_16x16x32_bf16 v[64:67], a[200:203], v[24:27], v[64:67]
    ds_read_b128 v[48:51], v12 offset:57344
    v_mfma_f32_16x16x32_bf16 v[68:71], a[204:207], v[24:27], v[68:71]
    s_waitcnt lgkmcnt(5)
    v_mfma_f32_16x16x32_bf16 v[72:75], a[200:203], v[28:31], v[72:75]
    ds_read_b128 v[52:55], v12 offset:58368
    v_mfma_f32_16x16x32_bf16 v[76:79], a[204:207], v[28:31], v[76:79]
    s_waitcnt lgkmcnt(5)
    v_mfma_f32_16x16x32_bf16 v[64:67], a[208:211], v[32:35], v[64:67]
    ds_read_b128 v[56:59], v12 offset:59392
    v_mfma_f32_16x16x32_bf16 v[68:71], a[212:215], v[32:35], v[68:71]
    s_waitcnt lgkmcnt(5)
    v_mfma_f32_16x16x32_bf16 v[72:75], a[208:211], v[36:39], v[72:75]
    ds_read_b128 v[60:63], v12 offset:60416
    v_mfma_f32_16x16x32_bf16 v[76:79], a[212:215], v[36:39], v[76:79]
    s_waitcnt lgkmcnt(5)
    v_mfma_f32_16x16x32_bf16 v[64:67], a[216:219], v[40:43], v[64:67]
    ds_read_b128 v[16:19], v12 offset:61440
    v_mfma_f32_16x16x32_bf16 v[68:71], a[220:223], v[40:43], v[68:71]
    s_waitcnt lgkmcnt(5)
    v_mfma_f32_16x16x32_bf16 v[72:75], a[216:219], v[44:47], v[72:75]
    ds_read_b128 v[20:23], v12 offset:62464
    v_mfma_f32_16x16x32_bf16 v[76:79], a[220:223], v[44:47], v[76:79]
    s_waitcnt lgkmcnt(5)
    v_mfma_f32_16x16x32_bf16 v[64:67], a[224:227], v[48:51], v[64:67]
    ds_read_b128 v[24:27], v12 offset:63488
    v_mfma_f32_16x16x32_bf16 v[68:71], a[228:231], v[48:51], v[68:71]
    s_waitcnt lgkmcnt(5)
    v_mfma_f32_16x16x32_bf16 v[72:75], a[224:227], v[52:55], v[72:75]
    ds_read_b128 v[28:31], v12 offset:64512
    v_mfma_f32_16x16x32_bf16 v[76:79], a[228:231], v[52:55], v[76:79]
    s_waitcnt lgkmcnt(5)
    v_mfma_f32_16x16x32_bf16 v[64:67], a[232:235], v[56:59], v[64:67]
    v_mfma_f32_16x16x32_bf16 v[68:71], a[236:239], v[56:59], v[68:71]
    s_waitcnt lgkmcnt(4)
    v_mfma_f32_16x16x32_bf16 v[72:75], a[232:235], v[60:63], v[72:75]
    v_mfma_f32_16x16x32_bf16 v[76:79], a[236:239], v[60:63], v[76:79]
    s_waitcnt lgkmcnt(3)
    v_mfma_f32_16x16x32_bf16 v[64:67], a[240:243], v[16:19], v[64:67]
    v_mfma_f32_16x16x32_bf16 v[68:71], a[244:247], v[16:19], v[68:71]
    s_waitcnt lgkmcnt(2)
    v_mfma_f32_16x16x32_bf16 v[72:75], a[240:243], v[20:23], v[72:75]
    v_mfma_f32_16x16x32_bf16 v[76:79], a[244:247], v[20:23], v[76:79]
    s_waitcnt lgkmcnt(1)
    v_mfma_f32_16x16x32_bf16 v[64:67], a[248:251], v[24:27], v[64:67]
    v_mfma_f32_16x16x32_bf16 v[68:71], a[252:255], v[24:27], v[68:71]
    s_waitcnt lgkmcnt(0)
    v_mfma_f32_16x16x32_bf16 v[72:75], a[248:251], v[28:31], v[72:75]
    v_mfma_f32_16x16x32_bf16 v[76:79], a[252:255], v[28:31], v[76:79]
    s_branch L_sgu_T
L_sd:
    s_and_b32 s41, s55, 2047
    s_add_u32 s41, s41, 243318784
    s_bfe_u32 s35, s55, 0xb000b
    s_add_u32 s35, s35, 243318784
    s_lshr_b32 s36, s55, 22
    v_lshrrev_b32 v4, 3, v1
    v_mul_lo_u32 v4, v4, s33
    v_and_b32 v5, 7, v1
    v_lshl_add_u32 v8, v5, 4, v4
    s_and_b32 s6, s21, 1
    s_lshl_b32 s4, s6, 6
    s_mul_i32 s4, s4, s33
    s_add_u32 s31, s31, s4
    v_lshrrev_b32 v4, 2, v1
    v_lshlrev_b32 v4, 7, v4
    v_and_b32 v5, 3, v1
    v_lshl_add_u32 v4, v5, 3, v4
    s_lshr_b32 s4, s21, 1
    s_lshl_b32 s4, s4, 14
    s_lshl_b32 s5, s6, 6
    s_add_u32 s4, s4, s5
    s_add_u32 s5, s4, 32
    v_add_u32 v9, s4, v4
    v_add_u32 v10, s5, v4
    s_lshl_b32 s40, s21, 13
    s_lshl_b32 s34, s33, 3
    s_mul_i32 s7, s33, 72
    s_add_u32 m0, s40, 0
    s_nop 0
    buffer_load_dwordx4 v8, s[12:15], s31 offen nt lds
    s_add_u32 s31, s31, s34
    s_add_u32 m0, s40, 1024
    s_nop 0
    buffer_load_dwordx4 v8, s[12:15], s31 offen nt lds
    s_add_u32 s31, s31, s34
    s_add_u32 m0, s40, 2048
    s_nop 0
    buffer_load_dwordx4 v8, s[12:15], s31 offen nt lds
    s_add_u32 s31, s31, s34
    s_add_u32 m0, s40, 3072
    s_nop 0
    buffer_load_dwordx4 v8, s[12:15], s31 offen nt lds
    s_add_u32 s31, s31, s34
    s_add_u32 m0, s40, 4096
    s_nop 0
    buffer_load_dwordx4 v8, s[12:15], s31 offen nt lds
    s_add_u32 s31, s31, s34
    s_add_u32 m0, s40, 5120
    s_nop 0
    buffer_load_dwordx4 v8, s[12:15], s31 offen nt lds
    s_add_u32 s31, s31, s34
    s_add_u32 m0, s40, 6144
    s_nop 0
    buffer_load_dwordx4 v8, s[12:15], s31 offen nt lds
    s_add_u32 s31, s31, s34
    s_add_u32 m0, s40, 7168
    s_nop 0
    buffer_load_dwordx4 v8, s[12:15], s31 offen nt lds
    s_add_u32 s31, s31, s7
    s_add_u32 m0, s40, 32768
    s_nop 0
    buffer_load_dwordx4 v8, s[12:15], s31 offen nt lds
    s_add_u32 s31, s31, s34
    s_add_u32 m0, s40, 33792
    s_nop 0
    buffer_load_dwordx4 v8, s[12:15], s31 offen nt lds
    s_add_u32 s31, s31, s34
    s_add_u32 m0, s40, 34816
    s_nop 0
    buffer_load_dwordx4 v8, s[12:15], s31 offen nt lds
    s_add_u32 s31, s31, s34
    s_add_u32 m0, s40, 35840
    s_nop 0
    buffer_load_dwordx4 v8, s[12:15], s31 offen nt lds
    s_add_u32 s31, s31, s34
    s_add_u32 m0, s40, 36864
    s_nop 0
    buffer_load_dwordx4 v8, s[12:15], s31 offen nt lds
    s_add_u32 s31, s31, s34
    s_add_u32 m0, s40, 37888
    s_nop 0
    buffer_load_dwordx4 v8, s[12:15], s31 offen nt lds
    s_add_u32 s31, s31, s34
    s_add_u32 m0, s40, 38912
    s_nop 0
    buffer_load_dwordx4 v8, s[12:15], s31 offen nt lds
    s_add_u32 s31, s31, s34
    s_add_u32 m0, s40, 39936
    s_nop 0
    buffer_load_dwordx4 v8, s[12:15], s31 offen nt lds
    s_add_u32 s31, s31, s7
    s_add_u32 m0, s40, 65536
    s_nop 0
    buffer_load_dwordx4 v8, s[12:15], s31 offen nt lds
    s_add_u32 s31, s31, s34
    s_add_u32 m0, s40, 66560
    s_nop 0
    buffer_load_dwordx4 v8, s[12:15], s31 offen nt lds
    s_add_u32 s31, s31, s34
    s_add_u32 m0, s40, 67584
    s_nop 0
    buffer_load_dwordx4 v8, s[12:15], s31 offen nt lds
    s_add_u32 s31, s31, s34
    s_add_u32 m0, s40, 68608
    s_nop 0
    buffer_load_dwordx4 v8, s[12:15], s31 offen nt lds
    s_add_u32 s31, s31, s34
    s_add_u32 m0, s40, 69632
    s_nop 0
    buffer_load_dwordx4 v8, s[12:15], s31 offen nt lds
    s_add_u32 s31, s31, s34
    s_add_u32 m0, s40, 70656
    s_nop 0
    buffer_load_dwordx4 v8, s[12:15], s31 offen nt lds
    s_add_u32 s31, s31, s34
    s_add_u32 m0, s40, 71680
    s_nop 0
    buffer_load_dwordx4 v8, s[12:15], s31 offen nt lds
    s_add_u32 s31, s31, s34
    s_add_u32 m0, s40, 72704
    s_nop 0
    buffer_load_dwordx4 v8, s[12:15], s31 offen nt lds
    s_add_u32 s31, s31, s7
    s_add_u32 m0, s40, 98304
    s_nop 0
    buffer_load_dwordx4 v8, s[12:15], s31 offen nt lds
    s_add_u32 s31, s31, s34
    s_add_u32 m0, s40, 99328
    s_nop 0
    buffer_load_dwordx4 v8, s[12:15], s31 offen nt lds
    s_add_u32 s31, s31, s34
    s_add_u32 m0, s40, 100352
    s_nop 0
    buffer_load_dwordx4 v8, s[12:15], s31 offen nt lds
    s_add_u32 s31, s31, s34
    s_add_u32 m0, s40, 101376
    s_nop 0
    buffer_load_dwordx4 v8, s[12:15], s31 offen nt lds
    s_add_u32 s31, s31, s34
    s_add_u32 m0, s40, 102400
    s_nop 0
    buffer_load_dwordx4 v8, s[12:15], s31 offen nt lds
    s_add_u32 s31, s31, s34
    s_add_u32 m0, s40, 103424
    s_nop 0
    buffer_load_dwordx4 v8, s[12:15], s31 offen nt lds
    s_add_u32 s31, s31, s34
    s_add_u32 m0, s40, 104448
    s_nop 0
    buffer_load_dwordx4 v8, s[12:15], s31 offen nt lds
    s_add_u32 s31, s31, s34
    s_add_u32 m0, s40, 105472
    s_nop 0
    buffer_load_dwordx4 v8, s[12:15], s31 offen nt lds
    s_add_u32 s31, s31, s7
    s_waitcnt vmcnt(24)
    s_barrier
    v_add_u32 v4, 0, v9
    v_add_u32 v5, 0, v10
    ds_read_b64_tr_b16 a[0:1], v4 offset:0
    ds_read_b64_tr_b16 a[2:3], v4 offset:2048
    ds_read_b64_tr_b16 a[4:5], v5 offset:0
    ds_read_b64_tr_b16 a[6:7], v5 offset:2048
    ds_read_b64_tr_b16 a[8:9], v4 offset:4096
    ds_read_b64_tr_b16 a[10:11], v4 offset:6144
    ds_read_b64_tr_b16 a[12:13], v5 offset:4096
    ds_read_b64_tr_b16 a[14:15], v5 offset:6144
    ds_read_b64_tr_b16 a[16:17], v4 offset:8192
    ds_read_b64_tr_b16 a[18:19], v4 offset:10240
    ds_read_b64_tr_b16 a[20:21], v5 offset:8192
    ds_read_b64_tr_b16 a[22:23], v5 offset:10240
    ds_read_b64_tr_b16 a[24:25], v4 offset:12288
    ds_read_b64_tr_b16 a[26:27], v4 offset:14336
    ds_read_b64_tr_b16 a[28:29], v5 offset:12288
    ds_read_b64_tr_b16 a[30:31], v5 offset:14336
    s_waitcnt lgkmcnt(0)
    s_barrier
    s_add_u32 m0, s40, 0
    s_nop 0
    buffer_load_dwordx4 v8, s[12:15], s31 offen nt lds
    s_add_u32 s31, s31, s34
    s_add_u32 m0, s40, 1024
    s_nop 0
    buffer_load_dwordx4 v8, s[12:15], s31 offen nt lds
    s_add_u32 s31, s31, s34
    s_add_u32 m0, s40, 2048
    s_nop 0
    buffer_load_dwordx4 v8, s[12:15], s31 offen nt lds
    s_add_u32 s31, s31, s34
    s_add_u32 m0, s40, 3072
    s_nop 0
    buffer_load_dwordx4 v8, s[12:15], s31 offen nt lds
    s_add_u32 s31, s31, s34
    s_add_u32 m0, s40, 4096
    s_nop 0
    buffer_load_dwordx4 v8, s[12:15], s31 offen nt lds
    s_add_u32 s31, s31, s34
    s_add_u32 m0, s40, 5120
    s_nop 0
    buffer_load_dwordx4 v8, s[12:15], s31 offen nt lds
    s_add_u32 s31, s31, s34
    s_add_u32 m0, s40, 6144
    s_nop 0
    buffer_load_dwordx4 v8, s[12:15], s31 offen nt lds
    s_add_u32 s31, s31, s34
    s_add_u32 m0, s40, 7168
    s_nop 0
    buffer_load_dwordx4 v8, s[12:15], s31 offen nt lds
    s_add_u32 s31, s31, s7
    s_waitcnt vmcnt(24)
    s_barrier
    v_add_u32 v4, 32768, v9
    v_add_u32 v5, 32768, v10
    ds_read_b64_tr_b16 a[32:33], v4 offset:0
    ds_read_b64_tr_b16 a[34:35], v4 offset:2048
    ds_read_b64_tr_b16 a[36:37], v5 offset:0
    ds_read_b64_tr_b16 a[38:39], v5 offset:2048
    ds_read_b64_tr_b16 a[40:41], v4 offset:4096
    ds_read_b64_tr_b16 a[42:43], v4 offset:6144
    ds_read_b64_tr_b16 a[44:45], v5 offset:4096
    ds_read_b64_tr_b16 a[46:47], v5 offset:6144
    ds_read_b64_tr_b16 a[48:49], v4 offset:8192
    ds_read_b64_tr_b16 a[50:51], v4 offset:10240
    ds_read_b64_tr_b16 a[52:53], v5 offset:8192
    ds_read_b64_tr_b16 a[54:55], v5 offset:10240
    ds_read_b64_tr_b16 a[56:57], v4 offset:12288
    ds_read_b64_tr_b16 a[58:59], v4 offset:14336
    ds_read_b64_tr_b16 a[60:61], v5 offset:12288
    ds_read_b64_tr_b16 a[62:63], v5 offset:14336
    s_waitcnt lgkmcnt(0)
    s_barrier
    s_add_u32 m0, s40, 32768
    s_nop 0
    buffer_load_dwordx4 v8, s[12:15], s31 offen nt lds
    s_add_u32 s31, s31, s34
    s_add_u32 m0, s40, 33792
    s_nop 0
    buffer_load_dwordx4 v8, s[12:15], s31 offen nt lds
    s_add_u32 s31, s31, s34
    s_add_u32 m0, s40, 34816
    s_nop 0
    buffer_load_dwordx4 v8, s[12:15], s31 offen nt lds
    s_add_u32 s31, s31, s34
    s_add_u32 m0, s40, 35840
    s_nop 0
    buffer_load_dwordx4 v8, s[12:15], s31 offen nt lds
    s_add_u32 s31, s31, s34
    s_add_u32 m0, s40, 36864
    s_nop 0
    buffer_load_dwordx4 v8, s[12:15], s31 offen nt lds
    s_add_u32 s31, s31, s34
    s_add_u32 m0, s40, 37888
    s_nop 0
    buffer_load_dwordx4 v8, s[12:15], s31 offen nt lds
    s_add_u32 s31, s31, s34
    s_add_u32 m0, s40, 38912
    s_nop 0
    buffer_load_dwordx4 v8, s[12:15], s31 offen nt lds
    s_add_u32 s31, s31, s34
    s_add_u32 m0, s40, 39936
    s_nop 0
    buffer_load_dwordx4 v8, s[12:15], s31 offen nt lds
    s_add_u32 s31, s31, s7
    s_waitcnt vmcnt(24)
    s_barrier
    v_add_u32 v4, 65536, v9
    v_add_u32 v5, 65536, v10
    ds_read_b64_tr_b16 a[64:65], v4 offset:0
    ds_read_b64_tr_b16 a[66:67], v4 offset:2048
    ds_read_b64_tr_b16 a[68:69], v5 offset:0
    ds_read_b64_tr_b16 a[70:71], v5 offset:2048
    ds_read_b64_tr_b16 a[72:73], v4 offset:4096
    ds_read_b64_tr_b16 a[74:75], v4 offset:6144
    ds_read_b64_tr_b16 a[76:77], v5 offset:4096
    ds_read_b64_tr_b16 a[78:79], v5 offset:6144
    ds_read_b64_tr_b16 a[80:81], v4 offset:8192
    ds_read_b64_tr_b16 a[82:83], v4 offset:10240
    ds_read_b64_tr_b16 a[84:85], v5 offset:8192
    ds_read_b64_tr_b16 a[86:87], v5 offset:10240
    ds_read_b64_tr_b16 a[88:89], v4 offset:12288
    ds_read_b64_tr_b16 a[90:91], v4 offset:14336
    ds_read_b64_tr_b16 a[92:93], v5 offset:12288
    ds_read_b64_tr_b16 a[94:95], v5 offset:14336
    s_waitcnt lgkmcnt(0)
    s_barrier
    s_add_u32 m0, s40, 65536
    s_nop 0
    buffer_load_dwordx4 v8, s[12:15], s31 offen nt lds
    s_add_u32 s31, s31, s34
    s_add_u32 m0, s40, 66560
    s_nop 0
    buffer_load_dwordx4 v8, s[12:15], s31 offen nt lds
    s_add_u32 s31, s31, s34
    s_add_u32 m0, s40, 67584
    s_nop 0
    buffer_load_dwordx4 v8, s[12:15], s31 offen nt lds
    s_add_u32 s31, s31, s34
    s_add_u32 m0, s40, 68608
    s_nop 0
    buffer_load_dwordx4 v8, s[12:15], s31 offen nt lds
    s_add_u32 s31, s31, s34
    s_add_u32 m0, s40, 69632
    s_nop 0
    buffer_load_dwordx4 v8, s[12:15], s31 offen nt lds
    s_add_u32 s31, s31, s34
    s_add_u32 m0, s40, 70656
    s_nop 0
    buffer_load_dwordx4 v8, s[12:15], s31 offen nt lds
    s_add_u32 s31, s31, s34
    s_add_u32 m0, s40, 71680
    s_nop 0
    buffer_load_dwordx4 v8, s[12:15], s31 offen nt lds
    s_add_u32 s31, s31, s34
    s_add_u32 m0, s40, 72704
    s_nop 0
    buffer_load_dwordx4 v8, s[12:15], s31 offen nt lds
    s_add_u32 s31, s31, s7
    s_waitcnt vmcnt(24)
    s_barrier
    v_add_u32 v4, 98304, v9
    v_add_u32 v5, 98304, v10
    ds_read_b64_tr_b16 a[96:97], v4 offset:0
    ds_read_b64_tr_b16 a[98:99], v4 offset:2048
    ds_read_b64_tr_b16 a[100:101], v5 offset:0
    ds_read_b64_tr_b16 a[102:103], v5 offset:2048
    ds_read_b64_tr_b16 a[104:105], v4 offset:4096
    ds_read_b64_tr_b16 a[106:107], v4 offset:6144
    ds_read_b64_tr_b16 a[108:109], v5 offset:4096
    ds_read_b64_tr_b16 a[110:111], v5 offset:6144
    ds_read_b64_tr_b16 a[112:113], v4 offset:8192
    ds_read_b64_tr_b16 a[114:115], v4 offset:10240
    ds_read_b64_tr_b16 a[116:117], v5 offset:8192
    ds_read_b64_tr_b16 a[118:119], v5 offset:10240
    ds_read_b64_tr_b16 a[120:121], v4 offset:12288
    ds_read_b64_tr_b16 a[122:123], v4 offset:14336
    ds_read_b64_tr_b16 a[124:125], v5 offset:12288
    ds_read_b64_tr_b16 a[126:127], v5 offset:14336
    s_waitcnt lgkmcnt(0)
    s_barrier
    s_waitcnt vmcnt(16)
    s_barrier
    v_add_u32 v4, 0, v9
    v_add_u32 v5, 0, v10
    ds_read_b64_tr_b16 a[128:129], v4 offset:0
    ds_read_b64_tr_b16 a[130:131], v4 offset:2048
    ds_read_b64_tr_b16 a[132:133], v5 offset:0
    ds_read_b64_tr_b16 a[134:135], v5 offset:2048
    ds_read_b64_tr_b16 a[136:137], v4 offset:4096
    ds_read_b64_tr_b16 a[138:139], v4 offset:6144
    ds_read_b64_tr_b16 a[140:141], v5 offset:4096
    ds_read_b64_tr_b16 a[142:143], v5 offset:6144
    ds_read_b64_tr_b16 a[144:145], v4 offset:8192
    ds_read_b64_tr_b16 a[146:147], v4 offset:10240
    ds_read_b64_tr_b16 a[148:149], v5 offset:8192
    ds_read_b64_tr_b16 a[150:151], v5 offset:10240
    ds_read_b64_tr_b16 a[152:153], v4 offset:12288
    ds_read_b64_tr_b16 a[154:155], v4 offset:14336
    ds_read_b64_tr_b16 a[156:157], v5 offset:12288
    ds_read_b64_tr_b16 a[158:159], v5 offset:14336
    s_waitcnt lgkmcnt(0)
    s_barrier
    s_waitcnt vmcnt(8)
    s_barrier
    v_add_u32 v4, 32768, v9
    v_add_u32 v5, 32768, v10
    ds_read_b64_tr_b16 a[160:161], v4 offset:0
    ds_read_b64_tr_b16 a[162:163], v4 offset:2048
    ds_read_b64_tr_b16 a[164:165], v5 offset:0
    ds_read_b64_tr_b16 a[166:167], v5 offset:2048
    ds_read_b64_tr_b16 a[168:169], v4 offset:4096
    ds_read_b64_tr_b16 a[170:171], v4 offset:6144
    ds_read_b64_tr_b16 a[172:173], v5 offset:4096
    ds_read_b64_tr_b16 a[174:175], v5 offset:6144
    ds_read_b64_tr_b16 a[176:177], v4 offset:8192
    ds_read_b64_tr_b16 a[178:179], v4 offset:10240
    ds_read_b64_tr_b16 a[180:181], v5 offset:8192
    ds_read_b64_tr_b16 a[182:183], v5 offset:10240
    ds_read_b64_tr_b16 a[184:185], v4 offset:12288
    ds_read_b64_tr_b16 a[186:187], v4 offset:14336
    ds_read_b64_tr_b16 a[188:189], v5 offset:12288
    ds_read_b64_tr_b16 a[190:191], v5 offset:14336
    s_waitcnt lgkmcnt(0)
    s_barrier
    s_waitcnt vmcnt(0)
    s_barrier
    v_add_u32 v4, 65536, v9
    v_add_u32 v5, 65536, v10
    ds_read_b64_tr_b16 a[192:193], v4 offset:0
    ds_read_b64_tr_b16 a[194:195], v4 offset:2048
    ds_read_b64_tr_b16 a[196:197], v5 offset:0
    ds_read_b64_tr_b16 a[198:199], v5 offset:2048
    ds_read_b64_tr_b16 a[200:201], v4 offset:4096
    ds_read_b64_tr_b16 a[202:203], v4 offset:6144
    ds_read_b64_tr_b16 a[204:205], v5 offset:4096
    ds_read_b64_tr_b16 a[206:207], v5 offset:6144
    ds_read_b64_tr_b16 a[208:209], v4 offset:8192
    ds_read_b64_tr_b16 a[210:211], v4 offset:10240
    ds_read_b64_tr_b16 a[212:213], v5 offset:8192
    ds_read_b64_tr_b16 a[214:215], v5 offset:10240
    ds_read_b64_tr_b16 a[216:217], v4 offset:12288
    ds_read_b64_tr_b16 a[218:219], v4 offset:14336
    ds_read_b64_tr_b16 a[220:221], v5 offset:12288
    ds_read_b64_tr_b16 a[222:223], v5 offset:14336
    s_waitcnt lgkmcnt(0)
    s_barrier
    s_mul_i32 s4, s6, s32
    s_lshr_b32 s5, s21, 1
    s_lshl_b32 s5, s5, 10
    s_add_u32 s4, s4, s5
    v_add_u32 v11, s4, v2
    s_lshl_b32 s40, s21, 10
    v_lshlrev_b32 v14, 3, v1
    v_mov_b32 v12, v14
    v_mov_b32 v13, 159232
    s_lshl_b32 s45, s32, 1
    s_lshl_b32 s46, s38, 1
    s_lshl_b32 s4, s21, 10
    s_add_u32 s37, s37, s4
    s_mov_b32 s43, 0
    s_cmp_eq_u32 s21, 0
    s_cselect_b32 s4, 0, 0x80000000
    v_mov_b32 v15, 0x80000000
    v_writelane_b32 v15, s4, 0
    s_add_u32 s4, s4, 2048
    v_writelane_b32 v15, s4, 1
    v_lshl_add_u32 v13, v1, 2, v13
    s_and_b32 s4, s49, 15
    s_lshr_b32 s5, s49, 4
    s_mul_i32 s5, s5, s21
    s_add_u32 s4, s4, s5
    s_sub_u32 s4, 13, s4
    s_cselect_b32 s5, 0x80000000, 0
    s_lshl_b32 s4, s4, 11
    s_and_b32 s4, s4, 0xffff
    s_or_b32 s4, s4, s5
    v_and_b32 v4, 15, v1
    v_lshlrev_b32 v4, 6, v4
    v_lshrrev_b32 v5, 5, v1
    v_lshl_add_u32 v4, v5, 10, v4
    v_bfe_u32 v5, v1, 4, 1
    v_mul_lo_u32 v5, v5, s32
    v_add3_u32 v3, v4, v5, s4
L_sd_L:
    s_cmp_lg_u32 s21, 0
    s_cbranch_scc1 L_sd_Lw
    v_mov_b32 v4, 0
    s_mov_b64 exec, 1
L_sd_p:
    v_mov_b32 v5, 0
    buffer_atomic_add v5, v4, s[8:11], s41 offen sc0
    s_sub_u32 s62, s62, 1
    s_cbranch_scc1 L_w_fail
    s_waitcnt vmcnt(0)
    v_cmp_gt_u32 vcc, s36, v5
    s_cbranch_vccz L_sd_p_ok
    s_sleep 1
    s_branch L_sd_p
L_sd_p_ok:
    s_mov_b64 exec, -1
L_sd_Lw:
    s_barrier
    s_add_u32 m0, s40, 0
    s_add_u32 s47, s30, 0
    buffer_load_dwordx4 v11, s[8:11], s47 offen sc1 lds
    s_add_u32 m0, s40, 4096
    s_add_u32 s47, s30, 2048
    buffer_load_dwordx4 v11, s[8:11], s47 offen sc1 lds
    s_add_u32 m0, s40, 8192
    s_add_u32 s47, s30, 4096
    buffer_load_dwordx4 v11, s[8:11], s47 offen sc1 lds
    s_add_u32 m0, s40, 12288
    s_add_u32 s47, s30, 6144
    buffer_load_dwordx4 v11, s[8:11], s47 offen sc1 lds
    s_add_u32 m0, s40, 16384
    s_add_u32 s47, s30, 8192
    buffer_load_dwordx4 v11, s[8:11], s47 offen sc1 lds
    s_add_u32 m0, s40, 20480
    s_add_u32 s47, s30, 10240
    buffer_load_dwordx4 v11, s[8:11], s47 offen sc1 lds
    s_add_u32 m0, s40, 24576
    s_add_u32 s47, s30, 12288
    buffer_load_dwordx4 v11, s[8:11], s47 offen sc1 lds
    s_add_u32 m0, s40, 28672
    s_add_u32 s47, s30, 14336
    buffer_load_dwordx4 v11, s[8:11], s47 offen sc1 lds
    s_add_u32 m0, s40, 32768
    s_add_u32 s47, s30, 16384
    buffer_load_dwordx4 v11, s[8:11], s47 offen sc1 lds
    s_add_u32 m0, s40, 36864
    s_add_u32 s47, s30, 18432
    buffer_load_dwordx4 v11, s[8:11], s47 offen sc1 lds
    s_add_u32 m0, s40, 40960
    s_add_u32 s47, s30, 20480
    buffer_load_dwordx4 v11, s[8:11], s47 offen sc1 lds
    s_add_u32 m0, s40, 45056
    s_add_u32 s47, s30, 22528
    buffer_load_dwordx4 v11, s[8:11], s47 offen sc1 lds
    s_add_u32 m0, s40, 49152
    s_add_u32 s47, s30, 24576
    buffer_load_dwordx4 v11, s[8:11], s47 offen sc1 lds
    s_add_u32 m0, s40, 53248
    s_add_u32 s47, s30, 26624
    buffer_load_dwordx4 v11, s[8:11], s47 offen sc1 lds
    s_xor_b32 s40, s40, 65536
    s_add_u32 s30, s30, s45
L_sd_L2:
    s_waitcnt vmcnt(10)
    s_barrier
    ds_read_b64 v[16:17], v12 offset:0
    ds_read_b64 v[18:19], v12 offset:512
    ds_read_b64 v[20:21], v12 offset:1024
    ds_read_b64 v[22:23], v12 offset:1536
    ds_read_b64 v[24:25], v12 offset:2048
    ds_read_b64 v[26:27], v12 offset:2560
    ds_read_b64 v[28:29], v12 offset:3072
    ds_read_b64 v[30:31], v12 offset:3584
    ds_read_b64 v[32:33], v12 offset:4096
    ds_read_b64 v[34:35], v12 offset:4608
    ds_read_b64 v[36:37], v12 offset:5120
    ds_read_b64 v[38:39], v12 offset:5632
    s_waitcnt lgkmcnt(10)
    v_mfma_f32_16x16x32_bf16 v[64:67], a[0:3], v[16:19], 0
    ds_read_b64 v[40:41], v12 offset:6144
    ds_read_b64 v[42:43], v12 offset:6656
    v_mfma_f32_16x16x32_bf16 v[68:71], a[4:7], v[16:19], 0
    s_waitcnt lgkmcnt(10)
    v_mfma_f32_16x16x32_bf16 v[72:75], a[0:3], v[20:23], 0
    ds_read_b64 v[44:45], v12 offset:7168
    ds_read_b64 v[46:47], v12 offset:7680
    v_mfma_f32_16x16x32_bf16 v[76:79], a[4:7], v[20:23], 0
    s_waitcnt lgkmcnt(10)
    v_mfma_f32_16x16x32_bf16 v[64:67], a[8:11], v[24:27], v[64:67]
    ds_read_b64 v[48:49], v12 offset:8192
    ds_read_b64 v[50:51], v12 offset:8704
    v_mfma_f32_16x16x32_bf16 v[68:71], a[12:15], v[24:27], v[68:71]
    s_waitcnt lgkmcnt(10)
    v_mfma_f32_16x16x32_bf16 v[72:75], a[8:11], v[28:31], v[72:75]
    ds_read_b64 v[52:53], v12 offset:9216
    ds_read_b64 v[54:55], v12 offset:9728
    v_mfma_f32_16x16x32_bf16 v[76:79], a[12:15], v[28:31], v[76:79]
    s_waitcnt lgkmcnt(10)
    v_mfma_f32_16x16x32_bf16 v[64:67], a[16:19], v[32:35], v[64:67]
    ds_read_b64 v[56:57], v12 offset:10240
    ds_read_b64 v[58:59], v12 offset:10752
    v_mfma_f32_16x16x32_bf16 v[68:71], a[20:23], v[32:35], v[68:71]
    s_waitcnt lgkmcnt(10)
    v_mfma_f32_16x16x32_bf16 v[72:75], a[16:19], v[36:39], v[72:75]
    ds_read_b64 v[60:61], v12 offset:11264
    ds_read_b64 v[62:63], v12 offset:11776
    v_mfma_f32_16x16x32_bf16 v[76:79], a[20:23], v[36:39], v[76:79]
    s_waitcnt lgkmcnt(10)
    v_mfma_f32_16x16x32_bf16 v[64:67], a[24:27], v[40:43], v[64:67]
    ds_read_b64 v[16:17], v12 offset:12288
    ds_read_b64 v[18:19], v12 offset:12800
    v_mfma_f32_16x16x32_bf16 v[68:71], a[28:31], v[40:43], v[68:71]
    s_waitcnt lgkmcnt(10)
    v_mfma_f32_16x16x32_bf16 v[72:75], a[24:27], v[44:47], v[72:75]
    ds_read_b64 v[20:21], v12 offset:13312
    ds_read_b64 v[22:23], v12 offset:13824
    v_mfma_f32_16x16x32_bf16 v[76:79], a[28:31], v[44:47], v[76:79]
    s_waitcnt lgkmcnt(10)
    v_mfma_f32_16x16x32_bf16 v[64:67], a[32:35], v[48:51], v[64:67]
    s_waitcnt vmcnt(7)
    s_barrier
    ds_read_b64 v[24:25], v12 offset:14336
    ds_read_b64 v[26:27], v12 offset:14848
    v_mfma_f32_16x16x32_bf16 v[68:71], a[36:39], v[48:51], v[68:71]
    s_waitcnt lgkmcnt(10)
    v_mfma_f32_16x16x32_bf16 v[72:75], a[32:35], v[52:55], v[72:75]
    ds_read_b64 v[28:29], v12 offset:15360
    ds_read_b64 v[30:31], v12 offset:15872
    v_mfma_f32_16x16x32_bf16 v[76:79], a[36:39], v[52:55], v[76:79]
    s_waitcnt lgkmcnt(10)
    v_mfma_f32_16x16x32_bf16 v[64:67], a[40:43], v[56:59], v[64:67]
    ds_read_b64 v[32:33], v12 offset:16384
    ds_read_b64 v[34:35], v12 offset:16896
    v_mfma_f32_16x16x32_bf16 v[68:71], a[44:47], v[56:59], v[68:71]
    s_waitcnt lgkmcnt(10)
    v_mfma_f32_16x16x32_bf16 v[72:75], a[40:43], v[60:63], v[72:75]
    ds_read_b64 v[36:37], v12 offset:17408
    ds_read_b64 v[38:39], v12 offset:17920
    v_mfma_f32_16x16x32_bf16 v[76:79], a[44:47], v[60:63], v[76:79]
    s_waitcnt lgkmcnt(10)
    v_mfma_f32_16x16x32_bf16 v[64:67], a[48:51], v[16:19], v[64:67]
    ds_read_b64 v[40:41], v12 offset:18432
    ds_read_b64 v[42:43], v12 offset:18944
    v_mfma_f32_16x16x32_bf16 v[68:71], a[52:55], v[16:19], v[68:71]
    s_waitcnt lgkmcnt(10)
    v_mfma_f32_16x16x32_bf16 v[72:75], a[48:51], v[20:23], v[72:75]
    ds_read_b64 v[44:45], v12 offset:19456
    ds_read_b64 v[46:47], v12 offset:19968
    v_mfma_f32_16x16x32_bf16 v[76:79], a[52:55], v[20:23], v[76:79]
    s_waitcnt lgkmcnt(10)
    v_mfma_f32_16x16x32_bf16 v[64:67], a[56:59], v[24:27], v[64:67]
    ds_read_b64 v[48:49], v12 offset:20480
    ds_read_b64 v[50:51], v12 offset:20992
    v_mfma_f32_16x16x32_bf16 v[68:71], a[60:63], v[24:27], v[68:71]
    s_waitcnt lgkmcnt(10)
    v_mfma_f32_16x16x32_bf16 v[72:75], a[56:59], v[28:31], v[72:75]
    ds_read_b64 v[52:53], v12 offset:21504
    ds_read_b64 v[54:55], v12 offset:22016
    v_mfma_f32_16x16x32_bf16 v[76:79], a[60:63], v[28:31], v[76:79]
    s_waitcnt lgkmcnt(10)
    v_mfma_f32_16x16x32_bf16 v[64:67], a[64:67], v[32:35], v[64:67]
    ds_read_b64 v[56:57], v12 offset:22528
    ds_read_b64 v[58:59], v12 offset:23040
    v_mfma_f32_16x16x32_bf16 v[68:71], a[68:71], v[32:35], v[68:71]
    s_waitcnt lgkmcnt(10)
    v_mfma_f32_16x16x32_bf16 v[72:75], a[64:67], v[36:39], v[72:75]
    ds_read_b64 v[60:61], v12 offset:23552
    ds_read_b64 v[62:63], v12 offset:24064
    v_mfma_f32_16x16x32_bf16 v[76:79], a[68:71], v[36:39], v[76:79]
    s_waitcnt lgkmcnt(10)
    v_mfma_f32_16x16x32_bf16 v[64:67], a[72:75], v[40:43], v[64:67]
    ds_read_b64 v[16:17], v12 offset:24576
    ds_read_b64 v[18:19], v12 offset:25088
    v_mfma_f32_16x16x32_bf16 v[68:71], a[76:79], v[40:43], v[68:71]
    s_waitcnt lgkmcnt(10)
    v_mfma_f32_16x16x32_bf16 v[72:75], a[72:75], v[44:47], v[72:75]
    ds_read_b64 v[20:21], v12 offset:25600
    ds_read_b64 v[22:23], v12 offset:26112
    v_mfma_f32_16x16x32_bf16 v[76:79], a[76:79], v[44:47], v[76:79]
    s_waitcnt lgkmcnt(10)
    v_mfma_f32_16x16x32_bf16 v[64:67], a[80:83], v[48:51], v[64:67]
    ds_read_b64 v[24:25], v12 offset:26624
    ds_read_b64 v[26:27], v12 offset:27136
    v_mfma_f32_16x16x32_bf16 v[68:71], a[84:87], v[48:51], v[68:71]
    s_waitcnt lgkmcnt(10)
    v_mfma_f32_16x16x32_bf16 v[72:75], a[80:83], v[52:55], v[72:75]
    ds_read_b64 v[28:29], v12 offset:27648
    ds_read_b64 v[30:31], v12 offset:28160
    v_mfma_f32_16x16x32_bf16 v[76:79], a[84:87], v[52:55], v[76:79]
    s_waitcnt lgkmcnt(10)
    v_mfma_f32_16x16x32_bf16 v[64:67], a[88:91], v[56:59], v[64:67]
    s_waitcnt vmcnt(3)
    s_barrier
    ds_read_b64 v[32:33], v12 offset:28672
    ds_read_b64 v[34:35], v12 offset:29184
    v_mfma_f32_16x16x32_bf16 v[68:71], a[92:95], v[56:59], v[68:71]
    s_waitcnt lgkmcnt(10)
    v_mfma_f32_16x16x32_bf16 v[72:75], a[88:91], v[60:63], v[72:75]
    ds_read_b64 v[36:37], v12 offset:29696
    ds_read_b64 v[38:39], v12 offset:30208
    v_mfma_f32_16x16x32_bf16 v[76:79], a[92:95], v[60:63], v[76:79]
    s_waitcnt lgkmcnt(10)
    v_mfma_f32_16x16x32_bf16 v[64:67], a[96:99], v[16:19], v[64:67]
    ds_read_b64 v[40:41], v12 offset:30720
    ds_read_b64 v[42:43], v12 offset:31232
    v_mfma_f32_16x16x32_bf16 v[68:71], a[100:103], v[16:19], v[68:71]
    s_waitcnt lgkmcnt(10)
    v_mfma_f32_16x16x32_bf16 v[72:75], a[96:99], v[20:23], v[72:75]
    ds_read_b64 v[44:45], v12 offset:31744
    ds_read_b64 v[46:47], v12 offset:32256
    v_mfma_f32_16x16x32_bf16 v[76:79], a[100:103], v[20:23], v[76:79]
    s_waitcnt lgkmcnt(10)
    v_mfma_f32_16x16x32_bf16 v[64:67], a[104:107], v[24:27], v[64:67]
    ds_read_b64 v[48:49], v12 offset:32768
    ds_read_b64 v[50:51], v12 offset:33280
    v_mfma_f32_16x16x32_bf16 v[68:71], a[108:111], v[24:27], v[68:71]
    s_waitcnt lgkmcnt(10)
    v_mfma_f32_16x16x32_bf16 v[72:75], a[104:107], v[28:31], v[72:75]
    ds_read_b64 v[52:53], v12 offset:33792
    ds_read_b64 v[54:55], v12 offset:34304
    v_mfma_f32_16x16x32_bf16 v[76:79], a[108:111], v[28:31], v[76:79]
    s_waitcnt lgkmcnt(10)
    v_mfma_f32_16x16x32_bf16 v[64:67], a[112:115], v[32:35], v[64:67]
    ds_read_b64 v[56:57], v12 offset:34816
    ds_read_b64 v[58:59], v12 offset:35328
    v_mfma_f32_16x16x32_bf16 v[68:71], a[116:119], v[32:35], v[68:71]
    s_waitcnt lgkmcnt(10)
    v_mfma_f32_16x16x32_bf16 v[72:75], a[112:115], v[36:39], v[72:75]
    ds_read_b64 v[60:61], v12 offset:35840
    ds_read_b64 v[62:63], v12 offset:36352
    v_mfma_f32_16x16x32_bf16 v[76:79], a[116:119], v[36:39], v[76:79]
    s_waitcnt lgkmcnt(10)
    v_mfma_f32_16x16x32_bf16 v[64:67], a[120:123], v[40:43], v[64:67]
    ds_read_b64 v[16:17], v12 offset:36864
    ds_read_b64 v[18:19], v12 offset:37376
    v_mfma_f32_16x16x32_bf16 v[68:71], a[124:127], v[40:43], v[68:71]
    s_waitcnt lgkmcnt(10)
    v_mfma_f32_16x16x32_bf16 v[72:75], a[120:123], v[44:47], v[72:75]
    ds_read_b64 v[20:21], v12 offset:37888
    ds_read_b64 v[22:23], v12 offset:38400
    v_mfma_f32_16x16x32_bf16 v[76:79], a[124:127], v[44:47], v[76:79]
    s_waitcnt lgkmcnt(10)
    v_mfma_f32_16x16x32_bf16 v[64:67], a[128:131], v[48:51], v[64:67]
    ds_read_b64 v[24:25], v12 offset:38912
    ds_read_b64 v[26:27], v12 offset:39424
    v_mfma_f32_16x16x32_bf16 v[68:71], a[132:135], v[48:51], v[68:71]
    s_waitcnt lgkmcnt(10)
    v_mfma_f32_16x16x32_bf16 v[72:75], a[128:131], v[52:55], v[72:75]
    ds_read_b64 v[28:29], v12 offset:39936
    ds_read_b64 v[30:31], v12 offset:40448
    v_mfma_f32_16x16x32_bf16 v[76:79], a[132:135], v[52:55], v[76:79]
    s_waitcnt lgkmcnt(10)
    v_mfma_f32_16x16x32_bf16 v[64:67], a[136:139], v[56:59], v[64:67]
    ds_read_b64 v[32:33], v12 offset:40960
    ds_read_b64 v[34:35], v12 offset:41472
    v_mfma_f32_16x16x32_bf16 v[68:71], a[140:143], v[56:59], v[68:71]
    s_waitcnt lgkmcnt(10)
    v_mfma_f32_16x16x32_bf16 v[72:75], a[136:139], v[60:63], v[72:75]
    ds_read_b64 v[36:37], v12 offset:41984
    ds_read_b64 v[38:39], v12 offset:42496
    v_mfma_f32_16x16x32_bf16 v[76:79], a[140:143], v[60:63], v[76:79]
    s_waitcnt lgkmcnt(10)
    v_mfma_f32_16x16x32_bf16 v[64:67], a[144:147], v[16:19], v[64:67]
    s_waitcnt vmcnt(0)
    s_barrier
    s_add_u32 s4, s41, 2048
    v_mov_b32 v6, 0
    buffer_atomic_add v6, v15, s[8:11], s4 offen sc0
    ds_read_b64 v[40:41], v12 offset:43008
    ds_read_b64 v[42:43], v12 offset:43520
    v_mfma_f32_16x16x32_bf16 v[68:71], a[148:151], v[16:19], v[68:71]
    s_waitcnt lgkmcnt(10)
    v_mfma_f32_16x16x32_bf16 v[72:75], a[144:147], v[20:23], v[72:75]
    ds_read_b64 v[44:45], v12 offset:44032
    ds_read_b64 v[46:47], v12 offset:44544
    v_mfma_f32_16x16x32_bf16 v[76:79], a[148:151], v[20:23], v[76:79]
    s_waitcnt lgkmcnt(10)
    v_mfma_f32_16x16x32_bf16 v[64:67], a[152:155], v[24:27], v[64:67]
    ds_read_b64 v[48:49], v12 offset:45056
    ds_read_b64 v[50:51], v12 offset:45568
    v_mfma_f32_16x16x32_bf16 v[68:71], a[156:159], v[24:27], v[68:71]
    s_waitcnt lgkmcnt(10)
    v_mfma_f32_16x16x32_bf16 v[72:75], a[152:155], v[28:31], v[72:75]
    ds_read_b64 v[52:53], v12 offset:46080
    ds_read_b64 v[54:55], v12 offset:46592
    v_mfma_f32_16x16x32_bf16 v[76:79], a[156:159], v[28:31], v[76:79]
    s_waitcnt lgkmcnt(10)
    v_mfma_f32_16x16x32_bf16 v[64:67], a[160:163], v[32:35], v[64:67]
    ds_read_b64 v[56:57], v12 offset:47104
    ds_read_b64 v[58:59], v12 offset:47616
    v_mfma_f32_16x16x32_bf16 v[68:71], a[164:167], v[32:35], v[68:71]
    s_waitcnt lgkmcnt(10)
    v_mfma_f32_16x16x32_bf16 v[72:75], a[160:163], v[36:39], v[72:75]
    ds_read_b64 v[60:61], v12 offset:48128
    ds_read_b64 v[62:63], v12 offset:48640
    v_mfma_f32_16x16x32_bf16 v[76:79], a[164:167], v[36:39], v[76:79]
    s_waitcnt lgkmcnt(10)
    v_mfma_f32_16x16x32_bf16 v[64:67], a[168:171], v[40:43], v[64:67]
    ds_read_b64 v[16:17], v12 offset:49152
    ds_read_b64 v[18:19], v12 offset:49664
    v_mfma_f32_16x16x32_bf16 v[68:71], a[172:175], v[40:43], v[68:71]
    s_waitcnt lgkmcnt(10)
    v_mfma_f32_16x16x32_bf16 v[72:75], a[168:171], v[44:47], v[72:75]
    ds_read_b64 v[20:21], v12 offset:50176
    ds_read_b64 v[22:23], v12 offset:50688
    v_mfma_f32_16x16x32_bf16 v[76:79], a[172:175], v[44:47], v[76:79]
    s_waitcnt lgkmcnt(10)
    v_mfma_f32_16x16x32_bf16 v[64:67], a[176:179], v[48:51], v[64:67]
    ds_read_b64 v[24:25], v12 offset:51200
    ds_read_b64 v[26:27], v12 offset:51712
    v_mfma_f32_16x16x32_bf16 v[68:71], a[180:183], v[48:51], v[68:71]
    s_waitcnt lgkmcnt(10)
    v_mfma_f32_16x16x32_bf16 v[72:75], a[176:179], v[52:55], v[72:75]
    ds_read_b64 v[28:29], v12 offset:52224
    ds_read_b64 v[30:31], v12 offset:52736
    v_mfma_f32_16x16x32_bf16 v[76:79], a[180:183], v[52:55], v[76:79]
    s_waitcnt lgkmcnt(10)
    v_mfma_f32_16x16x32_bf16 v[64:67], a[184:187], v[56:59], v[64:67]
    ds_read_b64 v[32:33], v12 offset:53248
    ds_read_b64 v[34:35], v12 offset:53760
    v_mfma_f32_16x16x32_bf16 v[68:71], a[188:191], v[56:59], v[68:71]
    s_waitcnt lgkmcnt(10)
    v_mfma_f32_16x16x32_bf16 v[72:75], a[184:187], v[60:63], v[72:75]
    ds_read_b64 v[36:37], v12 offset:54272
    ds_read_b64 v[38:39], v12 offset:54784
    v_mfma_f32_16x16x32_bf16 v[76:79], a[188:191], v[60:63], v[76:79]
    s_waitcnt lgkmcnt(10)
    v_mfma_f32_16x16x32_bf16 v[64:67], a[192:195], v[16:19], v[64:67]
    ds_read_b64 v[40:41], v12 offset:55296
    ds_read_b64 v[42:43], v12 offset:55808
    v_mfma_f32_16x16x32_bf16 v[68:71], a[196:199], v[16:19], v[68:71]
    s_waitcnt lgkmcnt(10)
    v_mfma_f32_16x16x32_bf16 v[72:75], a[192:195], v[20:23], v[72:75]
    ds_read_b64 v[44:45], v12 offset:56320
    ds_read_b64 v[46:47], v12 offset:56832
    v_mfma_f32_16x16x32_bf16 v[76:79], a[196:199], v[20:23], v[76:79]
    s_waitcnt lgkmcnt(10)
    v_mfma_f32_16x16x32_bf16 v[64:67], a[200:203], v[24:27], v[64:67]
    v_mfma_f32_16x16x32_bf16 v[68:71], a[204:207], v[24:27], v[68:71]
    s_waitcnt lgkmcnt(8)
    v_mfma_f32_16x16x32_bf16 v[72:75], a[200:203], v[28:31], v[72:75]
    v_mfma_f32_16x16x32_bf16 v[76:79], a[204:207], v[28:31], v[76:79]
    s_waitcnt lgkmcnt(6)
    v_mfma_f32_16x16x32_bf16 v[64:67], a[208:211], v[32:35], v[64:67]
    v_mfma_f32_16x16x32_bf16 v[68:71], a[212:215], v[32:35], v[68:71]
    s_waitcnt lgkmcnt(4)
    v_mfma_f32_16x16x32_bf16 v[72:75], a[208:211], v[36:39], v[72:75]
    v_mfma_f32_16x16x32_bf16 v[76:79], a[212:215], v[36:39], v[76:79]
    s_waitcnt lgkmcnt(2)
    v_mfma_f32_16x16x32_bf16 v[64:67], a[216:219], v[40:43], v[64:67]
    v_mfma_f32_16x16x32_bf16 v[68:71], a[220:223], v[40:43], v[68:71]
    s_waitcnt lgkmcnt(0)
    v_mfma_f32_16x16x32_bf16 v[72:75], a[216:219], v[44:47], v[72:75]
    v_mfma_f32_16x16x32_bf16 v[76:79], a[220:223], v[44:47], v[76:79]
L_sd_T:
    s_add_u32 s43, s43, 1
    s_add_u32 s41, s41, 2048
    v_xor_b32 v12, 65536, v12
    s_nop 6
    v_cvt_pk_bf16_f32 v80, v64, v65
    v_cvt_pk_bf16_f32 v81, v66, v67
    v_cvt_pk_bf16_f32 v82, v68, v69
    v_cvt_pk_bf16_f32 v83, v70, v71
    buffer_store_dwordx4 v[80:83], v2, s[8:11], s37 offen sc1
    s_add_u32 s5, s37, s38
    v_cvt_pk_bf16_f32 v96, v72, v73
    v_cvt_pk_bf16_f32 v97, v74, v75
    v_cvt_pk_bf16_f32 v98, v76, v77
    v_cvt_pk_bf16_f32 v99, v78, v79
    buffer_store_dwordx4 v[96:99], v2, s[8:11], s5 offen sc1
    s_add_u32 s37, s37, s46
    s_waitcnt vmcnt(2)
    s_cmp_lg_u32 s21, 0
    s_cbranch_scc1 L_bp_5
    s_mov_b64 exec, 3
    ds_write_b32 v13, v6
    s_mov_b64 exec, -1
    s_waitcnt lgkmcnt(0)
L_bp_5:
    s_barrier
    ds_read_b32 v7, v13
    v_xor_b32 v13, 256, v13
    s_waitcnt lgkmcnt(0)
    v_readlane_b32 s4, v7, 0
    v_readlane_b32 s5, v7, 1
    s_cmp_ge_u32 s4, s36
    s_cselect_b32 s44, 1, 0
    s_cmp_ge_u32 s43, 64
    s_cselect_b32 s44, 0, s44
    s_cmp_ge_u32 s5, s36
    s_cselect_b32 s39, 1, 0
    s_cmp_lg_u32 s44, 0
    s_cbranch_scc1 L_sd_T1
    s_waitcnt vmcnt(0)
    s_barrier
    s_cmp_lg_u32 s21, 0
    s_cbranch_scc1 L_sd_s1
    s_mov_b64 exec, 1
    v_mov_b32 v4, 0
    v_mov_b32 v5, 1
    buffer_atomic_add v5, v4, s[8:11], s35 offen
    s_mov_b64 exec, -1
L_sd_s1:
    s_add_u32 s35, s35, 2048
    s_cmp_lt_u32 s43, 64
    s_cbranch_scc1 L_sd_L
    s_branch L_w_done
L_sd_T1:
    s_add_u32 m0, s40, 0
    s_add_u32 s47, s30, 0
    buffer_load_dwordx4 v11, s[8:11], s47 offen sc1 lds
    s_add_u32 m0, s40, 4096
    s_add_u32 s47, s30, 2048
    buffer_load_dwordx4 v11, s[8:11], s47 offen sc1 lds
    s_add_u32 m0, s40, 8192
    s_add_u32 s47, s30, 4096
    buffer_load_dwordx4 v11, s[8:11], s47 offen sc1 lds
    s_add_u32 m0, s40, 12288
    s_add_u32 s47, s30, 6144
    buffer_load_dwordx4 v11, s[8:11], s47 offen sc1 lds
    s_add_u32 m0, s40, 16384
    s_add_u32 s47, s30, 8192
    buffer_load_dwordx4 v11, s[8:11], s47 offen sc1 lds
    s_add_u32 m0, s40, 20480
    s_add_u32 s47, s30, 10240
    buffer_load_dwordx4 v11, s[8:11], s47 offen sc1 lds
    s_add_u32 m0, s40, 24576
    s_add_u32 s47, s30, 12288
    buffer_load_dwordx4 v11, s[8:11], s47 offen sc1 lds
    s_add_u32 m0, s40, 28672
    s_add_u32 s47, s30, 14336
    buffer_load_dwordx4 v11, s[8:11], s47 offen sc1 lds
    s_add_u32 m0, s40, 32768
    s_add_u32 s47, s30, 16384
    buffer_load_dwordx4 v11, s[8:11], s47 offen sc1 lds
    s_add_u32 m0, s40, 36864
    s_add_u32 s47, s30, 18432
    buffer_load_dwordx4 v11, s[8:11], s47 offen sc1 lds
    s_add_u32 m0, s40, 40960
    s_add_u32 s47, s30, 20480
    buffer_load_dwordx4 v11, s[8:11], s47 offen sc1 lds
    s_add_u32 m0, s40, 45056
    s_add_u32 s47, s30, 22528
    buffer_load_dwordx4 v11, s[8:11], s47 offen sc1 lds
    s_add_u32 m0, s40, 49152
    s_add_u32 s47, s30, 24576
    buffer_load_dwordx4 v11, s[8:11], s47 offen sc1 lds
    s_add_u32 m0, s40, 53248
    s_add_u32 s47, s30, 26624
    buffer_load_dwordx4 v11, s[8:11], s47 offen sc1 lds
    s_xor_b32 s40, s40, 65536
    s_add_u32 s30, s30, s45
    s_cmp_lg_u32 s39, 0
    s_cbranch_scc1 L_sd_T2
    s_waitcnt vmcnt(14)
    s_barrier
    s_cmp_lg_u32 s21, 3
    s_cbranch_scc1 L_sd_s4
    s_mov_b64 exec, 1
    v_mov_b32 v4, 0
    v_mov_b32 v5, 1
    buffer_atomic_add v5, v4, s[8:11], s35 offen
    s_mov_b64 exec, -1
L_sd_s4:
    s_add_u32 s35, s35, 2048
    s_branch L_sd_L2
L_sd_T2:
    s_add_u32 s4, s41, 2048
    v_mov_b32 v6, 0
    buffer_atomic_add v6, v15, s[8:11], s4 offen sc0
    s_waitcnt vmcnt(0)
    s_branch L_sd_B1
L_sd_E:
    s_add_u32 s43, s43, 1
    s_add_u32 s41, s41, 2048
    v_xor_b32 v12, 65536, v12
    s_nop 6
    v_cvt_pk_bf16_f32 v80, v64, v65
    v_cvt_pk_bf16_f32 v81, v66, v67
    v_cvt_pk_bf16_f32 v82, v68, v69
    v_cvt_pk_bf16_f32 v83, v70, v71
    buffer_store_dwordx4 v[80:83], v2, s[8:11], s37 offen sc1
    s_add_u32 s5, s37, s38
    v_cvt_pk_bf16_f32 v96, v72, v73
    v_cvt_pk_bf16_f32 v97, v74, v75
    v_cvt_pk_bf16_f32 v98, v76, v77
    v_cvt_pk_bf16_f32 v99, v78, v79
    buffer_store_dwordx4 v[96:99], v2, s[8:11], s5 offen sc1
    s_add_u32 s37, s37, s46
    s_waitcnt vmcnt(2)
L_sd_B1:
    s_cmp_lg_u32 s21, 0
    s_cbranch_scc1 L_bp_6
    s_mov_b64 exec, 3
    ds_write_b32 v13, v6
    s_mov_b64 exec, -1
    s_waitcnt lgkmcnt(0)
L_bp_6:
    s_barrier
    ds_read_b32 v7, v13
    v_xor_b32 v13, 256, v13
    s_waitcnt lgkmcnt(0)
    v_readlane_b32 s4, v7, 0
    v_readlane_b32 s5, v7, 1
    s_cmp_ge_u32 s4, s36
    s_cselect_b32 s44, 1, 0
    s_cmp_ge_u32 s43, 63
    s_cselect_b32 s44, 0, s44
    s_cmp_ge_u32 s5, s36
    s_cselect_b32 s39, 1, 0
    s_cmp_eq_u32 s44, 0
    s_cbranch_scc1 L_sd_B0
    ds_read_b64 v[16:17], v12 offset:0
    ds_read_b64 v[18:19], v12 offset:512
    ds_read_b64 v[20:21], v12 offset:1024
    ds_read_b64 v[22:23], v12 offset:1536
    ds_read_b64 v[24:25], v12 offset:2048
    ds_read_b64 v[26:27], v12 offset:2560
    ds_read_b64 v[28:29], v12 offset:3072
    ds_read_b64 v[30:31], v12 offset:3584
    ds_read_b64 v[32:33], v12 offset:4096
    ds_read_b64 v[34:35], v12 offset:4608
    ds_read_b64 v[36:37], v12 offset:5120
    ds_read_b64 v[38:39], v12 offset:5632
    s_waitcnt lgkmcnt(10)
    v_mfma_f32_16x16x32_bf16 v[64:67], a[0:3], v[16:19], 0
    ds_read_b64 v[40:41], v12 offset:6144
    ds_read_b64 v[42:43], v12 offset:6656
    v_mfma_f32_16x16x32_bf16 v[68:71], a[4:7], v[16:19], 0
    s_waitcnt lgkmcnt(10)
    v_mfma_f32_16x16x32_bf16 v[72:75], a[0:3], v[20:23], 0
    ds_read_b64 v[44:45], v12 offset:7168
    ds_read_b64 v[46:47], v12 offset:7680
    v_mfma_f32_16x16x32_bf16 v[76:79], a[4:7], v[20:23], 0
    s_waitcnt lgkmcnt(10)
    v_mfma_f32_16x16x32_bf16 v[64:67], a[8:11], v[24:27], v[64:67]
    ds_read_b64 v[48:49], v12 offset:8192
    ds_read_b64 v[50:51], v12 offset:8704
    v_mfma_f32_16x16x32_bf16 v[68:71], a[12:15], v[24:27], v[68:71]
    s_waitcnt lgkmcnt(10)
    v_mfma_f32_16x16x32_bf16 v[72:75], a[8:11], v[28:31], v[72:75]
    ds_read_b64 v[52:53], v12 offset:9216
    ds_read_b64 v[54:55], v12 offset:9728
    v_mfma_f32_16x16x32_bf16 v[76:79], a[12:15], v[28:31], v[76:79]
    s_waitcnt lgkmcnt(10)
    v_mfma_f32_16x16x32_bf16 v[64:67], a[16:19], v[32:35], v[64:67]
    ds_read_b64 v[56:57], v12 offset:10240
    ds_read_b64 v[58:59], v12 offset:10752
    v_mfma_f32_16x16x32_bf16 v[68:71], a[20:23], v[32:35], v[68:71]
    s_waitcnt lgkmcnt(10)
    v_mfma_f32_16x16x32_bf16 v[72:75], a[16:19], v[36:39], v[72:75]
    ds_read_b64 v[60:61], v12 offset:11264
    ds_read_b64 v[62:63], v12 offset:11776
    v_mfma_f32_16x16x32_bf16 v[76:79], a[20:23], v[36:39], v[76:79]
    s_waitcnt lgkmcnt(10)
    v_mfma_f32_16x16x32_bf16 v[64:67], a[24:27], v[40:43], v[64:67]
    ds_read_b64 v[16:17], v12 offset:12288
    ds_read_b64 v[18:19], v12 offset:12800
    v_mfma_f32_16x16x32_bf16 v[68:71], a[28:31], v[40:43], v[68:71]
    s_waitcnt lgkmcnt(10)
    v_mfma_f32_16x16x32_bf16 v[72:75], a[24:27], v[44:47], v[72:75]
    ds_read_b64 v[20:21], v12 offset:13312
    ds_read_b64 v[22:23], v12 offset:13824
    v_mfma_f32_16x16x32_bf16 v[76:79], a[28:31], v[44:47], v[76:79]
    s_waitcnt lgkmcnt(10)
    v_mfma_f32_16x16x32_bf16 v[64:67], a[32:35], v[48:51], v[64:67]
    ds_read_b64 v[24:25], v12 offset:14336
    ds_read_b64 v[26:27], v12 offset:14848
    v_mfma_f32_16x16x32_bf16 v[68:71], a[36:39], v[48:51], v[68:71]
    s_add_u32 m0, s40, 0
    s_add_u32 s47, s30, 0
    buffer_load_dwordx4 v11, s[8:11], s47 offen sc1 lds
    s_waitcnt lgkmcnt(10)
    v_mfma_f32_16x16x32_bf16 v[72:75], a[32:35], v[52:55], v[72:75]
    ds_read_b64 v[28:29], v12 offset:15360
    ds_read_b64 v[30:31], v12 offset:15872
    v_mfma_f32_16x16x32_bf16 v[76:79], a[36:39], v[52:55], v[76:79]
    s_waitcnt lgkmcnt(10)
    v_mfma_f32_16x16x32_bf16 v[64:67], a[40:43], v[56:59], v[64:67]
    ds_read_b64 v[32:33], v12 offset:16384
    ds_read_b64 v[34:35], v12 offset:16896
    v_mfma_f32_16x16x32_bf16 v[68:71], a[44:47], v[56:59], v[68:71]
    s_add_u32 m0, s40, 4096
    s_add_u32 s47, s30, 2048
    buffer_load_dwordx4 v11, s[8:11], s47 offen sc1 lds
    s_waitcnt lgkmcnt(10)
    v_mfma_f32_16x16x32_bf16 v[72:75], a[40:43], v[60:63], v[72:75]
    ds_read_b64 v[36:37], v12 offset:17408
    ds_read_b64 v[38:39], v12 offset:17920
    v_mfma_f32_16x16x32_bf16 v[76:79], a[44:47], v[60:63], v[76:79]
    s_waitcnt lgkmcnt(10)
    v_mfma_f32_16x16x32_bf16 v[64:67], a[48:51], v[16:19], v[64:67]
    ds_read_b64 v[40:41], v12 offset:18432
    ds_read_b64 v[42:43], v12 offset:18944
    v_mfma_f32_16x16x32_bf16 v[68:71], a[52:55], v[16:19], v[68:71]
    s_add_u32 m0, s40, 8192
    s_add_u32 s47, s30, 4096
    buffer_load_dwordx4 v11, s[8:11], s47 offen sc1 lds
    s_waitcnt lgkmcnt(10)
    v_mfma_f32_16x16x32_bf16 v[72:75], a[48:51], v[20:23], v[72:75]
    ds_read_b64 v[44:45], v12 offset:19456
    ds_read_b64 v[46:47], v12 offset:19968
    v_mfma_f32_16x16x32_bf16 v[76:79], a[52:55], v[20:23], v[76:79]
    s_waitcnt vmcnt(3)
    s_barrier
    s_cmp_lg_u32 s21, 0
    s_cbranch_scc1 L_sd_s2
    s_mov_b64 exec, 1
    v_mov_b32 v4, 0
    v_mov_b32 v5, 1
    buffer_atomic_add v5, v4, s[8:11], s35 offen
    s_mov_b64 exec, -1
L_sd_s2:
    s_add_u32 s35, s35, 2048
    s_waitcnt lgkmcnt(10)
    v_mfma_f32_16x16x32_bf16 v[64:67], a[56:59], v[24:27], v[64:67]
    ds_read_b64 v[48:49], v12 offset:20480
    ds_read_b64 v[50:51], v12 offset:20992
    v_mfma_f32_16x16x32_bf16 v[68:71], a[60:63], v[24:27], v[68:71]
    s_add_u32 m0, s40, 12288
    s_add_u32 s47, s30, 6144
    buffer_load_dwordx4 v11, s[8:11], s47 offen sc1 lds
    s_waitcnt lgkmcnt(10)
    v_mfma_f32_16x16x32_bf16 v[72:75], a[56:59], v[28:31], v[72:75]
    ds_read_b64 v[52:53], v12 offset:21504
    ds_read_b64 v[54:55], v12 offset:22016
    v_mfma_f32_16x16x32_bf16 v[76:79], a[60:63], v[28:31], v[76:79]
    s_waitcnt lgkmcnt(10)
    v_mfma_f32_16x16x32_bf16 v[64:67], a[64:67], v[32:35], v[64:67]
    ds_read_b64 v[56:57], v12 offset:22528
    ds_read_b64 v[58:59], v12 offset:23040
    v_mfma_f32_16x16x32_bf16 v[68:71], a[68:71], v[32:35], v[68:71]
    s_add_u32 m0, s40, 16384
    s_add_u32 s47, s30, 8192
    buffer_load_dwordx4 v11, s[8:11], s47 offen sc1 lds
    s_waitcnt lgkmcnt(10)
    v_mfma_f32_16x16x32_bf16 v[72:75], a[64:67], v[36:39], v[72:75]
    ds_read_b64 v[60:61], v12 offset:23552
    ds_read_b64 v[62:63], v12 offset:24064
    v_mfma_f32_16x16x32_bf16 v[76:79], a[68:71], v[36:39], v[76:79]
    s_waitcnt lgkmcnt(10)
    v_mfma_f32_16x16x32_bf16 v[64:67], a[72:75], v[40:43], v[64:67]
    ds_read_b64 v[16:17], v12 offset:24576
    ds_read_b64 v[18:19], v12 offset:25088
    v_mfma_f32_16x16x32_bf16 v[68:71], a[76:79], v[40:43], v[68:71]
    s_add_u32 m0, s40, 20480
    s_add_u32 s47, s30, 10240
    buffer_load_dwordx4 v11, s[8:11], s47 offen sc1 lds
    s_waitcnt lgkmcnt(10)
    v_mfma_f32_16x16x32_bf16 v[72:75], a[72:75], v[44:47], v[72:75]
    ds_read_b64 v[20:21], v12 offset:25600
    ds_read_b64 v[22:23], v12 offset:26112
    v_mfma_f32_16x16x32_bf16 v[76:79], a[76:79], v[44:47], v[76:79]
    s_waitcnt lgkmcnt(10)
    v_mfma_f32_16x16x32_bf16 v[64:67], a[80:83], v[48:51], v[64:67]
    ds_read_b64 v[24:25], v12 offset:26624
    ds_read_b64 v[26:27], v12 offset:27136
    v_mfma_f32_16x16x32_bf16 v[68:71], a[84:87], v[48:51], v[68:71]
    s_add_u32 m0, s40, 24576
    s_add_u32 s47, s30, 12288
    buffer_load_dwordx4 v11, s[8:11], s47 offen sc1 lds
    s_waitcnt lgkmcnt(10)
    v_mfma_f32_16x16x32_bf16 v[72:75], a[80:83], v[52:55], v[72:75]
    ds_read_b64 v[28:29], v12 offset:27648
    ds_read_b64 v[30:31], v12 offset:28160
    v_mfma_f32_16x16x32_bf16 v[76:79], a[84:87], v[52:55], v[76:79]
    s_waitcnt lgkmcnt(10)
    v_mfma_f32_16x16x32_bf16 v[64:67], a[88:91], v[56:59], v[64:67]
    ds_read_b64 v[32:33], v12 offset:28672
    ds_read_b64 v[34:35], v12 offset:29184
    v_mfma_f32_16x16x32_bf16 v[68:71], a[92:95], v[56:59], v[68:71]
    s_add_u32 m0, s40, 28672
    s_add_u32 s47, s30, 14336
    buffer_load_dwordx4 v11, s[8:11], s47 offen sc1 lds
    s_waitcnt lgkmcnt(10)
    v_mfma_f32_16x16x32_bf16 v[72:75], a[88:91], v[60:63], v[72:75]
    ds_read_b64 v[36:37], v12 offset:29696
    ds_read_b64 v[38:39], v12 offset:30208
    v_mfma_f32_16x16x32_bf16 v[76:79], a[92:95], v[60:63], v[76:79]
    s_waitcnt lgkmcnt(10)
    v_mfma_f32_16x16x32_bf16 v[64:67], a[96:99], v[16:19], v[64:67]
    ds_read_b64 v[40:41], v12 offset:30720
    ds_read_b64 v[42:43], v12 offset:31232
    v_mfma_f32_16x16x32_bf16 v[68:71], a[100:103], v[16:19], v[68:71]
    s_add_u32 m0, s40, 32768
    s_add_u32 s47, s30, 16384
    buffer_load_dwordx4 v11, s[8:11], s47 offen sc1 lds
    s_waitcnt lgkmcnt(10)
    v_mfma_f32_16x16x32_bf16 v[72:75], a[96:99], v[20:23], v[72:75]
    ds_read_b64 v[44:45], v12 offset:31744
    ds_read_b64 v[46:47], v12 offset:32256
    v_mfma_f32_16x16x32_bf16 v[76:79], a[100:103], v[20:23], v[76:79]
    s_waitcnt lgkmcnt(10)
    v_mfma_f32_16x16x32_bf16 v[64:67], a[104:107], v[24:27], v[64:67]
    ds_read_b64 v[48:49], v12 offset:32768
    ds_read_b64 v[50:51], v12 offset:33280
    v_mfma_f32_16x16x32_bf16 v[68:71], a[108:111], v[24:27], v[68:71]
    s_add_u32 m0, s40, 36864
    s_add_u32 s47, s30, 18432
    buffer_load_dwordx4 v11, s[8:11], s47 offen sc1 lds
    s_waitcnt lgkmcnt(10)
    v_mfma_f32_16x16x32_bf16 v[72:75], a[104:107], v[28:31], v[72:75]
    ds_read_b64 v[52:53], v12 offset:33792
    ds_read_b64 v[54:55], v12 offset:34304
    v_mfma_f32_16x16x32_bf16 v[76:79], a[108:111], v[28:31], v[76:79]
    s_waitcnt lgkmcnt(10)
    v_mfma_f32_16x16x32_bf16 v[64:67], a[112:115], v[32:35], v[64:67]
    ds_read_b64 v[56:57], v12 offset:34816
    ds_read_b64 v[58:59], v12 offset:35328
    v_mfma_f32_16x16x32_bf16 v[68:71], a[116:119], v[32:35], v[68:71]
    s_add_u32 m0, s40, 40960
    s_add_u32 s47, s30, 20480
    buffer_load_dwordx4 v11, s[8:11], s47 offen sc1 lds
    s_waitcnt lgkmcnt(10)
    v_mfma_f32_16x16x32_bf16 v[72:75], a[112:115], v[36:39], v[72:75]
    ds_read_b64 v[60:61], v12 offset:35840
    ds_read_b64 v[62:63], v12 offset:36352
    v_mfma_f32_16x16x32_bf16 v[76:79], a[116:119], v[36:39], v[76:79]
    s_waitcnt lgkmcnt(10)
    v_mfma_f32_16x16x32_bf16 v[64:67], a[120:123], v[40:43], v[64:67]
    ds_read_b64 v[16:17], v12 offset:36864
    ds_read_b64 v[18:19], v12 offset:37376
    v_mfma_f32_16x16x32_bf16 v[68:71], a[124:127], v[40:43], v[68:71]
    s_add_u32 m0, s40, 45056
    s_add_u32 s47, s30, 22528
    buffer_load_dwordx4 v11, s[8:11], s47 offen sc1 lds
    s_waitcnt lgkmcnt(10)
    v_mfma_f32_16x16x32_bf16 v[72:75], a[120:123], v[44:47], v[72:75]
    ds_read_b64 v[20:21], v12 offset:37888
    ds_read_b64 v[22:23], v12 offset:38400
    v_mfma_f32_16x16x32_bf16 v[76:79], a[124:127], v[44:47], v[76:79]
    s_waitcnt lgkmcnt(10)
    v_mfma_f32_16x16x32_bf16 v[64:67], a[128:131], v[48:51], v[64:67]
    ds_read_b64 v[24:25], v12 offset:38912
    ds_read_b64 v[26:27], v12 offset:39424
    v_mfma_f32_16x16x32_bf16 v[68:71], a[132:135], v[48:51], v[68:71]
    s_add_u32 m0, s40, 49152
    s_add_u32 s47, s30, 24576
    buffer_load_dwordx4 v11, s[8:11], s47 offen sc1 lds
    s_waitcnt lgkmcnt(10)
    v_mfma_f32_16x16x32_bf16 v[72:75], a[128:131], v[52:55], v[72:75]
    ds_read_b64 v[28:29], v12 offset:39936
    ds_read_b64 v[30:31], v12 offset:40448
    v_mfma_f32_16x16x32_bf16 v[76:79], a[132:135], v[52:55], v[76:79]
    s_waitcnt lgkmcnt(10)
    v_mfma_f32_16x16x32_bf16 v[64:67], a[136:139], v[56:59], v[64:67]
    ds_read_b64 v[32:33], v12 offset:40960
    ds_read_b64 v[34:35], v12 offset:41472
    v_mfma_f32_16x16x32_bf16 v[68:71], a[140:143], v[56:59], v[68:71]
    s_add_u32 m0, s40, 53248
    s_add_u32 s47, s30, 26624
    buffer_load_dwordx4 v11, s[8:11], s47 offen sc1 lds
    s_xor_b32 s40, s40, 65536
    s_add_u32 s30, s30, s45
    s_waitcnt lgkmcnt(10)
    v_mfma_f32_16x16x32_bf16 v[72:75], a[136:139], v[60:63], v[72:75]
    ds_read_b64 v[36:37], v12 offset:41984
    ds_read_b64 v[38:39], v12 offset:42496
    v_mfma_f32_16x16x32_bf16 v[76:79], a[140:143], v[60:63], v[76:79]
    s_waitcnt lgkmcnt(10)
    v_mfma_f32_16x16x32_bf16 v[64:67], a[144:147], v[16:19], v[64:67]
    s_add_u32 s4, s41, 4096
    v_mov_b32 v6, 0
    buffer_atomic_add v6, v15, s[8:11], s4 offen sc0
    ds_read_b64 v[40:41], v12 offset:43008
    ds_read_b64 v[42:43], v12 offset:43520
    v_mfma_f32_16x16x32_bf16 v[68:71], a[148:151], v[16:19], v[68:71]
    s_waitcnt lgkmcnt(10)
    v_mfma_f32_16x16x32_bf16 v[72:75], a[144:147], v[20:23], v[72:75]
    ds_read_b64 v[44:45], v12 offset:44032
    ds_read_b64 v[46:47], v12 offset:44544
    v_mfma_f32_16x16x32_bf16 v[76:79], a[148:151], v[20:23], v[76:79]
    s_waitcnt lgkmcnt(10)
    v_mfma_f32_16x16x32_bf16 v[64:67], a[152:155], v[24:27], v[64:67]
    ds_read_b64 v[48:49], v12 offset:45056
    ds_read_b64 v[50:51], v12 offset:45568
    v_mfma_f32_16x16x32_bf16 v[68:71], a[156:159], v[24:27], v[68:71]
    s_waitcnt lgkmcnt(10)
    v_mfma_f32_16x16x32_bf16 v[72:75], a[152:155], v[28:31], v[72:75]
    ds_read_b64 v[52:53], v12 offset:46080
    ds_read_b64 v[54:55], v12 offset:46592
    v_mfma_f32_16x16x32_bf16 v[76:79], a[156:159], v[28:31], v[76:79]
    s_waitcnt lgkmcnt(10)
    v_mfma_f32_16x16x32_bf16 v[64:67], a[160:163], v[32:35], v[64:67]
    ds_read_b64 v[56:57], v12 offset:47104
    ds_read_b64 v[58:59], v12 offset:47616
    v_mfma_f32_16x16x32_bf16 v[68:71], a[164:167], v[32:35], v[68:71]
    s_waitcnt lgkmcnt(10)
    v_mfma_f32_16x16x32_bf16 v[72:75], a[160:163], v[36:39], v[72:75]
    ds_read_b64 v[60:61], v12 offset:48128
    ds_read_b64 v[62:63], v12 offset:48640
    v_mfma_f32_16x16x32_bf16 v[76:79], a[164:167], v[36:39], v[76:79]
    s_waitcnt lgkmcnt(10)
    v_mfma_f32_16x16x32_bf16 v[64:67], a[168:171], v[40:43], v[64:67]
    ds_read_b64 v[16:17], v12 offset:49152
    ds_read_b64 v[18:19], v12 offset:49664
    v_mfma_f32_16x16x32_bf16 v[68:71], a[172:175], v[40:43], v[68:71]
    s_waitcnt lgkmcnt(10)
    v_mfma_f32_16x16x32_bf16 v[72:75], a[168:171], v[44:47], v[72:75]
    ds_read_b64 v[20:21], v12 offset:50176
    ds_read_b64 v[22:23], v12 offset:50688
    v_mfma_f32_16x16x32_bf16 v[76:79], a[172:175], v[44:47], v[76:79]
    s_waitcnt lgkmcnt(10)
    v_mfma_f32_16x16x32_bf16 v[64:67], a[176:179], v[48:51], v[64:67]
    ds_read_b64 v[24:25], v12 offset:51200
    ds_read_b64 v[26:27], v12 offset:51712
    v_mfma_f32_16x16x32_bf16 v[68:71], a[180:183], v[48:51], v[68:71]
    s_waitcnt lgkmcnt(10)
    v_mfma_f32_16x16x32_bf16 v[72:75], a[176:179], v[52:55], v[72:75]
    ds_read_b64 v[28:29], v12 offset:52224
    ds_read_b64 v[30:31], v12 offset:52736
    v_mfma_f32_16x16x32_bf16 v[76:79], a[180:183], v[52:55], v[76:79]
    s_waitcnt lgkmcnt(10)
    v_mfma_f32_16x16x32_bf16 v[64:67], a[184:187], v[56:59], v[64:67]
    ds_read_b64 v[32:33], v12 offset:53248
    ds_read_b64 v[34:35], v12 offset:53760
    v_mfma_f32_16x16x32_bf16 v[68:71], a[188:191], v[56:59], v[68:71]
    s_waitcnt lgkmcnt(10)
    v_mfma_f32_16x16x32_bf16 v[72:75], a[184:187], v[60:63], v[72:75]
    ds_read_b64 v[36:37], v12 offset:54272
    ds_read_b64 v[38:39], v12 offset:54784
    v_mfma_f32_16x16x32_bf16 v[76:79], a[188:191], v[60:63], v[76:79]
    s_waitcnt lgkmcnt(10)
    v_mfma_f32_16x16x32_bf16 v[64:67], a[192:195], v[16:19], v[64:67]
    ds_read_b64 v[40:41], v12 offset:55296
    ds_read_b64 v[42:43], v12 offset:55808
    v_mfma_f32_16x16x32_bf16 v[68:71], a[196:199], v[16:19], v[68:71]
    s_waitcnt lgkmcnt(10)
    v_mfma_f32_16x16x32_bf16 v[72:75], a[192:195], v[20:23], v[72:75]
    ds_read_b64 v[44:45], v12 offset:56320
    ds_read_b64 v[46:47], v12 offset:56832
    v_mfma_f32_16x16x32_bf16 v[76:79], a[196:199], v[20:23], v[76:79]
    s_waitcnt lgkmcnt(10)
    v_mfma_f32_16x16x32_bf16 v[64:67], a[200:203], v[24:27], v[64:67]
    v_mfma_f32_16x16x32_bf16 v[68:71], a[204:207], v[24:27], v[68:71]
    s_waitcnt lgkmcnt(8)
    v_mfma_f32_16x16x32_bf16 v[72:75], a[200:203], v[28:31], v[72:75]
    v_mfma_f32_16x16x32_bf16 v[76:79], a[204:207], v[28:31], v[76:79]
    s_waitcnt lgkmcnt(6)
    v_mfma_f32_16x16x32_bf16 v[64:67], a[208:211], v[32:35], v[64:67]
    v_mfma_f32_16x16x32_bf16 v[68:71], a[212:215], v[32:35], v[68:71]
    s_waitcnt lgkmcnt(4)
    v_mfma_f32_16x16x32_bf16 v[72:75], a[208:211], v[36:39], v[72:75]
    v_mfma_f32_16x16x32_bf16 v[76:79], a[212:215], v[36:39], v[76:79]
    s_waitcnt lgkmcnt(2)
    v_mfma_f32_16x16x32_bf16 v[64:67], a[216:219], v[40:43], v[64:67]
    v_mfma_f32_16x16x32_bf16 v[68:71], a[220:223], v[40:43], v[68:71]
    s_waitcnt lgkmcnt(0)
    v_mfma_f32_16x16x32_bf16 v[72:75], a[216:219], v[44:47], v[72:75]
    v_mfma_f32_16x16x32_bf16 v[76:79], a[220:223], v[44:47], v[76:79]
    s_branch L_sd_E
L_sd_B0:
    ds_read_b64 v[16:17], v12 offset:0
    ds_read_b64 v[18:19], v12 offset:512
    ds_read_b64 v[20:21], v12 offset:1024
    ds_read_b64 v[22:23], v12 offset:1536
    ds_read_b64 v[24:25], v12 offset:2048
    ds_read_b64 v[26:27], v12 offset:2560
    ds_read_b64 v[28:29], v12 offset:3072
    ds_read_b64 v[30:31], v12 offset:3584
    ds_read_b64 v[32:33], v12 offset:4096
    ds_read_b64 v[34:35], v12 offset:4608
    ds_read_b64 v[36:37], v12 offset:5120
    ds_read_b64 v[38:39], v12 offset:5632
    s_waitcnt lgkmcnt(10)
    v_mfma_f32_16x16x32_bf16 v[64:67], a[0:3], v[16:19], 0
    ds_read_b64 v[40:41], v12 offset:6144
    ds_read_b64 v[42:43], v12 offset:6656
    v_mfma_f32_16x16x32_bf16 v[68:71], a[4:7], v[16:19], 0
    s_waitcnt lgkmcnt(10)
    v_mfma_f32_16x16x32_bf16 v[72:75], a[0:3], v[20:23], 0
    ds_read_b64 v[44:45], v12 offset:7168
    ds_read_b64 v[46:47], v12 offset:7680
    v_mfma_f32_16x16x32_bf16 v[76:79], a[4:7], v[20:23], 0
    s_waitcnt lgkmcnt(10)
    v_mfma_f32_16x16x32_bf16 v[64:67], a[8:11], v[24:27], v[64:67]
    ds_read_b64 v[48:49], v12 offset:8192
    ds_read_b64 v[50:51], v12 offset:8704
    v_mfma_f32_16x16x32_bf16 v[68:71], a[12:15], v[24:27], v[68:71]
    s_waitcnt lgkmcnt(10)
    v_mfma_f32_16x16x32_bf16 v[72:75], a[8:11], v[28:31], v[72:75]
    ds_read_b64 v[52:53], v12 offset:9216
    ds_read_b64 v[54:55], v12 offset:9728
    v_mfma_f32_16x16x32_bf16 v[76:79], a[12:15], v[28:31], v[76:79]
    s_waitcnt lgkmcnt(10)
    v_mfma_f32_16x16x32_bf16 v[64:67], a[16:19], v[32:35], v[64:67]
    ds_read_b64 v[56:57], v12 offset:10240
    ds_read_b64 v[58:59], v12 offset:10752
    v_mfma_f32_16x16x32_bf16 v[68:71], a[20:23], v[32:35], v[68:71]
    s_waitcnt lgkmcnt(10)
    v_mfma_f32_16x16x32_bf16 v[72:75], a[16:19], v[36:39], v[72:75]
    ds_read_b64 v[60:61], v12 offset:11264
    ds_read_b64 v[62:63], v12 offset:11776
    v_mfma_f32_16x16x32_bf16 v[76:79], a[20:23], v[36:39], v[76:79]
    s_waitcnt lgkmcnt(10)
    v_mfma_f32_16x16x32_bf16 v[64:67], a[24:27], v[40:43], v[64:67]
    ds_read_b64 v[16:17], v12 offset:12288
    ds_read_b64 v[18:19], v12 offset:12800
    v_mfma_f32_16x16x32_bf16 v[68:71], a[28:31], v[40:43], v[68:71]
    s_waitcnt lgkmcnt(10)
    v_mfma_f32_16x16x32_bf16 v[72:75], a[24:27], v[44:47], v[72:75]
    ds_read_b64 v[20:21], v12 offset:13312
    ds_read_b64 v[22:23], v12 offset:13824
    v_mfma_f32_16x16x32_bf16 v[76:79], a[28:31], v[44:47], v[76:79]
    s_waitcnt vmcnt(0)
    s_barrier
    s_cmp_lg_u32 s21, 0
    s_cbranch_scc1 L_sd_s3
    s_mov_b64 exec, 1
    v_mov_b32 v4, 0
    v_mov_b32 v5, 1
    buffer_atomic_add v5, v4, s[8:11], s35 offen
    s_mov_b64 exec, -1
L_sd_s3:
    s_add_u32 s35, s35, 2048
    s_waitcnt lgkmcnt(10)
    v_mfma_f32_16x16x32_bf16 v[64:67], a[32:35], v[48:51], v[64:67]
    ds_read_b64 v[24:25], v12 offset:14336
    ds_read_b64 v[26:27], v12 offset:14848
    v_mfma_f32_16x16x32_bf16 v[68:71], a[36:39], v[48:51], v[68:71]
    s_waitcnt lgkmcnt(10)
    v_mfma_f32_16x16x32_bf16 v[72:75], a[32:35], v[52:55], v[72:75]
    ds_read_b64 v[28:29], v12 offset:15360
    ds_read_b64 v[30:31], v12 offset:15872
    v_mfma_f32_16x16x32_bf16 v[76:79], a[36:39], v[52:55], v[76:79]
    s_waitcnt lgkmcnt(10)
    v_mfma_f32_16x16x32_bf16 v[64:67], a[40:43], v[56:59], v[64:67]
    ds_read_b64 v[32:33], v12 offset:16384
    ds_read_b64 v[34:35], v12 offset:16896
    v_mfma_f32_16x16x32_bf16 v[68:71], a[44:47], v[56:59], v[68:71]
    s_waitcnt lgkmcnt(10)
    v_mfma_f32_16x16x32_bf16 v[72:75], a[40:43], v[60:63], v[72:75]
    ds_read_b64 v[36:37], v12 offset:17408
    ds_read_b64 v[38:39], v12 offset:17920
    v_mfma_f32_16x16x32_bf16 v[76:79], a[44:47], v[60:63], v[76:79]
    s_waitcnt lgkmcnt(10)
    v_mfma_f32_16x16x32_bf16 v[64:67], a[48:51], v[16:19], v[64:67]
    ds_read_b64 v[40:41], v12 offset:18432
    ds_read_b64 v[42:43], v12 offset:18944
    v_mfma_f32_16x16x32_bf16 v[68:71], a[52:55], v[16:19], v[68:71]
    s_waitcnt lgkmcnt(10)
    v_mfma_f32_16x16x32_bf16 v[72:75], a[48:51], v[20:23], v[72:75]
    ds_read_b64 v[44:45], v12 offset:19456
    ds_read_b64 v[46:47], v12 offset:19968
    v_mfma_f32_16x16x32_bf16 v[76:79], a[52:55], v[20:23], v[76:79]
    s_waitcnt lgkmcnt(10)
    v_mfma_f32_16x16x32_bf16 v[64:67], a[56:59], v[24:27], v[64:67]
    ds_read_b64 v[48:49], v12 offset:20480
    ds_read_b64 v[50:51], v12 offset:20992
    v_mfma_f32_16x16x32_bf16 v[68:71], a[60:63], v[24:27], v[68:71]
    s_waitcnt lgkmcnt(10)
    v_mfma_f32_16x16x32_bf16 v[72:75], a[56:59], v[28:31], v[72:75]
    ds_read_b64 v[52:53], v12 offset:21504
    ds_read_b64 v[54:55], v12 offset:22016
    v_mfma_f32_16x16x32_bf16 v[76:79], a[60:63], v[28:31], v[76:79]
    s_waitcnt lgkmcnt(10)
    v_mfma_f32_16x16x32_bf16 v[64:67], a[64:67], v[32:35], v[64:67]
    ds_read_b64 v[56:57], v12 offset:22528
    ds_read_b64 v[58:59], v12 offset:23040
    v_mfma_f32_16x16x32_bf16 v[68:71], a[68:71], v[32:35], v[68:71]
    s_waitcnt lgkmcnt(10)
    v_mfma_f32_16x16x32_bf16 v[72:75], a[64:67], v[36:39], v[72:75]
    ds_read_b64 v[60:61], v12 offset:23552
    ds_read_b64 v[62:63], v12 offset:24064
    v_mfma_f32_16x16x32_bf16 v[76:79], a[68:71], v[36:39], v[76:79]
    s_waitcnt lgkmcnt(10)
    v_mfma_f32_16x16x32_bf16 v[64:67], a[72:75], v[40:43], v[64:67]
    ds_read_b64 v[16:17], v12 offset:24576
    ds_read_b64 v[18:19], v12 offset:25088
    v_mfma_f32_16x16x32_bf16 v[68:71], a[76:79], v[40:43], v[68:71]
    s_waitcnt lgkmcnt(10)
    v_mfma_f32_16x16x32_bf16 v[72:75], a[72:75], v[44:47], v[72:75]
    ds_read_b64 v[20:21], v12 offset:25600
    ds_read_b64 v[22:23], v12 offset:26112
    v_mfma_f32_16x16x32_bf16 v[76:79], a[76:79], v[44:47], v[76:79]
    s_waitcnt lgkmcnt(10)
    v_mfma_f32_16x16x32_bf16 v[64:67], a[80:83], v[48:51], v[64:67]
    ds_read_b64 v[24:25], v12 offset:26624
    ds_read_b64 v[26:27], v12 offset:27136
    v_mfma_f32_16x16x32_bf16 v[68:71], a[84:87], v[48:51], v[68:71]
    s_waitcnt lgkmcnt(10)
    v_mfma_f32_16x16x32_bf16 v[72:75], a[80:83], v[52:55], v[72:75]
    ds_read_b64 v[28:29], v12 offset:27648
    ds_read_b64 v[30:31], v12 offset:28160
    v_mfma_f32_16x16x32_bf16 v[76:79], a[84:87], v[52:55], v[76:79]
    s_waitcnt lgkmcnt(10)
    v_mfma_f32_16x16x32_bf16 v[64:67], a[88:91], v[56:59], v[64:67]
    ds_read_b64 v[32:33], v12 offset:28672
    ds_read_b64 v[34:35], v12 offset:29184
    v_mfma_f32_16x16x32_bf16 v[68:71], a[92:95], v[56:59], v[68:71]
    s_waitcnt lgkmcnt(10)
    v_mfma_f32_16x16x32_bf16 v[72:75], a[88:91], v[60:63], v[72:75]
    ds_read_b64 v[36:37], v12 offset:29696
    ds_read_b64 v[38:39], v12 offset:30208
    v_mfma_f32_16x16x32_bf16 v[76:79], a[92:95], v[60:63], v[76:79]
    s_waitcnt lgkmcnt(10)
    v_mfma_f32_16x16x32_bf16 v[64:67], a[96:99], v[16:19], v[64:67]
    ds_read_b64 v[40:41], v12 offset:30720
    ds_read_b64 v[42:43], v12 offset:31232
    v_mfma_f32_16x16x32_bf16 v[68:71], a[100:103], v[16:19], v[68:71]
    s_waitcnt lgkmcnt(10)
    v_mfma_f32_16x16x32_bf16 v[72:75], a[96:99], v[20:23], v[72:75]
    ds_read_b64 v[44:45], v12 offset:31744
    ds_read_b64 v[46:47], v12 offset:32256
    v_mfma_f32_16x16x32_bf16 v[76:79], a[100:103], v[20:23], v[76:79]
    s_waitcnt lgkmcnt(10)
    v_mfma_f32_16x16x32_bf16 v[64:67], a[104:107], v[24:27], v[64:67]
    ds_read_b64 v[48:49], v12 offset:32768
    ds_read_b64 v[50:51], v12 offset:33280
    v_mfma_f32_16x16x32_bf16 v[68:71], a[108:111], v[24:27], v[68:71]
    s_waitcnt lgkmcnt(10)
    v_mfma_f32_16x16x32_bf16 v[72:75], a[104:107], v[28:31], v[72:75]
    ds_read_b64 v[52:53], v12 offset:33792
    ds_read_b64 v[54:55], v12 offset:34304
    v_mfma_f32_16x16x32_bf16 v[76:79], a[108:111], v[28:31], v[76:79]
    s_waitcnt lgkmcnt(10)
    v_mfma_f32_16x16x32_bf16 v[64:67], a[112:115], v[32:35], v[64:67]
    ds_read_b64 v[56:57], v12 offset:34816
    ds_read_b64 v[58:59], v12 offset:35328
    v_mfma_f32_16x16x32_bf16 v[68:71], a[116:119], v[32:35], v[68:71]
    s_waitcnt lgkmcnt(10)
    v_mfma_f32_16x16x32_bf16 v[72:75], a[112:115], v[36:39], v[72:75]
    ds_read_b64 v[60:61], v12 offset:35840
    ds_read_b64 v[62:63], v12 offset:36352
    v_mfma_f32_16x16x32_bf16 v[76:79], a[116:119], v[36:39], v[76:79]
    s_waitcnt lgkmcnt(10)
    v_mfma_f32_16x16x32_bf16 v[64:67], a[120:123], v[40:43], v[64:67]
    ds_read_b64 v[16:17], v12 offset:36864
    ds_read_b64 v[18:19], v12 offset:37376
    v_mfma_f32_16x16x32_bf16 v[68:71], a[124:127], v[40:43], v[68:71]
    s_waitcnt lgkmcnt(10)
    v_mfma_f32_16x16x32_bf16 v[72:75], a[120:123], v[44:47], v[72:75]
    ds_read_b64 v[20:21], v12 offset:37888
    ds_read_b64 v[22:23], v12 offset:38400
    v_mfma_f32_16x16x32_bf16 v[76:79], a[124:127], v[44:47], v[76:79]
    s_waitcnt lgkmcnt(10)
    v_mfma_f32_16x16x32_bf16 v[64:67], a[128:131], v[48:51], v[64:67]
    ds_read_b64 v[24:25], v12 offset:38912
    ds_read_b64 v[26:27], v12 offset:39424
    v_mfma_f32_16x16x32_bf16 v[68:71], a[132:135], v[48:51], v[68:71]
    s_waitcnt lgkmcnt(10)
    v_mfma_f32_16x16x32_bf16 v[72:75], a[128:131], v[52:55], v[72:75]
    ds_read_b64 v[28:29], v12 offset:39936
    ds_read_b64 v[30:31], v12 offset:40448
    v_mfma_f32_16x16x32_bf16 v[76:79], a[132:135], v[52:55], v[76:79]
    s_waitcnt lgkmcnt(10)
    v_mfma_f32_16x16x32_bf16 v[64:67], a[136:139], v[56:59], v[64:67]
    ds_read_b64 v[32:33], v12 offset:40960
    ds_read_b64 v[34:35], v12 offset:41472
    v_mfma_f32_16x16x32_bf16 v[68:71], a[140:143], v[56:59], v[68:71]
    s_waitcnt lgkmcnt(10)
    v_mfma_f32_16x16x32_bf16 v[72:75], a[136:139], v[60:63], v[72:75]
    ds_read_b64 v[36:37], v12 offset:41984
    ds_read_b64 v[38:39], v12 offset:42496
    v_mfma_f32_16x16x32_bf16 v[76:79], a[140:143], v[60:63], v[76:79]
    s_waitcnt lgkmcnt(10)
    v_mfma_f32_16x16x32_bf16 v[64:67], a[144:147], v[16:19], v[64:67]
    s_add_u32 s4, s41, 2048
    v_mov_b32 v6, 0
    buffer_atomic_add v6, v15, s[8:11], s4 offen sc0
    ds_read_b64 v[40:41], v12 offset:43008
    ds_read_b64 v[42:43], v12 offset:43520
    v_mfma_f32_16x16x32_bf16 v[68:71], a[148:151], v[16:19], v[68:71]
    s_waitcnt lgkmcnt(10)
    v_mfma_f32_16x16x32_bf16 v[72:75], a[144:147], v[20:23], v[72:75]
    ds_read_b64 v[44:45], v12 offset:44032
    ds_read_b64 v[46:47], v12 offset:44544
    v_mfma_f32_16x16x32_bf16 v[76:79], a[148:151], v[20:23], v[76:79]
    s_waitcnt lgkmcnt(10)
    v_mfma_f32_16x16x32_bf16 v[64:67], a[152:155], v[24:27], v[64:67]
    ds_read_b64 v[48:49], v12 offset:45056
    ds_read_b64 v[50:51], v12 offset:45568
    v_mfma_f32_16x16x32_bf16 v[68:71], a[156:159], v[24:27], v[68:71]
    s_waitcnt lgkmcnt(10)
    v_mfma_f32_16x16x32_bf16 v[72:75], a[152:155], v[28:31], v[72:75]
    ds_read_b64 v[52:53], v12 offset:46080
    ds_read_b64 v[54:55], v12 offset:46592
    v_mfma_f32_16x16x32_bf16 v[76:79], a[156:159], v[28:31], v[76:79]
    s_waitcnt lgkmcnt(10)
    v_mfma_f32_16x16x32_bf16 v[64:67], a[160:163], v[32:35], v[64:67]
    ds_read_b64 v[56:57], v12 offset:47104
    ds_read_b64 v[58:59], v12 offset:47616
    v_mfma_f32_16x16x32_bf16 v[68:71], a[164:167], v[32:35], v[68:71]
    s_waitcnt lgkmcnt(10)
    v_mfma_f32_16x16x32_bf16 v[72:75], a[160:163], v[36:39], v[72:75]
    ds_read_b64 v[60:61], v12 offset:48128
    ds_read_b64 v[62:63], v12 offset:48640
    v_mfma_f32_16x16x32_bf16 v[76:79], a[164:167], v[36:39], v[76:79]
    s_waitcnt lgkmcnt(10)
    v_mfma_f32_16x16x32_bf16 v[64:67], a[168:171], v[40:43], v[64:67]
    ds_read_b64 v[16:17], v12 offset:49152
    ds_read_b64 v[18:19], v12 offset:49664
    v_mfma_f32_16x16x32_bf16 v[68:71], a[172:175], v[40:43], v[68:71]
    s_waitcnt lgkmcnt(10)
    v_mfma_f32_16x16x32_bf16 v[72:75], a[168:171], v[44:47], v[72:75]
    ds_read_b64 v[20:21], v12 offset:50176
    ds_read_b64 v[22:23], v12 offset:50688
    v_mfma_f32_16x16x32_bf16 v[76:79], a[172:175], v[44:47], v[76:79]
    s_waitcnt lgkmcnt(10)
    v_mfma_f32_16x16x32_bf16 v[64:67], a[176:179], v[48:51], v[64:67]
    ds_read_b64 v[24:25], v12 offset:51200
    ds_read_b64 v[26:27], v12 offset:51712
    v_mfma_f32_16x16x32_bf16 v[68:71], a[180:183], v[48:51], v[68:71]
    s_waitcnt lgkmcnt(10)
    v_mfma_f32_16x16x32_bf16 v[72:75], a[176:179], v[52:55], v[72:75]
    ds_read_b64 v[28:29], v12 offset:52224
    ds_read_b64 v[30:31], v12 offset:52736
    v_mfma_f32_16x16x32_bf16 v[76:79], a[180:183], v[52:55], v[76:79]
    s_waitcnt lgkmcnt(10)
    v_mfma_f32_16x16x32_bf16 v[64:67], a[184:187], v[56:59], v[64:67]
    ds_read_b64 v[32:33], v12 offset:53248
    ds_read_b64 v[34:35], v12 offset:53760
    v_mfma_f32_16x16x32_bf16 v[68:71], a[188:191], v[56:59], v[68:71]
    s_waitcnt lgkmcnt(10)
    v_mfma_f32_16x16x32_bf16 v[72:75], a[184:187], v[60:63], v[72:75]
    ds_read_b64 v[36:37], v12 offset:54272
    ds_read_b64 v[38:39], v12 offset:54784
    v_mfma_f32_16x16x32_bf16 v[76:79], a[188:191], v[60:63], v[76:79]
    s_waitcnt lgkmcnt(10)
    v_mfma_f32_16x16x32_bf16 v[64:67], a[192:195], v[16:19], v[64:67]
    ds_read_b64 v[40:41], v12 offset:55296
    ds_read_b64 v[42:43], v12 offset:55808
    v_mfma_f32_16x16x32_bf16 v[68:71], a[196:199], v[16:19], v[68:71]
    s_waitcnt lgkmcnt(10)
    v_mfma_f32_16x16x32_bf16 v[72:75], a[192:195], v[20:23], v[72:75]
    ds_read_b64 v[44:45], v12 offset:56320
    ds_read_b64 v[46:47], v12 offset:56832
    v_mfma_f32_16x16x32_bf16 v[76:79], a[196:199], v[20:23], v[76:79]
    s_waitcnt lgkmcnt(10)
    v_mfma_f32_16x16x32_bf16 v[64:67], a[200:203], v[24:27], v[64:67]
    v_mfma_f32_16x16x32_bf16 v[68:71], a[204:207], v[24:27], v[68:71]
    s_waitcnt lgkmcnt(8)
    v_mfma_f32_16x16x32_bf16 v[72:75], a[200:203], v[28:31], v[72:75]
    v_mfma_f32_16x16x32_bf16 v[76:79], a[204:207], v[28:31], v[76:79]
    s_waitcnt lgkmcnt(6)
    v_mfma_f32_16x16x32_bf16 v[64:67], a[208:211], v[32:35], v[64:67]
    v_mfma_f32_16x16x32_bf16 v[68:71], a[212:215], v[32:35], v[68:71]
    s_waitcnt lgkmcnt(4)
    v_mfma_f32_16x16x32_bf16 v[72:75], a[208:211], v[36:39], v[72:75]
    v_mfma_f32_16x16x32_bf16 v[76:79], a[212:215], v[36:39], v[76:79]
    s_waitcnt lgkmcnt(2)
    v_mfma_f32_16x16x32_bf16 v[64:67], a[216:219], v[40:43], v[64:67]
    v_mfma_f32_16x16x32_bf16 v[68:71], a[220:223], v[40:43], v[68:71]
    s_waitcnt lgkmcnt(0)
    v_mfma_f32_16x16x32_bf16 v[72:75], a[216:219], v[44:47], v[72:75]
    v_mfma_f32_16x16x32_bf16 v[76:79], a[220:223], v[44:47], v[76:79]
    s_branch L_sd_T
L_t8:
    s_cmp_lg_u32 s63, -1
    s_cbranch_scc1 L_nl_c
    v_mov_b32 v4, 192
L_nl_p:
    buffer_load_dword v5, v4, s[16:19], 0 offen sc1
    s_sub_u32 s62, s62, 1
    s_cbranch_scc1 L_w_fail
    s_waitcnt vmcnt(0)
    v_readfirstlane_b32 s4, v5
    s_and_b32 s5, s4, 0xffff
    s_cmp_lt_u32 s5, 8
    s_cbranch_scc1 L_nl_p
    s_lshr_b32 s4, s4, 16
    s_cmp_ge_u32 s4, 4
    s_cselect_b32 s63, 8192, 0
L_nl_c:
L_sln:
    s_and_b32 s41, s55, 2047
    s_add_u32 s41, s41, 243318784
    s_bfe_u32 s35, s55, 0xb000b
    s_add_u32 s35, s35, 243318784
    s_lshr_b32 s36, s55, 22
    v_and_b32 v10, 3, v1
    v_bfe_u32 v11, v1, 2, 2
    v_lshrrev_b32 v12, 4, v1
    s_lshl_b32 s4, s21, 13
    v_lshlrev_b32 v8, 10, v11
    v_lshl_add_u32 v8, v12, 8, v8
    v_lshl_add_u32 v8, v10, 4, v8
    v_add_u32 v8, s4, v8
    v_lshlrev_b32 v9, 11, v10
    v_lshl_add_u32 v9, v11, 6, v9
    v_and_b32 v13, 1, v12
    v_lshl_add_u32 v9, v13, 5, v9
    v_lshrrev_b32 v13, 1, v12
    v_lshl_add_u32 v9, v13, 4, v9
    s_lshl_b32 s4, s21, 9
    v_add_u32 v9, s4, v9
    v_lshlrev_b32 v7, 4, v10
    s_lshl_b32 s4, s21, 2
    v_add_u32 v6, s4, v7
    s_cmp_eq_u32 s21, 0
    s_cselect_b32 s4, 0, 0x80000000
    v_mov_b32 v15, 0x80000000
    v_writelane_b32 v15, s4, 0
    v_mov_b32 v14, 0
L_sln_l:
    s_lshr_b32 s43, s52, 3
    s_lshl_b32 s38, s43, 11
    s_lshr_b32 s37, s52, 2
    s_lshl_b32 s37, s37, 15
    s_and_b32 s4, s52, 3
    s_mul_i32 s4, s4, 64
    s_add_u32 s37, s37, s4
    s_add_u32 s39, s38, s41
    s_mov_b32 s44, 1
    s_cmp_lg_u32 s21, 0
    s_cbranch_scc1 L_sln_w0
    v_readfirstlane_b32 s4, v14
    s_cmp_ge_u32 s4, s36
    s_cbranch_scc1 L_sln_w0
    s_mov_b32 s44, 0
    s_add_u32 s40, s63, 243302400
    s_add_u32 s42, s43, 1
    v_mov_b32 v4, 0
    s_mov_b64 exec, 1
L_sln_f:
    v_mov_b32 v5, 0
    buffer_atomic_add v5, v4, s[8:11], s40 offen sc0
    s_sub_u32 s62, s62, 1
    s_cbranch_scc1 L_w_fail
    s_waitcnt vmcnt(0)
    v_cmp_gt_u32 vcc, s42, v5
    s_cbranch_vccz L_sln_f_ok
    s_sleep 20
    s_branch L_sln_f
L_sln_f_ok:
    s_mov_b64 exec, -1
L_sln_w0:
    s_barrier
    s_add_u32 s4, s37, 142606336
    s_add_u32 s5, s4, 4096
    buffer_load_dwordx4 v[16:19], v8, s[8:11], s4 offen offset:0 sc1
    buffer_load_dwordx4 v[20:23], v8, s[8:11], s5 offen offset:0 sc1
    s_cmp_lg_u32 s44, 0
    s_cbranch_scc1 L_sln_w
    v_mov_b32 v4, 0
    s_mov_b64 exec, 1
L_sln_p:
    v_mov_b32 v5, 0
    buffer_atomic_add v5, v4, s[8:11], s39 offen sc0
    s_sub_u32 s62, s62, 1
    s_cbranch_scc1 L_w_fail
    s_waitcnt vmcnt(0)
    v_cmp_gt_u32 vcc, s36, v5
    s_cbranch_vccz L_sln_p_ok
    s_sleep 1
    s_branch L_sln_p
L_sln_p_ok:
    s_mov_b64 exec, -1
L_sln_w:
    s_barrier
    s_add_u32 s4, s52, s53
    s_lshr_b32 s4, s4, 3
    s_lshl_b32 s4, s4, 11
    s_add_u32 s4, s4, s41
    v_mov_b32 v14, 0
    buffer_atomic_add v14, v15, s[8:11], s4 offen sc0
    s_add_u32 s4, s37, 167772160
    s_add_u32 s5, s4, 4096
    buffer_load_dwordx4 v[64:67], v8, s[8:11], s4 offen offset:0 sc1
    buffer_load_dwordx4 v[68:71], v8, s[8:11], s5 offen offset:0 sc1
    s_add_u32 s4, s37, 171966464
    s_add_u32 s5, s4, 4096
    buffer_load_dwordx4 v[72:75], v8, s[8:11], s4 offen offset:0 sc1
    buffer_load_dwordx4 v[76:79], v8, s[8:11], s5 offen offset:0 sc1
    s_add_u32 s4, s37, 176160768
    s_add_u32 s5, s4, 4096
    buffer_load_dwordx4 v[80:83], v8, s[8:11], s4 offen offset:0 sc1
    buffer_load_dwordx4 v[84:87], v8, s[8:11], s5 offen offset:0 sc1
    s_add_u32 s4, s37, 180355072
    s_add_u32 s5, s4, 4096
    buffer_load_dwordx4 v[88:91], v8, s[8:11], s4 offen offset:0 sc1
    buffer_load_dwordx4 v[92:95], v8, s[8:11], s5 offen offset:0 sc1
    s_waitcnt vmcnt(8)
    v_lshlrev_b32 v32, 16, v16
    v_and_b32 v33, 0xffff0000, v16
    v_lshlrev_b32 v34, 16, v17
    v_and_b32 v35, 0xffff0000, v17
    v_lshlrev_b32 v36, 16, v18
    v_and_b32 v37, 0xffff0000, v18
    v_lshlrev_b32 v38, 16, v19
    v_and_b32 v39, 0xffff0000, v19
    v_lshlrev_b32 v40, 16, v20
    v_and_b32 v41, 0xffff0000, v20
    v_lshlrev_b32 v42, 16, v21
    v_and_b32 v43, 0xffff0000, v21
    v_lshlrev_b32 v44, 16, v22
    v_and_b32 v45, 0xffff0000, v22
    v_lshlrev_b32 v46, 16, v23
    v_and_b32 v47, 0xffff0000, v23
    s_waitcnt vmcnt(7)
    v_lshlrev_b32 v128, 16, v64
    v_and_b32 v129, 0xffff0000, v64
    v_lshlrev_b32 v130, 16, v65
    v_and_b32 v131, 0xffff0000, v65
    v_lshlrev_b32 v132, 16, v66
    v_and_b32 v133, 0xffff0000, v66
    v_lshlrev_b32 v134, 16, v67
    v_and_b32 v135, 0xffff0000, v67
    v_pk_add_f32 v[32:33], v[32:33], v[128:129]
    v_pk_add_f32 v[34:35], v[34:35], v[130:131]
    v_pk_add_f32 v[36:37], v[36:37], v[132:133]
    v_pk_add_f32 v[38:39], v[38:39], v[134:135]
    s_waitcnt vmcnt(6)
    v_lshlrev_b32 v136, 16, v68
    v_and_b32 v137, 0xffff0000, v68
    v_lshlrev_b32 v138, 16, v69
    v_and_b32 v139, 0xffff0000, v69
    v_lshlrev_b32 v140, 16, v70
    v_and_b32 v141, 0xffff0000, v70
    v_lshlrev_b32 v142, 16, v71
    v_and_b32 v143, 0xffff0000, v71
    v_pk_add_f32 v[40:41], v[40:41], v[136:137]
    v_pk_add_f32 v[42:43], v[42:43], v[138:139]
    v_pk_add_f32 v[44:45], v[44:45], v[140:141]
    v_pk_add_f32 v[46:47], v[46:47], v[142:143]
    s_waitcnt vmcnt(5)
    v_lshlrev_b32 v128, 16, v72
    v_and_b32 v129, 0xffff0000, v72
    v_lshlrev_b32 v130, 16, v73
    v_and_b32 v131, 0xffff0000, v73
    v_lshlrev_b32 v132, 16, v74
    v_and_b32 v133, 0xffff0000, v74
    v_lshlrev_b32 v134, 16, v75
    v_and_b32 v135, 0xffff0000, v75
    v_pk_add_f32 v[32:33], v[32:33], v[128:129]
    v_pk_add_f32 v[34:35], v[34:35], v[130:131]
    v_pk_add_f32 v[36:37], v[36:37], v[132:133]
    v_pk_add_f32 v[38:39], v[38:39], v[134:135]
    s_waitcnt vmcnt(4)
    v_lshlrev_b32 v136, 16, v76
    v_and_b32 v137, 0xffff0000, v76
    v_lshlrev_b32 v138, 16, v77
    v_and_b32 v139, 0xffff0000, v77
    v_lshlrev_b32 v140, 16, v78
    v_and_b32 v141, 0xffff0000, v78
    v_lshlrev_b32 v142, 16, v79
    v_and_b32 v143, 0xffff0000, v79
    v_pk_add_f32 v[40:41], v[40:41], v[136:137]
    v_pk_add_f32 v[42:43], v[42:43], v[138:139]
    v_pk_add_f32 v[44:45], v[44:45], v[140:141]
    v_pk_add_f32 v[46:47], v[46:47], v[142:143]
    s_waitcnt vmcnt(3)
    v_lshlrev_b32 v128, 16, v80
    v_and_b32 v129, 0xffff0000, v80
    v_lshlrev_b32 v130, 16, v81
    v_and_b32 v131, 0xffff0000, v81
    v_lshlrev_b32 v132, 16, v82
    v_and_b32 v133, 0xffff0000, v82
    v_lshlrev_b32 v134, 16, v83
    v_and_b32 v135, 0xffff0000, v83
    v_pk_add_f32 v[32:33], v[32:33], v[128:129]
    v_pk_add_f32 v[34:35], v[34:35], v[130:131]
    v_pk_add_f32 v[36:37], v[36:37], v[132:133]
    v_pk_add_f32 v[38:39], v[38:39], v[134:135]
    s_waitcnt vmcnt(2)
    v_lshlrev_b32 v136, 16, v84
    v_and_b32 v137, 0xffff0000, v84
    v_lshlrev_b32 v138, 16, v85
    v_and_b32 v139, 0xffff0000, v85
    v_lshlrev_b32 v140, 16, v86
    v_and_b32 v141, 0xffff0000, v86
    v_lshlrev_b32 v142, 16, v87
    v_and_b32 v143, 0xffff0000, v87
    v_pk_add_f32 v[40:41], v[40:41], v[136:137]
    v_pk_add_f32 v[42:43], v[42:43], v[138:139]
    v_pk_add_f32 v[44:45], v[44:45], v[140:141]
    v_pk_add_f32 v[46:47], v[46:47], v[142:143]
    s_waitcnt vmcnt(1)
    v_lshlrev_b32 v128, 16, v88
    v_and_b32 v129, 0xffff0000, v88
    v_lshlrev_b32 v130, 16, v89
    v_and_b32 v131, 0xffff0000, v89
    v_lshlrev_b32 v132, 16, v90
    v_and_b32 v133, 0xffff0000, v90
    v_lshlrev_b32 v134, 16, v91
    v_and_b32 v135, 0xffff0000, v91
    v_pk_add_f32 v[32:33], v[32:33], v[128:129]
    v_pk_add_f32 v[34:35], v[34:35], v[130:131]
    v_pk_add_f32 v[36:37], v[36:37], v[132:133]
    v_pk_add_f32 v[38:39], v[38:39], v[134:135]
    s_waitcnt vmcnt(0)
    v_lshlrev_b32 v136, 16, v92
    v_and_b32 v137, 0xffff0000, v92
    v_lshlrev_b32 v138, 16, v93
    v_and_b32 v139, 0xffff0000, v93
    v_lshlrev_b32 v140, 16, v94
    v_and_b32 v141, 0xffff0000, v94
    v_lshlrev_b32 v142, 16, v95
    v_and_b32 v143, 0xffff0000, v95
    v_pk_add_f32 v[40:41], v[40:41], v[136:137]
    v_pk_add_f32 v[42:43], v[42:43], v[138:139]
    v_pk_add_f32 v[44:45], v[44:45], v[140:141]
    v_pk_add_f32 v[46:47], v[46:47], v[142:143]
    v_cvt_pk_bf16_f32 v16, v32, v33
    v_cvt_pk_bf16_f32 v17, v34, v35
    v_cvt_pk_bf16_f32 v18, v36, v37
    v_cvt_pk_bf16_f32 v19, v38, v39
    v_cvt_pk_bf16_f32 v20, v40, v41
    v_cvt_pk_bf16_f32 v21, v42, v43
    v_cvt_pk_bf16_f32 v22, v44, v45
    v_cvt_pk_bf16_f32 v23, v46, v47
    s_add_u32 s4, s37, 138412032
    s_add_u32 s5, s4, 4096
    buffer_store_dwordx4 v[16:19], v8, s[8:11], s4 offen offset:0 sc1
    buffer_store_dwordx4 v[20:23], v8, s[8:11], s5 offen offset:0 sc1
    v_lshlrev_b32 v32, 16, v16
    v_and_b32 v33, 0xffff0000, v16
    v_lshlrev_b32 v34, 16, v17
    v_and_b32 v35, 0xffff0000, v17
    v_lshlrev_b32 v36, 16, v18
    v_and_b32 v37, 0xffff0000, v18
    v_lshlrev_b32 v38, 16, v19
    v_and_b32 v39, 0xffff0000, v19
    v_lshlrev_b32 v40, 16, v20
    v_and_b32 v41, 0xffff0000, v20
    v_lshlrev_b32 v42, 16, v21
    v_and_b32 v43, 0xffff0000, v21
    v_lshlrev_b32 v44, 16, v22
    v_and_b32 v45, 0xffff0000, v22
    v_lshlrev_b32 v46, 16, v23
    v_and_b32 v47, 0xffff0000, v23
    v_pk_add_f32 v[144:145], v[32:33], v[34:35]
    v_pk_add_f32 v[144:145], v[144:145], v[36:37]
    v_pk_add_f32 v[144:145], v[144:145], v[38:39]
    v_pk_add_f32 v[144:145], v[144:145], v[40:41]
    v_pk_add_f32 v[144:145], v[144:145], v[42:43]
    v_pk_add_f32 v[144:145], v[144:145], v[44:45]
    v_pk_add_f32 v[144:145], v[144:145], v[46:47]
    v_add_f32 v144, v144, v145
    s_nop 1
    v_add_f32_dpp v144, v144, v144 row_ror:4 row_mask:0xf bank_mask:0xf
    s_nop 1
    v_add_f32_dpp v144, v144, v144 row_ror:8 row_mask:0xf bank_mask:0xf
    v_mov_b32 v148, v144
    s_nop 1
    v_permlane32_swap_b32 v144, v148
    v_add_f32 v144, v144, v148
    v_mov_b32 v148, v144
    s_nop 1
    v_permlane16_swap_b32 v144, v148
    v_add_f32 v144, v144, v148
    ds_write_b32 v6, v144 offset:0
    s_waitcnt lgkmcnt(0)
    s_barrier
    ds_read_b128 v[148:151], v7 offset:0
    s_waitcnt lgkmcnt(0)
    v_add_f32 v148, v148, v149
    v_add_f32 v150, v150, v151
    v_add_f32 v144, v148, v150
    v_mul_f32 v144, 0xba800000, v144
    v_pk_add_f32 v[32:33], v[32:33], v[144:145] op_sel_hi:[1,0]
    v_pk_add_f32 v[34:35], v[34:35], v[144:145] op_sel_hi:[1,0]
    v_pk_add_f32 v[36:37], v[36:37], v[144:145] op_sel_hi:[1,0]
    v_pk_add_f32 v[38:39], v[38:39], v[144:145] op_sel_hi:[1,0]
    v_pk_add_f32 v[40:41], v[40:41], v[144:145] op_sel_hi:[1,0]
    v_pk_add_f32 v[42:43], v[42:43], v[144:145] op_sel_hi:[1,0]
    v_pk_add_f32 v[44:45], v[44:45], v[144:145] op_sel_hi:[1,0]
    v_pk_add_f32 v[46:47], v[46:47], v[144:145] op_sel_hi:[1,0]
    v_pk_mul_f32 v[144:145], v[32:33], v[32:33]
    v_pk_fma_f32 v[144:145], v[34:35], v[34:35], v[144:145]
    v_pk_fma_f32 v[144:145], v[36:37], v[36:37], v[144:145]
    v_pk_fma_f32 v[144:145], v[38:39], v[38:39], v[144:145]
    v_pk_fma_f32 v[144:145], v[40:41], v[40:41], v[144:145]
    v_pk_fma_f32 v[144:145], v[42:43], v[42:43], v[144:145]
    v_pk_fma_f32 v[144:145], v[44:45], v[44:45], v[144:145]
    v_pk_fma_f32 v[144:145], v[46:47], v[46:47], v[144:145]
    v_add_f32 v144, v144, v145
    s_nop 1
    v_add_f32_dpp v144, v144, v144 row_ror:4 row_mask:0xf bank_mask:0xf
    s_nop 1
    v_add_f32_dpp v144, v144, v144 row_ror:8 row_mask:0xf bank_mask:0xf
    v_mov_b32 v148, v144
    s_nop 1
    v_permlane32_swap_b32 v144, v148
    v_add_f32 v144, v144, v148
    v_mov_b32 v148, v144
    s_nop 1
    v_permlane16_swap_b32 v144, v148
    v_add_f32 v144, v144, v148
    ds_write_b32 v6, v144 offset:256
    s_waitcnt lgkmcnt(0)
    s_barrier
    ds_read_b128 v[148:151], v7 offset:256
    s_waitcnt lgkmcnt(0)
    v_add_f32 v148, v148, v149
    v_add_f32 v150, v150, v151
    v_add_f32 v144, v148, v150
    v_mov_b32 v148, 0x3727c5ac
    v_fmac_f32 v148, 0x3a800000, v144
    v_rsq_f32 v144, v148
    s_nop 0
    v_pk_mul_f32 v[32:33], v[32:33], v[144:145] op_sel_hi:[1,0]
    v_pk_mul_f32 v[34:35], v[34:35], v[144:145] op_sel_hi:[1,0]
    v_pk_mul_f32 v[36:37], v[36:37], v[144:145] op_sel_hi:[1,0]
    v_pk_mul_f32 v[38:39], v[38:39], v[144:145] op_sel_hi:[1,0]
    v_pk_mul_f32 v[40:41], v[40:41], v[144:145] op_sel_hi:[1,0]
    v_pk_mul_f32 v[42:43], v[42:43], v[144:145] op_sel_hi:[1,0]
    v_pk_mul_f32 v[44:45], v[44:45], v[144:145] op_sel_hi:[1,0]
    v_pk_mul_f32 v[46:47], v[46:47], v[144:145] op_sel_hi:[1,0]
    v_cvt_pk_bf16_f32 v16, v32, v33
    v_cvt_pk_bf16_f32 v17, v34, v35
    v_cvt_pk_bf16_f32 v18, v36, v37
    v_cvt_pk_bf16_f32 v19, v38, v39
    v_cvt_pk_bf16_f32 v20, v40, v41
    v_cvt_pk_bf16_f32 v21, v42, v43
    v_cvt_pk_bf16_f32 v22, v44, v45
    v_cvt_pk_bf16_f32 v23, v46, v47
    s_add_u32 s4, s37, 146800640
    s_add_u32 s5, s4, 4096
    buffer_store_dwordx4 v[16:19], v8, s[8:11], s4 offen offset:0 sc1
    buffer_store_dwordx4 v[20:23], v8, s[8:11], s5 offen offset:0 sc1
    s_waitcnt vmcnt(0)
    s_barrier
    s_add_u32 s39, s38, s35
    s_cmp_lg_u32 s21, 0
    s_cbranch_scc1 L_sln_s
    s_mov_b64 exec, 1
    v_mov_b32 v4, 0
    v_mov_b32 v5, 1
    buffer_atomic_add v5, v4, s[8:11], s39 offen sc0
    s_waitcnt vmcnt(0)
    v_cmp_eq_u32 vcc, 7, v5
    s_cbranch_vccz L_sln_s1
    s_add_u32 s39, s38, 243320320
    v_mov_b32 v5, 1
    buffer_store_dword v5, v4, s[8:11], s39 offen sc1
L_sln_s1:
    s_mov_b64 exec, -1
L_sln_s:
    s_add_u32 s52, s52, s53
    s_cmp_lt_u32 s52, 512
    s_cbranch_scc1 L_sln_l
    s_branch L_w_done
L_t11:
L_sfin:
    s_and_b32 s41, s55, 2047
    s_add_u32 s41, s41, 243318784
    s_bfe_u32 s35, s55, 0xb000b
    s_add_u32 s35, s35, 243318784
    s_lshr_b32 s36, s55, 22
    v_and_b32 v10, 7, v1
    v_bfe_u32 v11, v1, 3, 1
    v_lshrrev_b32 v12, 4, v1
    s_lshl_b32 s4, s21, 13
    v_lshlrev_b32 v8, 10, v11
    v_lshl_add_u32 v8, v12, 8, v8
    v_lshl_add_u32 v8, v10, 4, v8
    v_add_u32 v8, s4, v8
    v_lshlrev_b32 v9, 11, v10
    v_lshl_add_u32 v9, v11, 6, v9
    v_and_b32 v13, 1, v12
    v_lshl_add_u32 v9, v13, 5, v9
    v_lshrrev_b32 v13, 1, v12
    v_lshl_add_u32 v9, v13, 4, v9
    s_lshl_b32 s4, s21, 9
    v_add_u32 v9, s4, v9
    v_lshlrev_b32 v7, 4, v10
    s_lshl_b32 s4, s21, 2
    v_add_u32 v6, s4, v7
    s_cmp_eq_u32 s21, 0
    s_cselect_b32 s4, 0, 0x80000000
    v_mov_b32 v15, 0x80000000
    v_writelane_b32 v15, s4, 0
    v_mov_b32 v14, 0
    s_mov_b32 s24, s86
    s_mov_b32 s25, s87
    s_mov_b32 s26, 0x400000
    s_mov_b32 s27, 0x00020000
L_sfin_l:
    s_lshr_b32 s43, s52, 2
    s_lshl_b32 s38, s43, 11
    s_lshr_b32 s37, s52, 1
    s_lshl_b32 s37, s37, 15
    s_and_b32 s4, s52, 1
    s_mul_i32 s4, s4, 128
    s_add_u32 s37, s37, s4
    s_add_u32 s39, s38, s41
    s_mov_b32 s44, 1
    s_cmp_lg_u32 s21, 0
    s_cbranch_scc1 L_sfin_w0
    v_readfirstlane_b32 s4, v14
    s_cmp_ge_u32 s4, s36
    s_cbranch_scc1 L_sfin_w0
    s_mov_b32 s44, 0
    s_add_u32 s40, s38, 243320320
    s_mov_b32 s42, 1
    v_mov_b32 v4, 0
L_sfin_f:
    buffer_load_dword v5, v4, s[8:11], s40 offen sc1
    s_sub_u32 s62, s62, 1
    s_cbranch_scc1 L_w_fail
    s_waitcnt vmcnt(0)
    v_cmp_gt_u32 vcc, s42, v5
    s_cbranch_vccz L_sfin_f_ok
    s_sleep 20
    s_branch L_sfin_f
L_sfin_f_ok:
L_sfin_w0:
    s_barrier
    s_add_u32 s4, s37, 138412032
    s_add_u32 s5, s4, 4096
    buffer_load_dwordx4 v[16:19], v8, s[8:11], s4 offen offset:0 sc1
    buffer_load_dwordx4 v[20:23], v8, s[8:11], s4 offen offset:2048 sc1
    buffer_load_dwordx4 v[24:27], v8, s[8:11], s5 offen offset:0 sc1
    buffer_load_dwordx4 v[28:31], v8, s[8:11], s5 offen offset:2048 sc1
    s_cmp_lg_u32 s44, 0
    s_cbranch_scc1 L_sfin_w
    v_mov_b32 v4, 0
    s_mov_b64 exec, 1
L_sfin_p:
    v_mov_b32 v5, 0
    buffer_atomic_add v5, v4, s[8:11], s39 offen sc0
    s_sub_u32 s62, s62, 1
    s_cbranch_scc1 L_w_fail
    s_waitcnt vmcnt(0)
    v_cmp_gt_u32 vcc, s36, v5
    s_cbranch_vccz L_sfin_p_ok
    s_sleep 1
    s_branch L_sfin_p
L_sfin_p_ok:
    s_mov_b64 exec, -1
L_sfin_w:
    s_barrier
    s_add_u32 s4, s52, s53
    s_lshr_b32 s4, s4, 2
    s_lshl_b32 s4, s4, 11
    s_add_u32 s4, s4, s41
    v_mov_b32 v14, 0
    buffer_atomic_add v14, v15, s[8:11], s4 offen sc0
    s_add_u32 s4, s37, 184549376
    s_add_u32 s5, s4, 4096
    buffer_load_dwordx4 v[64:67], v8, s[8:11], s4 offen offset:0 sc1
    buffer_load_dwordx4 v[68:71], v8, s[8:11], s4 offen offset:2048 sc1
    buffer_load_dwordx4 v[72:75], v8, s[8:11], s5 offen offset:0 sc1
    buffer_load_dwordx4 v[76:79], v8, s[8:11], s5 offen offset:2048 sc1
    s_add_u32 s4, s37, 188743680
    s_add_u32 s5, s4, 4096
    buffer_load_dwordx4 v[80:83], v8, s[8:11], s4 offen offset:0 sc1
    buffer_load_dwordx4 v[84:87], v8, s[8:11], s4 offen offset:2048 sc1
    buffer_load_dwordx4 v[88:91], v8, s[8:11], s5 offen offset:0 sc1
    buffer_load_dwordx4 v[92:95], v8, s[8:11], s5 offen offset:2048 sc1
    s_add_u32 s4, s37, 192937984
    s_add_u32 s5, s4, 4096
    buffer_load_dwordx4 v[96:99], v8, s[8:11], s4 offen offset:0 sc1
    buffer_load_dwordx4 v[100:103], v8, s[8:11], s4 offen offset:2048 sc1
    buffer_load_dwordx4 v[104:107], v8, s[8:11], s5 offen offset:0 sc1
    buffer_load_dwordx4 v[108:111], v8, s[8:11], s5 offen offset:2048 sc1
    s_add_u32 s4, s37, 197132288
    s_add_u32 s5, s4, 4096
    buffer_load_dwordx4 v[112:115], v8, s[8:11], s4 offen offset:0 sc1
    buffer_load_dwordx4 v[116:119], v8, s[8:11], s4 offen offset:2048 sc1
    buffer_load_dwordx4 v[120:123], v8, s[8:11], s5 offen offset:0 sc1
    buffer_load_dwordx4 v[124:127], v8, s[8:11], s5 offen offset:2048 sc1
    s_waitcnt vmcnt(16)
    v_lshlrev_b32 v32, 16, v16
    v_and_b32 v33, 0xffff0000, v16
    v_lshlrev_b32 v34, 16, v17
    v_and_b32 v35, 0xffff0000, v17
    v_lshlrev_b32 v36, 16, v18
    v_and_b32 v37, 0xffff0000, v18
    v_lshlrev_b32 v38, 16, v19
    v_and_b32 v39, 0xffff0000, v19
    v_lshlrev_b32 v40, 16, v20
    v_and_b32 v41, 0xffff0000, v20
    v_lshlrev_b32 v42, 16, v21
    v_and_b32 v43, 0xffff0000, v21
    v_lshlrev_b32 v44, 16, v22
    v_and_b32 v45, 0xffff0000, v22
    v_lshlrev_b32 v46, 16, v23
    v_and_b32 v47, 0xffff0000, v23
    v_lshlrev_b32 v48, 16, v24
    v_and_b32 v49, 0xffff0000, v24
    v_lshlrev_b32 v50, 16, v25
    v_and_b32 v51, 0xffff0000, v25
    v_lshlrev_b32 v52, 16, v26
    v_and_b32 v53, 0xffff0000, v26
    v_lshlrev_b32 v54, 16, v27
    v_and_b32 v55, 0xffff0000, v27
    v_lshlrev_b32 v56, 16, v28
    v_and_b32 v57, 0xffff0000, v28
    v_lshlrev_b32 v58, 16, v29
    v_and_b32 v59, 0xffff0000, v29
    v_lshlrev_b32 v60, 16, v30
    v_and_b32 v61, 0xffff0000, v30
    v_lshlrev_b32 v62, 16, v31
    v_and_b32 v63, 0xffff0000, v31
    s_waitcnt vmcnt(15)
    v_lshlrev_b32 v128, 16, v64
    v_and_b32 v129, 0xffff0000, v64
    v_lshlrev_b32 v130, 16, v65
    v_and_b32 v131, 0xffff0000, v65
    v_lshlrev_b32 v132, 16, v66
    v_and_b32 v133, 0xffff0000, v66
    v_lshlrev_b32 v134, 16, v67
    v_and_b32 v135, 0xffff0000, v67
    v_pk_add_f32 v[32:33], v[32:33], v[128:129]
    v_pk_add_f32 v[34:35], v[34:35], v[130:131]
    v_pk_add_f32 v[36:37], v[36:37], v[132:133]
    v_pk_add_f32 v[38:39], v[38:39], v[134:135]
    s_waitcnt vmcnt(14)
    v_lshlrev_b32 v136, 16, v68
    v_and_b32 v137, 0xffff0000, v68
    v_lshlrev_b32 v138, 16, v69
    v_and_b32 v139, 0xffff0000, v69
    v_lshlrev_b32 v140, 16, v70
    v_and_b32 v141, 0xffff0000, v70
    v_lshlrev_b32 v142, 16, v71
    v_and_b32 v143, 0xffff0000, v71
    v_pk_add_f32 v[40:41], v[40:41], v[136:137]
    v_pk_add_f32 v[42:43], v[42:43], v[138:139]
    v_pk_add_f32 v[44:45], v[44:45], v[140:141]
    v_pk_add_f32 v[46:47], v[46:47], v[142:143]
    s_waitcnt vmcnt(13)
    v_lshlrev_b32 v128, 16, v72
    v_and_b32 v129, 0xffff0000, v72
    v_lshlrev_b32 v130, 16, v73
    v_and_b32 v131, 0xffff0000, v73
    v_lshlrev_b32 v132, 16, v74
    v_and_b32 v133, 0xffff0000, v74
    v_lshlrev_b32 v134, 16, v75
    v_and_b32 v135, 0xffff0000, v75
    v_pk_add_f32 v[48:49], v[48:49], v[128:129]
    v_pk_add_f32 v[50:51], v[50:51], v[130:131]
    v_pk_add_f32 v[52:53], v[52:53], v[132:133]
    v_pk_add_f32 v[54:55], v[54:55], v[134:135]
    s_waitcnt vmcnt(12)
    v_lshlrev_b32 v136, 16, v76
    v_and_b32 v137, 0xffff0000, v76
    v_lshlrev_b32 v138, 16, v77
    v_and_b32 v139, 0xffff0000, v77
    v_lshlrev_b32 v140, 16, v78
    v_and_b32 v141, 0xffff0000, v78
    v_lshlrev_b32 v142, 16, v79
    v_and_b32 v143, 0xffff0000, v79
    v_pk_add_f32 v[56:57], v[56:57], v[136:137]
    v_pk_add_f32 v[58:59], v[58:59], v[138:139]
    v_pk_add_f32 v[60:61], v[60:61], v[140:141]
    v_pk_add_f32 v[62:63], v[62:63], v[142:143]
    s_waitcnt vmcnt(11)
    v_lshlrev_b32 v128, 16, v80
    v_and_b32 v129, 0xffff0000, v80
    v_lshlrev_b32 v130, 16, v81
    v_and_b32 v131, 0xffff0000, v81
    v_lshlrev_b32 v132, 16, v82
    v_and_b32 v133, 0xffff0000, v82
    v_lshlrev_b32 v134, 16, v83
    v_and_b32 v135, 0xffff0000, v83
    v_pk_add_f32 v[32:33], v[32:33], v[128:129]
    v_pk_add_f32 v[34:35], v[34:35], v[130:131]
    v_pk_add_f32 v[36:37], v[36:37], v[132:133]
    v_pk_add_f32 v[38:39], v[38:39], v[134:135]
    s_waitcnt vmcnt(10)
    v_lshlrev_b32 v136, 16, v84
    v_and_b32 v137, 0xffff0000, v84
    v_lshlrev_b32 v138, 16, v85
    v_and_b32 v139, 0xffff0000, v85
    v_lshlrev_b32 v140, 16, v86
    v_and_b32 v141, 0xffff0000, v86
    v_lshlrev_b32 v142, 16, v87
    v_and_b32 v143, 0xffff0000, v87
    v_pk_add_f32 v[40:41], v[40:41], v[136:137]
    v_pk_add_f32 v[42:43], v[42:43], v[138:139]
    v_pk_add_f32 v[44:45], v[44:45], v[140:141]
    v_pk_add_f32 v[46:47], v[46:47], v[142:143]
    s_waitcnt vmcnt(9)
    v_lshlrev_b32 v128, 16, v88
    v_and_b32 v129, 0xffff0000, v88
    v_lshlrev_b32 v130, 16, v89
    v_and_b32 v131, 0xffff0000, v89
    v_lshlrev_b32 v132, 16, v90
    v_and_b32 v133, 0xffff0000, v90
    v_lshlrev_b32 v134, 16, v91
    v_and_b32 v135, 0xffff0000, v91
    v_pk_add_f32 v[48:49], v[48:49], v[128:129]
    v_pk_add_f32 v[50:51], v[50:51], v[130:131]
    v_pk_add_f32 v[52:53], v[52:53], v[132:133]
    v_pk_add_f32 v[54:55], v[54:55], v[134:135]
    s_waitcnt vmcnt(8)
    v_lshlrev_b32 v136, 16, v92
    v_and_b32 v137, 0xffff0000, v92
    v_lshlrev_b32 v138, 16, v93
    v_and_b32 v139, 0xffff0000, v93
    v_lshlrev_b32 v140, 16, v94
    v_and_b32 v141, 0xffff0000, v94
    v_lshlrev_b32 v142, 16, v95
    v_and_b32 v143, 0xffff0000, v95
    v_pk_add_f32 v[56:57], v[56:57], v[136:137]
    v_pk_add_f32 v[58:59], v[58:59], v[138:139]
    v_pk_add_f32 v[60:61], v[60:61], v[140:141]
    v_pk_add_f32 v[62:63], v[62:63], v[142:143]
    s_waitcnt vmcnt(7)
    v_lshlrev_b32 v128, 16, v96
    v_and_b32 v129, 0xffff0000, v96
    v_lshlrev_b32 v130, 16, v97
    v_and_b32 v131, 0xffff0000, v97
    v_lshlrev_b32 v132, 16, v98
    v_and_b32 v133, 0xffff0000, v98
    v_lshlrev_b32 v134, 16, v99
    v_and_b32 v135, 0xffff0000, v99
    v_pk_add_f32 v[32:33], v[32:33], v[128:129]
    v_pk_add_f32 v[34:35], v[34:35], v[130:131]
    v_pk_add_f32 v[36:37], v[36:37], v[132:133]
    v_pk_add_f32 v[38:39], v[38:39], v[134:135]
    s_waitcnt vmcnt(6)
    v_lshlrev_b32 v136, 16, v100
    v_and_b32 v137, 0xffff0000, v100
    v_lshlrev_b32 v138, 16, v101
    v_and_b32 v139, 0xffff0000, v101
    v_lshlrev_b32 v140, 16, v102
    v_and_b32 v141, 0xffff0000, v102
    v_lshlrev_b32 v142, 16, v103
    v_and_b32 v143, 0xffff0000, v103
    v_pk_add_f32 v[40:41], v[40:41], v[136:137]
    v_pk_add_f32 v[42:43], v[42:43], v[138:139]
    v_pk_add_f32 v[44:45], v[44:45], v[140:141]
    v_pk_add_f32 v[46:47], v[46:47], v[142:143]
    s_waitcnt vmcnt(5)
    v_lshlrev_b32 v128, 16, v104
    v_and_b32 v129, 0xffff0000, v104
    v_lshlrev_b32 v130, 16, v105
    v_and_b32 v131, 0xffff0000, v105
    v_lshlrev_b32 v132, 16, v106
    v_and_b32 v133, 0xffff0000, v106
    v_lshlrev_b32 v134, 16, v107
    v_and_b32 v135, 0xffff0000, v107
    v_pk_add_f32 v[48:49], v[48:49], v[128:129]
    v_pk_add_f32 v[50:51], v[50:51], v[130:131]
    v_pk_add_f32 v[52:53], v[52:53], v[132:133]
    v_pk_add_f32 v[54:55], v[54:55], v[134:135]
    s_waitcnt vmcnt(4)
    v_lshlrev_b32 v136, 16, v108
    v_and_b32 v137, 0xffff0000, v108
    v_lshlrev_b32 v138, 16, v109
    v_and_b32 v139, 0xffff0000, v109
    v_lshlrev_b32 v140, 16, v110
    v_and_b32 v141, 0xffff0000, v110
    v_lshlrev_b32 v142, 16, v111
    v_and_b32 v143, 0xffff0000, v111
    v_pk_add_f32 v[56:57], v[56:57], v[136:137]
    v_pk_add_f32 v[58:59], v[58:59], v[138:139]
    v_pk_add_f32 v[60:61], v[60:61], v[140:141]
    v_pk_add_f32 v[62:63], v[62:63], v[142:143]
    s_waitcnt vmcnt(3)
    v_lshlrev_b32 v128, 16, v112
    v_and_b32 v129, 0xffff0000, v112
    v_lshlrev_b32 v130, 16, v113
    v_and_b32 v131, 0xffff0000, v113
    v_lshlrev_b32 v132, 16, v114
    v_and_b32 v133, 0xffff0000, v114
    v_lshlrev_b32 v134, 16, v115
    v_and_b32 v135, 0xffff0000, v115
    v_pk_add_f32 v[32:33], v[32:33], v[128:129]
    v_pk_add_f32 v[34:35], v[34:35], v[130:131]
    v_pk_add_f32 v[36:37], v[36:37], v[132:133]
    v_pk_add_f32 v[38:39], v[38:39], v[134:135]
    s_waitcnt vmcnt(2)
    v_lshlrev_b32 v136, 16, v116
    v_and_b32 v137, 0xffff0000, v116
    v_lshlrev_b32 v138, 16, v117
    v_and_b32 v139, 0xffff0000, v117
    v_lshlrev_b32 v140, 16, v118
    v_and_b32 v141, 0xffff0000, v118
    v_lshlrev_b32 v142, 16, v119
    v_and_b32 v143, 0xffff0000, v119
    v_pk_add_f32 v[40:41], v[40:41], v[136:137]
    v_pk_add_f32 v[42:43], v[42:43], v[138:139]
    v_pk_add_f32 v[44:45], v[44:45], v[140:141]
    v_pk_add_f32 v[46:47], v[46:47], v[142:143]
    s_waitcnt vmcnt(1)
    v_lshlrev_b32 v128, 16, v120
    v_and_b32 v129, 0xffff0000, v120
    v_lshlrev_b32 v130, 16, v121
    v_and_b32 v131, 0xffff0000, v121
    v_lshlrev_b32 v132, 16, v122
    v_and_b32 v133, 0xffff0000, v122
    v_lshlrev_b32 v134, 16, v123
    v_and_b32 v135, 0xffff0000, v123
    v_pk_add_f32 v[48:49], v[48:49], v[128:129]
    v_pk_add_f32 v[50:51], v[50:51], v[130:131]
    v_pk_add_f32 v[52:53], v[52:53], v[132:133]
    v_pk_add_f32 v[54:55], v[54:55], v[134:135]
    s_waitcnt vmcnt(0)
    v_lshlrev_b32 v136, 16, v124
    v_and_b32 v137, 0xffff0000, v124
    v_lshlrev_b32 v138, 16, v125
    v_and_b32 v139, 0xffff0000, v125
    v_lshlrev_b32 v140, 16, v126
    v_and_b32 v141, 0xffff0000, v126
    v_lshlrev_b32 v142, 16, v127
    v_and_b32 v143, 0xffff0000, v127
    v_pk_add_f32 v[56:57], v[56:57], v[136:137]
    v_pk_add_f32 v[58:59], v[58:59], v[138:139]
    v_pk_add_f32 v[60:61], v[60:61], v[140:141]
    v_pk_add_f32 v[62:63], v[62:63], v[142:143]
    v_cvt_pk_bf16_f32 v16, v32, v33
    v_cvt_pk_bf16_f32 v17, v34, v35
    v_cvt_pk_bf16_f32 v18, v36, v37
    v_cvt_pk_bf16_f32 v19, v38, v39
    v_cvt_pk_bf16_f32 v20, v40, v41
    v_cvt_pk_bf16_f32 v21, v42, v43
    v_cvt_pk_bf16_f32 v22, v44, v45
    v_cvt_pk_bf16_f32 v23, v46, v47
    v_cvt_pk_bf16_f32 v24, v48, v49
    v_cvt_pk_bf16_f32 v25, v50, v51
    v_cvt_pk_bf16_f32 v26, v52, v53
    v_cvt_pk_bf16_f32 v27, v54, v55
    v_cvt_pk_bf16_f32 v28, v56, v57
    v_cvt_pk_bf16_f32 v29, v58, v59
    v_cvt_pk_bf16_f32 v30, v60, v61
    v_cvt_pk_bf16_f32 v31, v62, v63
    s_mul_i32 s6, s52, 16384
    v_permlane16_swap_b32 v16, v18
    v_permlane16_swap_b32 v17, v19
    v_permlane16_swap_b32 v20, v22
    v_permlane16_swap_b32 v21, v23
    v_permlane16_swap_b32 v24, v26
    v_permlane16_swap_b32 v25, v27
    v_permlane16_swap_b32 v28, v30
    v_permlane16_swap_b32 v29, v31
    buffer_store_dwordx4 v[16:19], v9, s[24:27], s6 offen offset:0
    buffer_store_dwordx4 v[20:23], v9, s[24:27], s6 offen offset:128
    buffer_store_dwordx4 v[24:27], v9, s[24:27], s6 offen offset:256
    buffer_store_dwordx4 v[28:31], v9, s[24:27], s6 offen offset:384
    s_add_u32 s52, s52, s53
    s_cmp_lt_u32 s52, 256
    s_cbranch_scc1 L_sfin_l
    s_branch L_w_done
L_t6:
    s_cmp_lg_u32 s63, -1
    s_cbranch_scc1 L_nt_c
    v_mov_b32 v4, 192
L_nt_p:
    buffer_load_dword v5, v4, s[16:19], 0 offen sc1
    s_sub_u32 s62, s62, 1
    s_cbranch_scc1 L_w_fail
    s_waitcnt vmcnt(0)
    v_readfirstlane_b32 s4, v5
    s_and_b32 s5, s4, 0xffff
    s_cmp_lt_u32 s5, 8
    s_cbranch_scc1 L_nt_p
    s_lshr_b32 s4, s4, 16
    s_cmp_ge_u32 s4, 4
    s_cselect_b32 s63, 8192, 0
L_nt_c:
L_satt:
    s_and_b32 s41, s55, 2047
    s_add_u32 s41, s41, 243318784
    s_bfe_u32 s35, s55, 0xb000b
    s_add_u32 s35, s35, 243318784
    s_lshr_b32 s36, s55, 22
    v_and_b32 v4, 15, v1
    v_lshrrev_b32 v5, 4, v1
    v_lshlrev_b32 v6, 2, v5
    v_mov_b32 v7, 0xff000000
    v_mov_b32 v9, 0
    v_add_u32 v10, 0, v6
    v_cmp_gt_u32 vcc, v10, v4
    s_nop 1
    v_cndmask_b32 v12, v9, v7, vcc
    v_mov_b32 v20, 0x3f803f80
    v_add_u32 v10, 1, v6
    v_cmp_gt_u32 vcc, v10, v4
    s_nop 1
    v_cndmask_b32 v13, v9, v7, vcc
    v_mov_b32 v21, 0x3f803f80
    v_add_u32 v10, 2, v6
    v_cmp_gt_u32 vcc, v10, v4
    s_nop 1
    v_cndmask_b32 v14, v9, v7, vcc
    v_mov_b32 v22, 0x3f803f80
    v_add_u32 v10, 3, v6
    v_cmp_gt_u32 vcc, v10, v4
    s_nop 1
    v_cndmask_b32 v15, v9, v7, vcc
    v_mov_b32 v23, 0x3f803f80
    v_mov_b64 v[152:153], 0
    v_lshlrev_b32 v8, 3, v1
    s_lshl_b32 s4, s21, 12
    v_add_u32 v17, s4, v8
    v_lshlrev_b32 v18, 5, v4
    v_lshl_add_u32 v18, v5, 3, v18
    v_add_u32 v18, s4, v18
    s_mov_b32 s42, 0x3e0293ee
    s_lshl_b32 s44, s54, 2
    s_add_u32 s44, s44, s21
    s_mov_b32 s43, s52
    v_lshlrev_b32 v16, 7, v1
    s_lshl_b32 s45, s54, 10
    s_add_u32 s45, s45, 243302400
    s_add_u32 s45, s45, s63
    s_mov_b32 s37, 0x4008
L_satt_l:
    s_lshr_b32 s38, s43, 3
    s_lshl_b32 s38, s38, 4
    s_lshr_b32 s39, s44, 1
    s_add_u32 s38, s38, s39
    s_lshl_b32 s38, s38, 7
    s_add_u32 s38, s38, 243271680
    v_mov_b32 v4, 0
L_satt_q:
    buffer_load_dword v5, v4, s[8:11], s38 offen sc1
    s_sub_u32 s62, s62, 1
    s_cbranch_scc1 L_w_fail
    s_waitcnt vmcnt(0)
    v_cmp_gt_u32 vcc, s37, v5
    s_cbranch_vccz L_satt_q_ok
    s_sleep 8
    s_branch L_satt_q
L_satt_q_ok:
    s_lshl_b32 s6, s43, 18
    s_lshl_b32 s7, s44, 12
    s_add_u32 s6, s6, s7
    s_lshl_b32 s5, s43, 11
    s_xor_b32 s5, s5, s63
    s_and_b32 s5, s5, 8192
    s_lshl_b32 s4, s43, 19
    s_add_u32 s5, s5, s4
    s_lshr_b32 s4, s44, 1
    s_lshl_b32 s4, s4, 14
    s_and_b32 s7, s7, 4096
    s_add_u32 s7, s7, s4
    s_add_u32 s7, s7, s5
    s_add_u32 s4, s7, 20971520
    buffer_load_dwordx4 v[56:59], v2, s[8:11], s4 offen offset:0 sc1
    buffer_load_dwordx4 v[60:63], v2, s[8:11], s4 offen offset:1024 sc1
    buffer_load_dwordx4 v[64:67], v2, s[8:11], s4 offen offset:2048 sc1
    buffer_load_dwordx4 v[68:71], v2, s[8:11], s4 offen offset:3072 sc1
    s_add_u32 s4, s7, 21233664
    buffer_load_dwordx4 v[72:75], v2, s[8:11], s4 offen offset:0 sc1
    buffer_load_dwordx4 v[76:79], v2, s[8:11], s4 offen offset:1024 sc1
    buffer_load_dwordx4 v[80:83], v2, s[8:11], s4 offen offset:2048 sc1
    buffer_load_dwordx4 v[84:87], v2, s[8:11], s4 offen offset:3072 sc1
    s_add_u32 s4, s6, 4194304
    buffer_load_dwordx4 v[24:27], v2, s[8:11], s4 offen offset:0 sc1
    buffer_load_dwordx4 v[28:31], v2, s[8:11], s4 offen offset:1024 sc1
    buffer_load_dwordx4 v[32:35], v2, s[8:11], s4 offen offset:2048 sc1
    buffer_load_dwordx4 v[36:39], v2, s[8:11], s4 offen offset:3072 sc1
    s_add_u32 s4, s6, 4325376
    buffer_load_dwordx4 v[40:43], v2, s[8:11], s4 offen offset:0 sc1
    buffer_load_dwordx4 v[44:47], v2, s[8:11], s4 offen offset:1024 sc1
    buffer_load_dwordx4 v[48:51], v2, s[8:11], s4 offen offset:2048 sc1
    buffer_load_dwordx4 v[52:55], v2, s[8:11], s4 offen offset:3072 sc1
    s_lshl_b32 s4, s44, 14
    s_add_u32 s5, s5, s4
    s_add_u32 s4, s5, 54525952
    buffer_load_dwordx4 v[88:91], v2, s[8:11], s4 offen offset:0 sc1
    buffer_load_dwordx4 v[92:95], v2, s[8:11], s4 offen offset:1024 sc1
    buffer_load_dwordx4 v[96:99], v2, s[8:11], s4 offen offset:2048 sc1
    buffer_load_dwordx4 v[100:103], v2, s[8:11], s4 offen offset:3072 sc1
    s_add_u32 s4, s4, 4096
    buffer_load_dwordx4 v[104:107], v2, s[8:11], s4 offen offset:0 sc1
    buffer_load_dwordx4 v[108:111], v2, s[8:11], s4 offen offset:1024 sc1
    buffer_load_dwordx4 v[112:115], v2, s[8:11], s4 offen offset:2048 sc1
    buffer_load_dwordx4 v[116:119], v2, s[8:11], s4 offen offset:3072 sc1
    s_cmp_lg_u32 s21, 0
    s_cbranch_scc1 L_satt_go
    s_mov_b64 exec, 1
L_satt_far:
    v_mov_b32 v5, 0
    buffer_atomic_add v5, v16, s[8:11], s45 offen sc0
    s_sub_u32 s62, s62, 1
    s_cbranch_scc1 L_w_fail
    s_waitcnt vmcnt(0)
    v_cmp_gt_u32 vcc, s43, v5
    s_cbranch_vccz L_satt_near
    s_sleep 40
    s_branch L_satt_far
L_satt_near:
    s_mov_b64 exec, 0xff
L_satt_c:
    v_mov_b32 v5, 0
    buffer_atomic_add v5, v16, s[8:11], s45 offen sc0
    s_sub_u32 s62, s62, 1
    s_cbranch_scc1 L_w_fail
    s_waitcnt vmcnt(0)
    v_cmp_ge_u32 vcc, s43, v5
    s_cbranch_vccnz L_satt_c
    s_mov_b64 exec, -1
L_satt_go:
    s_barrier
    s_add_u32 s4, s5, 88080384
    buffer_load_dwordx2 v[136:137], v8, s[8:11], s4 offen offset:0 sc1
    buffer_load_dwordx2 v[138:139], v8, s[8:11], s4 offen offset:512 sc1
    buffer_load_dwordx2 v[140:141], v8, s[8:11], s4 offen offset:1024 sc1
    buffer_load_dwordx2 v[142:143], v8, s[8:11], s4 offen offset:1536 sc1
    buffer_load_dwordx2 v[144:145], v8, s[8:11], s4 offen offset:2048 sc1
    buffer_load_dwordx2 v[146:147], v8, s[8:11], s4 offen offset:2560 sc1
    buffer_load_dwordx2 v[148:149], v8, s[8:11], s4 offen offset:3072 sc1
    buffer_load_dwordx2 v[150:151], v8, s[8:11], s4 offen offset:3584 sc1
    s_waitcnt vmcnt(8)
    v_mfma_f32_16x16x32_bf16 v[160:163], v[56:59], v[24:27], v[12:15]
    v_mfma_f32_16x16x32_bf16 v[172:175], v[56:59], v[40:43], 0
    v_mfma_f32_16x16x32_bf16 v[176:179], v[72:75], v[40:43], v[12:15]
    v_mfma_f32_16x16x32_bf16 v[160:163], v[60:63], v[28:31], v[160:163]
    v_mfma_f32_16x16x32_bf16 v[172:175], v[60:63], v[44:47], v[172:175]
    v_mfma_f32_16x16x32_bf16 v[176:179], v[76:79], v[44:47], v[176:179]
    v_mfma_f32_16x16x32_bf16 v[160:163], v[64:67], v[32:35], v[160:163]
    v_mfma_f32_16x16x32_bf16 v[172:175], v[64:67], v[48:51], v[172:175]
    v_mfma_f32_16x16x32_bf16 v[176:179], v[80:83], v[48:51], v[176:179]
    v_mfma_f32_16x16x32_bf16 v[160:163], v[68:71], v[36:39], v[160:163]
    v_mfma_f32_16x16x32_bf16 v[172:175], v[68:71], v[52:55], v[172:175]
    v_mfma_f32_16x16x32_bf16 v[176:179], v[84:87], v[52:55], v[176:179]
    s_waitcnt vmcnt(7)
    ds_write_b64 v18, v[136:137] offset:0
    s_waitcnt vmcnt(6)
    ds_write_b64 v18, v[138:139] offset:512
    s_waitcnt vmcnt(5)
    ds_write_b64 v18, v[140:141] offset:1024
    s_waitcnt vmcnt(4)
    ds_write_b64 v18, v[142:143] offset:1536
    s_waitcnt vmcnt(3)
    ds_write_b64 v18, v[144:145] offset:2048
    s_waitcnt vmcnt(2)
    ds_write_b64 v18, v[146:147] offset:2560
    s_waitcnt vmcnt(1)
    ds_write_b64 v18, v[148:149] offset:3072
    s_waitcnt vmcnt(0)
    ds_write_b64 v18, v[150:151] offset:3584
    s_waitcnt lgkmcnt(0)
    ds_read_b64_tr_b16 v[120:121], v17 offset:0
    ds_read_b64_tr_b16 v[122:123], v17 offset:512
    ds_read_b64_tr_b16 v[124:125], v17 offset:1024
    ds_read_b64_tr_b16 v[126:127], v17 offset:1536
    ds_read_b64_tr_b16 v[128:129], v17 offset:2048
    ds_read_b64_tr_b16 v[130:131], v17 offset:2560
    ds_read_b64_tr_b16 v[132:133], v17 offset:3072
    ds_read_b64_tr_b16 v[134:135], v17 offset:3584
    s_waitcnt lgkmcnt(0)
    v_mfma_f32_16x16x32_bf16 v[156:159], v[120:123], v[24:27], 0
    v_mfma_f32_16x16x32_bf16 v[168:171], v[120:123], v[40:43], 0
    v_mfma_f32_16x16x32_bf16 v[156:159], v[124:127], v[28:31], v[156:159]
    v_mfma_f32_16x16x32_bf16 v[168:171], v[124:127], v[44:47], v[168:171]
    v_mfma_f32_16x16x32_bf16 v[156:159], v[128:131], v[32:35], v[156:159]
    v_mfma_f32_16x16x32_bf16 v[168:171], v[128:131], v[48:51], v[168:171]
    v_mfma_f32_16x16x32_bf16 v[156:159], v[132:135], v[36:39], v[156:159]
    v_mfma_f32_16x16x32_bf16 v[168:171], v[132:135], v[52:55], v[168:171]
    s_nop 7
    v_max_f32 v200, v156, v157
    v_max3_f32 v200, v160, v161, v200
    v_max3_f32 v200, v162, v163, v200
    v_mov_b32 v201, v200
    s_nop 1
    v_permlane32_swap_b32 v200, v201
    v_max_f32 v200, v200, v201
    v_mov_b32 v201, v200
    s_nop 1
    v_permlane16_swap_b32 v200, v201
    v_max_f32 v200, v200, v201
    v_mul_f32 v200, s42, v200
    v_fma_f32 v156, v156, s42, -v200
    v_fma_f32 v157, v157, s42, -v200
    v_fma_f32 v160, v160, s42, -v200
    v_fma_f32 v161, v161, s42, -v200
    v_fma_f32 v162, v162, s42, -v200
    v_fma_f32 v163, v163, s42, -v200
    v_exp_f32 v156, v156
    v_exp_f32 v157, v157
    v_exp_f32 v160, v160
    v_exp_f32 v161, v161
    v_exp_f32 v162, v162
    v_exp_f32 v163, v163
    v_mov_b32 v188, 0
    v_mov_b64 v[190:191], 0
    v_cvt_pk_bf16_f32 v189, v156, v157
    v_cvt_pk_bf16_f32 v180, v160, v161
    v_cvt_pk_bf16_f32 v181, v162, v163
    v_mov_b64 v[182:183], 0
    v_max_f32 v200, v168, v169
    v_max3_f32 v200, v172, v173, v200
    v_max3_f32 v200, v174, v175, v200
    v_max3_f32 v200, v176, v177, v200
    v_max3_f32 v200, v178, v179, v200
    v_mov_b32 v201, v200
    s_nop 1
    v_permlane32_swap_b32 v200, v201
    v_max_f32 v200, v200, v201
    v_mov_b32 v201, v200
    s_nop 1
    v_permlane16_swap_b32 v200, v201
    v_max_f32 v200, v200, v201
    v_mul_f32 v200, s42, v200
    v_fma_f32 v168, v168, s42, -v200
    v_fma_f32 v169, v169, s42, -v200
    v_fma_f32 v172, v172, s42, -v200
    v_fma_f32 v173, v173, s42, -v200
    v_fma_f32 v174, v174, s42, -v200
    v_fma_f32 v175, v175, s42, -v200
    v_fma_f32 v176, v176, s42, -v200
    v_fma_f32 v177, v177, s42, -v200
    v_fma_f32 v178, v178, s42, -v200
    v_fma_f32 v179, v179, s42, -v200
    v_exp_f32 v168, v168
    v_exp_f32 v169, v169
    v_exp_f32 v172, v172
    v_exp_f32 v173, v173
    v_exp_f32 v174, v174
    v_exp_f32 v175, v175
    v_exp_f32 v176, v176
    v_exp_f32 v177, v177
    v_exp_f32 v178, v178
    v_exp_f32 v179, v179
    v_mov_b32 v192, 0
    v_mov_b64 v[194:195], 0
    v_cvt_pk_bf16_f32 v193, v168, v169
    v_cvt_pk_bf16_f32 v184, v172, v173
    v_cvt_pk_bf16_f32 v185, v174, v175
    v_cvt_pk_bf16_f32 v186, v176, v177
    v_cvt_pk_bf16_f32 v187, v178, v179
    s_waitcnt vmcnt(0)
    v_mfma_f32_16x16x32_bf16 v[156:159], v[20:23], v[180:183], 0
    v_mfma_f32_16x16x32_bf16 v[156:159], v[20:23], v[188:191], v[156:159]
    v_mfma_f32_16x16x32_bf16 v[24:27], v[88:91], v[180:183], 0
    v_mfma_f32_16x16x32_bf16 v[24:27], v[136:139], v[188:191], v[24:27]
    v_mfma_f32_16x16x32_bf16 v[28:31], v[92:95], v[180:183], 0
    v_mfma_f32_16x16x32_bf16 v[28:31], v[138:141], v[188:191], v[28:31]
    v_mfma_f32_16x16x32_bf16 v[32:35], v[96:99], v[180:183], 0
    v_mfma_f32_16x16x32_bf16 v[32:35], v[140:143], v[188:191], v[32:35]
    v_mfma_f32_16x16x32_bf16 v[36:39], v[100:103], v[180:183], 0
    v_mfma_f32_16x16x32_bf16 v[36:39], v[142:145], v[188:191], v[36:39]
    v_mfma_f32_16x16x32_bf16 v[40:43], v[104:107], v[180:183], 0
    v_mfma_f32_16x16x32_bf16 v[40:43], v[144:147], v[188:191], v[40:43]
    v_mfma_f32_16x16x32_bf16 v[44:47], v[108:111], v[180:183], 0
    v_mfma_f32_16x16x32_bf16 v[44:47], v[146:149], v[188:191], v[44:47]
    v_mfma_f32_16x16x32_bf16 v[48:51], v[112:115], v[180:183], 0
    v_mfma_f32_16x16x32_bf16 v[48:51], v[148:151], v[188:191], v[48:51]
    v_mfma_f32_16x16x32_bf16 v[52:55], v[116:119], v[180:183], 0
    v_mfma_f32_16x16x32_bf16 v[52:55], v[150:153], v[188:191], v[52:55]
    v_mfma_f32_16x16x32_bf16 v[160:163], v[20:23], v[184:187], 0
    v_mfma_f32_16x16x32_bf16 v[160:163], v[20:23], v[192:195], v[160:163]
    v_mfma_f32_16x16x32_bf16 v[56:59], v[88:91], v[184:187], 0
    v_mfma_f32_16x16x32_bf16 v[56:59], v[136:139], v[192:195], v[56:59]
    v_mfma_f32_16x16x32_bf16 v[60:63], v[92:95], v[184:187], 0
    v_mfma_f32_16x16x32_bf16 v[60:63], v[138:141], v[192:195], v[60:63]
    v_mfma_f32_16x16x32_bf16 v[64:67], v[96:99], v[184:187], 0
    v_mfma_f32_16x16x32_bf16 v[64:67], v[140:143], v[192:195], v[64:67]
    v_mfma_f32_16x16x32_bf16 v[68:71], v[100:103], v[184:187], 0
    v_mfma_f32_16x16x32_bf16 v[68:71], v[142:145], v[192:195], v[68:71]
    v_mfma_f32_16x16x32_bf16 v[72:75], v[104:107], v[184:187], 0
    v_mfma_f32_16x16x32_bf16 v[72:75], v[144:147], v[192:195], v[72:75]
    v_mfma_f32_16x16x32_bf16 v[76:79], v[108:111], v[184:187], 0
    v_mfma_f32_16x16x32_bf16 v[76:79], v[146:149], v[192:195], v[76:79]
    v_mfma_f32_16x16x32_bf16 v[80:83], v[112:115], v[184:187], 0
    v_mfma_f32_16x16x32_bf16 v[80:83], v[148:151], v[192:195], v[80:83]
    v_mfma_f32_16x16x32_bf16 v[84:87], v[116:119], v[184:187], 0
    v_mfma_f32_16x16x32_bf16 v[84:87], v[150:153], v[192:195], v[84:87]
    v_rcp_f32 v200, v156
    v_rcp_f32 v202, v160
    s_nop 5
    s_add_u32 s4, s6, 121634816
    v_pk_mul_f32 v[24:25], v[24:25], v[200:201] op_sel_hi:[1,0]
    v_pk_mul_f32 v[26:27], v[26:27], v[200:201] op_sel_hi:[1,0]
    v_pk_mul_f32 v[28:29], v[28:29], v[200:201] op_sel_hi:[1,0]
    v_pk_mul_f32 v[30:31], v[30:31], v[200:201] op_sel_hi:[1,0]
    v_cvt_pk_bf16_f32 v164, v24, v25
    v_cvt_pk_bf16_f32 v165, v26, v27
    v_cvt_pk_bf16_f32 v166, v28, v29
    v_cvt_pk_bf16_f32 v167, v30, v31
    buffer_store_dwordx4 v[164:167], v2, s[8:11], s4 offen offset:0 sc1
    v_pk_mul_f32 v[32:33], v[32:33], v[200:201] op_sel_hi:[1,0]
    v_pk_mul_f32 v[34:35], v[34:35], v[200:201] op_sel_hi:[1,0]
    v_pk_mul_f32 v[36:37], v[36:37], v[200:201] op_sel_hi:[1,0]
    v_pk_mul_f32 v[38:39], v[38:39], v[200:201] op_sel_hi:[1,0]
    v_cvt_pk_bf16_f32 v168, v32, v33
    v_cvt_pk_bf16_f32 v169, v34, v35
    v_cvt_pk_bf16_f32 v170, v36, v37
    v_cvt_pk_bf16_f32 v171, v38, v39
    buffer_store_dwordx4 v[168:171], v2, s[8:11], s4 offen offset:1024 sc1
    v_pk_mul_f32 v[40:41], v[40:41], v[200:201] op_sel_hi:[1,0]
    v_pk_mul_f32 v[42:43], v[42:43], v[200:201] op_sel_hi:[1,0]
    v_pk_mul_f32 v[44:45], v[44:45], v[200:201] op_sel_hi:[1,0]
    v_pk_mul_f32 v[46:47], v[46:47], v[200:201] op_sel_hi:[1,0]
    v_cvt_pk_bf16_f32 v172, v40, v41
    v_cvt_pk_bf16_f32 v173, v42, v43
    v_cvt_pk_bf16_f32 v174, v44, v45
    v_cvt_pk_bf16_f32 v175, v46, v47
    buffer_store_dwordx4 v[172:175], v2, s[8:11], s4 offen offset:2048 sc1
    v_pk_mul_f32 v[48:49], v[48:49], v[200:201] op_sel_hi:[1,0]
    v_pk_mul_f32 v[50:51], v[50:51], v[200:201] op_sel_hi:[1,0]
    v_pk_mul_f32 v[52:53], v[52:53], v[200:201] op_sel_hi:[1,0]
    v_pk_mul_f32 v[54:55], v[54:55], v[200:201] op_sel_hi:[1,0]
    v_cvt_pk_bf16_f32 v176, v48, v49
    v_cvt_pk_bf16_f32 v177, v50, v51
    v_cvt_pk_bf16_f32 v178, v52, v53
    v_cvt_pk_bf16_f32 v179, v54, v55
    buffer_store_dwordx4 v[176:179], v2, s[8:11], s4 offen offset:3072 sc1
    s_add_u32 s4, s6, 121765888
    v_pk_mul_f32 v[56:57], v[56:57], v[202:203] op_sel_hi:[1,0]
    v_pk_mul_f32 v[58:59], v[58:59], v[202:203] op_sel_hi:[1,0]
    v_pk_mul_f32 v[60:61], v[60:61], v[202:203] op_sel_hi:[1,0]
    v_pk_mul_f32 v[62:63], v[62:63], v[202:203] op_sel_hi:[1,0]
    v_cvt_pk_bf16_f32 v164, v56, v57
    v_cvt_pk_bf16_f32 v165, v58, v59
    v_cvt_pk_bf16_f32 v166, v60, v61
    v_cvt_pk_bf16_f32 v167, v62, v63
    buffer_store_dwordx4 v[164:167], v2, s[8:11], s4 offen offset:0 sc1
    v_pk_mul_f32 v[64:65], v[64:65], v[202:203] op_sel_hi:[1,0]
    v_pk_mul_f32 v[66:67], v[66:67], v[202:203] op_sel_hi:[1,0]
    v_pk_mul_f32 v[68:69], v[68:69], v[202:203] op_sel_hi:[1,0]
    v_pk_mul_f32 v[70:71], v[70:71], v[202:203] op_sel_hi:[1,0]
    v_cvt_pk_bf16_f32 v168, v64, v65
    v_cvt_pk_bf16_f32 v169, v66, v67
    v_cvt_pk_bf16_f32 v170, v68, v69
    v_cvt_pk_bf16_f32 v171, v70, v71
    buffer_store_dwordx4 v[168:171], v2, s[8:11], s4 offen offset:1024 sc1
    v_pk_mul_f32 v[72:73], v[72:73], v[202:203] op_sel_hi:[1,0]
    v_pk_mul_f32 v[74:75], v[74:75], v[202:203] op_sel_hi:[1,0]
    v_pk_mul_f32 v[76:77], v[76:77], v[202:203] op_sel_hi:[1,0]
    v_pk_mul_f32 v[78:79], v[78:79], v[202:203] op_sel_hi:[1,0]
    v_cvt_pk_bf16_f32 v172, v72, v73
    v_cvt_pk_bf16_f32 v173, v74, v75
    v_cvt_pk_bf16_f32 v174, v76, v77
    v_cvt_pk_bf16_f32 v175, v78, v79
    buffer_store_dwordx4 v[172:175], v2, s[8:11], s4 offen offset:2048 sc1
    v_pk_mul_f32 v[80:81], v[80:81], v[202:203] op_sel_hi:[1,0]
    v_pk_mul_f32 v[82:83], v[82:83], v[202:203] op_sel_hi:[1,0]
    v_pk_mul_f32 v[84:85], v[84:85], v[202:203] op_sel_hi:[1,0]
    v_pk_mul_f32 v[86:87], v[86:87], v[202:203] op_sel_hi:[1,0]
    v_cvt_pk_bf16_f32 v176, v80, v81
    v_cvt_pk_bf16_f32 v177, v82, v83
    v_cvt_pk_bf16_f32 v178, v84, v85
    v_cvt_pk_bf16_f32 v179, v86, v87
    buffer_store_dwordx4 v[176:179], v2, s[8:11], s4 offen offset:3072 sc1
    s_waitcnt vmcnt(0)
    s_barrier
    s_lshl_b32 s38, s43, 11
    s_add_u32 s39, s38, s35
    s_cmp_lg_u32 s21, 0
    s_cbranch_scc1 L_satt_s
    s_mov_b64 exec, 1
    v_mov_b32 v4, 0
    v_mov_b32 v5, 1
    buffer_atomic_add v5, v4, s[8:11], s39 offen
    s_mov_b64 exec, -1
L_satt_s:
    s_add_u32 s43, s43, s53
    s_cmp_lt_u32 s43, 64
    s_cbranch_scc1 L_satt_l
    s_branch L_w_done
L_w_done:
    s_waitcnt vmcnt(0)
    s_barrier
    v_mov_b32 v7, 158720
    s_cmp_lg_u32 s21, 0
    s_cbranch_scc1 L_w_nx
    s_mov_b64 exec, 1
    s_lshr_b32 s4, s51, 16
    s_and_b32 s5, s51, 0xffff
    s_add_u32 s5, s5, 243269632
    v_mov_b32 v4, 0
    v_mov_b32 v5, s4
    v_mov_b32 v6, 1
    buffer_atomic_add v5, v4, s[8:11], s5 offen
    buffer_atomic_add v6, v4, s[8:11], s60 offen sc0
    s_waitcnt vmcnt(0)
    ds_write_b32 v7, v6
    s_waitcnt lgkmcnt(0)
    s_mov_b64 exec, -1
L_w_nx:
    s_barrier
    ds_read_b32 v6, v7
    s_waitcnt lgkmcnt(0)
    v_readfirstlane_b32 s61, v6
    s_add_u32 s61, s61, 32
    s_branch L_w_task
L_w_fail:
    s_mov_b64 exec, -1
    v_mov_b32 v7, 158720
    v_mov_b32 v6, 0x7fffff00
    ds_write_b32 v7, v6
    v_mov_b32 v4, 96
    v_mov_b32 v5, 1
    buffer_atomic_add v5, v4, s[16:19], 0 offen
    s_waitcnt vmcnt(0) lgkmcnt(0)
L_end:
    s_endpgm
.section .rodata,"a"
.p2align 6
.amdhsa_kernel sequential_preLN__memory_aug_recurrent_mem_tr__swiglu_ffn__prompt_kernel
.amdhsa_next_free_vgpr 512
.amdhsa_next_free_sgpr 102
.amdhsa_accum_offset 256
.amdhsa_group_segment_fixed_size 0
.amdhsa_kernarg_size 112
.amdhsa_user_sgpr_count 2
.amdhsa_user_sgpr_kernarg_segment_ptr 1
.amdhsa_system_sgpr_workgroup_id_x 1
.end_amdhsa_kernel
.p2align 6
task_table:
.long 64, 108, 3520, 108, 6976, 108, 10432, 108, 13888, 108, 17344, 108, 0, 0, 0, 0
.long 4,243288064,16,67584,0,0,20971520,0
.long 4,243288064,16,67584,0,256,20975616,0
.long 4,243288064,16,67712,0,512,20987904,0
.long 4,243288064,16,67712,0,768,20992000,0
.long 4,243288064,16,67840,0,1024,21004288,0
.long 4,243288064,16,67840,0,1280,21008384,0
.long 5,243288064,16,67584,0,0,54525952,0
.long 5,243288064,16,67584,0,256,54542336,0
.long 5,243288064,16,67712,0,512,54558720,0
.long 5,243288064,16,67712,0,768,54575104,0
.long 4,243288064,16,67584,262144,0,23068672,1
.long 4,243288064,16,67584,262144,256,23072768,1
.long 4,243288064,16,67712,262144,512,23085056,1
.long 4,243288064,16,67712,262144,768,23089152,1
.long 4,243288064,16,67840,262144,1024,23101440,1
.long 4,243288064,16,67840,262144,1280,23105536,1
.long 2,243288192,16,266240,524288,0,25165824,0
.long 2,243288192,16,266368,524288,512,25182208,0
.long 2,243288192,16,266496,524288,1024,25198592,0
.long 3,243288192,16,266240,524288,0,58720256,0
.long 3,243288192,16,266368,524288,512,58753024,0
.long 5,243288064,16,67584,262144,0,56623104,1
.long 5,243288064,16,67584,262144,256,56639488,1
.long 5,243288064,16,67712,262144,512,56655872,1
.long 5,243288064,16,67712,262144,768,56672256,1
.long 2,243288320,16,268288,1048576,0,29360128,0
.long 2,243288320,16,268416,1048576,512,29376512,0
.long 2,243288320,16,268544,1048576,1024,29392896,0
.long 3,243288320,16,268288,1048576,0,62914560,0
.long 3,243288320,16,268416,1048576,512,62947328,0
.long 1,243288064,16,1073743872,0,0,4194304,0
.long 1,243288064,16,1073744000,0,512,4202496,0
.long 1,243288064,16,1073744128,0,1024,4210688,0
.long 1,243288192,16,1073745920,524288,0,6291456,0
.long 1,243288192,16,1073746048,524288,512,6299648,0
.long 1,243288192,16,1073746176,524288,1024,6307840,0
.long 1,243288320,16,1073747968,1048576,0,8388608,0
.long 1,243288320,16,1073748096,1048576,512,8396800,0
.long 1,243288320,16,1073748224,1048576,1024,8404992,0
.long 2,243288448,16,270336,1572864,0,33554432,0
.long 2,243288448,16,270464,1572864,512,33570816,0
.long 2,243288448,16,270592,1572864,1024,33587200,0
.long 3,243288448,16,270336,1572864,0,67108864,0
.long 3,243288448,16,270464,1572864,512,67141632,0
.long 1,243288448,16,1073750016,1572864,0,10485760,0
.long 1,243288448,16,1073750144,1572864,512,10493952,0
.long 1,243288448,16,1073750272,1572864,1024,10502144,0
.long 2,243288576,16,272384,2097152,0,37748736,0
.long 2,243288576,16,272512,2097152,512,37765120,0
.long 2,243288576,16,272640,2097152,1024,37781504,0
.long 3,243288576,16,272384,2097152,0,71303168,0
.long 3,243288576,16,272512,2097152,512,71335936,0
.long 1,243288576,16,1073752064,2097152,0,12582912,0
.long 1,243288576,16,1073752192,2097152,512,12591104,0
.long 1,243288576,16,1073752320,2097152,1024,12599296,0
.long 2,243288704,16,274432,2621440,0,41943040,0
.long 2,243288704,16,274560,2621440,512,41959424,0
.long 2,243288704,16,274688,2621440,1024,41975808,0
.long 3,243288704,16,274432,2621440,0,75497472,0
.long 3,243288704,16,274560,2621440,512,75530240,0
.long 1,243288704,16,1073754112,2621440,0,14680064,0
.long 1,243288704,16,1073754240,2621440,512,14688256,0
.long 1,243288704,16,1073754368,2621440,1024,14696448,0
.long 2,243288832,16,276480,3145728,0,46137344,0
.long 2,243288832,16,276608,3145728,512,46153728,0
.long 2,243288832,16,276736,3145728,1024,46170112,0
.long 3,243288832,16,276480,3145728,0,79691776,0
.long 3,243288832,16,276608,3145728,512,79724544,0
.long 7,128,0,1920,121634816,0,167772160,9437184
.long 7,129,0,1920,121634816,256,167776256,9437184
.long 7,130,0,1920,121634816,512,167780352,9437184
.long 7,131,0,1920,121634816,768,167784448,9437184
.long 7,132,0,1920,121634816,1024,167788544,9437184
.long 7,133,0,1920,121634816,1280,167792640,9437184
.long 7,134,0,1920,121634816,1536,167796736,9437184
.long 7,135,0,1920,121634816,1792,167800832,9437184
.long 6,0,0,1920,0,3,0,0
.long 6,0,0,1920,0,3,6,786432
.long 6,0,0,1920,1,3,4,524288
.long 6,0,0,1920,2,3,2,262144
.long 8,0,0,1920,0,16,0,135528960
.long 8,0,0,1920,6,16,0,135528960
.long 8,0,0,1920,12,16,0,135528960
.long 9,128,0,1920,146800640,0,150994944,5768704
.long 9,129,0,1920,146800640,128,150996992,5768704
.long 9,130,0,1920,146800640,256,150999040,5768704
.long 9,131,0,1920,146800640,384,151001088,5768704
.long 9,132,0,1920,146800640,512,151003136,5768704
.long 9,133,0,1920,146800640,640,151005184,5768704
.long 9,134,0,1920,146800640,768,151007232,5768704
.long 9,135,0,1920,146800640,896,151009280,5768704
.long 10,64,0,1920,150994944,0,184549376,61342464
.long 10,65,0,1920,150994944,256,184553472,61342464
.long 10,66,0,1920,150994944,512,184557568,61342464
.long 10,67,0,1920,150994944,768,184561664,61342464
.long 11,0,0,1920,2,8,0,137102592
.long 3,243288832,16,277760,3145728,5120,80019456,0
.long 1,243288832,16,1073756160,3145728,0,16777216,0
.long 1,243288832,16,1073756928,3145728,3072,16826368,0
.long 1,243288832,16,1073757696,3145728,6144,16875520,0
.long 2,243288960,16,278784,3670016,1024,50364416,0
.long 2,243288960,16,279552,3670016,4096,50462720,0
.long 2,243288960,16,280320,3670016,7168,50561024,0
.long 3,243288960,16,279040,3670016,2048,84017152,0
.long 3,243288960,16,279808,3670016,5120,84213760,0
.long 1,243288960,16,1073758208,3670016,0,18874368,0
.long 1,243288960,16,1073758976,3670016,3072,18923520,0
.long 1,243288960,16,1073759744,3670016,6144,18972672,0
.long 4,243288064,16,67968,0,1536,21020672,0
.long 4,243288064,16,67968,0,1792,21024768,0
.long 4,243288064,16,68096,0,2048,21037056,0
.long 4,243288064,16,68096,0,2304,21041152,0
.long 5,243288064,16,67840,0,1024,54591488,0
.long 5,243288064,16,67840,0,1280,54607872,0
.long 5,243288064,16,67968,0,1536,54624256,0
.long 5,243288064,16,67968,0,1792,54640640,0
.long 5,243288064,16,68096,0,2048,54657024,0
.long 5,243288064,16,68096,0,2304,54673408,0
.long 4,243288064,16,67968,262144,1536,23117824,1
.long 4,243288064,16,67968,262144,1792,23121920,1
.long 4,243288064,16,68096,262144,2048,23134208,1
.long 4,243288064,16,68096,262144,2304,23138304,1
.long 5,243288064,16,67840,262144,1024,56688640,1
.long 2,243288192,16,266624,524288,1536,25214976,0
.long 2,243288192,16,266752,524288,2048,25231360,0
.long 3,243288192,16,266496,524288,1024,58785792,0
.long 3,243288192,16,266624,524288,1536,58818560,0
.long 3,243288192,16,266752,524288,2048,58851328,0
.long 5,243288064,16,67840,262144,1280,56705024,1
.long 5,243288064,16,67968,262144,1536,56721408,1
.long 5,243288064,16,67968,262144,1792,56737792,1
.long 5,243288064,16,68096,262144,2048,56754176,1
.long 5,243288064,16,68096,262144,2304,56770560,1
.long 2,243288320,16,268672,1048576,1536,29409280,0
.long 2,243288320,16,268800,1048576,2048,29425664,0
.long 3,243288320,16,268544,1048576,1024,62980096,0
.long 3,243288320,16,268672,1048576,1536,63012864,0
.long 3,243288320,16,268800,1048576,2048,63045632,0
.long 1,243288064,16,1073744256,0,1536,4218880,0
.long 1,243288064,16,1073744384,0,2048,4227072,0
.long 1,243288064,16,1073744512,0,2560,4235264,0
.long 1,243288192,16,1073746304,524288,1536,6316032,0
.long 1,243288192,16,1073746432,524288,2048,6324224,0
.long 1,243288192,16,1073746560,524288,2560,6332416,0
.long 1,243288320,16,1073748352,1048576,1536,8413184,0
.long 1,243288320,16,1073748480,1048576,2048,8421376,0
.long 1,243288320,16,1073748608,1048576,2560,8429568,0
.long 2,243288448,16,270720,1572864,1536,33603584,0
.long 2,243288448,16,270848,1572864,2048,33619968,0
.long 3,243288448,16,270592,1572864,1024,67174400,0
.long 3,243288448,16,270720,1572864,1536,67207168,0
.long 3,243288448,16,270848,1572864,2048,67239936,0
.long 1,243288448,16,1073750400,1572864,1536,10510336,0
.long 1,243288448,16,1073750528,1572864,2048,10518528,0
.long 1,243288448,16,1073750656,1572864,2560,10526720,0
.long 2,243288576,16,272768,2097152,1536,37797888,0
.long 2,243288576,16,272896,2097152,2048,37814272,0
.long 3,243288576,16,272640,2097152,1024,71368704,0
.long 3,243288576,16,272768,2097152,1536,71401472,0
.long 3,243288576,16,272896,2097152,2048,71434240,0
.long 1,243288576,16,1073752448,2097152,1536,12607488,0
.long 1,243288576,16,1073752576,2097152,2048,12615680,0
.long 1,243288576,16,1073752704,2097152,2560,12623872,0
.long 2,243288704,16,274816,2621440,1536,41992192,0
.long 2,243288704,16,274944,2621440,2048,42008576,0
.long 3,243288704,16,274688,2621440,1024,75563008,0
.long 3,243288704,16,274816,2621440,1536,75595776,0
.long 3,243288704,16,274944,2621440,2048,75628544,0
.long 1,243288704,16,1073754496,2621440,1536,14704640,0
.long 1,243288704,16,1073754624,2621440,2048,14712832,0
.long 1,243288704,16,1073754752,2621440,2560,14721024,0
.long 2,243288832,16,276864,3145728,1536,46186496,0
.long 2,243288832,16,276992,3145728,2048,46202880,0
.long 3,243288832,16,276736,3145728,1024,79757312,0
.long 3,243288832,16,276864,3145728,1536,79790080,0
.long 3,243288832,16,276992,3145728,2048,79822848,0
.long 7,128,0,1920,121667584,2097152,171966464,9437312
.long 7,129,0,1920,121667584,2097408,171970560,9437312
.long 7,130,0,1920,121667584,2097664,171974656,9437312
.long 7,131,0,1920,121667584,2097920,171978752,9437312
.long 7,132,0,1920,121667584,2098176,171982848,9437312
.long 7,133,0,1920,121667584,2098432,171986944,9437312
.long 7,134,0,1920,121667584,2098688,171991040,9437312
.long 7,135,0,1920,121667584,2098944,171995136,9437312
.long 6,0,0,1920,0,3,1,0
.long 6,0,0,1920,0,3,7,786432
.long 6,0,0,1920,1,3,5,524288
.long 6,0,0,1920,2,3,3,262144
.long 8,0,0,1920,1,16,0,135528960
.long 8,0,0,1920,7,16,0,135528960
.long 8,0,0,1920,13,16,0,135528960
.long 9,128,0,1920,146800640,1024,151011328,5768704
.long 9,129,0,1920,146800640,1152,151013376,5768704
.long 9,130,0,1920,146800640,1280,151015424,5768704
.long 9,131,0,1920,146800640,1408,151017472,5768704
.long 9,132,0,1920,146800640,1536,151019520,5768704
.long 9,133,0,1920,146800640,1664,151021568,5768704
.long 9,134,0,1920,146800640,1792,151023616,6030848
.long 9,135,0,1920,146800640,1920,151025664,6030848
.long 10,64,0,1920,150994944,1024,184565760,61342464
.long 10,65,0,1920,150994944,1280,184569856,61342464
.long 10,66,0,1920,150994944,1536,184573952,61342464
.long 10,67,0,1920,150994944,1792,184578048,61342464
.long 11,0,0,1920,3,8,0,137102592
.long 3,243288832,16,277888,3145728,5632,80052224,0
.long 1,243288832,16,1073756288,3145728,512,16785408,0
.long 1,243288832,16,1073757056,3145728,3584,16834560,0
.long 1,243288832,16,1073757824,3145728,6656,16883712,0
.long 2,243288960,16,278912,3670016,1536,50380800,0
.long 2,243288960,16,279680,3670016,4608,50479104,0
.long 2,243288960,16,280448,3670016,7680,50577408,0
.long 3,243288960,16,279168,3670016,2560,84049920,0
.long 3,243288960,16,279936,3670016,5632,84246528,0
.long 1,243288960,16,1073758336,3670016,512,18882560,0
.long 1,243288960,16,1073759104,3670016,3584,18931712,0
.long 1,243288960,16,1073759872,3670016,6656,18980864,0
.long 4,243288064,16,68224,0,2560,21053440,0
.long 4,243288064,16,68224,0,2816,21057536,0
.long 4,243288064,16,68352,0,3072,21069824,0
.long 4,243288064,16,68352,0,3328,21073920,0
.long 4,243288064,16,68480,0,3584,21086208,0
.long 4,243288064,16,68480,0,3840,21090304,0
.long 5,243288064,16,68224,0,2560,54689792,0
.long 5,243288064,16,68224,0,2816,54706176,0
.long 5,243288064,16,68352,0,3072,54722560,0
.long 5,243288064,16,68352,0,3328,54738944,0
.long 4,243288064,16,68224,262144,2560,23150592,1
.long 4,243288064,16,68224,262144,2816,23154688,1
.long 4,243288064,16,68352,262144,3072,23166976,1
.long 4,243288064,16,68352,262144,3328,23171072,1
.long 4,243288064,16,68480,262144,3584,23183360,1
.long 2,243288192,16,266880,524288,2560,25247744,0
.long 2,243288192,16,267008,524288,3072,25264128,0
.long 2,243288192,16,267136,524288,3584,25280512,0
.long 3,243288192,16,266880,524288,2560,58884096,0
.long 3,243288192,16,267008,524288,3072,58916864,0
.long 4,243288064,16,68480,262144,3840,23187456,1
.long 5,243288064,16,68224,262144,2560,56786944,1
.long 5,243288064,16,68224,262144,2816,56803328,1
.long 5,243288064,16,68352,262144,3072,56819712,1
.long 5,243288064,16,68352,262144,3328,56836096,1
.long 2,243288320,16,268928,1048576,2560,29442048,0
.long 2,243288320,16,269056,1048576,3072,29458432,0
.long 2,243288320,16,269184,1048576,3584,29474816,0
.long 3,243288320,16,268928,1048576,2560,63078400,0
.long 3,243288320,16,269056,1048576,3072,63111168,0
.long 1,243288064,16,1073744640,0,3072,4243456,0
.long 1,243288064,16,1073744768,0,3584,4251648,0
.long 1,243288064,16,1073744896,0,4096,4259840,0
.long 1,243288192,16,1073746688,524288,3072,6340608,0
.long 1,243288192,16,1073746816,524288,3584,6348800,0
.long 1,243288192,16,1073746944,524288,4096,6356992,0
.long 1,243288320,16,1073748736,1048576,3072,8437760,0
.long 1,243288320,16,1073748864,1048576,3584,8445952,0
.long 1,243288320,16,1073748992,1048576,4096,8454144,0
.long 2,243288448,16,270976,1572864,2560,33636352,0
.long 2,243288448,16,271104,1572864,3072,33652736,0
.long 2,243288448,16,271232,1572864,3584,33669120,0
.long 3,243288448,16,270976,1572864,2560,67272704,0
.long 3,243288448,16,271104,1572864,3072,67305472,0
.long 1,243288448,16,1073750784,1572864,3072,10534912,0
.long 1,243288448,16,1073750912,1572864,3584,10543104,0
.long 1,243288448,16,1073751040,1572864,4096,10551296,0
.long 2,243288576,16,273024,2097152,2560,37830656,0
.long 2,243288576,16,273152,2097152,3072,37847040,0
.long 2,243288576,16,273280,2097152,3584,37863424,0
.long 3,243288576,16,273024,2097152,2560,71467008,0
.long 3,243288576,16,273152,2097152,3072,71499776,0
.long 1,243288576,16,1073752832,2097152,3072,12632064,0
.long 1,243288576,16,1073752960,2097152,3584,12640256,0
.long 1,243288576,16,1073753088,2097152,4096,12648448,0
.long 2,243288704,16,275072,2621440,2560,42024960,0
.long 2,243288704,16,275200,2621440,3072,42041344,0
.long 2,243288704,16,275328,2621440,3584,42057728,0
.long 3,243288704,16,275072,2621440,2560,75661312,0
.long 3,243288704,16,275200,2621440,3072,75694080,0
.long 1,243288704,16,1073754880,2621440,3072,14729216,0
.long 1,243288704,16,1073755008,2621440,3584,14737408,0
.long 1,243288704,16,1073755136,2621440,4096,14745600,0
.long 2,243288832,16,277120,3145728,2560,46219264,0
.long 2,243288832,16,277248,3145728,3072,46235648,0
.long 2,243288832,16,277376,3145728,3584,46252032,0
.long 3,243288832,16,277120,3145728,2560,79855616,0
.long 3,243288832,16,277248,3145728,3072,79888384,0
.long 7,64,0,1920,121700352,4194304,176160768,9437440
.long 7,65,0,1920,121700352,4194560,176164864,9437440
.long 7,66,0,1920,121700352,4194816,176168960,9437440
.long 7,67,0,1920,121700352,4195072,176173056,9437440
.long 6,0,0,1920,0,3,2,262144
.long 6,0,0,1920,1,3,0,0
.long 6,0,0,1920,1,3,6,786432
.long 6,0,0,1920,2,3,4,524288
.long 8,0,0,1920,2,16,0,135528960
.long 8,0,0,1920,8,16,0,135528960
.long 8,0,0,1920,14,16,0,135528960
.long 9,192,0,1920,146800640,2048,151027712,6030848
.long 9,193,0,1920,146800640,2176,151029760,6030848
.long 9,194,0,1920,146800640,2304,151031808,6030848
.long 9,195,0,1920,146800640,2432,151033856,6030848
.long 9,196,0,1920,146800640,2560,151035904,6030848
.long 9,197,0,1920,146800640,2688,151037952,6030848
.long 9,198,0,1920,146800640,2816,151040000,6030848
.long 9,199,0,1920,146800640,2944,151042048,6030848
.long 9,200,0,1920,146800640,3072,151044096,6030848
.long 9,201,0,1920,146800640,3200,151046144,6030848
.long 9,202,0,1920,146800640,3328,151048192,6030848
.long 9,203,0,1920,146800640,3456,151050240,6030848
.long 10,64,0,1920,151023616,1835008,188743680,61342592
.long 10,65,0,1920,151023616,1835264,188747776,61342592
.long 10,66,0,1920,151023616,1835520,188751872,61342592
.long 10,67,0,1920,151023616,1835776,188755968,61342592
.long 11,0,0,1920,4,8,0,137102592
.long 3,243288832,16,278016,3145728,6144,80084992,0
.long 1,243288832,16,1073756416,3145728,1024,16793600,0
.long 1,243288832,16,1073757184,3145728,4096,16842752,0
.long 1,243288832,16,1073757952,3145728,7168,16891904,0
.long 2,243288960,16,279040,3670016,2048,50397184,0
.long 2,243288960,16,279808,3670016,5120,50495488,0
.long 3,243288960,16,278528,3670016,0,83886080,0
.long 3,243288960,16,279296,3670016,3072,84082688,0
.long 3,243288960,16,280064,3670016,6144,84279296,0
.long 1,243288960,16,1073758464,3670016,1024,18890752,0
.long 1,243288960,16,1073759232,3670016,4096,18939904,0
.long 1,243288960,16,1073760000,3670016,7168,18989056,0
.long 4,243288064,16,68608,0,4096,21102592,0
.long 4,243288064,16,68608,0,4352,21106688,0
.long 4,243288064,16,68736,0,4608,21118976,0
.long 4,243288064,16,68736,0,4864,21123072,0
.long 5,243288064,16,68480,0,3584,54755328,0
.long 5,243288064,16,68480,0,3840,54771712,0
.long 5,243288064,16,68608,0,4096,54788096,0
.long 5,243288064,16,68608,0,4352,54804480,0
.long 5,243288064,16,68736,0,4608,54820864,0
.long 5,243288064,16,68736,0,4864,54837248,0
.long 4,243288064,16,68608,262144,4096,23199744,1
.long 4,243288064,16,68608,262144,4352,23203840,1
.long 4,243288064,16,68736,262144,4608,23216128,1
.long 4,243288064,16,68736,262144,4864,23220224,1
.long 5,243288064,16,68480,262144,3584,56852480,1
.long 2,243288192,16,267264,524288,4096,25296896,0
.long 2,243288192,16,267392,524288,4608,25313280,0
.long 3,243288192,16,267136,524288,3584,58949632,0
.long 3,243288192,16,267264,524288,4096,58982400,0
.long 3,243288192,16,267392,524288,4608,59015168,0
.long 5,243288064,16,68480,262144,3840,56868864,1
.long 5,243288064,16,68608,262144,4096,56885248,1
.long 5,243288064,16,68608,262144,4352,56901632,1
.long 5,243288064,16,68736,262144,4608,56918016,1
.long 5,243288064,16,68736,262144,4864,56934400,1
.long 2,243288320,16,269312,1048576,4096,29491200,0
.long 2,243288320,16,269440,1048576,4608,29507584,0
.long 3,243288320,16,269184,1048576,3584,63143936,0
.long 3,243288320,16,269312,1048576,4096,63176704,0
.long 3,243288320,16,269440,1048576,4608,63209472,0
.long 1,243288064,16,1073745024,0,4608,4268032,0
.long 1,243288064,16,1073745152,0,5120,4276224,0
.long 1,243288064,16,1073745280,0,5632,4284416,0
.long 1,243288192,16,1073747072,524288,4608,6365184,0
.long 1,243288192,16,1073747200,524288,5120,6373376,0
.long 1,243288192,16,1073747328,524288,5632,6381568,0
.long 1,243288320,16,1073749120,1048576,4608,8462336,0
.long 1,243288320,16,1073749248,1048576,5120,8470528,0
.long 1,243288320,16,1073749376,1048576,5632,8478720,0
.long 2,243288448,16,271360,1572864,4096,33685504,0
.long 2,243288448,16,271488,1572864,4608,33701888,0
.long 3,243288448,16,271232,1572864,3584,67338240,0
.long 3,243288448,16,271360,1572864,4096,67371008,0
.long 3,243288448,16,271488,1572864,4608,67403776,0
.long 1,243288448,16,1073751168,1572864,4608,10559488,0
.long 1,243288448,16,1073751296,1572864,5120,10567680,0
.long 1,243288448,16,1073751424,1572864,5632,10575872,0
.long 2,243288576,16,273408,2097152,4096,37879808,0
.long 2,243288576,16,273536,2097152,4608,37896192,0
.long 3,243288576,16,273280,2097152,3584,71532544,0
.long 3,243288576,16,273408,2097152,4096,71565312,0
.long 3,243288576,16,273536,2097152,4608,71598080,0
.long 1,243288576,16,1073753216,2097152,4608,12656640,0
.long 1,243288576,16,1073753344,2097152,5120,12664832,0
.long 1,243288576,16,1073753472,2097152,5632,12673024,0
.long 2,243288704,16,275456,2621440,4096,42074112,0
.long 2,243288704,16,275584,2621440,4608,42090496,0
.long 3,243288704,16,275328,2621440,3584,75726848,0
.long 3,243288704,16,275456,2621440,4096,75759616,0
.long 3,243288704,16,275584,2621440,4608,75792384,0
.long 1,243288704,16,1073755264,2621440,4608,14753792,0
.long 1,243288704,16,1073755392,2621440,5120,14761984,0
.long 1,243288704,16,1073755520,2621440,5632,14770176,0
.long 2,243288832,16,277504,3145728,4096,46268416,0
.long 2,243288832,16,277632,3145728,4608,46284800,0
.long 3,243288832,16,277376,3145728,3584,79921152,0
.long 3,243288832,16,277504,3145728,4096,79953920,0
.long 3,243288832,16,277632,3145728,4608,79986688,0
.long 7,64,0,1920,121700352,4195328,176177152,9437440
.long 7,65,0,1920,121700352,4195584,176181248,9437440
.long 7,66,0,1920,121700352,4195840,176185344,9437440
.long 7,67,0,1920,121700352,4196096,176189440,9437440
.long 6,0,0,1920,0,3,3,262144
.long 6,0,0,1920,1,3,1,0
.long 6,0,0,1920,1,3,7,786432
.long 6,0,0,1920,2,3,5,524288
.long 8,0,0,1920,3,16,0,135528960
.long 8,0,0,1920,9,16,0,135528960
.long 8,0,0,1920,15,16,0,135528960
.long 9,192,0,1920,146800640,3584,151052288,6292992
.long 9,193,0,1920,146800640,3712,151054336,6292992
.long 9,194,0,1920,146800640,3840,151056384,6292992
.long 9,195,0,1920,146800640,3968,151058432,6292992
.long 9,196,0,1920,146800640,4096,151060480,6292992
.long 9,197,0,1920,146800640,4224,151062528,6292992
.long 9,198,0,1920,146800640,4352,151064576,6292992
.long 9,199,0,1920,146800640,4480,151066624,6292992
.long 9,200,0,1920,146800640,4608,151068672,6292992
.long 9,201,0,1920,146800640,4736,151070720,6292992
.long 9,202,0,1920,146800640,4864,151072768,6292992
.long 9,203,0,1920,146800640,4992,151074816,6292992
.long 10,64,0,1920,151023616,1836032,188760064,61342592
.long 10,65,0,1920,151023616,1836288,188764160,61342592
.long 10,66,0,1920,151023616,1836544,188768256,61342592
.long 10,67,0,1920,151023616,1836800,188772352,61342592
.long 11,0,0,1920,5,8,0,137102592
.long 3,243288832,16,278144,3145728,6656,80117760,0
.long 1,243288832,16,1073756544,3145728,1536,16801792,0
.long 1,243288832,16,1073757312,3145728,4608,16850944,0
.long 1,243288832,16,1073758080,3145728,7680,16900096,0
.long 2,243288960,16,279168,3670016,2560,50413568,0
.long 2,243288960,16,279936,3670016,5632,50511872,0
.long 3,243288960,16,278656,3670016,512,83918848,0
.long 3,243288960,16,279424,3670016,3584,84115456,0
.long 3,243288960,16,280192,3670016,6656,84312064,0
.long 1,243288960,16,1073758592,3670016,1536,18898944,0
.long 1,243288960,16,1073759360,3670016,4608,18948096,0
.long 1,243288960,16,1073760128,3670016,7680,18997248,0
.long 4,243288064,16,68864,0,5120,21135360,0
.long 4,243288064,16,68864,0,5376,21139456,0
.long 4,243288064,16,68992,0,5632,21151744,0
.long 4,243288064,16,68992,0,5888,21155840,0
.long 4,243288064,16,69120,0,6144,21168128,0
.long 4,243288064,16,69120,0,6400,21172224,0
.long 5,243288064,16,68864,0,5120,54853632,0
.long 5,243288064,16,68864,0,5376,54870016,0
.long 5,243288064,16,68992,0,5632,54886400,0
.long 5,243288064,16,68992,0,5888,54902784,0
.long 5,243288064,16,69120,0,6144,54919168,0
.long 5,243288064,16,69120,0,6400,54935552,0
.long 4,243288064,16,68864,262144,5120,23232512,1
.long 4,243288064,16,68864,262144,5376,23236608,1
.long 4,243288064,16,68992,262144,5632,23248896,1
.long 4,243288064,16,68992,262144,5888,23252992,1
.long 4,243288064,16,69120,262144,6144,23265280,1
.long 2,243288192,16,267520,524288,5120,25329664,0
.long 2,243288192,16,267648,524288,5632,25346048,0
.long 2,243288192,16,267776,524288,6144,25362432,0
.long 3,243288192,16,267520,524288,5120,59047936,0
.long 3,243288192,16,267648,524288,5632,59080704,0
.long 3,243288192,16,267776,524288,6144,59113472,0
.long 4,243288064,16,69120,262144,6400,23269376,1
.long 5,243288064,16,68864,262144,5120,56950784,1
.long 5,243288064,16,68864,262144,5376,56967168,1
.long 5,243288064,16,68992,262144,5632,56983552,1
.long 5,243288064,16,68992,262144,5888,56999936,1
.long 5,243288064,16,69120,262144,6144,57016320,1
.long 5,243288064,16,69120,262144,6400,57032704,1
.long 2,243288320,16,269568,1048576,5120,29523968,0
.long 2,243288320,16,269696,1048576,5632,29540352,0
.long 2,243288320,16,269824,1048576,6144,29556736,0
.long 3,243288320,16,269568,1048576,5120,63242240,0
.long 3,243288320,16,269696,1048576,5632,63275008,0
.long 3,243288320,16,269824,1048576,6144,63307776,0
.long 1,243288064,16,1073745408,0,6144,4292608,0
.long 1,243288064,16,1073745536,0,6656,4300800,0
.long 1,243288192,16,1073747456,524288,6144,6389760,0
.long 1,243288192,16,1073747584,524288,6656,6397952,0
.long 1,243288320,16,1073749504,1048576,6144,8486912,0
.long 1,243288320,16,1073749632,1048576,6656,8495104,0
.long 2,243288448,16,271616,1572864,5120,33718272,0
.long 2,243288448,16,271744,1572864,5632,33734656,0
.long 2,243288448,16,271872,1572864,6144,33751040,0
.long 3,243288448,16,271616,1572864,5120,67436544,0
.long 3,243288448,16,271744,1572864,5632,67469312,0
.long 3,243288448,16,271872,1572864,6144,67502080,0
.long 1,243288448,16,1073751552,1572864,6144,10584064,0
.long 1,243288448,16,1073751680,1572864,6656,10592256,0
.long 2,243288576,16,273664,2097152,5120,37912576,0
.long 2,243288576,16,273792,2097152,5632,37928960,0
.long 2,243288576,16,273920,2097152,6144,37945344,0
.long 3,243288576,16,273664,2097152,5120,71630848,0
.long 3,243288576,16,273792,2097152,5632,71663616,0
.long 3,243288576,16,273920,2097152,6144,71696384,0
.long 1,243288576,16,1073753600,2097152,6144,12681216,0
.long 1,243288576,16,1073753728,2097152,6656,12689408,0
.long 2,243288704,16,275712,2621440,5120,42106880,0
.long 2,243288704,16,275840,2621440,5632,42123264,0
.long 2,243288704,16,275968,2621440,6144,42139648,0
.long 3,243288704,16,275712,2621440,5120,75825152,0
.long 3,243288704,16,275840,2621440,5632,75857920,0
.long 3,243288704,16,275968,2621440,6144,75890688,0
.long 1,243288704,16,1073755648,2621440,6144,14778368,0
.long 1,243288704,16,1073755776,2621440,6656,14786560,0
.long 2,243288832,16,277760,3145728,5120,46301184,0
.long 2,243288832,16,277888,3145728,5632,46317568,0
.long 2,243288832,16,278016,3145728,6144,46333952,0
.long 7,64,0,1920,121733120,6291456,180355072,9437568
.long 7,65,0,1920,121733120,6291712,180359168,9437568
.long 7,66,0,1920,121733120,6291968,180363264,9437568
.long 7,67,0,1920,121733120,6292224,180367360,9437568
.long 6,0,0,1920,0,3,4,524288
.long 6,0,0,1920,1,3,2,262144
.long 6,0,0,1920,2,3,0,0
.long 6,0,0,1920,2,3,6,786432
.long 8,0,0,1920,4,16,0,135528960
.long 8,0,0,1920,10,16,0,135528960
.long 9,128,0,1920,146800640,5120,151076864,6292992
.long 9,129,0,1920,146800640,5248,151078912,6292992
.long 9,130,0,1920,146800640,5376,151080960,6555136
.long 9,131,0,1920,146800640,5504,151083008,6555136
.long 9,132,0,1920,146800640,5632,151085056,6555136
.long 9,133,0,1920,146800640,5760,151087104,6555136
.long 9,134,0,1920,146800640,5888,151089152,6555136
.long 9,135,0,1920,146800640,6016,151091200,6555136
.long 10,128,0,1920,151052288,3670016,192937984,61342720
.long 10,129,0,1920,151052288,3670272,192942080,61342720
.long 10,130,0,1920,151052288,3670528,192946176,61342720
.long 10,131,0,1920,151052288,3670784,192950272,61342720
.long 10,132,0,1920,151052288,3671040,192954368,61342720
.long 10,133,0,1920,151052288,3671296,192958464,61342720
.long 10,134,0,1920,151052288,3671552,192962560,61342720
.long 10,135,0,1920,151052288,3671808,192966656,61342720
.long 11,0,0,1920,0,8,0,137102592
.long 11,0,0,1920,6,8,0,137102592
.long 3,243288832,16,278272,3145728,7168,80150528,0
.long 1,243288832,16,1073756672,3145728,2048,16809984,0
.long 1,243288832,16,1073757440,3145728,5120,16859136,0
.long 2,243288960,16,278528,3670016,0,50331648,0
.long 2,243288960,16,279296,3670016,3072,50429952,0
.long 2,243288960,16,280064,3670016,6144,50528256,0
.long 3,243288960,16,278784,3670016,1024,83951616,0
.long 3,243288960,16,279552,3670016,4096,84148224,0
.long 3,243288960,16,280320,3670016,7168,84344832,0
.long 1,243288960,16,1073758720,3670016,2048,18907136,0
.long 1,243288960,16,1073759488,3670016,5120,18956288,0
.long 4,243288064,16,69248,0,6656,21184512,0
.long 4,243288064,16,69248,0,6912,21188608,0
.long 4,243288064,16,69376,0,7168,21200896,0
.long 4,243288064,16,69376,0,7424,21204992,0
.long 4,243288064,16,69504,0,7680,21217280,0
.long 4,243288064,16,69504,0,7936,21221376,0
.long 5,243288064,16,69248,0,6656,54951936,0
.long 5,243288064,16,69248,0,6912,54968320,0
.long 5,243288064,16,69376,0,7168,54984704,0
.long 5,243288064,16,69376,0,7424,55001088,0
.long 5,243288064,16,69504,0,7680,55017472,0
.long 5,243288064,16,69504,0,7936,55033856,0
.long 4,243288064,16,69248,262144,6656,23281664,1
.long 4,243288064,16,69248,262144,6912,23285760,1
.long 4,243288064,16,69376,262144,7168,23298048,1
.long 4,243288064,16,69376,262144,7424,23302144,1
.long 4,243288064,16,69504,262144,7680,23314432,1
.long 2,243288192,16,267904,524288,6656,25378816,0
.long 2,243288192,16,268032,524288,7168,25395200,0
.long 2,243288192,16,268160,524288,7680,25411584,0
.long 3,243288192,16,267904,524288,6656,59146240,0
.long 3,243288192,16,268032,524288,7168,59179008,0
.long 3,243288192,16,268160,524288,7680,59211776,0
.long 4,243288064,16,69504,262144,7936,23318528,1
.long 5,243288064,16,69248,262144,6656,57049088,1
.long 5,243288064,16,69248,262144,6912,57065472,1
.long 5,243288064,16,69376,262144,7168,57081856,1
.long 5,243288064,16,69376,262144,7424,57098240,1
.long 5,243288064,16,69504,262144,7680,57114624,1
.long 5,243288064,16,69504,262144,7936,57131008,1
.long 2,243288320,16,269952,1048576,6656,29573120,0
.long 2,243288320,16,270080,1048576,7168,29589504,0
.long 2,243288320,16,270208,1048576,7680,29605888,0
.long 3,243288320,16,269952,1048576,6656,63340544,0
.long 3,243288320,16,270080,1048576,7168,63373312,0
.long 3,243288320,16,270208,1048576,7680,63406080,0
.long 1,243288064,16,1073745664,0,7168,4308992,0
.long 1,243288064,16,1073745792,0,7680,4317184,0
.long 1,243288192,16,1073747712,524288,7168,6406144,0
.long 1,243288192,16,1073747840,524288,7680,6414336,0
.long 1,243288320,16,1073749760,1048576,7168,8503296,0
.long 1,243288320,16,1073749888,1048576,7680,8511488,0
.long 2,243288448,16,272000,1572864,6656,33767424,0
.long 2,243288448,16,272128,1572864,7168,33783808,0
.long 2,243288448,16,272256,1572864,7680,33800192,0
.long 3,243288448,16,272000,1572864,6656,67534848,0
.long 3,243288448,16,272128,1572864,7168,67567616,0
.long 3,243288448,16,272256,1572864,7680,67600384,0
.long 1,243288448,16,1073751808,1572864,7168,10600448,0
.long 1,243288448,16,1073751936,1572864,7680,10608640,0
.long 2,243288576,16,274048,2097152,6656,37961728,0
.long 2,243288576,16,274176,2097152,7168,37978112,0
.long 2,243288576,16,274304,2097152,7680,37994496,0
.long 3,243288576,16,274048,2097152,6656,71729152,0
.long 3,243288576,16,274176,2097152,7168,71761920,0
.long 3,243288576,16,274304,2097152,7680,71794688,0
.long 1,243288576,16,1073753856,2097152,7168,12697600,0
.long 1,243288576,16,1073753984,2097152,7680,12705792,0
.long 2,243288704,16,276096,2621440,6656,42156032,0
.long 2,243288704,16,276224,2621440,7168,42172416,0
.long 2,243288704,16,276352,2621440,7680,42188800,0
.long 3,243288704,16,276096,2621440,6656,75923456,0
.long 3,243288704,16,276224,2621440,7168,75956224,0
.long 3,243288704,16,276352,2621440,7680,75988992,0
.long 1,243288704,16,1073755904,2621440,7168,14794752,0
.long 1,243288704,16,1073756032,2621440,7680,14802944,0
.long 2,243288832,16,278144,3145728,6656,46350336,0
.long 2,243288832,16,278272,3145728,7168,46366720,0
.long 2,243288832,16,278400,3145728,7680,46383104,0
.long 7,64,0,1920,121733120,6292480,180371456,9437568
.long 7,65,0,1920,121733120,6292736,180375552,9437568
.long 7,66,0,1920,121733120,6292992,180379648,9437568
.long 7,67,0,1920,121733120,6293248,180383744,9437568
.long 6,0,0,1920,0,3,5,524288
.long 6,0,0,1920,1,3,3,262144
.long 6,0,0,1920,2,3,1,0
.long 6,0,0,1920,2,3,7,786432
.long 8,0,0,1920,5,16,0,135528960
.long 8,0,0,1920,11,16,0,135528960
.long 9,128,0,1920,146800640,6144,151093248,6555136
.long 9,129,0,1920,146800640,6272,151095296,6555136
.long 9,130,0,1920,146800640,6400,151097344,6555136
.long 9,131,0,1920,146800640,6528,151099392,6555136
.long 9,132,0,1920,146800640,6656,151101440,6555136
.long 9,133,0,1920,146800640,6784,151103488,6555136
.long 9,134,0,1920,146800640,6912,151105536,6555136
.long 9,135,0,1920,146800640,7040,151107584,6555136
.long 10,128,0,1920,151080960,5505024,197132288,61342848
.long 10,129,0,1920,151080960,5505280,197136384,61342848
.long 10,130,0,1920,151080960,5505536,197140480,61342848
.long 10,131,0,1920,151080960,5505792,197144576,61342848
.long 10,132,0,1920,151080960,5506048,197148672,61342848
.long 10,133,0,1920,151080960,5506304,197152768,61342848
.long 10,134,0,1920,151080960,5506560,197156864,61342848
.long 10,135,0,1920,151080960,5506816,197160960,61342848
.long 11,0,0,1920,1,8,0,137102592
.long 11,0,0,1920,7,8,0,137102592
.long 3,243288832,16,278400,3145728,7680,80183296,0
.long 1,243288832,16,1073756800,3145728,2560,16818176,0
.long 1,243288832,16,1073757568,3145728,5632,16867328,0
.long 2,243288960,16,278656,3670016,512,50348032,0
.long 2,243288960,16,279424,3670016,3584,50446336,0
.long 2,243288960,16,280192,3670016,6656,50544640,0
.long 3,243288960,16,278912,3670016,1536,83984384,0
.long 3,243288960,16,279680,3670016,4608,84180992,0
.long 3,243288960,16,280448,3670016,7680,84377600,0
.long 1,243288960,16,1073758848,3670016,2560,18915328,0
.long 1,243288960,16,1073759616,3670016,5632,18964480,0
```
